```python
import torch

def _softmax(x, axis=-1):
    return torch.softmax(x, dim=axis)
def _gelu(x):
    return torch.nn.functional.gelu(x, approximate="tanh")
def _silu(x):
    return torch.nn.functional.silu(x)
def _sigmoid(x):
    return torch.sigmoid(x)
def _layernorm(x, axis=-1, eps=1e-5):
    m = x.mean(dim=axis, keepdim=True)
    v = x.var(dim=axis, keepdim=True, unbiased=False)
    return (x - m) / torch.sqrt(v + eps)
def _scatter_add(tgt, idx, src, axis=0):
    return tgt.clone().index_add_(axis, idx, src)
def _segment_sum(src, seg, n):
    out = torch.zeros((n,) + src.shape[1:], dtype=src.dtype)
    return out.index_add_(0, seg, src)
def _pad(x, pw):
    flat = tuple(v for pair in reversed(pw) for v in pair)
    return torch.nn.functional.pad(x, flat)

kernel_name = 'concat_heads__mha_block_cached__gqa_block_cached__near_ridge'

def setup_inputs():

    _w = (lambda a: (lambda t: t.to(torch.bfloat16) if t.is_floating_point() else t)(torch.as_tensor(a)))
    def _A_setup():
        B, Sq, D = 8, 240, 512
        H, Sk, Dh = 32, 512, 128
        return {
            "x": _w((lambda *s: torch.randn(*s, dtype=torch.bfloat16) * 0.8)(B, Sq, D)),
            "k_cache": _w((lambda *s: torch.randn(*s, dtype=torch.bfloat16) * 0.8)(B, H, Sk, Dh)),
            "v_cache": _w((lambda *s: torch.randn(*s, dtype=torch.bfloat16) * 0.05)(B, H, Sk, Dh)),
            "wq": _w((lambda *s: torch.randn(*s, dtype=torch.bfloat16) * 0.8)(D, H * Dh) * (D ** -0.5)),
            "wo": _w((lambda *s: torch.randn(*s, dtype=torch.bfloat16) * 0.05)(H * Dh, D) * ((H * Dh) ** -0.5)),
        }
    _A_in = _A_setup()

    def _B_setup():
        B, Sq, D = 8, 240, 512
        Hq, Hkv, Sk, Dh = 32, 32, 512, 128
        assert Hq % Hkv == 0, (Hq, Hkv)
        return {
            "x": _w((lambda *s: torch.randn(*s, dtype=torch.bfloat16) * 0.8)(B, Sq, D)),
            "k_cache": _w((lambda *s: torch.randn(*s, dtype=torch.bfloat16) * 0.8)(B, Hkv, Sk, Dh)),
            "v_cache": _w((lambda *s: torch.randn(*s, dtype=torch.bfloat16) * 0.05)(B, Hkv, Sk, Dh)),
            "wq": _w((lambda *s: torch.randn(*s, dtype=torch.bfloat16) * 0.8)(D, Hq * Dh) * (D ** -0.5)),
            "wo": _w((lambda *s: torch.randn(*s, dtype=torch.bfloat16) * 0.05)(Hq * Dh, D) * ((Hq * Dh) ** -0.5)),
        }
    _B_in = _B_setup()

    return {
        "A_x": _A_in["x"],
        "A_k_cache": _A_in["k_cache"],
        "A_v_cache": _A_in["v_cache"],
        "A_wq": _A_in["wq"],
        "A_wo": _A_in["wo"],
        "B_x": _B_in["x"],
        "B_k_cache": _B_in["k_cache"],
        "B_v_cache": _B_in["v_cache"],
        "B_wq": _B_in["wq"],
        "B_wo": _B_in["wo"],
    }

def reference(A_x, A_k_cache, A_v_cache, A_wq, A_wo, B_x, B_k_cache, B_v_cache, B_wq, B_wo):
    def _A_ref(x, k_cache, v_cache, wq, wo):
        B, Sq, D = x.shape
        H, Dh = 32, 128
        q = (lambda x, *d: x.permute(*d))((x @ wq).reshape(B, Sq, H, Dh), 0, 2, 1, 3)
        scores = torch.einsum("bhqd,bhkd->bhqk", q, k_cache) * (Dh ** -0.5)
        p = _softmax(scores, axis=-1)
        o = torch.einsum("bhqk,bhkd->bhqd", p, v_cache)
        return (lambda x, *d: x.permute(*d))(o, 0, 2, 1, 3).reshape(B, Sq, H * Dh) @ wo

    def _B_ref(x, k_cache, v_cache, wq, wo):
        B, Sq, D = x.shape
        Hq, Dh = 32, 128
        Hkv = k_cache.shape[1]
        rep = Hq // Hkv
        q = (lambda x, *d: x.permute(*d))((x @ wq).reshape(B, Sq, Hq, Dh), 0, 2, 1, 3)
        k = (lambda x, n, axis: torch.repeat_interleave(x, n, dim=axis))(k_cache, rep, axis=1)
        v = (lambda x, n, axis: torch.repeat_interleave(x, n, dim=axis))(v_cache, rep, axis=1)
        scores = torch.einsum("bhqd,bhkd->bhqk", q, k) * (Dh ** -0.5)
        p = _softmax(scores, axis=-1)
        o = torch.einsum("bhqk,bhkd->bhqd", p, v)
        return (lambda x, *d: x.permute(*d))(o, 0, 2, 1, 3).reshape(B, Sq, Hq * Dh) @ wo

    a = _A_ref(A_x, A_k_cache, A_v_cache, A_wq, A_wo)
    b = _B_ref(B_x, B_k_cache, B_v_cache, B_wq, B_wo)
    return torch.concatenate([a, b], axis=-1)
```

```asm
; @launch kernel=attn1_kernel grid=(256,1,1) block=(512,1,1) lds=163840
; @launch kernel=oproj_kernel grid=(256,1,1) block=(512,1,1) lds=163840
.amdgcn_target "amdgcn-amd-amdhsa--gfx950"
.text
.globl attn1_kernel
.p2align 8
.type attn1_kernel,@function
attn1_kernel:
    s_cmp_ge_u32 s2, 256
    s_cbranch_scc1 L_end
    s_and_b32 s34, s2, 7
    s_lshr_b32 s35, s2, 3
    s_and_b32 s36, s34, 1
    s_load_dwordx16 s[64:79], s[0:1], 0
    s_load_dwordx8 s[80:87], s[0:1], 64
    s_load_dwordx2 s[88:89], s[0:1], 96
    s_lshr_b32 s37, s34, 1
    s_and_b32 s37, s37, 1
    s_lshl_b32 s37, s37, 2
    s_and_b32 s38, s35, 3
    s_add_u32 s37, s37, s38
    s_lshr_b32 s38, s34, 2
    s_lshl_b32 s38, s38, 4
    s_lshr_b32 s39, s35, 2
    s_add_u32 s38, s38, s39
    s_waitcnt lgkmcnt(0)
    s_cmp_eq_u32 s36, 0
    s_cselect_b32 s4, s64, s74
    s_cselect_b32 s5, s65, s75
    s_mov_b32 s6, 1966080
    s_mov_b32 s7, 0x00020000
    s_cselect_b32 s12, s66, s76
    s_cselect_b32 s13, s67, s77
    s_mov_b32 s14, 33554432
    s_mov_b32 s15, 0x00020000
    s_cselect_b32 s16, s68, s78
    s_cselect_b32 s17, s69, s79
    s_mov_b32 s18, 33554432
    s_mov_b32 s19, 0x00020000
    s_cselect_b32 s8, s70, s80
    s_cselect_b32 s9, s71, s81
    s_mov_b32 s10, 4194304
    s_mov_b32 s11, 0x00020000
    s_cselect_b32 s56, s72, s82
    s_cselect_b32 s57, s73, s83
    s_mov_b32 s58, 4194304
    s_mov_b32 s59, 0x00020000
    s_lshr_b32 s50, s34, 1
    s_lshl_b32 s50, s50, 5
    s_add_u32 s50, s50, s35
    s_lshl_b32 s50, s50, 15
    s_mov_b32 s20, s88
    s_mov_b32 s21, s89
    s_mov_b32 s22, 41943040
    s_mov_b32 s23, 0x00020000
    s_lshl_b32 s39, s37, 5
    s_add_u32 s39, s39, s38
    s_lshl_b32 s26, s39, 17
    s_lshl_b32 s27, s38, 8
    s_add_u32 s28, s26, 1048576
    s_add_u32 s29, s27, 2048
    s_mul_i32 s43, s36, 15728640
    s_lshl_b32 s39, s38, 13
    s_add_u32 s43, s43, s39
    s_add_u32 s44, s43, 4096
    s_add_u32 s45, s43, 65536
    s_add_u32 s46, s43, 69632
    s_mov_b32 s40, 0x3e0293ee
    s_mov_b32 s41, 0x3e0293ee
    s_mov_b32 s52, 0
    s_mov_b32 s53, 8192
    s_mov_b32 s54, 16384
    s_mov_b32 s55, 24576
    v_lshrrev_b32 v1, 6, v0
    s_nop 0
    v_readfirstlane_b32 s34, v1
    s_lshl_b32 s42, s34, 10
    s_lshl_b32 s62, s34, 6
    s_lshr_b32 s47, s34, 2
    v_and_b32 v9, 63, v0
    v_lshrrev_b32 v12, 5, v9
    s_mul_i32 s35, s37, 240
    s_lshl_b32 s36, s34, 5
    s_add_u32 s35, s35, s36
    v_lshrrev_b32 v18, 4, v9
    s_lshl_b32 s39, s34, 2
    v_add_u32 v16, s39, v18
    v_and_b32 v17, 15, v9
    v_lshlrev_b32 v19, 2, v18
    v_xor_b32 v19, v17, v19
    v_lshlrev_b32 v19, 4, v19
    v_lshl_add_u32 v6, v16, 13, v19
    v_lshl_add_u32 v7, v16, 8, v19
    v_and_b32 v19, 15, v16
    v_xor_b32 v19, v17, v19
    v_lshlrev_b32 v19, 4, v19
    v_lshl_add_u32 v8, v16, 8, v19
    v_lshrrev_b32 v16, 3, v9
    v_add_u32 v17, s35, v16
    v_lshlrev_b32 v2, 10, v17
    v_and_b32 v17, 7, v9
    v_lshl_add_u32 v2, v17, 4, v2
    v_lshrrev_b32 v18, 4, v9
    v_lshlrev_b32 v18, 4, v18
    v_xor_b32 v3, v2, v18
    v_xor_b32 v4, 64, v3
    s_lshl_b32 s48, s42, 2
    s_add_u32 s48, s48, 131072
    s_add_u32 m0, s48, 0
    s_add_u32 s34, s52, 0
    buffer_load_dwordx4 v3, s[4:7], s34 offen lds
    s_add_u32 m0, s48, 1024
    s_add_u32 s34, s53, 0
    buffer_load_dwordx4 v4, s[4:7], s34 offen lds
    s_add_u32 m0, s48, 2048
    s_add_u32 s34, s54, 0
    buffer_load_dwordx4 v3, s[4:7], s34 offen lds
    s_add_u32 m0, s48, 3072
    s_add_u32 s34, s55, 0
    buffer_load_dwordx4 v4, s[4:7], s34 offen lds
    s_add_u32 m0, s42, 0
    s_add_u32 s34, s27, 0
    buffer_load_dwordx4 v6, s[8:11], s34 offen lds
    s_add_u32 m0, s42, 8192
    s_add_u32 s34, s27, 262144
    buffer_load_dwordx4 v6, s[8:11], s34 offen lds
    s_add_u32 m0, s42, 16384
    s_add_u32 s34, s29, 0
    buffer_load_dwordx4 v6, s[8:11], s34 offen lds
    s_add_u32 m0, s42, 24576
    s_add_u32 s34, s29, 262144
    buffer_load_dwordx4 v6, s[8:11], s34 offen lds
    s_add_u32 m0, s42, 32768
    s_add_u32 s34, s27, 524288
    buffer_load_dwordx4 v6, s[8:11], s34 offen lds
    s_add_u32 m0, s42, 40960
    s_add_u32 s34, s27, 786432
    buffer_load_dwordx4 v6, s[8:11], s34 offen lds
    s_add_u32 m0, s42, 49152
    s_add_u32 s34, s29, 524288
    buffer_load_dwordx4 v6, s[8:11], s34 offen lds
    s_add_u32 m0, s42, 57344
    s_add_u32 s34, s29, 786432
    buffer_load_dwordx4 v6, s[8:11], s34 offen lds
    v_lshrrev_b32 v18, 4, v9
    v_xor_b32 v18, v17, v18
    v_lshlrev_b32 v18, 4, v18
    v_lshl_add_u32 v18, v16, 7, v18
    s_lshl_b32 s39, s42, 2
    s_add_u32 s39, s39, 131072
    v_and_b32 v16, 31, v9
    v_bfe_u32 v17, v9, 1, 3
    v_xor_b32 v17, v17, v12
    v_xor_b32 v18, 0, v17
    v_lshlrev_b32 v18, 4, v18
    v_lshl_add_u32 v18, v16, 7, v18
    v_add_u32 v60, s39, v18
    v_xor_b32 v18, 2, v17
    v_lshlrev_b32 v18, 4, v18
    v_lshl_add_u32 v18, v16, 7, v18
    v_add_u32 v61, s39, v18
    v_xor_b32 v18, 4, v17
    v_lshlrev_b32 v18, 4, v18
    v_lshl_add_u32 v18, v16, 7, v18
    v_add_u32 v62, s39, v18
    v_xor_b32 v18, 6, v17
    v_lshlrev_b32 v18, 4, v18
    v_lshl_add_u32 v18, v16, 7, v18
    v_add_u32 v63, s39, v18
    v_and_b32 v19, 31, v9
    v_add_u32 v16, s35, v19
    v_lshrrev_b32 v17, 5, v16
    v_lshlrev_b32 v17, 18, v17
    v_and_b32 v18, 31, v16
    v_lshlrev_b32 v18, 4, v18
    v_lshl_add_u32 v18, v12, 9, v18
    v_add_u32 v5, v17, v18
    v_add_u32 v19, s36, v19
    v_mov_b32 v16, 0x7f000000
    v_cmp_gt_u32 vcc, 240, v19
    s_nop 1
    v_cndmask_b32 v5, v16, v5, vcc
    v_bfe_u32 v16, v9, 2, 2
    v_and_b32 v17, 3, v9
    v_lshl_add_u32 v18, v12, 3, v16
    v_lshlrev_b32 v18, 8, v18
    v_bfe_u32 v19, v9, 4, 1
    v_lshl_add_u32 v18, v19, 5, v18
    v_and_b32 v19, 1, v17
    v_lshl_add_u32 v18, v19, 4, v18
    v_lshrrev_b32 v19, 1, v17
    v_lshl_add_u32 v18, v19, 3, v18
    v_xor_b32 v19, 0, v16
    v_lshl_add_u32 v20, v19, 6, v18
    v_xor_b32 v19, 1, v16
    v_lshl_add_u32 v21, v19, 6, v18
    v_xor_b32 v19, 2, v16
    v_lshl_add_u32 v22, v19, 6, v18
    v_xor_b32 v19, 3, v16
    v_lshl_add_u32 v23, v19, 6, v18
    v_and_b32 v16, 0x13, v9
    v_bfe_u32 v17, v9, 2, 1
    v_lshl_add_u32 v16, v17, 3, v16
    v_bfe_u32 v17, v9, 3, 1
    v_lshl_add_u32 v16, v17, 2, v16
    v_and_b32 v17, 15, v16
    v_xor_b32 v17, v17, v12
    v_xor_b32 v18, 0, v17
    v_lshlrev_b32 v18, 4, v18
    v_lshl_add_u32 v24, v16, 8, v18
    v_xor_b32 v18, 2, v17
    v_lshlrev_b32 v18, 4, v18
    v_lshl_add_u32 v25, v16, 8, v18
    v_xor_b32 v18, 4, v17
    v_lshlrev_b32 v18, 4, v18
    v_lshl_add_u32 v26, v16, 8, v18
    v_xor_b32 v18, 6, v17
    v_lshlrev_b32 v18, 4, v18
    v_lshl_add_u32 v27, v16, 8, v18
    v_xor_b32 v18, 8, v17
    v_lshlrev_b32 v18, 4, v18
    v_lshl_add_u32 v28, v16, 8, v18
    v_xor_b32 v18, 10, v17
    v_lshlrev_b32 v18, 4, v18
    v_lshl_add_u32 v29, v16, 8, v18
    v_xor_b32 v18, 12, v17
    v_lshlrev_b32 v18, 4, v18
    v_lshl_add_u32 v30, v16, 8, v18
    v_xor_b32 v18, 14, v17
    v_lshlrev_b32 v18, 4, v18
    v_lshl_add_u32 v31, v16, 8, v18
    v_and_b32 v9, 0xff, v0
    v_lshlrev_b32 v9, 7, v9
    s_cmp_eq_u32 s47, 0
    s_cselect_b32 s84, s12, s16
    s_cselect_b32 s85, s13, s17
    s_mov_b32 s86, s14
    s_mov_b32 s87, 0x00020000
    s_waitcnt vmcnt(4)
    s_barrier
    s_waitcnt vmcnt(8)
    ds_read_b128 a[64:67], v60
    ds_read_b128 a[68:71], v61
    ds_read_b128 a[72:75], v62
    ds_read_b128 a[76:79], v63
    s_waitcnt lgkmcnt(0)
    s_add_u32 m0, s48, 0
    s_add_u32 s34, s52, 128
    buffer_load_dwordx4 v3, s[4:7], s34 offen lds
    s_add_u32 m0, s48, 1024
    s_add_u32 s34, s53, 128
    buffer_load_dwordx4 v4, s[4:7], s34 offen lds
    s_add_u32 m0, s48, 2048
    s_add_u32 s34, s54, 128
    buffer_load_dwordx4 v3, s[4:7], s34 offen lds
    s_add_u32 m0, s48, 3072
    s_add_u32 s34, s55, 128
    buffer_load_dwordx4 v4, s[4:7], s34 offen lds
    ds_read_b64_tr_b16 v[32:33], v20 offset:0
    ds_read_b64_tr_b16 v[34:35], v20 offset:1024
    ds_read_b64_tr_b16 v[36:37], v21 offset:0
    ds_read_b64_tr_b16 v[38:39], v21 offset:1024
    ds_read_b64_tr_b16 v[40:41], v22 offset:0
    ds_read_b64_tr_b16 v[42:43], v22 offset:1024
    ds_read_b64_tr_b16 v[44:45], v23 offset:0
    ds_read_b64_tr_b16 v[46:47], v23 offset:1024
    ds_read_b64_tr_b16 v[48:49], v20 offset:16384
    ds_read_b64_tr_b16 v[50:51], v20 offset:17408
    s_waitcnt lgkmcnt(8)
    v_mfma_f32_32x32x16_bf16 v[64:79], v[32:35], a[64:67], 0
    ds_read_b64_tr_b16 v[52:53], v21 offset:16384
    ds_read_b64_tr_b16 v[54:55], v21 offset:17408
    s_waitcnt lgkmcnt(8)
    v_mfma_f32_32x32x16_bf16 v[80:95], v[36:39], a[64:67], 0
    ds_read_b64_tr_b16 v[56:57], v22 offset:16384
    ds_read_b64_tr_b16 v[58:59], v22 offset:17408
    s_waitcnt lgkmcnt(8)
    v_mfma_f32_32x32x16_bf16 v[96:111], v[40:43], a[64:67], 0
    ds_read_b64_tr_b16 v[32:33], v23 offset:16384
    ds_read_b64_tr_b16 v[34:35], v23 offset:17408
    s_waitcnt lgkmcnt(8)
    v_mfma_f32_32x32x16_bf16 v[112:127], v[44:47], a[64:67], 0
    ds_read_b64_tr_b16 v[36:37], v20 offset:4096
    ds_read_b64_tr_b16 v[38:39], v20 offset:5120
    s_add_u32 m0, s42, 65536
    s_add_u32 s34, s27, 1048576
    buffer_load_dwordx4 v6, s[8:11], s34 offen lds
    s_waitcnt lgkmcnt(8)
    v_mfma_f32_32x32x16_bf16 a[0:15], v[48:51], a[64:67], 0
    ds_read_b64_tr_b16 v[40:41], v21 offset:4096
    ds_read_b64_tr_b16 v[42:43], v21 offset:5120
    s_waitcnt lgkmcnt(8)
    v_mfma_f32_32x32x16_bf16 a[16:31], v[52:55], a[64:67], 0
    ds_read_b64_tr_b16 v[44:45], v22 offset:4096
    ds_read_b64_tr_b16 v[46:47], v22 offset:5120
    s_waitcnt lgkmcnt(8)
    v_mfma_f32_32x32x16_bf16 a[32:47], v[56:59], a[64:67], 0
    ds_read_b64_tr_b16 v[48:49], v23 offset:4096
    ds_read_b64_tr_b16 v[50:51], v23 offset:5120
    s_add_u32 m0, s42, 73728
    s_add_u32 s34, s27, 1310720
    buffer_load_dwordx4 v6, s[8:11], s34 offen lds
    s_waitcnt lgkmcnt(8)
    v_mfma_f32_32x32x16_bf16 a[48:63], v[32:35], a[64:67], 0
    ds_read_b64_tr_b16 v[52:53], v20 offset:20480
    ds_read_b64_tr_b16 v[54:55], v20 offset:21504
    s_waitcnt lgkmcnt(8)
    v_mfma_f32_32x32x16_bf16 v[64:79], v[36:39], a[68:71], v[64:79]
    ds_read_b64_tr_b16 v[56:57], v21 offset:20480
    ds_read_b64_tr_b16 v[58:59], v21 offset:21504
    s_waitcnt lgkmcnt(8)
    v_mfma_f32_32x32x16_bf16 v[80:95], v[40:43], a[68:71], v[80:95]
    ds_read_b64_tr_b16 v[32:33], v22 offset:20480
    ds_read_b64_tr_b16 v[34:35], v22 offset:21504
    s_add_u32 m0, s42, 81920
    s_add_u32 s34, s29, 1048576
    buffer_load_dwordx4 v6, s[8:11], s34 offen lds
    s_waitcnt lgkmcnt(8)
    v_mfma_f32_32x32x16_bf16 v[96:111], v[44:47], a[68:71], v[96:111]
    ds_read_b64_tr_b16 v[36:37], v23 offset:20480
    ds_read_b64_tr_b16 v[38:39], v23 offset:21504
    s_waitcnt lgkmcnt(8)
    v_mfma_f32_32x32x16_bf16 v[112:127], v[48:51], a[68:71], v[112:127]
    ds_read_b64_tr_b16 v[40:41], v20 offset:8192
    ds_read_b64_tr_b16 v[42:43], v20 offset:9216
    s_waitcnt lgkmcnt(8)
    v_mfma_f32_32x32x16_bf16 a[0:15], v[52:55], a[68:71], a[0:15]
    ds_read_b64_tr_b16 v[44:45], v21 offset:8192
    ds_read_b64_tr_b16 v[46:47], v21 offset:9216
    s_add_u32 m0, s42, 90112
    s_add_u32 s34, s29, 1310720
    buffer_load_dwordx4 v6, s[8:11], s34 offen lds
    s_waitcnt lgkmcnt(8)
    v_mfma_f32_32x32x16_bf16 a[16:31], v[56:59], a[68:71], a[16:31]
    ds_read_b64_tr_b16 v[48:49], v22 offset:8192
    ds_read_b64_tr_b16 v[50:51], v22 offset:9216
    s_waitcnt lgkmcnt(8)
    v_mfma_f32_32x32x16_bf16 a[32:47], v[32:35], a[68:71], a[32:47]
    ds_read_b64_tr_b16 v[52:53], v23 offset:8192
    ds_read_b64_tr_b16 v[54:55], v23 offset:9216
    s_waitcnt lgkmcnt(8)
    v_mfma_f32_32x32x16_bf16 a[48:63], v[36:39], a[68:71], a[48:63]
    ds_read_b64_tr_b16 v[56:57], v20 offset:24576
    ds_read_b64_tr_b16 v[58:59], v20 offset:25600
    s_add_u32 m0, s42, 98304
    s_add_u32 s34, s27, 1572864
    buffer_load_dwordx4 v6, s[8:11], s34 offen lds
    s_waitcnt lgkmcnt(8)
    v_mfma_f32_32x32x16_bf16 v[64:79], v[40:43], a[72:75], v[64:79]
    ds_read_b64_tr_b16 v[32:33], v21 offset:24576
    ds_read_b64_tr_b16 v[34:35], v21 offset:25600
    s_waitcnt lgkmcnt(8)
    v_mfma_f32_32x32x16_bf16 v[80:95], v[44:47], a[72:75], v[80:95]
    ds_read_b64_tr_b16 v[36:37], v22 offset:24576
    ds_read_b64_tr_b16 v[38:39], v22 offset:25600
    s_waitcnt lgkmcnt(8)
    v_mfma_f32_32x32x16_bf16 v[96:111], v[48:51], a[72:75], v[96:111]
    ds_read_b64_tr_b16 v[40:41], v23 offset:24576
    ds_read_b64_tr_b16 v[42:43], v23 offset:25600
    s_add_u32 m0, s42, 106496
    s_add_u32 s34, s27, 1835008
    buffer_load_dwordx4 v6, s[8:11], s34 offen lds
    s_waitcnt lgkmcnt(8)
    v_mfma_f32_32x32x16_bf16 v[112:127], v[52:55], a[72:75], v[112:127]
    ds_read_b64_tr_b16 v[44:45], v20 offset:12288
    ds_read_b64_tr_b16 v[46:47], v20 offset:13312
    s_waitcnt lgkmcnt(8)
    v_mfma_f32_32x32x16_bf16 a[0:15], v[56:59], a[72:75], a[0:15]
    ds_read_b64_tr_b16 v[48:49], v21 offset:12288
    ds_read_b64_tr_b16 v[50:51], v21 offset:13312
    s_waitcnt lgkmcnt(8)
    v_mfma_f32_32x32x16_bf16 a[16:31], v[32:35], a[72:75], a[16:31]
    ds_read_b64_tr_b16 v[52:53], v22 offset:12288
    ds_read_b64_tr_b16 v[54:55], v22 offset:13312
    s_add_u32 m0, s42, 114688
    s_add_u32 s34, s29, 1572864
    buffer_load_dwordx4 v6, s[8:11], s34 offen lds
    s_waitcnt lgkmcnt(8)
    v_mfma_f32_32x32x16_bf16 a[32:47], v[36:39], a[72:75], a[32:47]
    ds_read_b64_tr_b16 v[56:57], v23 offset:12288
    ds_read_b64_tr_b16 v[58:59], v23 offset:13312
    s_waitcnt vmcnt(7)
    ds_read_b128 a[80:83], v60
    s_waitcnt vmcnt(11)
    s_barrier
    s_waitcnt lgkmcnt(9)
    v_mfma_f32_32x32x16_bf16 a[48:63], v[40:43], a[72:75], a[48:63]
    ds_read_b64_tr_b16 v[32:33], v20 offset:28672
    ds_read_b64_tr_b16 v[34:35], v20 offset:29696
    ds_read_b128 a[84:87], v61
    s_waitcnt lgkmcnt(10)
    v_mfma_f32_32x32x16_bf16 v[64:79], v[44:47], a[76:79], v[64:79]
    ds_read_b64_tr_b16 v[36:37], v21 offset:28672
    ds_read_b64_tr_b16 v[38:39], v21 offset:29696
    s_add_u32 m0, s42, 122880
    s_add_u32 s34, s29, 1835008
    buffer_load_dwordx4 v6, s[8:11], s34 offen lds
    ds_read_b128 a[88:91], v62
    s_waitcnt lgkmcnt(11)
    v_mfma_f32_32x32x16_bf16 v[80:95], v[48:51], a[76:79], v[80:95]
    ds_read_b64_tr_b16 v[40:41], v22 offset:28672
    ds_read_b64_tr_b16 v[42:43], v22 offset:29696
    ds_read_b128 a[92:95], v63
    s_waitcnt lgkmcnt(12)
    v_mfma_f32_32x32x16_bf16 v[96:111], v[52:55], a[76:79], v[96:111]
    ds_read_b64_tr_b16 v[44:45], v23 offset:28672
    ds_read_b64_tr_b16 v[46:47], v23 offset:29696
    s_waitcnt lgkmcnt(12)
    v_mfma_f32_32x32x16_bf16 v[112:127], v[56:59], a[76:79], v[112:127]
    ds_read_b64_tr_b16 v[48:49], v20 offset:32768
    ds_read_b64_tr_b16 v[50:51], v20 offset:33792
    s_waitcnt lgkmcnt(11)
    v_mfma_f32_32x32x16_bf16 a[0:15], v[32:35], a[76:79], a[0:15]
    ds_read_b64_tr_b16 v[52:53], v21 offset:32768
    ds_read_b64_tr_b16 v[54:55], v21 offset:33792
    s_waitcnt lgkmcnt(6)
    s_add_u32 m0, s48, 0
    s_add_u32 s34, s52, 256
    buffer_load_dwordx4 v3, s[4:7], s34 offen lds
    s_waitcnt lgkmcnt(10)
    v_mfma_f32_32x32x16_bf16 a[16:31], v[36:39], a[76:79], a[16:31]
    ds_read_b64_tr_b16 v[56:57], v22 offset:32768
    ds_read_b64_tr_b16 v[58:59], v22 offset:33792
    s_add_u32 m0, s48, 1024
    s_add_u32 s34, s53, 256
    buffer_load_dwordx4 v4, s[4:7], s34 offen lds
    s_waitcnt lgkmcnt(9)
    v_mfma_f32_32x32x16_bf16 a[32:47], v[40:43], a[76:79], a[32:47]
    ds_read_b64_tr_b16 v[32:33], v23 offset:32768
    ds_read_b64_tr_b16 v[34:35], v23 offset:33792
    s_add_u32 m0, s48, 2048
    s_add_u32 s34, s54, 256
    buffer_load_dwordx4 v3, s[4:7], s34 offen lds
    s_waitcnt lgkmcnt(8)
    v_mfma_f32_32x32x16_bf16 a[48:63], v[44:47], a[76:79], a[48:63]
    ds_read_b64_tr_b16 v[36:37], v20 offset:49152
    ds_read_b64_tr_b16 v[38:39], v20 offset:50176
    s_add_u32 m0, s48, 3072
    s_add_u32 s34, s55, 256
    buffer_load_dwordx4 v4, s[4:7], s34 offen lds
    s_waitcnt vmcnt(8)
    s_barrier
    s_waitcnt lgkmcnt(8)
    v_mfma_f32_32x32x16_bf16 v[64:79], v[48:51], a[80:83], v[64:79]
    ds_read_b64_tr_b16 v[40:41], v21 offset:49152
    ds_read_b64_tr_b16 v[42:43], v21 offset:50176
    s_waitcnt lgkmcnt(8)
    v_mfma_f32_32x32x16_bf16 v[80:95], v[52:55], a[80:83], v[80:95]
    ds_read_b64_tr_b16 v[44:45], v22 offset:49152
    ds_read_b64_tr_b16 v[46:47], v22 offset:50176
    s_waitcnt lgkmcnt(8)
    v_mfma_f32_32x32x16_bf16 v[96:111], v[56:59], a[80:83], v[96:111]
    ds_read_b64_tr_b16 v[48:49], v23 offset:49152
    ds_read_b64_tr_b16 v[50:51], v23 offset:50176
    s_waitcnt lgkmcnt(8)
    v_mfma_f32_32x32x16_bf16 v[112:127], v[32:35], a[80:83], v[112:127]
    ds_read_b64_tr_b16 v[52:53], v20 offset:36864
    ds_read_b64_tr_b16 v[54:55], v20 offset:37888
    s_add_u32 m0, s42, 0
    s_add_u32 s34, s27, 2097152
    buffer_load_dwordx4 v6, s[8:11], s34 offen lds
    s_waitcnt lgkmcnt(8)
    v_mfma_f32_32x32x16_bf16 a[0:15], v[36:39], a[80:83], a[0:15]
    ds_read_b64_tr_b16 v[56:57], v21 offset:36864
    ds_read_b64_tr_b16 v[58:59], v21 offset:37888
    s_waitcnt lgkmcnt(8)
    v_mfma_f32_32x32x16_bf16 a[16:31], v[40:43], a[80:83], a[16:31]
    ds_read_b64_tr_b16 v[32:33], v22 offset:36864
    ds_read_b64_tr_b16 v[34:35], v22 offset:37888
    s_waitcnt lgkmcnt(8)
    v_mfma_f32_32x32x16_bf16 a[32:47], v[44:47], a[80:83], a[32:47]
    ds_read_b64_tr_b16 v[36:37], v23 offset:36864
    ds_read_b64_tr_b16 v[38:39], v23 offset:37888
    s_add_u32 m0, s42, 8192
    s_add_u32 s34, s27, 2359296
    buffer_load_dwordx4 v6, s[8:11], s34 offen lds
    s_waitcnt lgkmcnt(8)
    v_mfma_f32_32x32x16_bf16 a[48:63], v[48:51], a[80:83], a[48:63]
    ds_read_b64_tr_b16 v[40:41], v20 offset:53248
    ds_read_b64_tr_b16 v[42:43], v20 offset:54272
    s_waitcnt lgkmcnt(8)
    v_mfma_f32_32x32x16_bf16 v[64:79], v[52:55], a[84:87], v[64:79]
    ds_read_b64_tr_b16 v[44:45], v21 offset:53248
    ds_read_b64_tr_b16 v[46:47], v21 offset:54272
    s_waitcnt lgkmcnt(8)
    v_mfma_f32_32x32x16_bf16 v[80:95], v[56:59], a[84:87], v[80:95]
    ds_read_b64_tr_b16 v[48:49], v22 offset:53248
    ds_read_b64_tr_b16 v[50:51], v22 offset:54272
    s_add_u32 m0, s42, 16384
    s_add_u32 s34, s29, 2097152
    buffer_load_dwordx4 v6, s[8:11], s34 offen lds
    s_waitcnt lgkmcnt(8)
    v_mfma_f32_32x32x16_bf16 v[96:111], v[32:35], a[84:87], v[96:111]
    ds_read_b64_tr_b16 v[52:53], v23 offset:53248
    ds_read_b64_tr_b16 v[54:55], v23 offset:54272
    s_waitcnt lgkmcnt(8)
    v_mfma_f32_32x32x16_bf16 v[112:127], v[36:39], a[84:87], v[112:127]
    ds_read_b64_tr_b16 v[56:57], v20 offset:40960
    ds_read_b64_tr_b16 v[58:59], v20 offset:41984
    s_waitcnt lgkmcnt(8)
    v_mfma_f32_32x32x16_bf16 a[0:15], v[40:43], a[84:87], a[0:15]
    ds_read_b64_tr_b16 v[32:33], v21 offset:40960
    ds_read_b64_tr_b16 v[34:35], v21 offset:41984
    s_add_u32 m0, s42, 24576
    s_add_u32 s34, s29, 2359296
    buffer_load_dwordx4 v6, s[8:11], s34 offen lds
    s_waitcnt lgkmcnt(8)
    v_mfma_f32_32x32x16_bf16 a[16:31], v[44:47], a[84:87], a[16:31]
    ds_read_b64_tr_b16 v[36:37], v22 offset:40960
    ds_read_b64_tr_b16 v[38:39], v22 offset:41984
    s_waitcnt lgkmcnt(8)
    v_mfma_f32_32x32x16_bf16 a[32:47], v[48:51], a[84:87], a[32:47]
    ds_read_b64_tr_b16 v[40:41], v23 offset:40960
    ds_read_b64_tr_b16 v[42:43], v23 offset:41984
    s_waitcnt lgkmcnt(8)
    v_mfma_f32_32x32x16_bf16 a[48:63], v[52:55], a[84:87], a[48:63]
    ds_read_b64_tr_b16 v[44:45], v20 offset:57344
    ds_read_b64_tr_b16 v[46:47], v20 offset:58368
    s_waitcnt lgkmcnt(8)
    v_mfma_f32_32x32x16_bf16 v[64:79], v[56:59], a[88:91], v[64:79]
    ds_read_b64_tr_b16 v[48:49], v21 offset:57344
    ds_read_b64_tr_b16 v[50:51], v21 offset:58368
    s_waitcnt lgkmcnt(8)
    v_mfma_f32_32x32x16_bf16 v[80:95], v[32:35], a[88:91], v[80:95]
    ds_read_b64_tr_b16 v[52:53], v22 offset:57344
    ds_read_b64_tr_b16 v[54:55], v22 offset:58368
    s_waitcnt lgkmcnt(8)
    v_mfma_f32_32x32x16_bf16 v[96:111], v[36:39], a[88:91], v[96:111]
    ds_read_b64_tr_b16 v[56:57], v23 offset:57344
    ds_read_b64_tr_b16 v[58:59], v23 offset:58368
    s_waitcnt lgkmcnt(8)
    v_mfma_f32_32x32x16_bf16 v[112:127], v[40:43], a[88:91], v[112:127]
    ds_read_b64_tr_b16 v[32:33], v20 offset:45056
    ds_read_b64_tr_b16 v[34:35], v20 offset:46080
    s_waitcnt lgkmcnt(8)
    v_mfma_f32_32x32x16_bf16 a[0:15], v[44:47], a[88:91], a[0:15]
    ds_read_b64_tr_b16 v[36:37], v21 offset:45056
    ds_read_b64_tr_b16 v[38:39], v21 offset:46080
    s_waitcnt lgkmcnt(8)
    v_mfma_f32_32x32x16_bf16 a[16:31], v[48:51], a[88:91], a[16:31]
    ds_read_b64_tr_b16 v[40:41], v22 offset:45056
    ds_read_b64_tr_b16 v[42:43], v22 offset:46080
    s_waitcnt lgkmcnt(8)
    v_mfma_f32_32x32x16_bf16 a[32:47], v[52:55], a[88:91], a[32:47]
    ds_read_b64_tr_b16 v[44:45], v23 offset:45056
    ds_read_b64_tr_b16 v[46:47], v23 offset:46080
    s_waitcnt vmcnt(4)
    ds_read_b128 a[64:67], v60
    s_waitcnt lgkmcnt(9)
    v_mfma_f32_32x32x16_bf16 a[48:63], v[56:59], a[88:91], a[48:63]
    ds_read_b64_tr_b16 v[48:49], v20 offset:61440
    ds_read_b64_tr_b16 v[50:51], v20 offset:62464
    ds_read_b128 a[68:71], v61
    s_waitcnt lgkmcnt(10)
    v_mfma_f32_32x32x16_bf16 v[64:79], v[32:35], a[92:95], v[64:79]
    ds_read_b64_tr_b16 v[52:53], v21 offset:61440
    ds_read_b64_tr_b16 v[54:55], v21 offset:62464
    ds_read_b128 a[72:75], v62
    s_waitcnt lgkmcnt(11)
    v_mfma_f32_32x32x16_bf16 v[80:95], v[36:39], a[92:95], v[80:95]
    ds_read_b64_tr_b16 v[56:57], v22 offset:61440
    ds_read_b64_tr_b16 v[58:59], v22 offset:62464
    ds_read_b128 a[76:79], v63
    s_waitcnt lgkmcnt(12)
    v_mfma_f32_32x32x16_bf16 v[96:111], v[40:43], a[92:95], v[96:111]
    ds_read_b64_tr_b16 v[32:33], v23 offset:61440
    ds_read_b64_tr_b16 v[34:35], v23 offset:62464
    s_waitcnt lgkmcnt(12)
    v_mfma_f32_32x32x16_bf16 v[112:127], v[44:47], a[92:95], v[112:127]
    v_add_u32 v20, 0x10000, v20
    v_add_u32 v21, 0x10000, v21
    v_add_u32 v22, 0x10000, v22
    v_add_u32 v23, 0x10000, v23
    ds_read_b64_tr_b16 v[36:37], v20 offset:0
    ds_read_b64_tr_b16 v[38:39], v20 offset:1024
    s_waitcnt lgkmcnt(11)
    v_mfma_f32_32x32x16_bf16 a[0:15], v[48:51], a[92:95], a[0:15]
    ds_read_b64_tr_b16 v[40:41], v21 offset:0
    ds_read_b64_tr_b16 v[42:43], v21 offset:1024
    s_waitcnt lgkmcnt(6)
    s_add_u32 m0, s48, 0
    s_add_u32 s34, s52, 384
    buffer_load_dwordx4 v3, s[4:7], s34 offen lds
    s_waitcnt lgkmcnt(10)
    v_mfma_f32_32x32x16_bf16 a[16:31], v[52:55], a[92:95], a[16:31]
    ds_read_b64_tr_b16 v[44:45], v22 offset:0
    ds_read_b64_tr_b16 v[46:47], v22 offset:1024
    s_add_u32 m0, s48, 1024
    s_add_u32 s34, s53, 384
    buffer_load_dwordx4 v4, s[4:7], s34 offen lds
    s_waitcnt lgkmcnt(9)
    v_mfma_f32_32x32x16_bf16 a[32:47], v[56:59], a[92:95], a[32:47]
    ds_read_b64_tr_b16 v[48:49], v23 offset:0
    ds_read_b64_tr_b16 v[50:51], v23 offset:1024
    s_add_u32 m0, s48, 2048
    s_add_u32 s34, s54, 384
    buffer_load_dwordx4 v3, s[4:7], s34 offen lds
    s_waitcnt lgkmcnt(8)
    v_mfma_f32_32x32x16_bf16 a[48:63], v[32:35], a[92:95], a[48:63]
    ds_read_b64_tr_b16 v[52:53], v20 offset:16384
    ds_read_b64_tr_b16 v[54:55], v20 offset:17408
    s_add_u32 m0, s48, 3072
    s_add_u32 s34, s55, 384
    buffer_load_dwordx4 v4, s[4:7], s34 offen lds
    s_waitcnt vmcnt(12)
    s_barrier
    s_waitcnt lgkmcnt(8)
    v_mfma_f32_32x32x16_bf16 v[64:79], v[36:39], a[64:67], v[64:79]
    ds_read_b64_tr_b16 v[56:57], v21 offset:16384
    ds_read_b64_tr_b16 v[58:59], v21 offset:17408
    s_waitcnt lgkmcnt(8)
    v_mfma_f32_32x32x16_bf16 v[80:95], v[40:43], a[64:67], v[80:95]
    ds_read_b64_tr_b16 v[32:33], v22 offset:16384
    ds_read_b64_tr_b16 v[34:35], v22 offset:17408
    s_waitcnt lgkmcnt(8)
    v_mfma_f32_32x32x16_bf16 v[96:111], v[44:47], a[64:67], v[96:111]
    ds_read_b64_tr_b16 v[36:37], v23 offset:16384
    ds_read_b64_tr_b16 v[38:39], v23 offset:17408
    s_waitcnt lgkmcnt(8)
    v_mfma_f32_32x32x16_bf16 v[112:127], v[48:51], a[64:67], v[112:127]
    ds_read_b64_tr_b16 v[40:41], v20 offset:4096
    ds_read_b64_tr_b16 v[42:43], v20 offset:5120
    s_add_u32 m0, s42, 32768
    s_add_u32 s34, s27, 2621440
    buffer_load_dwordx4 v6, s[8:11], s34 offen lds
    s_waitcnt lgkmcnt(8)
    v_mfma_f32_32x32x16_bf16 a[0:15], v[52:55], a[64:67], a[0:15]
    ds_read_b64_tr_b16 v[44:45], v21 offset:4096
    ds_read_b64_tr_b16 v[46:47], v21 offset:5120
    s_waitcnt lgkmcnt(8)
    v_mfma_f32_32x32x16_bf16 a[16:31], v[56:59], a[64:67], a[16:31]
    ds_read_b64_tr_b16 v[48:49], v22 offset:4096
    ds_read_b64_tr_b16 v[50:51], v22 offset:5120
    s_waitcnt lgkmcnt(8)
    v_mfma_f32_32x32x16_bf16 a[32:47], v[32:35], a[64:67], a[32:47]
    ds_read_b64_tr_b16 v[52:53], v23 offset:4096
    ds_read_b64_tr_b16 v[54:55], v23 offset:5120
    s_add_u32 m0, s42, 40960
    s_add_u32 s34, s27, 2883584
    buffer_load_dwordx4 v6, s[8:11], s34 offen lds
    s_waitcnt lgkmcnt(8)
    v_mfma_f32_32x32x16_bf16 a[48:63], v[36:39], a[64:67], a[48:63]
    ds_read_b64_tr_b16 v[56:57], v20 offset:20480
    ds_read_b64_tr_b16 v[58:59], v20 offset:21504
    s_waitcnt lgkmcnt(8)
    v_mfma_f32_32x32x16_bf16 v[64:79], v[40:43], a[68:71], v[64:79]
    ds_read_b64_tr_b16 v[32:33], v21 offset:20480
    ds_read_b64_tr_b16 v[34:35], v21 offset:21504
    s_waitcnt lgkmcnt(8)
    v_mfma_f32_32x32x16_bf16 v[80:95], v[44:47], a[68:71], v[80:95]
    ds_read_b64_tr_b16 v[36:37], v22 offset:20480
    ds_read_b64_tr_b16 v[38:39], v22 offset:21504
    s_add_u32 m0, s42, 49152
    s_add_u32 s34, s29, 2621440
    buffer_load_dwordx4 v6, s[8:11], s34 offen lds
    s_waitcnt lgkmcnt(8)
    v_mfma_f32_32x32x16_bf16 v[96:111], v[48:51], a[68:71], v[96:111]
    ds_read_b64_tr_b16 v[40:41], v23 offset:20480
    ds_read_b64_tr_b16 v[42:43], v23 offset:21504
    s_waitcnt lgkmcnt(8)
    v_mfma_f32_32x32x16_bf16 v[112:127], v[52:55], a[68:71], v[112:127]
    ds_read_b64_tr_b16 v[44:45], v20 offset:8192
    ds_read_b64_tr_b16 v[46:47], v20 offset:9216
    s_waitcnt lgkmcnt(8)
    v_mfma_f32_32x32x16_bf16 a[0:15], v[56:59], a[68:71], a[0:15]
    ds_read_b64_tr_b16 v[48:49], v21 offset:8192
    ds_read_b64_tr_b16 v[50:51], v21 offset:9216
    s_add_u32 m0, s42, 57344
    s_add_u32 s34, s29, 2883584
    buffer_load_dwordx4 v6, s[8:11], s34 offen lds
    s_waitcnt lgkmcnt(8)
    v_mfma_f32_32x32x16_bf16 a[16:31], v[32:35], a[68:71], a[16:31]
    ds_read_b64_tr_b16 v[52:53], v22 offset:8192
    ds_read_b64_tr_b16 v[54:55], v22 offset:9216
    s_waitcnt lgkmcnt(8)
    v_mfma_f32_32x32x16_bf16 a[32:47], v[36:39], a[68:71], a[32:47]
    ds_read_b64_tr_b16 v[56:57], v23 offset:8192
    ds_read_b64_tr_b16 v[58:59], v23 offset:9216
    s_waitcnt lgkmcnt(8)
    v_mfma_f32_32x32x16_bf16 a[48:63], v[40:43], a[68:71], a[48:63]
    ds_read_b64_tr_b16 v[32:33], v20 offset:24576
    ds_read_b64_tr_b16 v[34:35], v20 offset:25600
    s_waitcnt lgkmcnt(8)
    v_mfma_f32_32x32x16_bf16 v[64:79], v[44:47], a[72:75], v[64:79]
    ds_read_b64_tr_b16 v[36:37], v21 offset:24576
    ds_read_b64_tr_b16 v[38:39], v21 offset:25600
    s_waitcnt lgkmcnt(8)
    v_mfma_f32_32x32x16_bf16 v[80:95], v[48:51], a[72:75], v[80:95]
    ds_read_b64_tr_b16 v[40:41], v22 offset:24576
    ds_read_b64_tr_b16 v[42:43], v22 offset:25600
    s_waitcnt lgkmcnt(8)
    v_mfma_f32_32x32x16_bf16 v[96:111], v[52:55], a[72:75], v[96:111]
    ds_read_b64_tr_b16 v[44:45], v23 offset:24576
    ds_read_b64_tr_b16 v[46:47], v23 offset:25600
    s_waitcnt lgkmcnt(8)
    v_mfma_f32_32x32x16_bf16 v[112:127], v[56:59], a[72:75], v[112:127]
    ds_read_b64_tr_b16 v[48:49], v20 offset:12288
    ds_read_b64_tr_b16 v[50:51], v20 offset:13312
    s_waitcnt lgkmcnt(8)
    v_mfma_f32_32x32x16_bf16 a[0:15], v[32:35], a[72:75], a[0:15]
    ds_read_b64_tr_b16 v[52:53], v21 offset:12288
    ds_read_b64_tr_b16 v[54:55], v21 offset:13312
    s_waitcnt lgkmcnt(8)
    v_mfma_f32_32x32x16_bf16 a[16:31], v[36:39], a[72:75], a[16:31]
    ds_read_b64_tr_b16 v[56:57], v22 offset:12288
    ds_read_b64_tr_b16 v[58:59], v22 offset:13312
    s_waitcnt lgkmcnt(8)
    v_mfma_f32_32x32x16_bf16 a[32:47], v[40:43], a[72:75], a[32:47]
    ds_read_b64_tr_b16 v[32:33], v23 offset:12288
    ds_read_b64_tr_b16 v[34:35], v23 offset:13312
    s_waitcnt vmcnt(4)
    ds_read_b128 a[80:83], v60
    s_waitcnt lgkmcnt(9)
    v_mfma_f32_32x32x16_bf16 a[48:63], v[44:47], a[72:75], a[48:63]
    ds_read_b64_tr_b16 v[36:37], v20 offset:28672
    ds_read_b64_tr_b16 v[38:39], v20 offset:29696
    ds_read_b128 a[84:87], v61
    s_waitcnt lgkmcnt(10)
    v_mfma_f32_32x32x16_bf16 v[64:79], v[48:51], a[76:79], v[64:79]
    ds_read_b64_tr_b16 v[40:41], v21 offset:28672
    ds_read_b64_tr_b16 v[42:43], v21 offset:29696
    ds_read_b128 a[88:91], v62
    s_waitcnt lgkmcnt(11)
    v_mfma_f32_32x32x16_bf16 v[80:95], v[52:55], a[76:79], v[80:95]
    ds_read_b64_tr_b16 v[44:45], v22 offset:28672
    ds_read_b64_tr_b16 v[46:47], v22 offset:29696
    ds_read_b128 a[92:95], v63
    s_waitcnt lgkmcnt(12)
    v_mfma_f32_32x32x16_bf16 v[96:111], v[56:59], a[76:79], v[96:111]
    ds_read_b64_tr_b16 v[48:49], v23 offset:28672
    ds_read_b64_tr_b16 v[50:51], v23 offset:29696
    s_waitcnt lgkmcnt(12)
    v_mfma_f32_32x32x16_bf16 v[112:127], v[32:35], a[76:79], v[112:127]
    ds_read_b64_tr_b16 v[52:53], v20 offset:32768
    ds_read_b64_tr_b16 v[54:55], v20 offset:33792
    s_waitcnt lgkmcnt(11)
    v_mfma_f32_32x32x16_bf16 a[0:15], v[36:39], a[76:79], a[0:15]
    ds_read_b64_tr_b16 v[56:57], v21 offset:32768
    ds_read_b64_tr_b16 v[58:59], v21 offset:33792
    s_waitcnt lgkmcnt(6)
    s_add_u32 m0, s48, 0
    s_add_u32 s34, s52, 512
    buffer_load_dwordx4 v3, s[4:7], s34 offen lds
    s_waitcnt lgkmcnt(10)
    v_mfma_f32_32x32x16_bf16 a[16:31], v[40:43], a[76:79], a[16:31]
    ds_read_b64_tr_b16 v[32:33], v22 offset:32768
    ds_read_b64_tr_b16 v[34:35], v22 offset:33792
    s_add_u32 m0, s48, 1024
    s_add_u32 s34, s53, 512
    buffer_load_dwordx4 v4, s[4:7], s34 offen lds
    s_waitcnt lgkmcnt(9)
    v_mfma_f32_32x32x16_bf16 a[32:47], v[44:47], a[76:79], a[32:47]
    ds_read_b64_tr_b16 v[36:37], v23 offset:32768
    ds_read_b64_tr_b16 v[38:39], v23 offset:33792
    s_add_u32 m0, s48, 2048
    s_add_u32 s34, s54, 512
    buffer_load_dwordx4 v3, s[4:7], s34 offen lds
    s_waitcnt lgkmcnt(8)
    v_mfma_f32_32x32x16_bf16 a[48:63], v[48:51], a[76:79], a[48:63]
    ds_read_b64_tr_b16 v[40:41], v20 offset:49152
    ds_read_b64_tr_b16 v[42:43], v20 offset:50176
    s_add_u32 m0, s48, 3072
    s_add_u32 s34, s55, 512
    buffer_load_dwordx4 v4, s[4:7], s34 offen lds
    s_waitcnt vmcnt(12)
    s_barrier
    s_waitcnt lgkmcnt(8)
    v_mfma_f32_32x32x16_bf16 v[64:79], v[52:55], a[80:83], v[64:79]
    ds_read_b64_tr_b16 v[44:45], v21 offset:49152
    ds_read_b64_tr_b16 v[46:47], v21 offset:50176
    s_waitcnt lgkmcnt(8)
    v_mfma_f32_32x32x16_bf16 v[80:95], v[56:59], a[80:83], v[80:95]
    ds_read_b64_tr_b16 v[48:49], v22 offset:49152
    ds_read_b64_tr_b16 v[50:51], v22 offset:50176
    s_waitcnt lgkmcnt(8)
    v_mfma_f32_32x32x16_bf16 v[96:111], v[32:35], a[80:83], v[96:111]
    ds_read_b64_tr_b16 v[52:53], v23 offset:49152
    ds_read_b64_tr_b16 v[54:55], v23 offset:50176
    s_waitcnt lgkmcnt(8)
    v_mfma_f32_32x32x16_bf16 v[112:127], v[36:39], a[80:83], v[112:127]
    ds_read_b64_tr_b16 v[56:57], v20 offset:36864
    ds_read_b64_tr_b16 v[58:59], v20 offset:37888
    s_add_u32 m0, s42, 65536
    s_add_u32 s34, s27, 3145728
    buffer_load_dwordx4 v6, s[8:11], s34 offen lds
    s_waitcnt lgkmcnt(8)
    v_mfma_f32_32x32x16_bf16 a[0:15], v[40:43], a[80:83], a[0:15]
    ds_read_b64_tr_b16 v[32:33], v21 offset:36864
    ds_read_b64_tr_b16 v[34:35], v21 offset:37888
    s_waitcnt lgkmcnt(8)
    v_mfma_f32_32x32x16_bf16 a[16:31], v[44:47], a[80:83], a[16:31]
    ds_read_b64_tr_b16 v[36:37], v22 offset:36864
    ds_read_b64_tr_b16 v[38:39], v22 offset:37888
    s_waitcnt lgkmcnt(8)
    v_mfma_f32_32x32x16_bf16 a[32:47], v[48:51], a[80:83], a[32:47]
    ds_read_b64_tr_b16 v[40:41], v23 offset:36864
    ds_read_b64_tr_b16 v[42:43], v23 offset:37888
    s_add_u32 m0, s42, 73728
    s_add_u32 s34, s27, 3407872
    buffer_load_dwordx4 v6, s[8:11], s34 offen lds
    s_waitcnt lgkmcnt(8)
    v_mfma_f32_32x32x16_bf16 a[48:63], v[52:55], a[80:83], a[48:63]
    ds_read_b64_tr_b16 v[44:45], v20 offset:53248
    ds_read_b64_tr_b16 v[46:47], v20 offset:54272
    s_waitcnt lgkmcnt(8)
    v_mfma_f32_32x32x16_bf16 v[64:79], v[56:59], a[84:87], v[64:79]
    ds_read_b64_tr_b16 v[48:49], v21 offset:53248
    ds_read_b64_tr_b16 v[50:51], v21 offset:54272
    s_waitcnt lgkmcnt(8)
    v_mfma_f32_32x32x16_bf16 v[80:95], v[32:35], a[84:87], v[80:95]
    ds_read_b64_tr_b16 v[52:53], v22 offset:53248
    ds_read_b64_tr_b16 v[54:55], v22 offset:54272
    s_add_u32 m0, s42, 81920
    s_add_u32 s34, s29, 3145728
    buffer_load_dwordx4 v6, s[8:11], s34 offen lds
    s_waitcnt lgkmcnt(8)
    v_mfma_f32_32x32x16_bf16 v[96:111], v[36:39], a[84:87], v[96:111]
    ds_read_b64_tr_b16 v[56:57], v23 offset:53248
    ds_read_b64_tr_b16 v[58:59], v23 offset:54272
    s_waitcnt lgkmcnt(8)
    v_mfma_f32_32x32x16_bf16 v[112:127], v[40:43], a[84:87], v[112:127]
    ds_read_b64_tr_b16 v[32:33], v20 offset:40960
    ds_read_b64_tr_b16 v[34:35], v20 offset:41984
    s_waitcnt lgkmcnt(8)
    v_mfma_f32_32x32x16_bf16 a[0:15], v[44:47], a[84:87], a[0:15]
    ds_read_b64_tr_b16 v[36:37], v21 offset:40960
    ds_read_b64_tr_b16 v[38:39], v21 offset:41984
    s_add_u32 m0, s42, 90112
    s_add_u32 s34, s29, 3407872
    buffer_load_dwordx4 v6, s[8:11], s34 offen lds
    s_waitcnt lgkmcnt(8)
    v_mfma_f32_32x32x16_bf16 a[16:31], v[48:51], a[84:87], a[16:31]
    ds_read_b64_tr_b16 v[40:41], v22 offset:40960
    ds_read_b64_tr_b16 v[42:43], v22 offset:41984
    s_waitcnt lgkmcnt(8)
    v_mfma_f32_32x32x16_bf16 a[32:47], v[52:55], a[84:87], a[32:47]
    ds_read_b64_tr_b16 v[44:45], v23 offset:40960
    ds_read_b64_tr_b16 v[46:47], v23 offset:41984
    s_waitcnt lgkmcnt(8)
    v_mfma_f32_32x32x16_bf16 a[48:63], v[56:59], a[84:87], a[48:63]
    ds_read_b64_tr_b16 v[48:49], v20 offset:57344
    ds_read_b64_tr_b16 v[50:51], v20 offset:58368
    s_waitcnt lgkmcnt(8)
    v_mfma_f32_32x32x16_bf16 v[64:79], v[32:35], a[88:91], v[64:79]
    ds_read_b64_tr_b16 v[52:53], v21 offset:57344
    ds_read_b64_tr_b16 v[54:55], v21 offset:58368
    s_waitcnt lgkmcnt(8)
    v_mfma_f32_32x32x16_bf16 v[80:95], v[36:39], a[88:91], v[80:95]
    ds_read_b64_tr_b16 v[56:57], v22 offset:57344
    ds_read_b64_tr_b16 v[58:59], v22 offset:58368
    s_waitcnt lgkmcnt(8)
    v_mfma_f32_32x32x16_bf16 v[96:111], v[40:43], a[88:91], v[96:111]
    ds_read_b64_tr_b16 v[32:33], v23 offset:57344
    ds_read_b64_tr_b16 v[34:35], v23 offset:58368
    s_waitcnt lgkmcnt(8)
    v_mfma_f32_32x32x16_bf16 v[112:127], v[44:47], a[88:91], v[112:127]
    ds_read_b64_tr_b16 v[36:37], v20 offset:45056
    ds_read_b64_tr_b16 v[38:39], v20 offset:46080
    s_waitcnt lgkmcnt(8)
    v_mfma_f32_32x32x16_bf16 a[0:15], v[48:51], a[88:91], a[0:15]
    ds_read_b64_tr_b16 v[40:41], v21 offset:45056
    ds_read_b64_tr_b16 v[42:43], v21 offset:46080
    s_waitcnt lgkmcnt(8)
    v_mfma_f32_32x32x16_bf16 a[16:31], v[52:55], a[88:91], a[16:31]
    ds_read_b64_tr_b16 v[44:45], v22 offset:45056
    ds_read_b64_tr_b16 v[46:47], v22 offset:46080
    s_waitcnt lgkmcnt(8)
    v_mfma_f32_32x32x16_bf16 a[32:47], v[56:59], a[88:91], a[32:47]
    ds_read_b64_tr_b16 v[48:49], v23 offset:45056
    ds_read_b64_tr_b16 v[50:51], v23 offset:46080
    s_waitcnt vmcnt(4)
    ds_read_b128 a[64:67], v60
    s_waitcnt lgkmcnt(9)
    v_mfma_f32_32x32x16_bf16 a[48:63], v[32:35], a[88:91], a[48:63]
    ds_read_b64_tr_b16 v[52:53], v20 offset:61440
    ds_read_b64_tr_b16 v[54:55], v20 offset:62464
    ds_read_b128 a[68:71], v61
    s_waitcnt lgkmcnt(10)
    v_mfma_f32_32x32x16_bf16 v[64:79], v[36:39], a[92:95], v[64:79]
    ds_read_b64_tr_b16 v[56:57], v21 offset:61440
    ds_read_b64_tr_b16 v[58:59], v21 offset:62464
    ds_read_b128 a[72:75], v62
    s_waitcnt lgkmcnt(11)
    v_mfma_f32_32x32x16_bf16 v[80:95], v[40:43], a[92:95], v[80:95]
    ds_read_b64_tr_b16 v[32:33], v22 offset:61440
    ds_read_b64_tr_b16 v[34:35], v22 offset:62464
    ds_read_b128 a[76:79], v63
    s_waitcnt lgkmcnt(12)
    v_mfma_f32_32x32x16_bf16 v[96:111], v[44:47], a[92:95], v[96:111]
    ds_read_b64_tr_b16 v[36:37], v23 offset:61440
    ds_read_b64_tr_b16 v[38:39], v23 offset:62464
    s_waitcnt lgkmcnt(12)
    v_mfma_f32_32x32x16_bf16 v[112:127], v[48:51], a[92:95], v[112:127]
    v_add_u32 v20, 0xffff0000, v20
    v_add_u32 v21, 0xffff0000, v21
    v_add_u32 v22, 0xffff0000, v22
    v_add_u32 v23, 0xffff0000, v23
    ds_read_b64_tr_b16 v[40:41], v20 offset:0
    ds_read_b64_tr_b16 v[42:43], v20 offset:1024
    s_waitcnt lgkmcnt(11)
    v_mfma_f32_32x32x16_bf16 a[0:15], v[52:55], a[92:95], a[0:15]
    ds_read_b64_tr_b16 v[44:45], v21 offset:0
    ds_read_b64_tr_b16 v[46:47], v21 offset:1024
    s_waitcnt lgkmcnt(6)
    s_add_u32 m0, s48, 0
    s_add_u32 s34, s52, 640
    buffer_load_dwordx4 v3, s[4:7], s34 offen lds
    s_waitcnt lgkmcnt(10)
    v_mfma_f32_32x32x16_bf16 a[16:31], v[56:59], a[92:95], a[16:31]
    ds_read_b64_tr_b16 v[48:49], v22 offset:0
    ds_read_b64_tr_b16 v[50:51], v22 offset:1024
    s_add_u32 m0, s48, 1024
    s_add_u32 s34, s53, 640
    buffer_load_dwordx4 v4, s[4:7], s34 offen lds
    s_waitcnt lgkmcnt(9)
    v_mfma_f32_32x32x16_bf16 a[32:47], v[32:35], a[92:95], a[32:47]
    ds_read_b64_tr_b16 v[52:53], v23 offset:0
    ds_read_b64_tr_b16 v[54:55], v23 offset:1024
    s_add_u32 m0, s48, 2048
    s_add_u32 s34, s54, 640
    buffer_load_dwordx4 v3, s[4:7], s34 offen lds
    s_waitcnt lgkmcnt(8)
    v_mfma_f32_32x32x16_bf16 a[48:63], v[36:39], a[92:95], a[48:63]
    ds_read_b64_tr_b16 v[56:57], v20 offset:16384
    ds_read_b64_tr_b16 v[58:59], v20 offset:17408
    s_add_u32 m0, s48, 3072
    s_add_u32 s34, s55, 640
    buffer_load_dwordx4 v4, s[4:7], s34 offen lds
    s_waitcnt vmcnt(12)
    s_barrier
    s_waitcnt lgkmcnt(8)
    v_mfma_f32_32x32x16_bf16 v[64:79], v[40:43], a[64:67], v[64:79]
    ds_read_b64_tr_b16 v[32:33], v21 offset:16384
    ds_read_b64_tr_b16 v[34:35], v21 offset:17408
    s_waitcnt lgkmcnt(8)
    v_mfma_f32_32x32x16_bf16 v[80:95], v[44:47], a[64:67], v[80:95]
    ds_read_b64_tr_b16 v[36:37], v22 offset:16384
    ds_read_b64_tr_b16 v[38:39], v22 offset:17408
    s_waitcnt lgkmcnt(8)
    v_mfma_f32_32x32x16_bf16 v[96:111], v[48:51], a[64:67], v[96:111]
    ds_read_b64_tr_b16 v[40:41], v23 offset:16384
    ds_read_b64_tr_b16 v[42:43], v23 offset:17408
    s_waitcnt lgkmcnt(8)
    v_mfma_f32_32x32x16_bf16 v[112:127], v[52:55], a[64:67], v[112:127]
    ds_read_b64_tr_b16 v[44:45], v20 offset:4096
    ds_read_b64_tr_b16 v[46:47], v20 offset:5120
    s_add_u32 m0, s42, 98304
    s_add_u32 s34, s27, 3670016
    buffer_load_dwordx4 v6, s[8:11], s34 offen lds
    s_waitcnt lgkmcnt(8)
    v_mfma_f32_32x32x16_bf16 a[0:15], v[56:59], a[64:67], a[0:15]
    ds_read_b64_tr_b16 v[48:49], v21 offset:4096
    ds_read_b64_tr_b16 v[50:51], v21 offset:5120
    s_waitcnt lgkmcnt(8)
    v_mfma_f32_32x32x16_bf16 a[16:31], v[32:35], a[64:67], a[16:31]
    ds_read_b64_tr_b16 v[52:53], v22 offset:4096
    ds_read_b64_tr_b16 v[54:55], v22 offset:5120
    s_waitcnt lgkmcnt(8)
    v_mfma_f32_32x32x16_bf16 a[32:47], v[36:39], a[64:67], a[32:47]
    ds_read_b64_tr_b16 v[56:57], v23 offset:4096
    ds_read_b64_tr_b16 v[58:59], v23 offset:5120
    s_add_u32 m0, s42, 106496
    s_add_u32 s34, s27, 3932160
    buffer_load_dwordx4 v6, s[8:11], s34 offen lds
    s_waitcnt lgkmcnt(8)
    v_mfma_f32_32x32x16_bf16 a[48:63], v[40:43], a[64:67], a[48:63]
    ds_read_b64_tr_b16 v[32:33], v20 offset:20480
    ds_read_b64_tr_b16 v[34:35], v20 offset:21504
    s_waitcnt lgkmcnt(8)
    v_mfma_f32_32x32x16_bf16 v[64:79], v[44:47], a[68:71], v[64:79]
    ds_read_b64_tr_b16 v[36:37], v21 offset:20480
    ds_read_b64_tr_b16 v[38:39], v21 offset:21504
    s_waitcnt lgkmcnt(8)
    v_mfma_f32_32x32x16_bf16 v[80:95], v[48:51], a[68:71], v[80:95]
    ds_read_b64_tr_b16 v[40:41], v22 offset:20480
    ds_read_b64_tr_b16 v[42:43], v22 offset:21504
    s_add_u32 m0, s42, 114688
    s_add_u32 s34, s29, 3670016
    buffer_load_dwordx4 v6, s[8:11], s34 offen lds
    s_waitcnt lgkmcnt(8)
    v_mfma_f32_32x32x16_bf16 v[96:111], v[52:55], a[68:71], v[96:111]
    ds_read_b64_tr_b16 v[44:45], v23 offset:20480
    ds_read_b64_tr_b16 v[46:47], v23 offset:21504
    s_waitcnt lgkmcnt(8)
    v_mfma_f32_32x32x16_bf16 v[112:127], v[56:59], a[68:71], v[112:127]
    ds_read_b64_tr_b16 v[48:49], v20 offset:8192
    ds_read_b64_tr_b16 v[50:51], v20 offset:9216
    s_waitcnt lgkmcnt(8)
    v_mfma_f32_32x32x16_bf16 a[0:15], v[32:35], a[68:71], a[0:15]
    ds_read_b64_tr_b16 v[52:53], v21 offset:8192
    ds_read_b64_tr_b16 v[54:55], v21 offset:9216
    s_add_u32 m0, s42, 122880
    s_add_u32 s34, s29, 3932160
    buffer_load_dwordx4 v6, s[8:11], s34 offen lds
    s_waitcnt lgkmcnt(8)
    v_mfma_f32_32x32x16_bf16 a[16:31], v[36:39], a[68:71], a[16:31]
    ds_read_b64_tr_b16 v[56:57], v22 offset:8192
    ds_read_b64_tr_b16 v[58:59], v22 offset:9216
    s_waitcnt lgkmcnt(8)
    v_mfma_f32_32x32x16_bf16 a[32:47], v[40:43], a[68:71], a[32:47]
    ds_read_b64_tr_b16 v[32:33], v23 offset:8192
    ds_read_b64_tr_b16 v[34:35], v23 offset:9216
    s_waitcnt lgkmcnt(8)
    v_mfma_f32_32x32x16_bf16 a[48:63], v[44:47], a[68:71], a[48:63]
    ds_read_b64_tr_b16 v[36:37], v20 offset:24576
    ds_read_b64_tr_b16 v[38:39], v20 offset:25600
    s_waitcnt lgkmcnt(8)
    v_mfma_f32_32x32x16_bf16 v[64:79], v[48:51], a[72:75], v[64:79]
    ds_read_b64_tr_b16 v[40:41], v21 offset:24576
    ds_read_b64_tr_b16 v[42:43], v21 offset:25600
    s_waitcnt lgkmcnt(8)
    v_mfma_f32_32x32x16_bf16 v[80:95], v[52:55], a[72:75], v[80:95]
    ds_read_b64_tr_b16 v[44:45], v22 offset:24576
    ds_read_b64_tr_b16 v[46:47], v22 offset:25600
    s_waitcnt lgkmcnt(8)
    v_mfma_f32_32x32x16_bf16 v[96:111], v[56:59], a[72:75], v[96:111]
    ds_read_b64_tr_b16 v[48:49], v23 offset:24576
    ds_read_b64_tr_b16 v[50:51], v23 offset:25600
    s_waitcnt lgkmcnt(8)
    v_mfma_f32_32x32x16_bf16 v[112:127], v[32:35], a[72:75], v[112:127]
    ds_read_b64_tr_b16 v[52:53], v20 offset:12288
    ds_read_b64_tr_b16 v[54:55], v20 offset:13312
    s_waitcnt lgkmcnt(8)
    v_mfma_f32_32x32x16_bf16 a[0:15], v[36:39], a[72:75], a[0:15]
    ds_read_b64_tr_b16 v[56:57], v21 offset:12288
    ds_read_b64_tr_b16 v[58:59], v21 offset:13312
    s_waitcnt lgkmcnt(8)
    v_mfma_f32_32x32x16_bf16 a[16:31], v[40:43], a[72:75], a[16:31]
    ds_read_b64_tr_b16 v[32:33], v22 offset:12288
    ds_read_b64_tr_b16 v[34:35], v22 offset:13312
    s_waitcnt lgkmcnt(8)
    v_mfma_f32_32x32x16_bf16 a[32:47], v[44:47], a[72:75], a[32:47]
    ds_read_b64_tr_b16 v[36:37], v23 offset:12288
    ds_read_b64_tr_b16 v[38:39], v23 offset:13312
    s_waitcnt vmcnt(4)
    ds_read_b128 a[80:83], v60
    s_waitcnt lgkmcnt(9)
    v_mfma_f32_32x32x16_bf16 a[48:63], v[48:51], a[72:75], a[48:63]
    ds_read_b64_tr_b16 v[40:41], v20 offset:28672
    ds_read_b64_tr_b16 v[42:43], v20 offset:29696
    ds_read_b128 a[84:87], v61
    s_waitcnt lgkmcnt(10)
    v_mfma_f32_32x32x16_bf16 v[64:79], v[52:55], a[76:79], v[64:79]
    ds_read_b64_tr_b16 v[44:45], v21 offset:28672
    ds_read_b64_tr_b16 v[46:47], v21 offset:29696
    ds_read_b128 a[88:91], v62
    s_waitcnt lgkmcnt(11)
    v_mfma_f32_32x32x16_bf16 v[80:95], v[56:59], a[76:79], v[80:95]
    ds_read_b64_tr_b16 v[48:49], v22 offset:28672
    ds_read_b64_tr_b16 v[50:51], v22 offset:29696
    ds_read_b128 a[92:95], v63
    s_waitcnt lgkmcnt(12)
    v_mfma_f32_32x32x16_bf16 v[96:111], v[32:35], a[76:79], v[96:111]
    ds_read_b64_tr_b16 v[52:53], v23 offset:28672
    ds_read_b64_tr_b16 v[54:55], v23 offset:29696
    s_waitcnt lgkmcnt(12)
    v_mfma_f32_32x32x16_bf16 v[112:127], v[36:39], a[76:79], v[112:127]
    ds_read_b64_tr_b16 v[56:57], v20 offset:32768
    ds_read_b64_tr_b16 v[58:59], v20 offset:33792
    s_waitcnt lgkmcnt(11)
    v_mfma_f32_32x32x16_bf16 a[0:15], v[40:43], a[76:79], a[0:15]
    ds_read_b64_tr_b16 v[32:33], v21 offset:32768
    ds_read_b64_tr_b16 v[34:35], v21 offset:33792
    s_waitcnt lgkmcnt(6)
    s_add_u32 m0, s48, 0
    s_add_u32 s34, s52, 768
    buffer_load_dwordx4 v3, s[4:7], s34 offen lds
    s_waitcnt lgkmcnt(10)
    v_mfma_f32_32x32x16_bf16 a[16:31], v[44:47], a[76:79], a[16:31]
    ds_read_b64_tr_b16 v[36:37], v22 offset:32768
    ds_read_b64_tr_b16 v[38:39], v22 offset:33792
    s_add_u32 m0, s48, 1024
    s_add_u32 s34, s53, 768
    buffer_load_dwordx4 v4, s[4:7], s34 offen lds
    s_waitcnt lgkmcnt(9)
    v_mfma_f32_32x32x16_bf16 a[32:47], v[48:51], a[76:79], a[32:47]
    ds_read_b64_tr_b16 v[40:41], v23 offset:32768
    ds_read_b64_tr_b16 v[42:43], v23 offset:33792
    s_add_u32 m0, s48, 2048
    s_add_u32 s34, s54, 768
    buffer_load_dwordx4 v3, s[4:7], s34 offen lds
    s_waitcnt lgkmcnt(8)
    v_mfma_f32_32x32x16_bf16 a[48:63], v[52:55], a[76:79], a[48:63]
    ds_read_b64_tr_b16 v[44:45], v20 offset:49152
    ds_read_b64_tr_b16 v[46:47], v20 offset:50176
    s_add_u32 m0, s48, 3072
    s_add_u32 s34, s55, 768
    buffer_load_dwordx4 v4, s[4:7], s34 offen lds
    s_waitcnt vmcnt(12)
    s_barrier
    s_waitcnt lgkmcnt(8)
    v_mfma_f32_32x32x16_bf16 v[64:79], v[56:59], a[80:83], v[64:79]
    ds_read_b64_tr_b16 v[48:49], v21 offset:49152
    ds_read_b64_tr_b16 v[50:51], v21 offset:50176
    s_waitcnt lgkmcnt(8)
    v_mfma_f32_32x32x16_bf16 v[80:95], v[32:35], a[80:83], v[80:95]
    ds_read_b64_tr_b16 v[52:53], v22 offset:49152
    ds_read_b64_tr_b16 v[54:55], v22 offset:50176
    s_waitcnt lgkmcnt(8)
    v_mfma_f32_32x32x16_bf16 v[96:111], v[36:39], a[80:83], v[96:111]
    ds_read_b64_tr_b16 v[56:57], v23 offset:49152
    ds_read_b64_tr_b16 v[58:59], v23 offset:50176
    s_waitcnt lgkmcnt(8)
    v_mfma_f32_32x32x16_bf16 v[112:127], v[40:43], a[80:83], v[112:127]
    ds_read_b64_tr_b16 v[32:33], v20 offset:36864
    ds_read_b64_tr_b16 v[34:35], v20 offset:37888
    s_add_u32 m0, s42, 0
    s_add_u32 s34, s26, 0
    buffer_load_dwordx4 v8, s[12:15], s34 offen nt lds
    s_waitcnt lgkmcnt(8)
    v_mfma_f32_32x32x16_bf16 a[0:15], v[44:47], a[80:83], a[0:15]
    ds_read_b64_tr_b16 v[36:37], v21 offset:36864
    ds_read_b64_tr_b16 v[38:39], v21 offset:37888
    s_waitcnt lgkmcnt(8)
    v_mfma_f32_32x32x16_bf16 a[16:31], v[48:51], a[80:83], a[16:31]
    ds_read_b64_tr_b16 v[40:41], v22 offset:36864
    ds_read_b64_tr_b16 v[42:43], v22 offset:37888
    s_waitcnt lgkmcnt(8)
    v_mfma_f32_32x32x16_bf16 a[32:47], v[52:55], a[80:83], a[32:47]
    ds_read_b64_tr_b16 v[44:45], v23 offset:36864
    ds_read_b64_tr_b16 v[46:47], v23 offset:37888
    s_add_u32 m0, s42, 8192
    s_add_u32 s34, s26, 8192
    buffer_load_dwordx4 v8, s[12:15], s34 offen nt lds
    s_waitcnt lgkmcnt(8)
    v_mfma_f32_32x32x16_bf16 a[48:63], v[56:59], a[80:83], a[48:63]
    ds_read_b64_tr_b16 v[48:49], v20 offset:53248
    ds_read_b64_tr_b16 v[50:51], v20 offset:54272
    s_waitcnt lgkmcnt(8)
    v_mfma_f32_32x32x16_bf16 v[64:79], v[32:35], a[84:87], v[64:79]
    ds_read_b64_tr_b16 v[52:53], v21 offset:53248
    ds_read_b64_tr_b16 v[54:55], v21 offset:54272
    s_waitcnt lgkmcnt(8)
    v_mfma_f32_32x32x16_bf16 v[80:95], v[36:39], a[84:87], v[80:95]
    ds_read_b64_tr_b16 v[56:57], v22 offset:53248
    ds_read_b64_tr_b16 v[58:59], v22 offset:54272
    s_add_u32 m0, s42, 16384
    s_add_u32 s34, s26, 16384
    buffer_load_dwordx4 v8, s[12:15], s34 offen nt lds
    s_waitcnt lgkmcnt(8)
    v_mfma_f32_32x32x16_bf16 v[96:111], v[40:43], a[84:87], v[96:111]
    ds_read_b64_tr_b16 v[32:33], v23 offset:53248
    ds_read_b64_tr_b16 v[34:35], v23 offset:54272
    s_waitcnt lgkmcnt(8)
    v_mfma_f32_32x32x16_bf16 v[112:127], v[44:47], a[84:87], v[112:127]
    ds_read_b64_tr_b16 v[36:37], v20 offset:40960
    ds_read_b64_tr_b16 v[38:39], v20 offset:41984
    s_waitcnt lgkmcnt(8)
    v_mfma_f32_32x32x16_bf16 a[0:15], v[48:51], a[84:87], a[0:15]
    ds_read_b64_tr_b16 v[40:41], v21 offset:40960
    ds_read_b64_tr_b16 v[42:43], v21 offset:41984
    s_add_u32 m0, s42, 24576
    s_add_u32 s34, s26, 24576
    buffer_load_dwordx4 v8, s[12:15], s34 offen nt lds
    s_waitcnt lgkmcnt(8)
    v_mfma_f32_32x32x16_bf16 a[16:31], v[52:55], a[84:87], a[16:31]
    ds_read_b64_tr_b16 v[44:45], v22 offset:40960
    ds_read_b64_tr_b16 v[46:47], v22 offset:41984
    s_waitcnt lgkmcnt(8)
    v_mfma_f32_32x32x16_bf16 a[32:47], v[56:59], a[84:87], a[32:47]
    ds_read_b64_tr_b16 v[48:49], v23 offset:40960
    ds_read_b64_tr_b16 v[50:51], v23 offset:41984
    s_waitcnt lgkmcnt(8)
    v_mfma_f32_32x32x16_bf16 a[48:63], v[32:35], a[84:87], a[48:63]
    ds_read_b64_tr_b16 v[52:53], v20 offset:57344
    ds_read_b64_tr_b16 v[54:55], v20 offset:58368
    s_waitcnt lgkmcnt(8)
    v_mfma_f32_32x32x16_bf16 v[64:79], v[36:39], a[88:91], v[64:79]
    ds_read_b64_tr_b16 v[56:57], v21 offset:57344
    ds_read_b64_tr_b16 v[58:59], v21 offset:58368
    s_waitcnt lgkmcnt(8)
    v_mfma_f32_32x32x16_bf16 v[80:95], v[40:43], a[88:91], v[80:95]
    ds_read_b64_tr_b16 v[32:33], v22 offset:57344
    ds_read_b64_tr_b16 v[34:35], v22 offset:58368
    s_waitcnt lgkmcnt(8)
    v_mfma_f32_32x32x16_bf16 v[96:111], v[44:47], a[88:91], v[96:111]
    ds_read_b64_tr_b16 v[36:37], v23 offset:57344
    ds_read_b64_tr_b16 v[38:39], v23 offset:58368
    s_waitcnt lgkmcnt(8)
    v_mfma_f32_32x32x16_bf16 v[112:127], v[48:51], a[88:91], v[112:127]
    ds_read_b64_tr_b16 v[40:41], v20 offset:45056
    ds_read_b64_tr_b16 v[42:43], v20 offset:46080
    s_waitcnt lgkmcnt(8)
    v_mfma_f32_32x32x16_bf16 a[0:15], v[52:55], a[88:91], a[0:15]
    ds_read_b64_tr_b16 v[44:45], v21 offset:45056
    ds_read_b64_tr_b16 v[46:47], v21 offset:46080
    s_waitcnt lgkmcnt(8)
    v_mfma_f32_32x32x16_bf16 a[16:31], v[56:59], a[88:91], a[16:31]
    ds_read_b64_tr_b16 v[48:49], v22 offset:45056
    ds_read_b64_tr_b16 v[50:51], v22 offset:46080
    s_waitcnt lgkmcnt(8)
    v_mfma_f32_32x32x16_bf16 a[32:47], v[32:35], a[88:91], a[32:47]
    ds_read_b64_tr_b16 v[52:53], v23 offset:45056
    ds_read_b64_tr_b16 v[54:55], v23 offset:46080
    s_waitcnt vmcnt(4)
    ds_read_b128 a[64:67], v60
    s_waitcnt lgkmcnt(9)
    v_mfma_f32_32x32x16_bf16 a[48:63], v[36:39], a[88:91], a[48:63]
    ds_read_b64_tr_b16 v[56:57], v20 offset:61440
    ds_read_b64_tr_b16 v[58:59], v20 offset:62464
    ds_read_b128 a[68:71], v61
    s_waitcnt lgkmcnt(10)
    v_mfma_f32_32x32x16_bf16 v[64:79], v[40:43], a[92:95], v[64:79]
    ds_read_b64_tr_b16 v[32:33], v21 offset:61440
    ds_read_b64_tr_b16 v[34:35], v21 offset:62464
    ds_read_b128 a[72:75], v62
    s_waitcnt lgkmcnt(11)
    v_mfma_f32_32x32x16_bf16 v[80:95], v[44:47], a[92:95], v[80:95]
    ds_read_b64_tr_b16 v[36:37], v22 offset:61440
    ds_read_b64_tr_b16 v[38:39], v22 offset:62464
    ds_read_b128 a[76:79], v63
    s_waitcnt lgkmcnt(12)
    v_mfma_f32_32x32x16_bf16 v[96:111], v[48:51], a[92:95], v[96:111]
    ds_read_b64_tr_b16 v[40:41], v23 offset:61440
    ds_read_b64_tr_b16 v[42:43], v23 offset:62464
    s_waitcnt lgkmcnt(12)
    v_mfma_f32_32x32x16_bf16 v[112:127], v[52:55], a[92:95], v[112:127]
    v_add_u32 v20, 0x10000, v20
    v_add_u32 v21, 0x10000, v21
    v_add_u32 v22, 0x10000, v22
    v_add_u32 v23, 0x10000, v23
    ds_read_b64_tr_b16 v[44:45], v20 offset:0
    ds_read_b64_tr_b16 v[46:47], v20 offset:1024
    s_waitcnt lgkmcnt(11)
    v_mfma_f32_32x32x16_bf16 a[0:15], v[56:59], a[92:95], a[0:15]
    ds_read_b64_tr_b16 v[48:49], v21 offset:0
    ds_read_b64_tr_b16 v[50:51], v21 offset:1024
    s_waitcnt lgkmcnt(6)
    s_add_u32 m0, s48, 0
    s_add_u32 s34, s52, 896
    buffer_load_dwordx4 v3, s[4:7], s34 offen lds
    s_waitcnt lgkmcnt(10)
    v_mfma_f32_32x32x16_bf16 a[16:31], v[32:35], a[92:95], a[16:31]
    ds_read_b64_tr_b16 v[52:53], v22 offset:0
    ds_read_b64_tr_b16 v[54:55], v22 offset:1024
    s_add_u32 m0, s48, 1024
    s_add_u32 s34, s53, 896
    buffer_load_dwordx4 v4, s[4:7], s34 offen lds
    s_waitcnt lgkmcnt(9)
    v_mfma_f32_32x32x16_bf16 a[32:47], v[36:39], a[92:95], a[32:47]
    ds_read_b64_tr_b16 v[56:57], v23 offset:0
    ds_read_b64_tr_b16 v[58:59], v23 offset:1024
    s_add_u32 m0, s48, 2048
    s_add_u32 s34, s54, 896
    buffer_load_dwordx4 v3, s[4:7], s34 offen lds
    s_waitcnt lgkmcnt(8)
    v_mfma_f32_32x32x16_bf16 a[48:63], v[40:43], a[92:95], a[48:63]
    ds_read_b64_tr_b16 v[32:33], v20 offset:16384
    ds_read_b64_tr_b16 v[34:35], v20 offset:17408
    s_add_u32 m0, s48, 3072
    s_add_u32 s34, s55, 896
    buffer_load_dwordx4 v4, s[4:7], s34 offen lds
    s_waitcnt vmcnt(12)
    s_barrier
    s_waitcnt lgkmcnt(8)
    v_mfma_f32_32x32x16_bf16 v[64:79], v[44:47], a[64:67], v[64:79]
    ds_read_b64_tr_b16 v[36:37], v21 offset:16384
    ds_read_b64_tr_b16 v[38:39], v21 offset:17408
    s_waitcnt lgkmcnt(8)
    v_mfma_f32_32x32x16_bf16 v[80:95], v[48:51], a[64:67], v[80:95]
    ds_read_b64_tr_b16 v[40:41], v22 offset:16384
    ds_read_b64_tr_b16 v[42:43], v22 offset:17408
    s_waitcnt lgkmcnt(8)
    v_mfma_f32_32x32x16_bf16 v[96:111], v[52:55], a[64:67], v[96:111]
    ds_read_b64_tr_b16 v[44:45], v23 offset:16384
    ds_read_b64_tr_b16 v[46:47], v23 offset:17408
    s_waitcnt lgkmcnt(8)
    v_mfma_f32_32x32x16_bf16 v[112:127], v[56:59], a[64:67], v[112:127]
    ds_read_b64_tr_b16 v[48:49], v20 offset:4096
    ds_read_b64_tr_b16 v[50:51], v20 offset:5120
    s_add_u32 m0, s42, 32768
    s_add_u32 s34, s26, 0
    buffer_load_dwordx4 v7, s[16:19], s34 offen nt lds
    s_waitcnt lgkmcnt(8)
    v_mfma_f32_32x32x16_bf16 a[0:15], v[32:35], a[64:67], a[0:15]
    ds_read_b64_tr_b16 v[52:53], v21 offset:4096
    ds_read_b64_tr_b16 v[54:55], v21 offset:5120
    s_waitcnt lgkmcnt(8)
    v_mfma_f32_32x32x16_bf16 a[16:31], v[36:39], a[64:67], a[16:31]
    ds_read_b64_tr_b16 v[56:57], v22 offset:4096
    ds_read_b64_tr_b16 v[58:59], v22 offset:5120
    s_waitcnt lgkmcnt(8)
    v_mfma_f32_32x32x16_bf16 a[32:47], v[40:43], a[64:67], a[32:47]
    ds_read_b64_tr_b16 v[32:33], v23 offset:4096
    ds_read_b64_tr_b16 v[34:35], v23 offset:5120
    s_add_u32 m0, s42, 40960
    s_add_u32 s34, s26, 8192
    buffer_load_dwordx4 v7, s[16:19], s34 offen nt lds
    s_waitcnt lgkmcnt(8)
    v_mfma_f32_32x32x16_bf16 a[48:63], v[44:47], a[64:67], a[48:63]
    ds_read_b64_tr_b16 v[36:37], v20 offset:20480
    ds_read_b64_tr_b16 v[38:39], v20 offset:21504
    s_waitcnt lgkmcnt(8)
    v_mfma_f32_32x32x16_bf16 v[64:79], v[48:51], a[68:71], v[64:79]
    ds_read_b64_tr_b16 v[40:41], v21 offset:20480
    ds_read_b64_tr_b16 v[42:43], v21 offset:21504
    s_waitcnt lgkmcnt(8)
    v_mfma_f32_32x32x16_bf16 v[80:95], v[52:55], a[68:71], v[80:95]
    ds_read_b64_tr_b16 v[44:45], v22 offset:20480
    ds_read_b64_tr_b16 v[46:47], v22 offset:21504
    s_add_u32 m0, s42, 49152
    s_add_u32 s34, s26, 32768
    buffer_load_dwordx4 v8, s[12:15], s34 offen nt lds
    s_waitcnt lgkmcnt(8)
    v_mfma_f32_32x32x16_bf16 v[96:111], v[56:59], a[68:71], v[96:111]
    ds_read_b64_tr_b16 v[48:49], v23 offset:20480
    ds_read_b64_tr_b16 v[50:51], v23 offset:21504
    s_waitcnt lgkmcnt(8)
    v_mfma_f32_32x32x16_bf16 v[112:127], v[32:35], a[68:71], v[112:127]
    ds_read_b64_tr_b16 v[52:53], v20 offset:8192
    ds_read_b64_tr_b16 v[54:55], v20 offset:9216
    s_waitcnt lgkmcnt(8)
    v_mfma_f32_32x32x16_bf16 a[0:15], v[36:39], a[68:71], a[0:15]
    ds_read_b64_tr_b16 v[56:57], v21 offset:8192
    ds_read_b64_tr_b16 v[58:59], v21 offset:9216
    s_add_u32 m0, s42, 57344
    s_add_u32 s34, s26, 40960
    buffer_load_dwordx4 v8, s[12:15], s34 offen nt lds
    s_waitcnt lgkmcnt(8)
    v_mfma_f32_32x32x16_bf16 a[16:31], v[40:43], a[68:71], a[16:31]
    ds_read_b64_tr_b16 v[32:33], v22 offset:8192
    ds_read_b64_tr_b16 v[34:35], v22 offset:9216
    s_waitcnt lgkmcnt(8)
    v_mfma_f32_32x32x16_bf16 a[32:47], v[44:47], a[68:71], a[32:47]
    ds_read_b64_tr_b16 v[36:37], v23 offset:8192
    ds_read_b64_tr_b16 v[38:39], v23 offset:9216
    s_waitcnt lgkmcnt(8)
    v_mfma_f32_32x32x16_bf16 a[48:63], v[48:51], a[68:71], a[48:63]
    ds_read_b64_tr_b16 v[40:41], v20 offset:24576
    ds_read_b64_tr_b16 v[42:43], v20 offset:25600
    s_waitcnt lgkmcnt(8)
    v_mfma_f32_32x32x16_bf16 v[64:79], v[52:55], a[72:75], v[64:79]
    ds_read_b64_tr_b16 v[44:45], v21 offset:24576
    ds_read_b64_tr_b16 v[46:47], v21 offset:25600
    s_waitcnt lgkmcnt(8)
    v_mfma_f32_32x32x16_bf16 v[80:95], v[56:59], a[72:75], v[80:95]
    ds_read_b64_tr_b16 v[48:49], v22 offset:24576
    ds_read_b64_tr_b16 v[50:51], v22 offset:25600
    s_waitcnt lgkmcnt(8)
    v_mfma_f32_32x32x16_bf16 v[96:111], v[32:35], a[72:75], v[96:111]
    ds_read_b64_tr_b16 v[52:53], v23 offset:24576
    ds_read_b64_tr_b16 v[54:55], v23 offset:25600
    s_waitcnt lgkmcnt(8)
    v_mfma_f32_32x32x16_bf16 v[112:127], v[36:39], a[72:75], v[112:127]
    ds_read_b64_tr_b16 v[56:57], v20 offset:12288
    ds_read_b64_tr_b16 v[58:59], v20 offset:13312
    s_waitcnt lgkmcnt(8)
    v_mfma_f32_32x32x16_bf16 a[0:15], v[40:43], a[72:75], a[0:15]
    ds_read_b64_tr_b16 v[32:33], v21 offset:12288
    ds_read_b64_tr_b16 v[34:35], v21 offset:13312
    s_waitcnt lgkmcnt(8)
    v_mfma_f32_32x32x16_bf16 a[16:31], v[44:47], a[72:75], a[16:31]
    ds_read_b64_tr_b16 v[36:37], v22 offset:12288
    ds_read_b64_tr_b16 v[38:39], v22 offset:13312
    s_waitcnt lgkmcnt(8)
    v_mfma_f32_32x32x16_bf16 a[32:47], v[48:51], a[72:75], a[32:47]
    ds_read_b64_tr_b16 v[40:41], v23 offset:12288
    ds_read_b64_tr_b16 v[42:43], v23 offset:13312
    s_waitcnt vmcnt(4)
    ds_read_b128 a[80:83], v60
    s_waitcnt lgkmcnt(9)
    v_mfma_f32_32x32x16_bf16 a[48:63], v[52:55], a[72:75], a[48:63]
    ds_read_b64_tr_b16 v[44:45], v20 offset:28672
    ds_read_b64_tr_b16 v[46:47], v20 offset:29696
    ds_read_b128 a[84:87], v61
    s_waitcnt lgkmcnt(10)
    v_mfma_f32_32x32x16_bf16 v[64:79], v[56:59], a[76:79], v[64:79]
    ds_read_b64_tr_b16 v[48:49], v21 offset:28672
    ds_read_b64_tr_b16 v[50:51], v21 offset:29696
    ds_read_b128 a[88:91], v62
    s_waitcnt lgkmcnt(11)
    v_mfma_f32_32x32x16_bf16 v[80:95], v[32:35], a[76:79], v[80:95]
    ds_read_b64_tr_b16 v[52:53], v22 offset:28672
    ds_read_b64_tr_b16 v[54:55], v22 offset:29696
    ds_read_b128 a[92:95], v63
    s_waitcnt lgkmcnt(12)
    v_mfma_f32_32x32x16_bf16 v[96:111], v[36:39], a[76:79], v[96:111]
    ds_read_b64_tr_b16 v[56:57], v23 offset:28672
    ds_read_b64_tr_b16 v[58:59], v23 offset:29696
    s_waitcnt lgkmcnt(12)
    v_mfma_f32_32x32x16_bf16 v[112:127], v[40:43], a[76:79], v[112:127]
    ds_read_b64_tr_b16 v[32:33], v20 offset:32768
    ds_read_b64_tr_b16 v[34:35], v20 offset:33792
    s_waitcnt lgkmcnt(11)
    v_mfma_f32_32x32x16_bf16 a[0:15], v[44:47], a[76:79], a[0:15]
    ds_read_b64_tr_b16 v[36:37], v21 offset:32768
    ds_read_b64_tr_b16 v[38:39], v21 offset:33792
    s_waitcnt lgkmcnt(10)
    v_mfma_f32_32x32x16_bf16 a[16:31], v[48:51], a[76:79], a[16:31]
    ds_read_b64_tr_b16 v[40:41], v22 offset:32768
    ds_read_b64_tr_b16 v[42:43], v22 offset:33792
    s_waitcnt lgkmcnt(9)
    v_mfma_f32_32x32x16_bf16 a[32:47], v[52:55], a[76:79], a[32:47]
    ds_read_b64_tr_b16 v[44:45], v23 offset:32768
    ds_read_b64_tr_b16 v[46:47], v23 offset:33792
    s_waitcnt lgkmcnt(8)
    v_mfma_f32_32x32x16_bf16 a[48:63], v[56:59], a[76:79], a[48:63]
    ds_read_b64_tr_b16 v[48:49], v20 offset:49152
    ds_read_b64_tr_b16 v[50:51], v20 offset:50176
    s_waitcnt vmcnt(10)
    s_barrier
    s_waitcnt lgkmcnt(8)
    v_mfma_f32_32x32x16_bf16 v[64:79], v[32:35], a[80:83], v[64:79]
    ds_read_b64_tr_b16 v[52:53], v21 offset:49152
    ds_read_b64_tr_b16 v[54:55], v21 offset:50176
    s_waitcnt lgkmcnt(8)
    v_mfma_f32_32x32x16_bf16 v[80:95], v[36:39], a[80:83], v[80:95]
    ds_read_b64_tr_b16 v[56:57], v22 offset:49152
    ds_read_b64_tr_b16 v[58:59], v22 offset:50176
    s_waitcnt lgkmcnt(8)
    v_mfma_f32_32x32x16_bf16 v[96:111], v[40:43], a[80:83], v[96:111]
    ds_read_b64_tr_b16 v[32:33], v23 offset:49152
    ds_read_b64_tr_b16 v[34:35], v23 offset:50176
    s_waitcnt lgkmcnt(8)
    v_mfma_f32_32x32x16_bf16 v[112:127], v[44:47], a[80:83], v[112:127]
    ds_read_b64_tr_b16 v[36:37], v20 offset:36864
    ds_read_b64_tr_b16 v[38:39], v20 offset:37888
    s_add_u32 m0, s42, 65536
    s_add_u32 s34, s26, 16384
    buffer_load_dwordx4 v7, s[16:19], s34 offen nt lds
    s_waitcnt lgkmcnt(8)
    v_mfma_f32_32x32x16_bf16 a[0:15], v[48:51], a[80:83], a[0:15]
    ds_read_b64_tr_b16 v[40:41], v21 offset:36864
    ds_read_b64_tr_b16 v[42:43], v21 offset:37888
    s_waitcnt lgkmcnt(8)
    v_mfma_f32_32x32x16_bf16 a[16:31], v[52:55], a[80:83], a[16:31]
    ds_read_b64_tr_b16 v[44:45], v22 offset:36864
    ds_read_b64_tr_b16 v[46:47], v22 offset:37888
    s_waitcnt lgkmcnt(8)
    v_mfma_f32_32x32x16_bf16 a[32:47], v[56:59], a[80:83], a[32:47]
    ds_read_b64_tr_b16 v[48:49], v23 offset:36864
    ds_read_b64_tr_b16 v[50:51], v23 offset:37888
    s_add_u32 m0, s42, 73728
    s_add_u32 s34, s26, 24576
    buffer_load_dwordx4 v7, s[16:19], s34 offen nt lds
    s_waitcnt lgkmcnt(8)
    v_mfma_f32_32x32x16_bf16 a[48:63], v[32:35], a[80:83], a[48:63]
    ds_read_b64_tr_b16 v[52:53], v20 offset:53248
    ds_read_b64_tr_b16 v[54:55], v20 offset:54272
    s_waitcnt lgkmcnt(8)
    v_mfma_f32_32x32x16_bf16 v[64:79], v[36:39], a[84:87], v[64:79]
    ds_read_b64_tr_b16 v[56:57], v21 offset:53248
    ds_read_b64_tr_b16 v[58:59], v21 offset:54272
    s_waitcnt lgkmcnt(8)
    v_mfma_f32_32x32x16_bf16 v[80:95], v[40:43], a[84:87], v[80:95]
    ds_read_b64_tr_b16 v[32:33], v22 offset:53248
    ds_read_b64_tr_b16 v[34:35], v22 offset:54272
    s_add_u32 m0, s42, 81920
    s_add_u32 s34, s26, 49152
    buffer_load_dwordx4 v8, s[12:15], s34 offen nt lds
    s_waitcnt lgkmcnt(8)
    v_mfma_f32_32x32x16_bf16 v[96:111], v[44:47], a[84:87], v[96:111]
    ds_read_b64_tr_b16 v[36:37], v23 offset:53248
    ds_read_b64_tr_b16 v[38:39], v23 offset:54272
    s_waitcnt lgkmcnt(8)
    v_mfma_f32_32x32x16_bf16 v[112:127], v[48:51], a[84:87], v[112:127]
    ds_read_b64_tr_b16 v[40:41], v20 offset:40960
    ds_read_b64_tr_b16 v[42:43], v20 offset:41984
    s_waitcnt lgkmcnt(8)
    v_mfma_f32_32x32x16_bf16 a[0:15], v[52:55], a[84:87], a[0:15]
    ds_read_b64_tr_b16 v[44:45], v21 offset:40960
    ds_read_b64_tr_b16 v[46:47], v21 offset:41984
    s_add_u32 m0, s42, 90112
    s_add_u32 s34, s26, 57344
    buffer_load_dwordx4 v8, s[12:15], s34 offen nt lds
    s_waitcnt lgkmcnt(8)
    v_mfma_f32_32x32x16_bf16 a[16:31], v[56:59], a[84:87], a[16:31]
    ds_read_b64_tr_b16 v[48:49], v22 offset:40960
    ds_read_b64_tr_b16 v[50:51], v22 offset:41984
    s_waitcnt lgkmcnt(8)
    v_mfma_f32_32x32x16_bf16 a[32:47], v[32:35], a[84:87], a[32:47]
    ds_read_b64_tr_b16 v[52:53], v23 offset:40960
    ds_read_b64_tr_b16 v[54:55], v23 offset:41984
    s_waitcnt lgkmcnt(8)
    v_mfma_f32_32x32x16_bf16 a[48:63], v[36:39], a[84:87], a[48:63]
    ds_read_b64_tr_b16 v[56:57], v20 offset:57344
    ds_read_b64_tr_b16 v[58:59], v20 offset:58368
    s_waitcnt lgkmcnt(8)
    v_mfma_f32_32x32x16_bf16 v[64:79], v[40:43], a[88:91], v[64:79]
    ds_read_b64_tr_b16 v[32:33], v21 offset:57344
    ds_read_b64_tr_b16 v[34:35], v21 offset:58368
    s_waitcnt lgkmcnt(8)
    v_mfma_f32_32x32x16_bf16 v[80:95], v[44:47], a[88:91], v[80:95]
    ds_read_b64_tr_b16 v[36:37], v22 offset:57344
    ds_read_b64_tr_b16 v[38:39], v22 offset:58368
    s_waitcnt lgkmcnt(8)
    v_mfma_f32_32x32x16_bf16 v[96:111], v[48:51], a[88:91], v[96:111]
    ds_read_b64_tr_b16 v[40:41], v23 offset:57344
    ds_read_b64_tr_b16 v[42:43], v23 offset:58368
    s_waitcnt lgkmcnt(8)
    v_mfma_f32_32x32x16_bf16 v[112:127], v[52:55], a[88:91], v[112:127]
    ds_read_b64_tr_b16 v[44:45], v20 offset:45056
    ds_read_b64_tr_b16 v[46:47], v20 offset:46080
    s_waitcnt lgkmcnt(8)
    v_mfma_f32_32x32x16_bf16 a[0:15], v[56:59], a[88:91], a[0:15]
    ds_read_b64_tr_b16 v[48:49], v21 offset:45056
    ds_read_b64_tr_b16 v[50:51], v21 offset:46080
    s_waitcnt lgkmcnt(8)
    v_mfma_f32_32x32x16_bf16 a[16:31], v[32:35], a[88:91], a[16:31]
    ds_read_b64_tr_b16 v[52:53], v22 offset:45056
    ds_read_b64_tr_b16 v[54:55], v22 offset:46080
    s_waitcnt lgkmcnt(8)
    v_mfma_f32_32x32x16_bf16 a[32:47], v[36:39], a[88:91], a[32:47]
    ds_read_b64_tr_b16 v[56:57], v23 offset:45056
    ds_read_b64_tr_b16 v[58:59], v23 offset:46080
    s_waitcnt lgkmcnt(8)
    v_mfma_f32_32x32x16_bf16 a[48:63], v[40:43], a[88:91], a[48:63]
    ds_read_b64_tr_b16 v[32:33], v20 offset:61440
    ds_read_b64_tr_b16 v[34:35], v20 offset:62464
    s_waitcnt lgkmcnt(8)
    v_mfma_f32_32x32x16_bf16 v[64:79], v[44:47], a[92:95], v[64:79]
    ds_read_b64_tr_b16 v[36:37], v21 offset:61440
    ds_read_b64_tr_b16 v[38:39], v21 offset:62464
    s_waitcnt lgkmcnt(8)
    v_mfma_f32_32x32x16_bf16 v[80:95], v[48:51], a[92:95], v[80:95]
    ds_read_b64_tr_b16 v[40:41], v22 offset:61440
    ds_read_b64_tr_b16 v[42:43], v22 offset:62464
    s_waitcnt lgkmcnt(8)
    v_mfma_f32_32x32x16_bf16 v[96:111], v[52:55], a[92:95], v[96:111]
    ds_read_b64_tr_b16 v[44:45], v23 offset:61440
    ds_read_b64_tr_b16 v[46:47], v23 offset:62464
    s_waitcnt lgkmcnt(8)
    v_mfma_f32_32x32x16_bf16 v[112:127], v[56:59], a[92:95], v[112:127]
    ds_read_b128 v[48:51], v24 offset:0
    s_waitcnt lgkmcnt(7)
    v_mfma_f32_32x32x16_bf16 a[0:15], v[32:35], a[92:95], a[0:15]
    ds_read_b128 v[52:55], v25 offset:0
    s_waitcnt lgkmcnt(6)
    v_mfma_f32_32x32x16_bf16 a[16:31], v[36:39], a[92:95], a[16:31]
    ds_read_b128 v[56:59], v26 offset:0
    s_waitcnt lgkmcnt(5)
    v_mfma_f32_32x32x16_bf16 a[32:47], v[40:43], a[92:95], a[32:47]
    ds_read_b128 v[32:35], v27 offset:0
    s_waitcnt lgkmcnt(4)
    v_mfma_f32_32x32x16_bf16 a[48:63], v[44:47], a[92:95], a[48:63]
    ds_read_b128 v[36:39], v28 offset:0
    s_nop 7
    s_nop 7
    v_mov_b32 v60, 0x43800000
    v_pk_mul_f32 v[64:65], v[64:65], s[40:41]
    v_pk_mul_f32 v[66:67], v[66:67], s[40:41]
    v_pk_mul_f32 v[68:69], v[68:69], s[40:41]
    v_pk_mul_f32 v[70:71], v[70:71], s[40:41]
    v_pk_mul_f32 v[72:73], v[72:73], s[40:41]
    v_pk_mul_f32 v[74:75], v[74:75], s[40:41]
    v_pk_mul_f32 v[76:77], v[76:77], s[40:41]
    v_pk_mul_f32 v[78:79], v[78:79], s[40:41]
    v_cvt_pk_bf16_f32 v128, v64, v65
    v_cvt_pk_bf16_f32 v129, v66, v67
    v_cvt_pk_bf16_f32 v130, v68, v69
    v_cvt_pk_bf16_f32 v131, v70, v71
    v_cvt_pk_bf16_f32 v132, v72, v73
    v_cvt_pk_bf16_f32 v133, v74, v75
    v_cvt_pk_bf16_f32 v134, v76, v77
    v_cvt_pk_bf16_f32 v135, v78, v79
    v_pk_mul_f32 v[80:81], v[80:81], s[40:41]
    v_pk_mul_f32 v[82:83], v[82:83], s[40:41]
    v_pk_mul_f32 v[84:85], v[84:85], s[40:41]
    v_pk_mul_f32 v[86:87], v[86:87], s[40:41]
    v_pk_mul_f32 v[88:89], v[88:89], s[40:41]
    v_pk_mul_f32 v[90:91], v[90:91], s[40:41]
    v_pk_mul_f32 v[92:93], v[92:93], s[40:41]
    v_pk_mul_f32 v[94:95], v[94:95], s[40:41]
    v_cvt_pk_bf16_f32 v136, v80, v81
    v_cvt_pk_bf16_f32 v137, v82, v83
    v_cvt_pk_bf16_f32 v138, v84, v85
    v_cvt_pk_bf16_f32 v139, v86, v87
    v_cvt_pk_bf16_f32 v140, v88, v89
    v_cvt_pk_bf16_f32 v141, v90, v91
    v_cvt_pk_bf16_f32 v142, v92, v93
    v_cvt_pk_bf16_f32 v143, v94, v95
    v_pk_mul_f32 v[96:97], v[96:97], s[40:41]
    v_pk_mul_f32 v[98:99], v[98:99], s[40:41]
    v_pk_mul_f32 v[100:101], v[100:101], s[40:41]
    v_pk_mul_f32 v[102:103], v[102:103], s[40:41]
    v_pk_mul_f32 v[104:105], v[104:105], s[40:41]
    v_pk_mul_f32 v[106:107], v[106:107], s[40:41]
    v_pk_mul_f32 v[108:109], v[108:109], s[40:41]
    v_pk_mul_f32 v[110:111], v[110:111], s[40:41]
    v_cvt_pk_bf16_f32 v144, v96, v97
    v_cvt_pk_bf16_f32 v145, v98, v99
    v_cvt_pk_bf16_f32 v146, v100, v101
    v_cvt_pk_bf16_f32 v147, v102, v103
    v_cvt_pk_bf16_f32 v148, v104, v105
    v_cvt_pk_bf16_f32 v149, v106, v107
    v_cvt_pk_bf16_f32 v150, v108, v109
    v_cvt_pk_bf16_f32 v151, v110, v111
    v_pk_mul_f32 v[112:113], v[112:113], s[40:41]
    v_pk_mul_f32 v[114:115], v[114:115], s[40:41]
    v_pk_mul_f32 v[116:117], v[116:117], s[40:41]
    v_pk_mul_f32 v[118:119], v[118:119], s[40:41]
    v_pk_mul_f32 v[120:121], v[120:121], s[40:41]
    v_pk_mul_f32 v[122:123], v[122:123], s[40:41]
    v_pk_mul_f32 v[124:125], v[124:125], s[40:41]
    v_pk_mul_f32 v[126:127], v[126:127], s[40:41]
    v_cvt_pk_bf16_f32 v152, v112, v113
    v_cvt_pk_bf16_f32 v153, v114, v115
    v_cvt_pk_bf16_f32 v154, v116, v117
    v_cvt_pk_bf16_f32 v155, v118, v119
    v_cvt_pk_bf16_f32 v156, v120, v121
    v_cvt_pk_bf16_f32 v157, v122, v123
    v_cvt_pk_bf16_f32 v158, v124, v125
    v_cvt_pk_bf16_f32 v159, v126, v127
    s_waitcnt vmcnt(6)
    s_barrier
    s_nop 1
    s_waitcnt lgkmcnt(4)
    v_mfma_f32_32x32x16_bf16 v[64:79], v[48:51], v[128:131], 0
    ds_read_b128 v[40:43], v29 offset:0
    v_accvgpr_read_b32 v104, a0
    v_accvgpr_read_b32 v105, a1
    v_mul_f32 v104, s40, v104
    v_mul_f32 v105, s40, v105
    v_cvt_pk_bf16_f32 v104, v104, v105
    v_accvgpr_write_b32 a64, v104
    s_waitcnt lgkmcnt(4)
    v_mfma_f32_32x32x16_bf16 v[64:79], v[52:55], v[132:135], v[64:79]
    ds_read_b128 v[44:47], v30 offset:0
    s_add_u32 m0, s42, 98304
    s_add_u32 s34, s26, 32768
    buffer_load_dwordx4 v7, s[16:19], s34 offen nt lds
    s_add_u32 m0, s42, 106496
    s_add_u32 s34, s26, 40960
    buffer_load_dwordx4 v7, s[16:19], s34 offen nt lds
    v_accvgpr_read_b32 v106, a2
    v_accvgpr_read_b32 v107, a3
    v_mul_f32 v106, s40, v106
    v_mul_f32 v107, s40, v107
    v_cvt_pk_bf16_f32 v106, v106, v107
    v_accvgpr_write_b32 a65, v106
    s_waitcnt lgkmcnt(4)
    v_mfma_f32_32x32x16_bf16 v[64:79], v[56:59], v[136:139], v[64:79]
    ds_read_b128 v[48:51], v31 offset:0
    s_add_u32 m0, s42, 114688
    s_add_u32 s34, s26, 65536
    buffer_load_dwordx4 v8, s[12:15], s34 offen nt lds
    v_accvgpr_read_b32 v108, a4
    v_accvgpr_read_b32 v109, a5
    v_mul_f32 v108, s40, v108
    v_mul_f32 v109, s40, v109
    v_cvt_pk_bf16_f32 v108, v108, v109
    v_accvgpr_write_b32 a66, v108
    s_waitcnt lgkmcnt(4)
    v_mfma_f32_32x32x16_bf16 v[64:79], v[32:35], v[140:143], v[64:79]
    ds_read_b128 v[52:55], v24 offset:8192
    s_add_u32 m0, s42, 122880
    s_add_u32 s34, s26, 73728
    buffer_load_dwordx4 v8, s[12:15], s34 offen nt lds
    v_accvgpr_read_b32 v110, a6
    v_accvgpr_read_b32 v111, a7
    v_mul_f32 v110, s40, v110
    v_mul_f32 v111, s40, v111
    v_cvt_pk_bf16_f32 v110, v110, v111
    v_accvgpr_write_b32 a67, v110
    s_waitcnt lgkmcnt(4)
    v_mfma_f32_32x32x16_bf16 v[64:79], v[36:39], v[144:147], v[64:79]
    ds_read_b128 v[56:59], v25 offset:8192
    s_add_u32 m0, s42, 131072
    s_add_u32 s34, s26, 49152
    buffer_load_dwordx4 v7, s[16:19], s34 offen nt lds
    v_accvgpr_read_b32 v104, a8
    v_accvgpr_read_b32 v105, a9
    v_mul_f32 v104, s40, v104
    v_mul_f32 v105, s40, v105
    v_cvt_pk_bf16_f32 v104, v104, v105
    v_accvgpr_write_b32 a68, v104
    s_waitcnt lgkmcnt(4)
    v_mfma_f32_32x32x16_bf16 v[64:79], v[40:43], v[148:151], v[64:79]
    ds_read_b128 v[32:35], v26 offset:8192
    s_add_u32 m0, s42, 139264
    s_add_u32 s34, s26, 57344
    buffer_load_dwordx4 v7, s[16:19], s34 offen nt lds
    v_accvgpr_read_b32 v106, a10
    v_accvgpr_read_b32 v107, a11
    v_mul_f32 v106, s40, v106
    v_mul_f32 v107, s40, v107
    v_cvt_pk_bf16_f32 v106, v106, v107
    v_accvgpr_write_b32 a69, v106
    s_waitcnt lgkmcnt(4)
    v_mfma_f32_32x32x16_bf16 v[64:79], v[44:47], v[152:155], v[64:79]
    ds_read_b128 v[36:39], v27 offset:8192
    s_add_u32 m0, s42, 147456
    s_add_u32 s34, s26, 81920
    buffer_load_dwordx4 v8, s[12:15], s34 offen nt lds
    v_accvgpr_read_b32 v108, a12
    v_accvgpr_read_b32 v109, a13
    v_mul_f32 v108, s40, v108
    v_mul_f32 v109, s40, v109
    v_cvt_pk_bf16_f32 v108, v108, v109
    v_accvgpr_write_b32 a70, v108
    s_waitcnt lgkmcnt(4)
    v_mfma_f32_32x32x16_bf16 v[64:79], v[48:51], v[156:159], v[64:79]
    ds_read_b128 v[40:43], v28 offset:8192
    s_add_u32 m0, s42, 155648
    s_add_u32 s34, s26, 90112
    buffer_load_dwordx4 v8, s[12:15], s34 offen nt lds
    v_accvgpr_read_b32 v110, a14
    v_accvgpr_read_b32 v111, a15
    v_mul_f32 v110, s40, v110
    v_mul_f32 v111, s40, v111
    v_cvt_pk_bf16_f32 v110, v110, v111
    v_accvgpr_write_b32 a71, v110
    v_accvgpr_read_b32 v104, a16
    v_accvgpr_read_b32 v105, a17
    v_mul_f32 v104, s40, v104
    v_mul_f32 v105, s40, v105
    v_cvt_pk_bf16_f32 v104, v104, v105
    v_accvgpr_write_b32 a72, v104
    v_accvgpr_read_b32 v106, a18
    v_accvgpr_read_b32 v107, a19
    v_mul_f32 v106, s40, v106
    v_mul_f32 v107, s40, v107
    v_cvt_pk_bf16_f32 v106, v106, v107
    v_accvgpr_write_b32 a73, v106
    v_accvgpr_read_b32 v108, a20
    v_accvgpr_read_b32 v109, a21
    v_mul_f32 v108, s40, v108
    v_mul_f32 v109, s40, v109
    v_cvt_pk_bf16_f32 v108, v108, v109
    v_accvgpr_write_b32 a74, v108
    v_accvgpr_read_b32 v110, a22
    v_accvgpr_read_b32 v111, a23
    v_mul_f32 v110, s40, v110
    v_mul_f32 v111, s40, v111
    v_cvt_pk_bf16_f32 v110, v110, v111
    v_accvgpr_write_b32 a75, v110
    v_accvgpr_read_b32 v104, a24
    v_accvgpr_read_b32 v105, a25
    v_mul_f32 v104, s40, v104
    v_mul_f32 v105, s40, v105
    v_cvt_pk_bf16_f32 v104, v104, v105
    v_accvgpr_write_b32 a76, v104
    v_accvgpr_read_b32 v106, a26
    v_accvgpr_read_b32 v107, a27
    v_mul_f32 v106, s40, v106
    v_mul_f32 v107, s40, v107
    v_cvt_pk_bf16_f32 v106, v106, v107
    v_accvgpr_write_b32 a77, v106
    v_accvgpr_read_b32 v108, a28
    v_accvgpr_read_b32 v109, a29
    v_mul_f32 v108, s40, v108
    v_mul_f32 v109, s40, v109
    v_cvt_pk_bf16_f32 v108, v108, v109
    v_accvgpr_write_b32 a78, v108
    v_accvgpr_read_b32 v110, a30
    v_accvgpr_read_b32 v111, a31
    v_mul_f32 v110, s40, v110
    v_mul_f32 v111, s40, v111
    v_cvt_pk_bf16_f32 v110, v110, v111
    v_accvgpr_write_b32 a79, v110
    s_nop 7
    v_max3_f32 v16, v64, v65, v66
    v_max3_f32 v16, v16, v67, v68
    v_max3_f32 v16, v16, v69, v70
    v_max3_f32 v16, v16, v71, v72
    v_max3_f32 v16, v16, v73, v74
    v_max3_f32 v16, v16, v75, v76
    v_max3_f32 v16, v16, v77, v78
    v_max_f32 v16, v16, v79
    v_mov_b32 v17, v16
    s_nop 1
    v_permlane32_swap_b32 v16, v17
    s_nop 1
    v_max_f32 v16, v16, v17
    v_sub_f32 v13, 0, v16
    v_mov_b32 v112, v13
    v_mov_b32 v113, v13
    v_mov_b32 v114, v13
    v_mov_b32 v115, v13
    v_mov_b32 v116, v13
    v_mov_b32 v117, v13
    v_mov_b32 v118, v13
    v_mov_b32 v119, v13
    v_mov_b32 v120, v13
    v_mov_b32 v121, v13
    v_mov_b32 v122, v13
    v_mov_b32 v123, v13
    v_mov_b32 v124, v13
    v_mov_b32 v125, v13
    v_mov_b32 v126, v13
    v_mov_b32 v127, v13
    v_add_f32 v64, v64, v13
    v_add_f32 v65, v65, v13
    v_add_f32 v66, v66, v13
    v_add_f32 v67, v67, v13
    v_add_f32 v68, v68, v13
    v_add_f32 v69, v69, v13
    v_add_f32 v70, v70, v13
    v_add_f32 v71, v71, v13
    v_add_f32 v72, v72, v13
    v_add_f32 v73, v73, v13
    v_add_f32 v74, v74, v13
    v_add_f32 v75, v75, v13
    v_add_f32 v76, v76, v13
    v_add_f32 v77, v77, v13
    v_add_f32 v78, v78, v13
    v_add_f32 v79, v79, v13
    s_waitcnt lgkmcnt(4)
    v_mfma_f32_32x32x16_bf16 v[80:95], v[52:55], v[128:131], v[112:127]
    ds_read_b128 v[44:47], v29 offset:8192
    v_exp_f32 v16, v64
    v_exp_f32 v17, v65
    v_exp_f32 v18, v66
    v_exp_f32 v19, v67
    v_mov_b32 v14, v16
    v_mov_b32 v15, v17
    s_waitcnt lgkmcnt(4)
    v_mfma_f32_32x32x16_bf16 v[80:95], v[56:59], v[132:135], v[80:95]
    ds_read_b128 v[48:51], v30 offset:8192
    v_cvt_pk_bf16_f32 v96, v16, v17
    v_exp_f32 v16, v68
    v_exp_f32 v17, v69
    v_add_f32 v14, v14, v18
    v_add_f32 v15, v15, v19
    v_cvt_pk_bf16_f32 v97, v18, v19
    v_exp_f32 v18, v70
    s_waitcnt lgkmcnt(4)
    v_mfma_f32_32x32x16_bf16 v[80:95], v[32:35], v[136:139], v[80:95]
    ds_read_b128 v[52:55], v31 offset:8192
    v_exp_f32 v19, v71
    v_add_f32 v14, v14, v16
    v_add_f32 v15, v15, v17
    v_cvt_pk_bf16_f32 v98, v16, v17
    v_exp_f32 v16, v72
    v_exp_f32 v17, v73
    v_add_f32 v14, v14, v18
    s_waitcnt lgkmcnt(4)
    v_mfma_f32_32x32x16_bf16 v[80:95], v[36:39], v[140:143], v[80:95]
    ds_read_b128 v[56:59], v24 offset:16384
    v_add_f32 v15, v15, v19
    v_cvt_pk_bf16_f32 v99, v18, v19
    v_exp_f32 v18, v74
    v_exp_f32 v19, v75
    v_add_f32 v14, v14, v16
    v_add_f32 v15, v15, v17
    v_cvt_pk_bf16_f32 v100, v16, v17
    v_exp_f32 v16, v76
    s_waitcnt lgkmcnt(4)
    v_mfma_f32_32x32x16_bf16 v[80:95], v[40:43], v[144:147], v[80:95]
    ds_read_b128 v[32:35], v25 offset:16384
    v_exp_f32 v17, v77
    v_add_f32 v14, v14, v18
    v_add_f32 v15, v15, v19
    v_cvt_pk_bf16_f32 v101, v18, v19
    v_exp_f32 v18, v78
    v_exp_f32 v19, v79
    v_add_f32 v14, v14, v16
    s_waitcnt lgkmcnt(4)
    v_mfma_f32_32x32x16_bf16 v[80:95], v[44:47], v[148:151], v[80:95]
    ds_read_b128 v[36:39], v26 offset:16384
    v_add_f32 v15, v15, v17
    v_cvt_pk_bf16_f32 v102, v16, v17
    s_nop 0
    v_add_f32 v14, v14, v18
    v_add_f32 v15, v15, v19
    v_cvt_pk_bf16_f32 v103, v18, v19
    v_add_f32 v14, v14, v15
    v_accvgpr_read_b32 v104, a32
    v_accvgpr_read_b32 v105, a33
    v_mul_f32 v104, s40, v104
    v_mul_f32 v105, s40, v105
    v_cvt_pk_bf16_f32 v104, v104, v105
    v_accvgpr_write_b32 a80, v104
    s_waitcnt lgkmcnt(4)
    v_mfma_f32_32x32x16_bf16 v[80:95], v[48:51], v[152:155], v[80:95]
    ds_read_b128 v[40:43], v27 offset:16384
    v_accvgpr_read_b32 v106, a34
    v_accvgpr_read_b32 v107, a35
    v_mul_f32 v106, s40, v106
    v_mul_f32 v107, s40, v107
    v_cvt_pk_bf16_f32 v106, v106, v107
    v_accvgpr_write_b32 a81, v106
    v_accvgpr_read_b32 v108, a36
    v_accvgpr_read_b32 v109, a37
    v_mul_f32 v108, s40, v108
    v_mul_f32 v109, s40, v109
    v_cvt_pk_bf16_f32 v108, v108, v109
    v_accvgpr_write_b32 a82, v108
    s_waitcnt lgkmcnt(4)
    v_mfma_f32_32x32x16_bf16 v[80:95], v[52:55], v[156:159], v[80:95]
    ds_read_b128 v[44:47], v28 offset:16384
    v_accvgpr_read_b32 v110, a38
    v_accvgpr_read_b32 v111, a39
    v_mul_f32 v110, s40, v110
    v_mul_f32 v111, s40, v111
    v_cvt_pk_bf16_f32 v110, v110, v111
    v_accvgpr_write_b32 a83, v110
    v_accvgpr_read_b32 v104, a40
    v_accvgpr_read_b32 v105, a41
    v_mul_f32 v104, s40, v104
    v_mul_f32 v105, s40, v105
    v_cvt_pk_bf16_f32 v104, v104, v105
    v_accvgpr_write_b32 a84, v104
    v_accvgpr_read_b32 v106, a42
    v_accvgpr_read_b32 v107, a43
    v_mul_f32 v106, s40, v106
    v_mul_f32 v107, s40, v107
    v_cvt_pk_bf16_f32 v106, v106, v107
    v_accvgpr_write_b32 a85, v106
    v_accvgpr_read_b32 v108, a44
    v_accvgpr_read_b32 v109, a45
    v_mul_f32 v108, s40, v108
    v_mul_f32 v109, s40, v109
    v_cvt_pk_bf16_f32 v108, v108, v109
    v_accvgpr_write_b32 a86, v108
    v_accvgpr_read_b32 v110, a46
    v_accvgpr_read_b32 v111, a47
    v_mul_f32 v110, s40, v110
    v_mul_f32 v111, s40, v111
    v_cvt_pk_bf16_f32 v110, v110, v111
    v_accvgpr_write_b32 a87, v110
    v_accvgpr_read_b32 v104, a48
    v_accvgpr_read_b32 v105, a49
    v_mul_f32 v104, s40, v104
    v_mul_f32 v105, s40, v105
    v_cvt_pk_bf16_f32 v104, v104, v105
    v_accvgpr_write_b32 a88, v104
    v_accvgpr_read_b32 v106, a50
    v_accvgpr_read_b32 v107, a51
    v_mul_f32 v106, s40, v106
    v_mul_f32 v107, s40, v107
    v_cvt_pk_bf16_f32 v106, v106, v107
    v_accvgpr_write_b32 a89, v106
    v_accvgpr_read_b32 v108, a52
    v_accvgpr_read_b32 v109, a53
    v_mul_f32 v108, s40, v108
    v_mul_f32 v109, s40, v109
    v_cvt_pk_bf16_f32 v108, v108, v109
    v_accvgpr_write_b32 a90, v108
    v_accvgpr_read_b32 v110, a54
    v_accvgpr_read_b32 v111, a55
    v_mul_f32 v110, s40, v110
    v_mul_f32 v111, s40, v111
    v_cvt_pk_bf16_f32 v110, v110, v111
    v_accvgpr_write_b32 a91, v110
    v_accvgpr_read_b32 v104, a56
    v_accvgpr_read_b32 v105, a57
    v_mul_f32 v104, s40, v104
    v_mul_f32 v105, s40, v105
    v_cvt_pk_bf16_f32 v104, v104, v105
    v_accvgpr_write_b32 a92, v104
    v_accvgpr_read_b32 v106, a58
    v_accvgpr_read_b32 v107, a59
    v_mul_f32 v106, s40, v106
    v_mul_f32 v107, s40, v107
    v_cvt_pk_bf16_f32 v106, v106, v107
    v_accvgpr_write_b32 a93, v106
    v_accvgpr_read_b32 v108, a60
    v_accvgpr_read_b32 v109, a61
    v_mul_f32 v108, s40, v108
    v_mul_f32 v109, s40, v109
    v_cvt_pk_bf16_f32 v108, v108, v109
    v_accvgpr_write_b32 a94, v108
    v_accvgpr_read_b32 v110, a62
    v_accvgpr_read_b32 v111, a63
    v_mul_f32 v110, s40, v110
    v_mul_f32 v111, s40, v111
    v_cvt_pk_bf16_f32 v110, v110, v111
    v_accvgpr_write_b32 a95, v110
    v_mov_b32 v9, v14
    s_nop 7
    s_waitcnt vmcnt(10)
    s_barrier
    s_waitcnt lgkmcnt(4)
    v_mfma_f32_32x32x16_bf16 v[64:79], v[56:59], v[128:131], v[112:127]
    ds_read_b128 v[48:51], v29 offset:16384
    v_exp_f32 v16, v80
    v_exp_f32 v17, v81
    s_waitcnt lgkmcnt(4)
    v_mfma_f32_32x32x16_bf16 v[64:79], v[32:35], v[132:135], v[64:79]
    ds_read_b128 v[52:55], v30 offset:16384
    s_add_u32 m0, s42, 0
    s_add_u32 s34, s26, 65536
    buffer_load_dwordx4 v7, s[16:19], s34 offen nt lds
    v_exp_f32 v18, v82
    v_exp_f32 v19, v83
    s_waitcnt lgkmcnt(4)
    v_mfma_f32_32x32x16_bf16 v[64:79], v[36:39], v[136:139], v[64:79]
    ds_read_b128 v[56:59], v31 offset:16384
    v_mov_b32 v14, v16
    v_mov_b32 v15, v17
    v_cvt_pk_bf16_f32 v104, v16, v17
    s_waitcnt lgkmcnt(4)
    v_mfma_f32_32x32x16_bf16 v[64:79], v[40:43], v[140:143], v[64:79]
    v_add_u32 v20, 0xffff8000, v20
    v_add_u32 v21, 0xffff8000, v21
    v_add_u32 v22, 0xffff8000, v22
    v_add_u32 v23, 0xffff8000, v23
    ds_read_b64_tr_b16 v[32:33], v20 offset:0
    ds_read_b64_tr_b16 v[34:35], v20 offset:1024
    v_exp_f32 v16, v84
    v_exp_f32 v17, v85
    s_waitcnt lgkmcnt(5)
    v_mfma_f32_32x32x16_bf16 v[64:79], v[44:47], v[144:147], v[64:79]
    ds_read_b64_tr_b16 v[36:37], v20 offset:4096
    ds_read_b64_tr_b16 v[38:39], v20 offset:5120
    v_add_f32 v14, v14, v18
    v_add_f32 v15, v15, v19
    v_cvt_pk_bf16_f32 v105, v18, v19
    s_waitcnt lgkmcnt(6)
    v_mfma_f32_32x32x16_bf16 v[64:79], v[48:51], v[148:151], v[64:79]
    ds_read_b64_tr_b16 v[40:41], v21 offset:0
    ds_read_b64_tr_b16 v[42:43], v21 offset:1024
    v_exp_f32 v18, v86
    v_exp_f32 v19, v87
    s_waitcnt lgkmcnt(7)
    v_mfma_f32_32x32x16_bf16 v[64:79], v[52:55], v[152:155], v[64:79]
    ds_read_b64_tr_b16 v[44:45], v21 offset:4096
    ds_read_b64_tr_b16 v[46:47], v21 offset:5120
    v_add_f32 v14, v14, v16
    v_add_f32 v15, v15, v17
    v_cvt_pk_bf16_f32 v106, v16, v17
    s_waitcnt lgkmcnt(8)
    v_mfma_f32_32x32x16_bf16 v[64:79], v[56:59], v[156:159], v[64:79]
    ds_read_b64_tr_b16 v[48:49], v22 offset:0
    ds_read_b64_tr_b16 v[50:51], v22 offset:1024
    v_exp_f32 v16, v88
    v_exp_f32 v17, v89
    s_waitcnt lgkmcnt(8)
    v_mfma_f32_32x32x16_bf16 a[0:15], v[32:35], v[96:99], 0
    ds_read_b64_tr_b16 v[52:53], v22 offset:4096
    ds_read_b64_tr_b16 v[54:55], v22 offset:5120
    s_add_u32 m0, s42, 8192
    s_add_u32 s34, s26, 73728
    buffer_load_dwordx4 v7, s[16:19], s34 offen nt lds
    v_add_f32 v14, v14, v18
    v_add_f32 v15, v15, v19
    v_cvt_pk_bf16_f32 v107, v18, v19
    v_exp_f32 v18, v90
    s_waitcnt lgkmcnt(8)
    v_mfma_f32_32x32x16_bf16 a[0:15], v[36:39], v[100:103], a[0:15]
    ds_read_b64_tr_b16 v[56:57], v23 offset:0
    ds_read_b64_tr_b16 v[58:59], v23 offset:1024
    v_exp_f32 v19, v91
    v_add_f32 v14, v14, v16
    v_add_f32 v15, v15, v17
    s_waitcnt lgkmcnt(8)
    v_mfma_f32_32x32x16_bf16 a[16:31], v[40:43], v[96:99], 0
    ds_read_b64_tr_b16 v[32:33], v23 offset:4096
    ds_read_b64_tr_b16 v[34:35], v23 offset:5120
    v_cvt_pk_bf16_f32 v108, v16, v17
    v_exp_f32 v16, v92
    v_exp_f32 v17, v93
    s_waitcnt lgkmcnt(8)
    v_mfma_f32_32x32x16_bf16 a[16:31], v[44:47], v[100:103], a[16:31]
    ds_read_b128 v[36:39], v24 offset:24576
    v_add_f32 v14, v14, v18
    v_add_f32 v15, v15, v19
    v_cvt_pk_bf16_f32 v109, v18, v19
    v_exp_f32 v18, v94
    s_waitcnt lgkmcnt(7)
    v_mfma_f32_32x32x16_bf16 a[32:47], v[48:51], v[96:99], 0
    ds_read_b128 v[40:43], v25 offset:24576
    v_exp_f32 v19, v95
    v_add_f32 v14, v14, v16
    v_add_f32 v15, v15, v17
    s_waitcnt lgkmcnt(6)
    v_mfma_f32_32x32x16_bf16 a[32:47], v[52:55], v[100:103], a[32:47]
    ds_read_b128 v[44:47], v26 offset:24576
    v_cvt_pk_bf16_f32 v110, v16, v17
    s_nop 0
    v_add_f32 v14, v14, v18
    v_add_f32 v15, v15, v19
    s_waitcnt lgkmcnt(5)
    v_mfma_f32_32x32x16_bf16 a[48:63], v[56:59], v[96:99], 0
    ds_read_b128 v[48:51], v27 offset:24576
    v_cvt_pk_bf16_f32 v111, v18, v19
    v_add_f32 v14, v14, v15
    s_waitcnt lgkmcnt(4)
    v_mfma_f32_32x32x16_bf16 a[48:63], v[32:35], v[100:103], a[48:63]
    ds_read_b128 v[52:55], v28 offset:24576
    v_cmp_nle_f32 vcc, v14, v60
    s_cbranch_vccnz L_slow1
L_back1:
    v_add_f32 v9, v9, v14
    s_waitcnt lgkmcnt(4)
    v_mfma_f32_32x32x16_bf16 v[80:95], v[36:39], v[128:131], v[112:127]
    ds_read_b128 v[56:59], v29 offset:24576
    v_exp_f32 v16, v64
    v_exp_f32 v17, v65
    s_waitcnt lgkmcnt(4)
    v_mfma_f32_32x32x16_bf16 v[80:95], v[40:43], v[132:135], v[80:95]
    ds_read_b128 v[32:35], v30 offset:24576
    v_exp_f32 v18, v66
    v_exp_f32 v19, v67
    s_waitcnt lgkmcnt(4)
    v_mfma_f32_32x32x16_bf16 v[80:95], v[44:47], v[136:139], v[80:95]
    ds_read_b128 v[36:39], v31 offset:24576
    v_mov_b32 v14, v16
    v_mov_b32 v15, v17
    v_cvt_pk_bf16_f32 v96, v16, v17
    s_waitcnt lgkmcnt(4)
    v_mfma_f32_32x32x16_bf16 v[80:95], v[48:51], v[140:143], v[80:95]
    ds_read_b64_tr_b16 v[40:41], v20 offset:8192
    ds_read_b64_tr_b16 v[42:43], v20 offset:9216
    v_exp_f32 v16, v68
    v_exp_f32 v17, v69
    s_waitcnt lgkmcnt(5)
    v_mfma_f32_32x32x16_bf16 v[80:95], v[52:55], v[144:147], v[80:95]
    ds_read_b64_tr_b16 v[44:45], v20 offset:12288
    ds_read_b64_tr_b16 v[46:47], v20 offset:13312
    v_add_f32 v14, v14, v18
    v_add_f32 v15, v15, v19
    v_cvt_pk_bf16_f32 v97, v18, v19
    s_waitcnt lgkmcnt(6)
    v_mfma_f32_32x32x16_bf16 v[80:95], v[56:59], v[148:151], v[80:95]
    ds_read_b64_tr_b16 v[48:49], v21 offset:8192
    ds_read_b64_tr_b16 v[50:51], v21 offset:9216
    v_exp_f32 v18, v70
    v_exp_f32 v19, v71
    s_waitcnt lgkmcnt(7)
    v_mfma_f32_32x32x16_bf16 v[80:95], v[32:35], v[152:155], v[80:95]
    ds_read_b64_tr_b16 v[52:53], v21 offset:12288
    ds_read_b64_tr_b16 v[54:55], v21 offset:13312
    v_add_f32 v14, v14, v16
    v_add_f32 v15, v15, v17
    v_cvt_pk_bf16_f32 v98, v16, v17
    s_waitcnt lgkmcnt(8)
    v_mfma_f32_32x32x16_bf16 v[80:95], v[36:39], v[156:159], v[80:95]
    ds_read_b64_tr_b16 v[56:57], v22 offset:8192
    ds_read_b64_tr_b16 v[58:59], v22 offset:9216
    v_exp_f32 v16, v72
    v_exp_f32 v17, v73
    s_waitcnt lgkmcnt(8)
    v_mfma_f32_32x32x16_bf16 a[0:15], v[40:43], v[104:107], a[0:15]
    ds_read_b64_tr_b16 v[32:33], v22 offset:12288
    ds_read_b64_tr_b16 v[34:35], v22 offset:13312
    v_add_f32 v14, v14, v18
    v_add_f32 v15, v15, v19
    v_cvt_pk_bf16_f32 v99, v18, v19
    v_exp_f32 v18, v74
    s_waitcnt lgkmcnt(8)
    v_mfma_f32_32x32x16_bf16 a[0:15], v[44:47], v[108:111], a[0:15]
    ds_read_b64_tr_b16 v[36:37], v23 offset:8192
    ds_read_b64_tr_b16 v[38:39], v23 offset:9216
    v_exp_f32 v19, v75
    v_add_f32 v14, v14, v16
    v_add_f32 v15, v15, v17
    s_waitcnt lgkmcnt(8)
    v_mfma_f32_32x32x16_bf16 a[16:31], v[48:51], v[104:107], a[16:31]
    ds_read_b64_tr_b16 v[40:41], v23 offset:12288
    ds_read_b64_tr_b16 v[42:43], v23 offset:13312
    v_cvt_pk_bf16_f32 v100, v16, v17
    v_exp_f32 v16, v76
    v_exp_f32 v17, v77
    s_waitcnt lgkmcnt(8)
    v_mfma_f32_32x32x16_bf16 a[16:31], v[52:55], v[108:111], a[16:31]
    ds_read_b128 v[44:47], v24 offset:49152
    v_add_f32 v14, v14, v18
    v_add_f32 v15, v15, v19
    v_cvt_pk_bf16_f32 v101, v18, v19
    v_exp_f32 v18, v78
    s_waitcnt lgkmcnt(7)
    v_mfma_f32_32x32x16_bf16 a[32:47], v[56:59], v[104:107], a[32:47]
    ds_read_b128 v[48:51], v25 offset:49152
    v_exp_f32 v19, v79
    v_add_f32 v14, v14, v16
    v_add_f32 v15, v15, v17
    s_waitcnt lgkmcnt(6)
    v_mfma_f32_32x32x16_bf16 a[32:47], v[32:35], v[108:111], a[32:47]
    ds_read_b128 v[52:55], v26 offset:49152
    v_cvt_pk_bf16_f32 v102, v16, v17
    s_nop 0
    v_add_f32 v14, v14, v18
    v_add_f32 v15, v15, v19
    s_waitcnt lgkmcnt(5)
    v_mfma_f32_32x32x16_bf16 a[48:63], v[36:39], v[104:107], a[48:63]
    ds_read_b128 v[56:59], v27 offset:49152
    v_cvt_pk_bf16_f32 v103, v18, v19
    v_add_f32 v14, v14, v15
    s_waitcnt lgkmcnt(4)
    v_mfma_f32_32x32x16_bf16 a[48:63], v[40:43], v[108:111], a[48:63]
    ds_read_b128 v[32:35], v28 offset:49152
    v_cmp_nle_f32 vcc, v14, v60
    s_cbranch_vccnz L_slow2
L_back2:
    v_add_f32 v9, v9, v14
    s_waitcnt vmcnt(8)
    s_barrier
    s_waitcnt lgkmcnt(4)
    v_mfma_f32_32x32x16_bf16 v[64:79], v[44:47], v[128:131], v[112:127]
    ds_read_b128 v[36:39], v29 offset:49152
    v_exp_f32 v16, v80
    v_exp_f32 v17, v81
    s_waitcnt lgkmcnt(4)
    v_mfma_f32_32x32x16_bf16 v[64:79], v[48:51], v[132:135], v[64:79]
    ds_read_b128 v[40:43], v30 offset:49152
    s_add_u32 m0, s42, 16384
    s_add_u32 s34, s26, 98304
    buffer_load_dwordx4 v8, s[12:15], s34 offen nt lds
    v_exp_f32 v18, v82
    v_exp_f32 v19, v83
    s_waitcnt lgkmcnt(4)
    v_mfma_f32_32x32x16_bf16 v[64:79], v[52:55], v[136:139], v[64:79]
    ds_read_b128 v[44:47], v31 offset:49152
    v_mov_b32 v14, v16
    v_mov_b32 v15, v17
    v_cvt_pk_bf16_f32 v104, v16, v17
    s_waitcnt lgkmcnt(4)
    v_mfma_f32_32x32x16_bf16 v[64:79], v[56:59], v[140:143], v[64:79]
    ds_read_b64_tr_b16 v[48:49], v20 offset:32768
    ds_read_b64_tr_b16 v[50:51], v20 offset:33792
    v_exp_f32 v16, v84
    v_exp_f32 v17, v85
    s_waitcnt lgkmcnt(5)
    v_mfma_f32_32x32x16_bf16 v[64:79], v[32:35], v[144:147], v[64:79]
    ds_read_b64_tr_b16 v[52:53], v20 offset:36864
    ds_read_b64_tr_b16 v[54:55], v20 offset:37888
    s_add_u32 m0, s42, 24576
    s_add_u32 s34, s26, 106496
    buffer_load_dwordx4 v8, s[12:15], s34 offen nt lds
    v_add_f32 v14, v14, v18
    v_add_f32 v15, v15, v19
    v_cvt_pk_bf16_f32 v105, v18, v19
    s_waitcnt lgkmcnt(6)
    v_mfma_f32_32x32x16_bf16 v[64:79], v[36:39], v[148:151], v[64:79]
    ds_read_b64_tr_b16 v[56:57], v21 offset:32768
    ds_read_b64_tr_b16 v[58:59], v21 offset:33792
    v_exp_f32 v18, v86
    v_exp_f32 v19, v87
    s_waitcnt lgkmcnt(7)
    v_mfma_f32_32x32x16_bf16 v[64:79], v[40:43], v[152:155], v[64:79]
    ds_read_b64_tr_b16 v[32:33], v21 offset:36864
    ds_read_b64_tr_b16 v[34:35], v21 offset:37888
    v_add_f32 v14, v14, v16
    v_add_f32 v15, v15, v17
    v_cvt_pk_bf16_f32 v106, v16, v17
    s_waitcnt lgkmcnt(8)
    v_mfma_f32_32x32x16_bf16 v[64:79], v[44:47], v[156:159], v[64:79]
    ds_read_b64_tr_b16 v[36:37], v22 offset:32768
    ds_read_b64_tr_b16 v[38:39], v22 offset:33792
    v_exp_f32 v16, v88
    v_exp_f32 v17, v89
    s_waitcnt lgkmcnt(8)
    v_mfma_f32_32x32x16_bf16 a[0:15], v[48:51], v[96:99], a[0:15]
    ds_read_b64_tr_b16 v[40:41], v22 offset:36864
    ds_read_b64_tr_b16 v[42:43], v22 offset:37888
    s_add_u32 m0, s42, 32768
    s_add_u32 s34, s26, 81920
    buffer_load_dwordx4 v7, s[16:19], s34 offen nt lds
    v_add_f32 v14, v14, v18
    v_add_f32 v15, v15, v19
    v_cvt_pk_bf16_f32 v107, v18, v19
    v_exp_f32 v18, v90
    s_waitcnt lgkmcnt(8)
    v_mfma_f32_32x32x16_bf16 a[0:15], v[52:55], v[100:103], a[0:15]
    ds_read_b64_tr_b16 v[44:45], v23 offset:32768
    ds_read_b64_tr_b16 v[46:47], v23 offset:33792
    v_exp_f32 v19, v91
    v_add_f32 v14, v14, v16
    v_add_f32 v15, v15, v17
    s_waitcnt lgkmcnt(8)
    v_mfma_f32_32x32x16_bf16 a[16:31], v[56:59], v[96:99], a[16:31]
    ds_read_b64_tr_b16 v[48:49], v23 offset:36864
    ds_read_b64_tr_b16 v[50:51], v23 offset:37888
    v_cvt_pk_bf16_f32 v108, v16, v17
    v_exp_f32 v16, v92
    v_exp_f32 v17, v93
    s_waitcnt lgkmcnt(8)
    v_mfma_f32_32x32x16_bf16 a[16:31], v[32:35], v[100:103], a[16:31]
    ds_read_b128 v[52:55], v24 offset:57344
    v_add_f32 v14, v14, v18
    v_add_f32 v15, v15, v19
    v_cvt_pk_bf16_f32 v109, v18, v19
    v_exp_f32 v18, v94
    s_waitcnt lgkmcnt(7)
    v_mfma_f32_32x32x16_bf16 a[32:47], v[36:39], v[96:99], a[32:47]
    ds_read_b128 v[56:59], v25 offset:57344
    s_add_u32 m0, s42, 40960
    s_add_u32 s34, s26, 90112
    buffer_load_dwordx4 v7, s[16:19], s34 offen nt lds
    v_exp_f32 v19, v95
    v_add_f32 v14, v14, v16
    v_add_f32 v15, v15, v17
    s_waitcnt lgkmcnt(6)
    v_mfma_f32_32x32x16_bf16 a[32:47], v[40:43], v[100:103], a[32:47]
    ds_read_b128 v[32:35], v26 offset:57344
    v_cvt_pk_bf16_f32 v110, v16, v17
    s_nop 0
    v_add_f32 v14, v14, v18
    v_add_f32 v15, v15, v19
    s_waitcnt lgkmcnt(5)
    v_mfma_f32_32x32x16_bf16 a[48:63], v[44:47], v[96:99], a[48:63]
    ds_read_b128 v[36:39], v27 offset:57344
    v_cvt_pk_bf16_f32 v111, v18, v19
    v_add_f32 v14, v14, v15
    s_waitcnt lgkmcnt(4)
    v_mfma_f32_32x32x16_bf16 a[48:63], v[48:51], v[100:103], a[48:63]
    ds_read_b128 v[40:43], v28 offset:57344
    v_cmp_nle_f32 vcc, v14, v60
    s_cbranch_vccnz L_slow3
L_back3:
    v_add_f32 v9, v9, v14
    s_waitcnt lgkmcnt(4)
    v_mfma_f32_32x32x16_bf16 v[80:95], v[52:55], v[128:131], v[112:127]
    ds_read_b128 v[44:47], v29 offset:57344
    v_exp_f32 v16, v64
    v_exp_f32 v17, v65
    s_waitcnt lgkmcnt(4)
    v_mfma_f32_32x32x16_bf16 v[80:95], v[56:59], v[132:135], v[80:95]
    ds_read_b128 v[48:51], v30 offset:57344
    v_exp_f32 v18, v66
    v_exp_f32 v19, v67
    s_waitcnt lgkmcnt(4)
    v_mfma_f32_32x32x16_bf16 v[80:95], v[32:35], v[136:139], v[80:95]
    ds_read_b128 v[52:55], v31 offset:57344
    v_mov_b32 v14, v16
    v_mov_b32 v15, v17
    v_cvt_pk_bf16_f32 v96, v16, v17
    s_waitcnt lgkmcnt(4)
    v_mfma_f32_32x32x16_bf16 v[80:95], v[36:39], v[140:143], v[80:95]
    ds_read_b64_tr_b16 v[56:57], v20 offset:40960
    ds_read_b64_tr_b16 v[58:59], v20 offset:41984
    v_exp_f32 v16, v68
    v_exp_f32 v17, v69
    s_waitcnt lgkmcnt(5)
    v_mfma_f32_32x32x16_bf16 v[80:95], v[40:43], v[144:147], v[80:95]
    ds_read_b64_tr_b16 v[32:33], v20 offset:45056
    ds_read_b64_tr_b16 v[34:35], v20 offset:46080
    v_add_f32 v14, v14, v18
    v_add_f32 v15, v15, v19
    v_cvt_pk_bf16_f32 v97, v18, v19
    s_waitcnt lgkmcnt(6)
    v_mfma_f32_32x32x16_bf16 v[80:95], v[44:47], v[148:151], v[80:95]
    ds_read_b64_tr_b16 v[36:37], v21 offset:40960
    ds_read_b64_tr_b16 v[38:39], v21 offset:41984
    v_exp_f32 v18, v70
    v_exp_f32 v19, v71
    s_waitcnt lgkmcnt(7)
    v_mfma_f32_32x32x16_bf16 v[80:95], v[48:51], v[152:155], v[80:95]
    ds_read_b64_tr_b16 v[40:41], v21 offset:45056
    ds_read_b64_tr_b16 v[42:43], v21 offset:46080
    v_add_f32 v14, v14, v16
    v_add_f32 v15, v15, v17
    v_cvt_pk_bf16_f32 v98, v16, v17
    s_waitcnt lgkmcnt(8)
    v_mfma_f32_32x32x16_bf16 v[80:95], v[52:55], v[156:159], v[80:95]
    ds_read_b64_tr_b16 v[44:45], v22 offset:40960
    ds_read_b64_tr_b16 v[46:47], v22 offset:41984
    v_exp_f32 v16, v72
    v_exp_f32 v17, v73
    s_waitcnt lgkmcnt(8)
    v_mfma_f32_32x32x16_bf16 a[0:15], v[56:59], v[104:107], a[0:15]
    ds_read_b64_tr_b16 v[48:49], v22 offset:45056
    ds_read_b64_tr_b16 v[50:51], v22 offset:46080
    v_add_f32 v14, v14, v18
    v_add_f32 v15, v15, v19
    v_cvt_pk_bf16_f32 v99, v18, v19
    v_exp_f32 v18, v74
    s_waitcnt lgkmcnt(8)
    v_mfma_f32_32x32x16_bf16 a[0:15], v[32:35], v[108:111], a[0:15]
    ds_read_b64_tr_b16 v[52:53], v23 offset:40960
    ds_read_b64_tr_b16 v[54:55], v23 offset:41984
    v_exp_f32 v19, v75
    v_add_f32 v14, v14, v16
    v_add_f32 v15, v15, v17
    s_waitcnt lgkmcnt(8)
    v_mfma_f32_32x32x16_bf16 a[16:31], v[36:39], v[104:107], a[16:31]
    ds_read_b64_tr_b16 v[56:57], v23 offset:45056
    ds_read_b64_tr_b16 v[58:59], v23 offset:46080
    v_cvt_pk_bf16_f32 v100, v16, v17
    v_exp_f32 v16, v76
    v_exp_f32 v17, v77
    s_waitcnt lgkmcnt(8)
    v_mfma_f32_32x32x16_bf16 a[16:31], v[40:43], v[108:111], a[16:31]
    v_add_u32 v24, 0x14000, v24
    v_add_u32 v25, 0x14000, v25
    v_add_u32 v26, 0x14000, v26
    v_add_u32 v27, 0x14000, v27
    v_add_u32 v28, 0x14000, v28
    v_add_u32 v29, 0x14000, v29
    v_add_u32 v30, 0x14000, v30
    v_add_u32 v31, 0x14000, v31
    ds_read_b128 v[32:35], v24 offset:0
    v_add_f32 v14, v14, v18
    v_add_f32 v15, v15, v19
    v_cvt_pk_bf16_f32 v101, v18, v19
    v_exp_f32 v18, v78
    s_waitcnt lgkmcnt(7)
    v_mfma_f32_32x32x16_bf16 a[32:47], v[44:47], v[104:107], a[32:47]
    ds_read_b128 v[36:39], v25 offset:0
    v_exp_f32 v19, v79
    v_add_f32 v14, v14, v16
    v_add_f32 v15, v15, v17
    s_waitcnt lgkmcnt(6)
    v_mfma_f32_32x32x16_bf16 a[32:47], v[48:51], v[108:111], a[32:47]
    ds_read_b128 v[40:43], v26 offset:0
    v_cvt_pk_bf16_f32 v102, v16, v17
    s_nop 0
    v_add_f32 v14, v14, v18
    v_add_f32 v15, v15, v19
    s_waitcnt lgkmcnt(5)
    v_mfma_f32_32x32x16_bf16 a[48:63], v[52:55], v[104:107], a[48:63]
    ds_read_b128 v[44:47], v27 offset:0
    v_cvt_pk_bf16_f32 v103, v18, v19
    v_add_f32 v14, v14, v15
    s_waitcnt lgkmcnt(4)
    v_mfma_f32_32x32x16_bf16 a[48:63], v[56:59], v[108:111], a[48:63]
    ds_read_b128 v[48:51], v28 offset:0
    v_cmp_nle_f32 vcc, v14, v60
    s_cbranch_vccnz L_slow4
L_back4:
    v_add_f32 v9, v9, v14
    s_waitcnt vmcnt(8)
    s_barrier
    s_waitcnt lgkmcnt(4)
    v_mfma_f32_32x32x16_bf16 v[64:79], v[32:35], v[128:131], v[112:127]
    ds_read_b128 v[52:55], v29 offset:0
    v_exp_f32 v16, v80
    v_exp_f32 v17, v81
    s_waitcnt lgkmcnt(4)
    v_mfma_f32_32x32x16_bf16 v[64:79], v[36:39], v[132:135], v[64:79]
    ds_read_b128 v[56:59], v30 offset:0
    s_add_u32 m0, s42, 49152
    s_add_u32 s34, s26, 114688
    buffer_load_dwordx4 v8, s[12:15], s34 offen nt lds
    v_exp_f32 v18, v82
    v_exp_f32 v19, v83
    s_waitcnt lgkmcnt(4)
    v_mfma_f32_32x32x16_bf16 v[64:79], v[40:43], v[136:139], v[64:79]
    ds_read_b128 v[32:35], v31 offset:0
    v_mov_b32 v14, v16
    v_mov_b32 v15, v17
    v_cvt_pk_bf16_f32 v104, v16, v17
    s_waitcnt lgkmcnt(4)
    v_mfma_f32_32x32x16_bf16 v[64:79], v[44:47], v[140:143], v[64:79]
    v_add_u32 v20, 0x10000, v20
    v_add_u32 v21, 0x10000, v21
    v_add_u32 v22, 0x10000, v22
    v_add_u32 v23, 0x10000, v23
    ds_read_b64_tr_b16 v[36:37], v20 offset:0
    ds_read_b64_tr_b16 v[38:39], v20 offset:1024
    v_exp_f32 v16, v84
    v_exp_f32 v17, v85
    s_waitcnt lgkmcnt(5)
    v_mfma_f32_32x32x16_bf16 v[64:79], v[48:51], v[144:147], v[64:79]
    ds_read_b64_tr_b16 v[40:41], v20 offset:4096
    ds_read_b64_tr_b16 v[42:43], v20 offset:5120
    s_add_u32 m0, s42, 57344
    s_add_u32 s34, s26, 122880
    buffer_load_dwordx4 v8, s[12:15], s34 offen nt lds
    v_add_f32 v14, v14, v18
    v_add_f32 v15, v15, v19
    v_cvt_pk_bf16_f32 v105, v18, v19
    s_waitcnt lgkmcnt(6)
    v_mfma_f32_32x32x16_bf16 v[64:79], v[52:55], v[148:151], v[64:79]
    ds_read_b64_tr_b16 v[44:45], v21 offset:0
    ds_read_b64_tr_b16 v[46:47], v21 offset:1024
    v_exp_f32 v18, v86
    v_exp_f32 v19, v87
    s_waitcnt lgkmcnt(7)
    v_mfma_f32_32x32x16_bf16 v[64:79], v[56:59], v[152:155], v[64:79]
    ds_read_b64_tr_b16 v[48:49], v21 offset:4096
    ds_read_b64_tr_b16 v[50:51], v21 offset:5120
    v_add_f32 v14, v14, v16
    v_add_f32 v15, v15, v17
    v_cvt_pk_bf16_f32 v106, v16, v17
    s_waitcnt lgkmcnt(8)
    v_mfma_f32_32x32x16_bf16 v[64:79], v[32:35], v[156:159], v[64:79]
    ds_read_b64_tr_b16 v[52:53], v22 offset:0
    ds_read_b64_tr_b16 v[54:55], v22 offset:1024
    v_exp_f32 v16, v88
    v_exp_f32 v17, v89
    s_waitcnt lgkmcnt(8)
    v_mfma_f32_32x32x16_bf16 a[0:15], v[36:39], v[96:99], a[0:15]
    ds_read_b64_tr_b16 v[56:57], v22 offset:4096
    ds_read_b64_tr_b16 v[58:59], v22 offset:5120
    s_add_u32 m0, s42, 65536
    s_add_u32 s34, s26, 98304
    buffer_load_dwordx4 v7, s[16:19], s34 offen nt lds
    v_add_f32 v14, v14, v18
    v_add_f32 v15, v15, v19
    v_cvt_pk_bf16_f32 v107, v18, v19
    v_exp_f32 v18, v90
    s_waitcnt lgkmcnt(8)
    v_mfma_f32_32x32x16_bf16 a[0:15], v[40:43], v[100:103], a[0:15]
    ds_read_b64_tr_b16 v[32:33], v23 offset:0
    ds_read_b64_tr_b16 v[34:35], v23 offset:1024
    v_exp_f32 v19, v91
    v_add_f32 v14, v14, v16
    v_add_f32 v15, v15, v17
    s_waitcnt lgkmcnt(8)
    v_mfma_f32_32x32x16_bf16 a[16:31], v[44:47], v[96:99], a[16:31]
    ds_read_b64_tr_b16 v[36:37], v23 offset:4096
    ds_read_b64_tr_b16 v[38:39], v23 offset:5120
    v_cvt_pk_bf16_f32 v108, v16, v17
    v_exp_f32 v16, v92
    v_exp_f32 v17, v93
    s_waitcnt lgkmcnt(8)
    v_mfma_f32_32x32x16_bf16 a[16:31], v[48:51], v[100:103], a[16:31]
    ds_read_b128 v[40:43], v24 offset:8192
    v_add_f32 v14, v14, v18
    v_add_f32 v15, v15, v19
    v_cvt_pk_bf16_f32 v109, v18, v19
    v_exp_f32 v18, v94
    s_waitcnt lgkmcnt(7)
    v_mfma_f32_32x32x16_bf16 a[32:47], v[52:55], v[96:99], a[32:47]
    ds_read_b128 v[44:47], v25 offset:8192
    s_add_u32 m0, s42, 73728
    s_add_u32 s34, s26, 106496
    buffer_load_dwordx4 v7, s[16:19], s34 offen nt lds
    v_exp_f32 v19, v95
    v_add_f32 v14, v14, v16
    v_add_f32 v15, v15, v17
    s_waitcnt lgkmcnt(6)
    v_mfma_f32_32x32x16_bf16 a[32:47], v[56:59], v[100:103], a[32:47]
    ds_read_b128 v[48:51], v26 offset:8192
    v_cvt_pk_bf16_f32 v110, v16, v17
    s_nop 0
    v_add_f32 v14, v14, v18
    v_add_f32 v15, v15, v19
    s_waitcnt lgkmcnt(5)
    v_mfma_f32_32x32x16_bf16 a[48:63], v[32:35], v[96:99], a[48:63]
    ds_read_b128 v[52:55], v27 offset:8192
    v_cvt_pk_bf16_f32 v111, v18, v19
    v_add_f32 v14, v14, v15
    s_waitcnt lgkmcnt(4)
    v_mfma_f32_32x32x16_bf16 a[48:63], v[36:39], v[100:103], a[48:63]
    ds_read_b128 v[56:59], v28 offset:8192
    v_cmp_nle_f32 vcc, v14, v60
    s_cbranch_vccnz L_slow5
L_back5:
    v_add_f32 v9, v9, v14
    s_waitcnt lgkmcnt(4)
    v_mfma_f32_32x32x16_bf16 v[80:95], v[40:43], v[128:131], v[112:127]
    ds_read_b128 v[32:35], v29 offset:8192
    v_exp_f32 v16, v64
    v_exp_f32 v17, v65
    s_waitcnt lgkmcnt(4)
    v_mfma_f32_32x32x16_bf16 v[80:95], v[44:47], v[132:135], v[80:95]
    ds_read_b128 v[36:39], v30 offset:8192
    v_exp_f32 v18, v66
    v_exp_f32 v19, v67
    s_waitcnt lgkmcnt(4)
    v_mfma_f32_32x32x16_bf16 v[80:95], v[48:51], v[136:139], v[80:95]
    ds_read_b128 v[40:43], v31 offset:8192
    v_mov_b32 v14, v16
    v_mov_b32 v15, v17
    v_cvt_pk_bf16_f32 v96, v16, v17
    s_waitcnt lgkmcnt(4)
    v_mfma_f32_32x32x16_bf16 v[80:95], v[52:55], v[140:143], v[80:95]
    ds_read_b64_tr_b16 v[44:45], v20 offset:8192
    ds_read_b64_tr_b16 v[46:47], v20 offset:9216
    v_exp_f32 v16, v68
    v_exp_f32 v17, v69
    s_waitcnt lgkmcnt(5)
    v_mfma_f32_32x32x16_bf16 v[80:95], v[56:59], v[144:147], v[80:95]
    ds_read_b64_tr_b16 v[48:49], v20 offset:12288
    ds_read_b64_tr_b16 v[50:51], v20 offset:13312
    v_add_f32 v14, v14, v18
    v_add_f32 v15, v15, v19
    v_cvt_pk_bf16_f32 v97, v18, v19
    s_waitcnt lgkmcnt(6)
    v_mfma_f32_32x32x16_bf16 v[80:95], v[32:35], v[148:151], v[80:95]
    ds_read_b64_tr_b16 v[52:53], v21 offset:8192
    ds_read_b64_tr_b16 v[54:55], v21 offset:9216
    v_exp_f32 v18, v70
    v_exp_f32 v19, v71
    s_waitcnt lgkmcnt(7)
    v_mfma_f32_32x32x16_bf16 v[80:95], v[36:39], v[152:155], v[80:95]
    ds_read_b64_tr_b16 v[56:57], v21 offset:12288
    ds_read_b64_tr_b16 v[58:59], v21 offset:13312
    v_add_f32 v14, v14, v16
    v_add_f32 v15, v15, v17
    v_cvt_pk_bf16_f32 v98, v16, v17
    s_waitcnt lgkmcnt(8)
    v_mfma_f32_32x32x16_bf16 v[80:95], v[40:43], v[156:159], v[80:95]
    ds_read_b64_tr_b16 v[32:33], v22 offset:8192
    ds_read_b64_tr_b16 v[34:35], v22 offset:9216
    v_exp_f32 v16, v72
    v_exp_f32 v17, v73
    s_waitcnt lgkmcnt(8)
    v_mfma_f32_32x32x16_bf16 a[0:15], v[44:47], v[104:107], a[0:15]
    ds_read_b64_tr_b16 v[36:37], v22 offset:12288
    ds_read_b64_tr_b16 v[38:39], v22 offset:13312
    v_add_f32 v14, v14, v18
    v_add_f32 v15, v15, v19
    v_cvt_pk_bf16_f32 v99, v18, v19
    v_exp_f32 v18, v74
    s_waitcnt lgkmcnt(8)
    v_mfma_f32_32x32x16_bf16 a[0:15], v[48:51], v[108:111], a[0:15]
    ds_read_b64_tr_b16 v[40:41], v23 offset:8192
    ds_read_b64_tr_b16 v[42:43], v23 offset:9216
    v_exp_f32 v19, v75
    v_add_f32 v14, v14, v16
    v_add_f32 v15, v15, v17
    s_waitcnt lgkmcnt(8)
    v_mfma_f32_32x32x16_bf16 a[16:31], v[52:55], v[104:107], a[16:31]
    ds_read_b64_tr_b16 v[44:45], v23 offset:12288
    ds_read_b64_tr_b16 v[46:47], v23 offset:13312
    v_cvt_pk_bf16_f32 v100, v16, v17
    v_exp_f32 v16, v76
    v_exp_f32 v17, v77
    s_waitcnt lgkmcnt(8)
    v_mfma_f32_32x32x16_bf16 a[16:31], v[56:59], v[108:111], a[16:31]
    ds_read_b128 v[48:51], v24 offset:32768
    v_add_f32 v14, v14, v18
    v_add_f32 v15, v15, v19
    v_cvt_pk_bf16_f32 v101, v18, v19
    v_exp_f32 v18, v78
    s_waitcnt lgkmcnt(7)
    v_mfma_f32_32x32x16_bf16 a[32:47], v[32:35], v[104:107], a[32:47]
    ds_read_b128 v[52:55], v25 offset:32768
    v_exp_f32 v19, v79
    v_add_f32 v14, v14, v16
    v_add_f32 v15, v15, v17
    s_waitcnt lgkmcnt(6)
    v_mfma_f32_32x32x16_bf16 a[32:47], v[36:39], v[108:111], a[32:47]
    ds_read_b128 v[56:59], v26 offset:32768
    v_cvt_pk_bf16_f32 v102, v16, v17
    s_nop 0
    v_add_f32 v14, v14, v18
    v_add_f32 v15, v15, v19
    s_waitcnt lgkmcnt(5)
    v_mfma_f32_32x32x16_bf16 a[48:63], v[40:43], v[104:107], a[48:63]
    ds_read_b128 v[32:35], v27 offset:32768
    v_cvt_pk_bf16_f32 v103, v18, v19
    v_add_f32 v14, v14, v15
    s_waitcnt lgkmcnt(4)
    v_mfma_f32_32x32x16_bf16 a[48:63], v[44:47], v[108:111], a[48:63]
    ds_read_b128 v[36:39], v28 offset:32768
    v_cmp_nle_f32 vcc, v14, v60
    s_cbranch_vccnz L_slow6
L_back6:
    v_add_f32 v9, v9, v14
    s_waitcnt vmcnt(8)
    s_barrier
    s_waitcnt lgkmcnt(4)
    v_mfma_f32_32x32x16_bf16 v[64:79], v[48:51], v[128:131], v[112:127]
    ds_read_b128 v[40:43], v29 offset:32768
    v_exp_f32 v16, v80
    v_exp_f32 v17, v81
    s_waitcnt lgkmcnt(4)
    v_mfma_f32_32x32x16_bf16 v[64:79], v[52:55], v[132:135], v[64:79]
    ds_read_b128 v[44:47], v30 offset:32768
    s_add_u32 m0, s42, 81920
    s_add_u32 s34, s28, 0
    buffer_load_dwordx4 v8, s[12:15], s34 offen nt lds
    v_exp_f32 v18, v82
    v_exp_f32 v19, v83
    s_waitcnt lgkmcnt(4)
    v_mfma_f32_32x32x16_bf16 v[64:79], v[56:59], v[136:139], v[64:79]
    ds_read_b128 v[48:51], v31 offset:32768
    v_mov_b32 v14, v16
    v_mov_b32 v15, v17
    v_cvt_pk_bf16_f32 v104, v16, v17
    s_waitcnt lgkmcnt(4)
    v_mfma_f32_32x32x16_bf16 v[64:79], v[32:35], v[140:143], v[64:79]
    ds_read_b64_tr_b16 v[52:53], v20 offset:32768
    ds_read_b64_tr_b16 v[54:55], v20 offset:33792
    v_exp_f32 v16, v84
    v_exp_f32 v17, v85
    s_waitcnt lgkmcnt(5)
    v_mfma_f32_32x32x16_bf16 v[64:79], v[36:39], v[144:147], v[64:79]
    ds_read_b64_tr_b16 v[56:57], v20 offset:36864
    ds_read_b64_tr_b16 v[58:59], v20 offset:37888
    s_add_u32 m0, s42, 90112
    s_add_u32 s34, s28, 8192
    buffer_load_dwordx4 v8, s[12:15], s34 offen nt lds
    v_add_f32 v14, v14, v18
    v_add_f32 v15, v15, v19
    v_cvt_pk_bf16_f32 v105, v18, v19
    s_waitcnt lgkmcnt(6)
    v_mfma_f32_32x32x16_bf16 v[64:79], v[40:43], v[148:151], v[64:79]
    ds_read_b64_tr_b16 v[32:33], v21 offset:32768
    ds_read_b64_tr_b16 v[34:35], v21 offset:33792
    v_exp_f32 v18, v86
    v_exp_f32 v19, v87
    s_waitcnt lgkmcnt(7)
    v_mfma_f32_32x32x16_bf16 v[64:79], v[44:47], v[152:155], v[64:79]
    ds_read_b64_tr_b16 v[36:37], v21 offset:36864
    ds_read_b64_tr_b16 v[38:39], v21 offset:37888
    v_add_f32 v14, v14, v16
    v_add_f32 v15, v15, v17
    v_cvt_pk_bf16_f32 v106, v16, v17
    s_waitcnt lgkmcnt(8)
    v_mfma_f32_32x32x16_bf16 v[64:79], v[48:51], v[156:159], v[64:79]
    ds_read_b64_tr_b16 v[40:41], v22 offset:32768
    ds_read_b64_tr_b16 v[42:43], v22 offset:33792
    v_exp_f32 v16, v88
    v_exp_f32 v17, v89
    s_waitcnt lgkmcnt(8)
    v_mfma_f32_32x32x16_bf16 a[0:15], v[52:55], v[96:99], a[0:15]
    ds_read_b64_tr_b16 v[44:45], v22 offset:36864
    ds_read_b64_tr_b16 v[46:47], v22 offset:37888
    s_add_u32 m0, s42, 98304
    s_add_u32 s34, s26, 114688
    buffer_load_dwordx4 v7, s[16:19], s34 offen nt lds
    v_add_f32 v14, v14, v18
    v_add_f32 v15, v15, v19
    v_cvt_pk_bf16_f32 v107, v18, v19
    v_exp_f32 v18, v90
    s_waitcnt lgkmcnt(8)
    v_mfma_f32_32x32x16_bf16 a[0:15], v[56:59], v[100:103], a[0:15]
    ds_read_b64_tr_b16 v[48:49], v23 offset:32768
    ds_read_b64_tr_b16 v[50:51], v23 offset:33792
    v_exp_f32 v19, v91
    v_add_f32 v14, v14, v16
    v_add_f32 v15, v15, v17
    s_waitcnt lgkmcnt(8)
    v_mfma_f32_32x32x16_bf16 a[16:31], v[32:35], v[96:99], a[16:31]
    ds_read_b64_tr_b16 v[52:53], v23 offset:36864
    ds_read_b64_tr_b16 v[54:55], v23 offset:37888
    v_cvt_pk_bf16_f32 v108, v16, v17
    v_exp_f32 v16, v92
    v_exp_f32 v17, v93
    s_waitcnt lgkmcnt(8)
    v_mfma_f32_32x32x16_bf16 a[16:31], v[36:39], v[100:103], a[16:31]
    ds_read_b128 v[56:59], v24 offset:40960
    v_add_f32 v14, v14, v18
    v_add_f32 v15, v15, v19
    v_cvt_pk_bf16_f32 v109, v18, v19
    v_exp_f32 v18, v94
    s_waitcnt lgkmcnt(7)
    v_mfma_f32_32x32x16_bf16 a[32:47], v[40:43], v[96:99], a[32:47]
    ds_read_b128 v[32:35], v25 offset:40960
    s_add_u32 m0, s42, 106496
    s_add_u32 s34, s26, 122880
    buffer_load_dwordx4 v7, s[16:19], s34 offen nt lds
    v_exp_f32 v19, v95
    v_add_f32 v14, v14, v16
    v_add_f32 v15, v15, v17
    s_waitcnt lgkmcnt(6)
    v_mfma_f32_32x32x16_bf16 a[32:47], v[44:47], v[100:103], a[32:47]
    ds_read_b128 v[36:39], v26 offset:40960
    v_cvt_pk_bf16_f32 v110, v16, v17
    s_nop 0
    v_add_f32 v14, v14, v18
    v_add_f32 v15, v15, v19
    s_waitcnt lgkmcnt(5)
    v_mfma_f32_32x32x16_bf16 a[48:63], v[48:51], v[96:99], a[48:63]
    ds_read_b128 v[40:43], v27 offset:40960
    v_cvt_pk_bf16_f32 v111, v18, v19
    v_add_f32 v14, v14, v15
    s_waitcnt lgkmcnt(4)
    v_mfma_f32_32x32x16_bf16 a[48:63], v[52:55], v[100:103], a[48:63]
    ds_read_b128 v[44:47], v28 offset:40960
    v_cmp_nle_f32 vcc, v14, v60
    s_cbranch_vccnz L_slow7
L_back7:
    v_add_f32 v9, v9, v14
    s_waitcnt lgkmcnt(4)
    v_mfma_f32_32x32x16_bf16 v[80:95], v[56:59], v[128:131], v[112:127]
    ds_read_b128 v[48:51], v29 offset:40960
    v_exp_f32 v16, v64
    v_exp_f32 v17, v65
    s_waitcnt lgkmcnt(4)
    v_mfma_f32_32x32x16_bf16 v[80:95], v[32:35], v[132:135], v[80:95]
    ds_read_b128 v[52:55], v30 offset:40960
    v_exp_f32 v18, v66
    v_exp_f32 v19, v67
    s_waitcnt lgkmcnt(4)
    v_mfma_f32_32x32x16_bf16 v[80:95], v[36:39], v[136:139], v[80:95]
    ds_read_b128 v[56:59], v31 offset:40960
    v_mov_b32 v14, v16
    v_mov_b32 v15, v17
    v_cvt_pk_bf16_f32 v96, v16, v17
    s_waitcnt lgkmcnt(4)
    v_mfma_f32_32x32x16_bf16 v[80:95], v[40:43], v[140:143], v[80:95]
    ds_read_b64_tr_b16 v[32:33], v20 offset:40960
    ds_read_b64_tr_b16 v[34:35], v20 offset:41984
    v_exp_f32 v16, v68
    v_exp_f32 v17, v69
    s_waitcnt lgkmcnt(5)
    v_mfma_f32_32x32x16_bf16 v[80:95], v[44:47], v[144:147], v[80:95]
    ds_read_b64_tr_b16 v[36:37], v20 offset:45056
    ds_read_b64_tr_b16 v[38:39], v20 offset:46080
    v_add_f32 v14, v14, v18
    v_add_f32 v15, v15, v19
    v_cvt_pk_bf16_f32 v97, v18, v19
    s_waitcnt lgkmcnt(6)
    v_mfma_f32_32x32x16_bf16 v[80:95], v[48:51], v[148:151], v[80:95]
    ds_read_b64_tr_b16 v[40:41], v21 offset:40960
    ds_read_b64_tr_b16 v[42:43], v21 offset:41984
    v_exp_f32 v18, v70
    v_exp_f32 v19, v71
    s_waitcnt lgkmcnt(7)
    v_mfma_f32_32x32x16_bf16 v[80:95], v[52:55], v[152:155], v[80:95]
    ds_read_b64_tr_b16 v[44:45], v21 offset:45056
    ds_read_b64_tr_b16 v[46:47], v21 offset:46080
    v_add_f32 v14, v14, v16
    v_add_f32 v15, v15, v17
    v_cvt_pk_bf16_f32 v98, v16, v17
    s_waitcnt lgkmcnt(8)
    v_mfma_f32_32x32x16_bf16 v[80:95], v[56:59], v[156:159], v[80:95]
    ds_read_b64_tr_b16 v[48:49], v22 offset:40960
    ds_read_b64_tr_b16 v[50:51], v22 offset:41984
    v_exp_f32 v16, v72
    v_exp_f32 v17, v73
    s_waitcnt lgkmcnt(8)
    v_mfma_f32_32x32x16_bf16 a[0:15], v[32:35], v[104:107], a[0:15]
    ds_read_b64_tr_b16 v[52:53], v22 offset:45056
    ds_read_b64_tr_b16 v[54:55], v22 offset:46080
    v_add_f32 v14, v14, v18
    v_add_f32 v15, v15, v19
    v_cvt_pk_bf16_f32 v99, v18, v19
    v_exp_f32 v18, v74
    s_waitcnt lgkmcnt(8)
    v_mfma_f32_32x32x16_bf16 a[0:15], v[36:39], v[108:111], a[0:15]
    ds_read_b64_tr_b16 v[56:57], v23 offset:40960
    ds_read_b64_tr_b16 v[58:59], v23 offset:41984
    v_exp_f32 v19, v75
    v_add_f32 v14, v14, v16
    v_add_f32 v15, v15, v17
    s_waitcnt lgkmcnt(8)
    v_mfma_f32_32x32x16_bf16 a[16:31], v[40:43], v[104:107], a[16:31]
    ds_read_b64_tr_b16 v[32:33], v23 offset:45056
    ds_read_b64_tr_b16 v[34:35], v23 offset:46080
    v_cvt_pk_bf16_f32 v100, v16, v17
    v_exp_f32 v16, v76
    v_exp_f32 v17, v77
    s_waitcnt lgkmcnt(8)
    v_mfma_f32_32x32x16_bf16 a[16:31], v[44:47], v[108:111], a[16:31]
    v_add_u32 v24, 0x10000, v24
    v_add_u32 v25, 0x10000, v25
    v_add_u32 v26, 0x10000, v26
    v_add_u32 v27, 0x10000, v27
    v_add_u32 v28, 0x10000, v28
    v_add_u32 v29, 0x10000, v29
    v_add_u32 v30, 0x10000, v30
    v_add_u32 v31, 0x10000, v31
    ds_read_b128 v[36:39], v24 offset:0
    v_add_f32 v14, v14, v18
    v_add_f32 v15, v15, v19
    v_cvt_pk_bf16_f32 v101, v18, v19
    v_exp_f32 v18, v78
    s_waitcnt lgkmcnt(7)
    v_mfma_f32_32x32x16_bf16 a[32:47], v[48:51], v[104:107], a[32:47]
    ds_read_b128 v[40:43], v25 offset:0
    v_exp_f32 v19, v79
    v_add_f32 v14, v14, v16
    v_add_f32 v15, v15, v17
    s_waitcnt lgkmcnt(6)
    v_mfma_f32_32x32x16_bf16 a[32:47], v[52:55], v[108:111], a[32:47]
    ds_read_b128 v[44:47], v26 offset:0
    v_cvt_pk_bf16_f32 v102, v16, v17
    s_nop 0
    v_add_f32 v14, v14, v18
    v_add_f32 v15, v15, v19
    s_waitcnt lgkmcnt(5)
    v_mfma_f32_32x32x16_bf16 a[48:63], v[56:59], v[104:107], a[48:63]
    ds_read_b128 v[48:51], v27 offset:0
    v_cvt_pk_bf16_f32 v103, v18, v19
    v_add_f32 v14, v14, v15
    s_waitcnt lgkmcnt(4)
    v_mfma_f32_32x32x16_bf16 a[48:63], v[32:35], v[108:111], a[48:63]
    ds_read_b128 v[52:55], v28 offset:0
    v_cmp_nle_f32 vcc, v14, v60
    s_cbranch_vccnz L_slow8
L_back8:
    v_add_f32 v9, v9, v14
    s_waitcnt vmcnt(8)
    s_barrier
    s_waitcnt lgkmcnt(4)
    v_mfma_f32_32x32x16_bf16 v[64:79], v[36:39], v[128:131], v[112:127]
    ds_read_b128 v[56:59], v29 offset:0
    v_exp_f32 v16, v80
    v_exp_f32 v17, v81
    s_waitcnt lgkmcnt(4)
    v_mfma_f32_32x32x16_bf16 v[64:79], v[40:43], v[132:135], v[64:79]
    ds_read_b128 v[32:35], v30 offset:0
    s_add_u32 m0, s42, 114688
    s_add_u32 s34, s28, 16384
    buffer_load_dwordx4 v8, s[12:15], s34 offen nt lds
    v_exp_f32 v18, v82
    v_exp_f32 v19, v83
    s_waitcnt lgkmcnt(4)
    v_mfma_f32_32x32x16_bf16 v[64:79], v[44:47], v[136:139], v[64:79]
    ds_read_b128 v[36:39], v31 offset:0
    v_mov_b32 v14, v16
    v_mov_b32 v15, v17
    v_cvt_pk_bf16_f32 v104, v16, v17
    s_waitcnt lgkmcnt(4)
    v_mfma_f32_32x32x16_bf16 v[64:79], v[48:51], v[140:143], v[64:79]
    v_add_u32 v20, 0xfffe8000, v20
    v_add_u32 v21, 0xfffe8000, v21
    v_add_u32 v22, 0xfffe8000, v22
    v_add_u32 v23, 0xfffe8000, v23
    ds_read_b64_tr_b16 v[40:41], v20 offset:0
    ds_read_b64_tr_b16 v[42:43], v20 offset:1024
    v_exp_f32 v16, v84
    v_exp_f32 v17, v85
    s_waitcnt lgkmcnt(5)
    v_mfma_f32_32x32x16_bf16 v[64:79], v[52:55], v[144:147], v[64:79]
    ds_read_b64_tr_b16 v[44:45], v20 offset:4096
    ds_read_b64_tr_b16 v[46:47], v20 offset:5120
    s_add_u32 m0, s42, 122880
    s_add_u32 s34, s28, 24576
    buffer_load_dwordx4 v8, s[12:15], s34 offen nt lds
    v_add_f32 v14, v14, v18
    v_add_f32 v15, v15, v19
    v_cvt_pk_bf16_f32 v105, v18, v19
    s_waitcnt lgkmcnt(6)
    v_mfma_f32_32x32x16_bf16 v[64:79], v[56:59], v[148:151], v[64:79]
    ds_read_b64_tr_b16 v[48:49], v21 offset:0
    ds_read_b64_tr_b16 v[50:51], v21 offset:1024
    v_exp_f32 v18, v86
    v_exp_f32 v19, v87
    s_waitcnt lgkmcnt(7)
    v_mfma_f32_32x32x16_bf16 v[64:79], v[32:35], v[152:155], v[64:79]
    ds_read_b64_tr_b16 v[52:53], v21 offset:4096
    ds_read_b64_tr_b16 v[54:55], v21 offset:5120
    v_add_f32 v14, v14, v16
    v_add_f32 v15, v15, v17
    v_cvt_pk_bf16_f32 v106, v16, v17
    s_waitcnt lgkmcnt(8)
    v_mfma_f32_32x32x16_bf16 v[64:79], v[36:39], v[156:159], v[64:79]
    ds_read_b64_tr_b16 v[56:57], v22 offset:0
    ds_read_b64_tr_b16 v[58:59], v22 offset:1024
    v_exp_f32 v16, v88
    v_exp_f32 v17, v89
    s_waitcnt lgkmcnt(8)
    v_mfma_f32_32x32x16_bf16 a[0:15], v[40:43], v[96:99], a[0:15]
    ds_read_b64_tr_b16 v[32:33], v22 offset:4096
    ds_read_b64_tr_b16 v[34:35], v22 offset:5120
    s_add_u32 m0, s42, 131072
    s_add_u32 s34, s28, 0
    buffer_load_dwordx4 v7, s[16:19], s34 offen nt lds
    v_add_f32 v14, v14, v18
    v_add_f32 v15, v15, v19
    v_cvt_pk_bf16_f32 v107, v18, v19
    v_exp_f32 v18, v90
    s_waitcnt lgkmcnt(8)
    v_mfma_f32_32x32x16_bf16 a[0:15], v[44:47], v[100:103], a[0:15]
    ds_read_b64_tr_b16 v[36:37], v23 offset:0
    ds_read_b64_tr_b16 v[38:39], v23 offset:1024
    v_exp_f32 v19, v91
    v_add_f32 v14, v14, v16
    v_add_f32 v15, v15, v17
    s_waitcnt lgkmcnt(8)
    v_mfma_f32_32x32x16_bf16 a[16:31], v[48:51], v[96:99], a[16:31]
    ds_read_b64_tr_b16 v[40:41], v23 offset:4096
    ds_read_b64_tr_b16 v[42:43], v23 offset:5120
    v_cvt_pk_bf16_f32 v108, v16, v17
    v_exp_f32 v16, v92
    v_exp_f32 v17, v93
    s_waitcnt lgkmcnt(8)
    v_mfma_f32_32x32x16_bf16 a[16:31], v[52:55], v[100:103], a[16:31]
    ds_read_b128 v[44:47], v24 offset:8192
    v_add_f32 v14, v14, v18
    v_add_f32 v15, v15, v19
    v_cvt_pk_bf16_f32 v109, v18, v19
    v_exp_f32 v18, v94
    s_waitcnt lgkmcnt(7)
    v_mfma_f32_32x32x16_bf16 a[32:47], v[56:59], v[96:99], a[32:47]
    ds_read_b128 v[48:51], v25 offset:8192
    s_add_u32 m0, s42, 139264
    s_add_u32 s34, s28, 8192
    buffer_load_dwordx4 v7, s[16:19], s34 offen nt lds
    v_exp_f32 v19, v95
    v_add_f32 v14, v14, v16
    v_add_f32 v15, v15, v17
    s_waitcnt lgkmcnt(6)
    v_mfma_f32_32x32x16_bf16 a[32:47], v[32:35], v[100:103], a[32:47]
    ds_read_b128 v[52:55], v26 offset:8192
    v_cvt_pk_bf16_f32 v110, v16, v17
    s_nop 0
    v_add_f32 v14, v14, v18
    v_add_f32 v15, v15, v19
    s_waitcnt lgkmcnt(5)
    v_mfma_f32_32x32x16_bf16 a[48:63], v[36:39], v[96:99], a[48:63]
    ds_read_b128 v[56:59], v27 offset:8192
    v_cvt_pk_bf16_f32 v111, v18, v19
    v_add_f32 v14, v14, v15
    s_waitcnt lgkmcnt(4)
    v_mfma_f32_32x32x16_bf16 a[48:63], v[40:43], v[100:103], a[48:63]
    ds_read_b128 v[32:35], v28 offset:8192
    v_cmp_nle_f32 vcc, v14, v60
    s_cbranch_vccnz L_slow9
L_back9:
    v_add_f32 v9, v9, v14
    s_waitcnt lgkmcnt(4)
    v_mfma_f32_32x32x16_bf16 v[80:95], v[44:47], v[128:131], v[112:127]
    ds_read_b128 v[36:39], v29 offset:8192
    v_exp_f32 v16, v64
    v_exp_f32 v17, v65
    s_waitcnt lgkmcnt(4)
    v_mfma_f32_32x32x16_bf16 v[80:95], v[48:51], v[132:135], v[80:95]
    ds_read_b128 v[40:43], v30 offset:8192
    v_exp_f32 v18, v66
    v_exp_f32 v19, v67
    s_waitcnt lgkmcnt(4)
    v_mfma_f32_32x32x16_bf16 v[80:95], v[52:55], v[136:139], v[80:95]
    ds_read_b128 v[44:47], v31 offset:8192
    v_mov_b32 v14, v16
    v_mov_b32 v15, v17
    v_cvt_pk_bf16_f32 v96, v16, v17
    s_waitcnt lgkmcnt(4)
    v_mfma_f32_32x32x16_bf16 v[80:95], v[56:59], v[140:143], v[80:95]
    ds_read_b64_tr_b16 v[48:49], v20 offset:8192
    ds_read_b64_tr_b16 v[50:51], v20 offset:9216
    v_exp_f32 v16, v68
    v_exp_f32 v17, v69
    s_waitcnt lgkmcnt(5)
    v_mfma_f32_32x32x16_bf16 v[80:95], v[32:35], v[144:147], v[80:95]
    ds_read_b64_tr_b16 v[52:53], v20 offset:12288
    ds_read_b64_tr_b16 v[54:55], v20 offset:13312
    v_add_f32 v14, v14, v18
    v_add_f32 v15, v15, v19
    v_cvt_pk_bf16_f32 v97, v18, v19
    s_waitcnt lgkmcnt(6)
    v_mfma_f32_32x32x16_bf16 v[80:95], v[36:39], v[148:151], v[80:95]
    ds_read_b64_tr_b16 v[56:57], v21 offset:8192
    ds_read_b64_tr_b16 v[58:59], v21 offset:9216
    v_exp_f32 v18, v70
    v_exp_f32 v19, v71
    s_waitcnt lgkmcnt(7)
    v_mfma_f32_32x32x16_bf16 v[80:95], v[40:43], v[152:155], v[80:95]
    ds_read_b64_tr_b16 v[32:33], v21 offset:12288
    ds_read_b64_tr_b16 v[34:35], v21 offset:13312
    v_add_f32 v14, v14, v16
    v_add_f32 v15, v15, v17
    v_cvt_pk_bf16_f32 v98, v16, v17
    s_waitcnt lgkmcnt(8)
    v_mfma_f32_32x32x16_bf16 v[80:95], v[44:47], v[156:159], v[80:95]
    ds_read_b64_tr_b16 v[36:37], v22 offset:8192
    ds_read_b64_tr_b16 v[38:39], v22 offset:9216
    v_exp_f32 v16, v72
    v_exp_f32 v17, v73
    s_waitcnt lgkmcnt(8)
    v_mfma_f32_32x32x16_bf16 a[0:15], v[48:51], v[104:107], a[0:15]
    ds_read_b64_tr_b16 v[40:41], v22 offset:12288
    ds_read_b64_tr_b16 v[42:43], v22 offset:13312
    v_add_f32 v14, v14, v18
    v_add_f32 v15, v15, v19
    v_cvt_pk_bf16_f32 v99, v18, v19
    v_exp_f32 v18, v74
    s_waitcnt lgkmcnt(8)
    v_mfma_f32_32x32x16_bf16 a[0:15], v[52:55], v[108:111], a[0:15]
    ds_read_b64_tr_b16 v[44:45], v23 offset:8192
    ds_read_b64_tr_b16 v[46:47], v23 offset:9216
    v_exp_f32 v19, v75
    v_add_f32 v14, v14, v16
    v_add_f32 v15, v15, v17
    s_waitcnt lgkmcnt(8)
    v_mfma_f32_32x32x16_bf16 a[16:31], v[56:59], v[104:107], a[16:31]
    ds_read_b64_tr_b16 v[48:49], v23 offset:12288
    ds_read_b64_tr_b16 v[50:51], v23 offset:13312
    v_cvt_pk_bf16_f32 v100, v16, v17
    v_exp_f32 v16, v76
    v_exp_f32 v17, v77
    s_waitcnt lgkmcnt(8)
    v_mfma_f32_32x32x16_bf16 a[16:31], v[32:35], v[108:111], a[16:31]
    v_add_u32 v24, 0xfffe0000, v24
    v_add_u32 v25, 0xfffe0000, v25
    v_add_u32 v26, 0xfffe0000, v26
    v_add_u32 v27, 0xfffe0000, v27
    v_add_u32 v28, 0xfffe0000, v28
    v_add_u32 v29, 0xfffe0000, v29
    v_add_u32 v30, 0xfffe0000, v30
    v_add_u32 v31, 0xfffe0000, v31
    ds_read_b128 v[52:55], v24 offset:0
    v_add_f32 v14, v14, v18
    v_add_f32 v15, v15, v19
    v_cvt_pk_bf16_f32 v101, v18, v19
    v_exp_f32 v18, v78
    s_waitcnt lgkmcnt(7)
    v_mfma_f32_32x32x16_bf16 a[32:47], v[36:39], v[104:107], a[32:47]
    ds_read_b128 v[56:59], v25 offset:0
    v_exp_f32 v19, v79
    v_add_f32 v14, v14, v16
    v_add_f32 v15, v15, v17
    s_waitcnt lgkmcnt(6)
    v_mfma_f32_32x32x16_bf16 a[32:47], v[40:43], v[108:111], a[32:47]
    ds_read_b128 v[32:35], v26 offset:0
    v_cvt_pk_bf16_f32 v102, v16, v17
    s_nop 0
    v_add_f32 v14, v14, v18
    v_add_f32 v15, v15, v19
    s_waitcnt lgkmcnt(5)
    v_mfma_f32_32x32x16_bf16 a[48:63], v[44:47], v[104:107], a[48:63]
    ds_read_b128 v[36:39], v27 offset:0
    v_cvt_pk_bf16_f32 v103, v18, v19
    v_add_f32 v14, v14, v15
    s_waitcnt lgkmcnt(4)
    v_mfma_f32_32x32x16_bf16 a[48:63], v[48:51], v[108:111], a[48:63]
    ds_read_b128 v[40:43], v28 offset:0
    v_cmp_nle_f32 vcc, v14, v60
    s_cbranch_vccnz L_slow10
L_back10:
    v_add_f32 v9, v9, v14
    s_waitcnt vmcnt(8)
    s_barrier
    s_waitcnt lgkmcnt(4)
    v_mfma_f32_32x32x16_bf16 v[64:79], v[52:55], v[128:131], v[112:127]
    ds_read_b128 v[44:47], v29 offset:0
    v_exp_f32 v16, v80
    v_exp_f32 v17, v81
    s_waitcnt lgkmcnt(4)
    v_mfma_f32_32x32x16_bf16 v[64:79], v[56:59], v[132:135], v[64:79]
    ds_read_b128 v[48:51], v30 offset:0
    s_add_u32 m0, s42, 0
    s_add_u32 s34, s28, 32768
    buffer_load_dwordx4 v8, s[12:15], s34 offen nt lds
    v_exp_f32 v18, v82
    v_exp_f32 v19, v83
    s_waitcnt lgkmcnt(4)
    v_mfma_f32_32x32x16_bf16 v[64:79], v[32:35], v[136:139], v[64:79]
    ds_read_b128 v[52:55], v31 offset:0
    v_mov_b32 v14, v16
    v_mov_b32 v15, v17
    v_cvt_pk_bf16_f32 v104, v16, v17
    s_waitcnt lgkmcnt(4)
    v_mfma_f32_32x32x16_bf16 v[64:79], v[36:39], v[140:143], v[64:79]
    ds_read_b64_tr_b16 v[56:57], v20 offset:32768
    ds_read_b64_tr_b16 v[58:59], v20 offset:33792
    v_exp_f32 v16, v84
    v_exp_f32 v17, v85
    s_waitcnt lgkmcnt(5)
    v_mfma_f32_32x32x16_bf16 v[64:79], v[40:43], v[144:147], v[64:79]
    ds_read_b64_tr_b16 v[32:33], v20 offset:36864
    ds_read_b64_tr_b16 v[34:35], v20 offset:37888
    s_add_u32 m0, s42, 8192
    s_add_u32 s34, s28, 40960
    buffer_load_dwordx4 v8, s[12:15], s34 offen nt lds
    v_add_f32 v14, v14, v18
    v_add_f32 v15, v15, v19
    v_cvt_pk_bf16_f32 v105, v18, v19
    s_waitcnt lgkmcnt(6)
    v_mfma_f32_32x32x16_bf16 v[64:79], v[44:47], v[148:151], v[64:79]
    ds_read_b64_tr_b16 v[36:37], v21 offset:32768
    ds_read_b64_tr_b16 v[38:39], v21 offset:33792
    v_exp_f32 v18, v86
    v_exp_f32 v19, v87
    s_waitcnt lgkmcnt(7)
    v_mfma_f32_32x32x16_bf16 v[64:79], v[48:51], v[152:155], v[64:79]
    ds_read_b64_tr_b16 v[40:41], v21 offset:36864
    ds_read_b64_tr_b16 v[42:43], v21 offset:37888
    v_add_f32 v14, v14, v16
    v_add_f32 v15, v15, v17
    v_cvt_pk_bf16_f32 v106, v16, v17
    s_waitcnt lgkmcnt(8)
    v_mfma_f32_32x32x16_bf16 v[64:79], v[52:55], v[156:159], v[64:79]
    ds_read_b64_tr_b16 v[44:45], v22 offset:32768
    ds_read_b64_tr_b16 v[46:47], v22 offset:33792
    v_exp_f32 v16, v88
    v_exp_f32 v17, v89
    s_waitcnt lgkmcnt(8)
    v_mfma_f32_32x32x16_bf16 a[0:15], v[56:59], v[96:99], a[0:15]
    ds_read_b64_tr_b16 v[48:49], v22 offset:36864
    ds_read_b64_tr_b16 v[50:51], v22 offset:37888
    s_add_u32 m0, s42, 147456
    s_add_u32 s34, s28, 16384
    buffer_load_dwordx4 v7, s[16:19], s34 offen nt lds
    v_add_f32 v14, v14, v18
    v_add_f32 v15, v15, v19
    v_cvt_pk_bf16_f32 v107, v18, v19
    v_exp_f32 v18, v90
    s_waitcnt lgkmcnt(8)
    v_mfma_f32_32x32x16_bf16 a[0:15], v[32:35], v[100:103], a[0:15]
    ds_read_b64_tr_b16 v[52:53], v23 offset:32768
    ds_read_b64_tr_b16 v[54:55], v23 offset:33792
    v_exp_f32 v19, v91
    v_add_f32 v14, v14, v16
    v_add_f32 v15, v15, v17
    s_waitcnt lgkmcnt(8)
    v_mfma_f32_32x32x16_bf16 a[16:31], v[36:39], v[96:99], a[16:31]
    ds_read_b64_tr_b16 v[56:57], v23 offset:36864
    ds_read_b64_tr_b16 v[58:59], v23 offset:37888
    v_cvt_pk_bf16_f32 v108, v16, v17
    v_exp_f32 v16, v92
    v_exp_f32 v17, v93
    s_waitcnt lgkmcnt(8)
    v_mfma_f32_32x32x16_bf16 a[16:31], v[40:43], v[100:103], a[16:31]
    ds_read_b128 v[32:35], v24 offset:8192
    v_add_f32 v14, v14, v18
    v_add_f32 v15, v15, v19
    v_cvt_pk_bf16_f32 v109, v18, v19
    v_exp_f32 v18, v94
    s_waitcnt lgkmcnt(7)
    v_mfma_f32_32x32x16_bf16 a[32:47], v[44:47], v[96:99], a[32:47]
    ds_read_b128 v[36:39], v25 offset:8192
    s_add_u32 m0, s42, 155648
    s_add_u32 s34, s28, 24576
    buffer_load_dwordx4 v7, s[16:19], s34 offen nt lds
    v_exp_f32 v19, v95
    v_add_f32 v14, v14, v16
    v_add_f32 v15, v15, v17
    s_waitcnt lgkmcnt(6)
    v_mfma_f32_32x32x16_bf16 a[32:47], v[48:51], v[100:103], a[32:47]
    ds_read_b128 v[40:43], v26 offset:8192
    v_cvt_pk_bf16_f32 v110, v16, v17
    s_nop 0
    v_add_f32 v14, v14, v18
    v_add_f32 v15, v15, v19
    s_waitcnt lgkmcnt(5)
    v_mfma_f32_32x32x16_bf16 a[48:63], v[52:55], v[96:99], a[48:63]
    ds_read_b128 v[44:47], v27 offset:8192
    v_cvt_pk_bf16_f32 v111, v18, v19
    v_add_f32 v14, v14, v15
    s_waitcnt lgkmcnt(4)
    v_mfma_f32_32x32x16_bf16 a[48:63], v[56:59], v[100:103], a[48:63]
    ds_read_b128 v[48:51], v28 offset:8192
    v_cmp_nle_f32 vcc, v14, v60
    s_cbranch_vccnz L_slow11
L_back11:
    v_add_f32 v9, v9, v14
    s_waitcnt lgkmcnt(4)
    v_mfma_f32_32x32x16_bf16 v[80:95], v[32:35], v[128:131], v[112:127]
    ds_read_b128 v[52:55], v29 offset:8192
    v_exp_f32 v16, v64
    v_exp_f32 v17, v65
    s_waitcnt lgkmcnt(4)
    v_mfma_f32_32x32x16_bf16 v[80:95], v[36:39], v[132:135], v[80:95]
    ds_read_b128 v[56:59], v30 offset:8192
    v_exp_f32 v18, v66
    v_exp_f32 v19, v67
    s_waitcnt lgkmcnt(4)
    v_mfma_f32_32x32x16_bf16 v[80:95], v[40:43], v[136:139], v[80:95]
    ds_read_b128 v[32:35], v31 offset:8192
    v_mov_b32 v14, v16
    v_mov_b32 v15, v17
    v_cvt_pk_bf16_f32 v96, v16, v17
    s_waitcnt lgkmcnt(4)
    v_mfma_f32_32x32x16_bf16 v[80:95], v[44:47], v[140:143], v[80:95]
    ds_read_b64_tr_b16 v[36:37], v20 offset:40960
    ds_read_b64_tr_b16 v[38:39], v20 offset:41984
    v_exp_f32 v16, v68
    v_exp_f32 v17, v69
    s_waitcnt lgkmcnt(5)
    v_mfma_f32_32x32x16_bf16 v[80:95], v[48:51], v[144:147], v[80:95]
    ds_read_b64_tr_b16 v[40:41], v20 offset:45056
    ds_read_b64_tr_b16 v[42:43], v20 offset:46080
    v_add_f32 v14, v14, v18
    v_add_f32 v15, v15, v19
    v_cvt_pk_bf16_f32 v97, v18, v19
    s_waitcnt lgkmcnt(6)
    v_mfma_f32_32x32x16_bf16 v[80:95], v[52:55], v[148:151], v[80:95]
    ds_read_b64_tr_b16 v[44:45], v21 offset:40960
    ds_read_b64_tr_b16 v[46:47], v21 offset:41984
    v_exp_f32 v18, v70
    v_exp_f32 v19, v71
    s_waitcnt lgkmcnt(7)
    v_mfma_f32_32x32x16_bf16 v[80:95], v[56:59], v[152:155], v[80:95]
    ds_read_b64_tr_b16 v[48:49], v21 offset:45056
    ds_read_b64_tr_b16 v[50:51], v21 offset:46080
    v_add_f32 v14, v14, v16
    v_add_f32 v15, v15, v17
    v_cvt_pk_bf16_f32 v98, v16, v17
    s_waitcnt lgkmcnt(8)
    v_mfma_f32_32x32x16_bf16 v[80:95], v[32:35], v[156:159], v[80:95]
    ds_read_b64_tr_b16 v[52:53], v22 offset:40960
    ds_read_b64_tr_b16 v[54:55], v22 offset:41984
    v_exp_f32 v16, v72
    v_exp_f32 v17, v73
    s_waitcnt lgkmcnt(8)
    v_mfma_f32_32x32x16_bf16 a[0:15], v[36:39], v[104:107], a[0:15]
    ds_read_b64_tr_b16 v[56:57], v22 offset:45056
    ds_read_b64_tr_b16 v[58:59], v22 offset:46080
    v_add_f32 v14, v14, v18
    v_add_f32 v15, v15, v19
    v_cvt_pk_bf16_f32 v99, v18, v19
    v_exp_f32 v18, v74
    s_waitcnt lgkmcnt(8)
    v_mfma_f32_32x32x16_bf16 a[0:15], v[40:43], v[108:111], a[0:15]
    ds_read_b64_tr_b16 v[32:33], v23 offset:40960
    ds_read_b64_tr_b16 v[34:35], v23 offset:41984
    v_exp_f32 v19, v75
    v_add_f32 v14, v14, v16
    v_add_f32 v15, v15, v17
    s_waitcnt lgkmcnt(8)
    v_mfma_f32_32x32x16_bf16 a[16:31], v[44:47], v[104:107], a[16:31]
    ds_read_b64_tr_b16 v[36:37], v23 offset:45056
    ds_read_b64_tr_b16 v[38:39], v23 offset:46080
    v_cvt_pk_bf16_f32 v100, v16, v17
    v_exp_f32 v16, v76
    v_exp_f32 v17, v77
    s_waitcnt lgkmcnt(8)
    v_mfma_f32_32x32x16_bf16 a[16:31], v[48:51], v[108:111], a[16:31]
    ds_read_b128 v[40:43], v24 offset:32768
    v_add_f32 v14, v14, v18
    v_add_f32 v15, v15, v19
    v_cvt_pk_bf16_f32 v101, v18, v19
    v_exp_f32 v18, v78
    s_waitcnt lgkmcnt(7)
    v_mfma_f32_32x32x16_bf16 a[32:47], v[52:55], v[104:107], a[32:47]
    ds_read_b128 v[44:47], v25 offset:32768
    v_exp_f32 v19, v79
    v_add_f32 v14, v14, v16
    v_add_f32 v15, v15, v17
    s_waitcnt lgkmcnt(6)
    v_mfma_f32_32x32x16_bf16 a[32:47], v[56:59], v[108:111], a[32:47]
    ds_read_b128 v[48:51], v26 offset:32768
    v_cvt_pk_bf16_f32 v102, v16, v17
    s_nop 0
    v_add_f32 v14, v14, v18
    v_add_f32 v15, v15, v19
    s_waitcnt lgkmcnt(5)
    v_mfma_f32_32x32x16_bf16 a[48:63], v[32:35], v[104:107], a[48:63]
    ds_read_b128 v[52:55], v27 offset:32768
    v_cvt_pk_bf16_f32 v103, v18, v19
    v_add_f32 v14, v14, v15
    s_waitcnt lgkmcnt(4)
    v_mfma_f32_32x32x16_bf16 a[48:63], v[36:39], v[108:111], a[48:63]
    ds_read_b128 v[56:59], v28 offset:32768
    v_cmp_nle_f32 vcc, v14, v60
    s_cbranch_vccnz L_slow12
L_back12:
    v_add_f32 v9, v9, v14
    s_waitcnt vmcnt(8)
    s_barrier
    s_waitcnt lgkmcnt(4)
    v_mfma_f32_32x32x16_bf16 v[64:79], v[40:43], v[128:131], v[112:127]
    ds_read_b128 v[32:35], v29 offset:32768
    v_exp_f32 v16, v80
    v_exp_f32 v17, v81
    s_waitcnt lgkmcnt(4)
    v_mfma_f32_32x32x16_bf16 v[64:79], v[44:47], v[132:135], v[64:79]
    ds_read_b128 v[36:39], v30 offset:32768
    s_add_u32 m0, s42, 16384
    s_add_u32 s34, s28, 49152
    buffer_load_dwordx4 v8, s[12:15], s34 offen nt lds
    v_exp_f32 v18, v82
    v_exp_f32 v19, v83
    s_waitcnt lgkmcnt(4)
    v_mfma_f32_32x32x16_bf16 v[64:79], v[48:51], v[136:139], v[64:79]
    ds_read_b128 v[40:43], v31 offset:32768
    v_mov_b32 v14, v16
    v_mov_b32 v15, v17
    v_cvt_pk_bf16_f32 v104, v16, v17
    s_waitcnt lgkmcnt(4)
    v_mfma_f32_32x32x16_bf16 v[64:79], v[52:55], v[140:143], v[64:79]
    v_add_u32 v20, 0x10000, v20
    v_add_u32 v21, 0x10000, v21
    v_add_u32 v22, 0x10000, v22
    v_add_u32 v23, 0x10000, v23
    ds_read_b64_tr_b16 v[44:45], v20 offset:0
    ds_read_b64_tr_b16 v[46:47], v20 offset:1024
    v_exp_f32 v16, v84
    v_exp_f32 v17, v85
    s_waitcnt lgkmcnt(5)
    v_mfma_f32_32x32x16_bf16 v[64:79], v[56:59], v[144:147], v[64:79]
    ds_read_b64_tr_b16 v[48:49], v20 offset:4096
    ds_read_b64_tr_b16 v[50:51], v20 offset:5120
    s_add_u32 m0, s42, 24576
    s_add_u32 s34, s28, 57344
    buffer_load_dwordx4 v8, s[12:15], s34 offen nt lds
    v_add_f32 v14, v14, v18
    v_add_f32 v15, v15, v19
    v_cvt_pk_bf16_f32 v105, v18, v19
    s_waitcnt lgkmcnt(6)
    v_mfma_f32_32x32x16_bf16 v[64:79], v[32:35], v[148:151], v[64:79]
    ds_read_b64_tr_b16 v[52:53], v21 offset:0
    ds_read_b64_tr_b16 v[54:55], v21 offset:1024
    v_exp_f32 v18, v86
    v_exp_f32 v19, v87
    s_waitcnt lgkmcnt(7)
    v_mfma_f32_32x32x16_bf16 v[64:79], v[36:39], v[152:155], v[64:79]
    ds_read_b64_tr_b16 v[56:57], v21 offset:4096
    ds_read_b64_tr_b16 v[58:59], v21 offset:5120
    v_add_f32 v14, v14, v16
    v_add_f32 v15, v15, v17
    v_cvt_pk_bf16_f32 v106, v16, v17
    s_waitcnt lgkmcnt(8)
    v_mfma_f32_32x32x16_bf16 v[64:79], v[40:43], v[156:159], v[64:79]
    ds_read_b64_tr_b16 v[32:33], v22 offset:0
    ds_read_b64_tr_b16 v[34:35], v22 offset:1024
    v_exp_f32 v16, v88
    v_exp_f32 v17, v89
    s_waitcnt lgkmcnt(8)
    v_mfma_f32_32x32x16_bf16 a[0:15], v[44:47], v[96:99], a[0:15]
    ds_read_b64_tr_b16 v[36:37], v22 offset:4096
    ds_read_b64_tr_b16 v[38:39], v22 offset:5120
    s_add_u32 m0, s42, 32768
    s_add_u32 s34, s28, 32768
    buffer_load_dwordx4 v7, s[16:19], s34 offen nt lds
    v_add_f32 v14, v14, v18
    v_add_f32 v15, v15, v19
    v_cvt_pk_bf16_f32 v107, v18, v19
    v_exp_f32 v18, v90
    s_waitcnt lgkmcnt(8)
    v_mfma_f32_32x32x16_bf16 a[0:15], v[48:51], v[100:103], a[0:15]
    ds_read_b64_tr_b16 v[40:41], v23 offset:0
    ds_read_b64_tr_b16 v[42:43], v23 offset:1024
    v_exp_f32 v19, v91
    v_add_f32 v14, v14, v16
    v_add_f32 v15, v15, v17
    s_waitcnt lgkmcnt(8)
    v_mfma_f32_32x32x16_bf16 a[16:31], v[52:55], v[96:99], a[16:31]
    ds_read_b64_tr_b16 v[44:45], v23 offset:4096
    ds_read_b64_tr_b16 v[46:47], v23 offset:5120
    v_cvt_pk_bf16_f32 v108, v16, v17
    v_exp_f32 v16, v92
    v_exp_f32 v17, v93
    s_waitcnt lgkmcnt(8)
    v_mfma_f32_32x32x16_bf16 a[16:31], v[56:59], v[100:103], a[16:31]
    ds_read_b128 v[48:51], v24 offset:40960
    v_add_f32 v14, v14, v18
    v_add_f32 v15, v15, v19
    v_cvt_pk_bf16_f32 v109, v18, v19
    v_exp_f32 v18, v94
    s_waitcnt lgkmcnt(7)
    v_mfma_f32_32x32x16_bf16 a[32:47], v[32:35], v[96:99], a[32:47]
    ds_read_b128 v[52:55], v25 offset:40960
    s_add_u32 m0, s42, 40960
    s_add_u32 s34, s28, 40960
    buffer_load_dwordx4 v7, s[16:19], s34 offen nt lds
    v_exp_f32 v19, v95
    v_add_f32 v14, v14, v16
    v_add_f32 v15, v15, v17
    s_waitcnt lgkmcnt(6)
    v_mfma_f32_32x32x16_bf16 a[32:47], v[36:39], v[100:103], a[32:47]
    ds_read_b128 v[56:59], v26 offset:40960
    v_cvt_pk_bf16_f32 v110, v16, v17
    s_nop 0
    v_add_f32 v14, v14, v18
    v_add_f32 v15, v15, v19
    s_waitcnt lgkmcnt(5)
    v_mfma_f32_32x32x16_bf16 a[48:63], v[40:43], v[96:99], a[48:63]
    ds_read_b128 v[32:35], v27 offset:40960
    v_cvt_pk_bf16_f32 v111, v18, v19
    v_add_f32 v14, v14, v15
    s_waitcnt lgkmcnt(4)
    v_mfma_f32_32x32x16_bf16 a[48:63], v[44:47], v[100:103], a[48:63]
    ds_read_b128 v[36:39], v28 offset:40960
    v_cmp_nle_f32 vcc, v14, v60
    s_cbranch_vccnz L_slow13
L_back13:
    v_add_f32 v9, v9, v14
    s_waitcnt lgkmcnt(4)
    v_mfma_f32_32x32x16_bf16 v[80:95], v[48:51], v[128:131], v[112:127]
    ds_read_b128 v[40:43], v29 offset:40960
    v_exp_f32 v16, v64
    v_exp_f32 v17, v65
    s_waitcnt lgkmcnt(4)
    v_mfma_f32_32x32x16_bf16 v[80:95], v[52:55], v[132:135], v[80:95]
    ds_read_b128 v[44:47], v30 offset:40960
    v_exp_f32 v18, v66
    v_exp_f32 v19, v67
    s_waitcnt lgkmcnt(4)
    v_mfma_f32_32x32x16_bf16 v[80:95], v[56:59], v[136:139], v[80:95]
    ds_read_b128 v[48:51], v31 offset:40960
    v_mov_b32 v14, v16
    v_mov_b32 v15, v17
    v_cvt_pk_bf16_f32 v96, v16, v17
    s_waitcnt lgkmcnt(4)
    v_mfma_f32_32x32x16_bf16 v[80:95], v[32:35], v[140:143], v[80:95]
    ds_read_b64_tr_b16 v[52:53], v20 offset:8192
    ds_read_b64_tr_b16 v[54:55], v20 offset:9216
    v_exp_f32 v16, v68
    v_exp_f32 v17, v69
    s_waitcnt lgkmcnt(5)
    v_mfma_f32_32x32x16_bf16 v[80:95], v[36:39], v[144:147], v[80:95]
    ds_read_b64_tr_b16 v[56:57], v20 offset:12288
    ds_read_b64_tr_b16 v[58:59], v20 offset:13312
    v_add_f32 v14, v14, v18
    v_add_f32 v15, v15, v19
    v_cvt_pk_bf16_f32 v97, v18, v19
    s_waitcnt lgkmcnt(6)
    v_mfma_f32_32x32x16_bf16 v[80:95], v[40:43], v[148:151], v[80:95]
    ds_read_b64_tr_b16 v[32:33], v21 offset:8192
    ds_read_b64_tr_b16 v[34:35], v21 offset:9216
    v_exp_f32 v18, v70
    v_exp_f32 v19, v71
    s_waitcnt lgkmcnt(7)
    v_mfma_f32_32x32x16_bf16 v[80:95], v[44:47], v[152:155], v[80:95]
    ds_read_b64_tr_b16 v[36:37], v21 offset:12288
    ds_read_b64_tr_b16 v[38:39], v21 offset:13312
    v_add_f32 v14, v14, v16
    v_add_f32 v15, v15, v17
    v_cvt_pk_bf16_f32 v98, v16, v17
    s_waitcnt lgkmcnt(8)
    v_mfma_f32_32x32x16_bf16 v[80:95], v[48:51], v[156:159], v[80:95]
    ds_read_b64_tr_b16 v[40:41], v22 offset:8192
    ds_read_b64_tr_b16 v[42:43], v22 offset:9216
    v_exp_f32 v16, v72
    v_exp_f32 v17, v73
    s_waitcnt lgkmcnt(8)
    v_mfma_f32_32x32x16_bf16 a[0:15], v[52:55], v[104:107], a[0:15]
    ds_read_b64_tr_b16 v[44:45], v22 offset:12288
    ds_read_b64_tr_b16 v[46:47], v22 offset:13312
    v_add_f32 v14, v14, v18
    v_add_f32 v15, v15, v19
    v_cvt_pk_bf16_f32 v99, v18, v19
    v_exp_f32 v18, v74
    s_waitcnt lgkmcnt(8)
    v_mfma_f32_32x32x16_bf16 a[0:15], v[56:59], v[108:111], a[0:15]
    ds_read_b64_tr_b16 v[48:49], v23 offset:8192
    ds_read_b64_tr_b16 v[50:51], v23 offset:9216
    v_exp_f32 v19, v75
    v_add_f32 v14, v14, v16
    v_add_f32 v15, v15, v17
    s_waitcnt lgkmcnt(8)
    v_mfma_f32_32x32x16_bf16 a[16:31], v[32:35], v[104:107], a[16:31]
    ds_read_b64_tr_b16 v[52:53], v23 offset:12288
    ds_read_b64_tr_b16 v[54:55], v23 offset:13312
    v_cvt_pk_bf16_f32 v100, v16, v17
    v_exp_f32 v16, v76
    v_exp_f32 v17, v77
    s_waitcnt lgkmcnt(8)
    v_mfma_f32_32x32x16_bf16 a[16:31], v[36:39], v[108:111], a[16:31]
    v_add_u32 v24, 0x10000, v24
    v_add_u32 v25, 0x10000, v25
    v_add_u32 v26, 0x10000, v26
    v_add_u32 v27, 0x10000, v27
    v_add_u32 v28, 0x10000, v28
    v_add_u32 v29, 0x10000, v29
    v_add_u32 v30, 0x10000, v30
    v_add_u32 v31, 0x10000, v31
    ds_read_b128 v[56:59], v24 offset:0
    v_add_f32 v14, v14, v18
    v_add_f32 v15, v15, v19
    v_cvt_pk_bf16_f32 v101, v18, v19
    v_exp_f32 v18, v78
    s_waitcnt lgkmcnt(7)
    v_mfma_f32_32x32x16_bf16 a[32:47], v[40:43], v[104:107], a[32:47]
    ds_read_b128 v[32:35], v25 offset:0
    v_exp_f32 v19, v79
    v_add_f32 v14, v14, v16
    v_add_f32 v15, v15, v17
    s_waitcnt lgkmcnt(6)
    v_mfma_f32_32x32x16_bf16 a[32:47], v[44:47], v[108:111], a[32:47]
    ds_read_b128 v[36:39], v26 offset:0
    v_cvt_pk_bf16_f32 v102, v16, v17
    s_nop 0
    v_add_f32 v14, v14, v18
    v_add_f32 v15, v15, v19
    s_waitcnt lgkmcnt(5)
    v_mfma_f32_32x32x16_bf16 a[48:63], v[48:51], v[104:107], a[48:63]
    ds_read_b128 v[40:43], v27 offset:0
    v_cvt_pk_bf16_f32 v103, v18, v19
    v_add_f32 v14, v14, v15
    s_waitcnt lgkmcnt(4)
    v_mfma_f32_32x32x16_bf16 a[48:63], v[52:55], v[108:111], a[48:63]
    ds_read_b128 v[44:47], v28 offset:0
    v_cmp_nle_f32 vcc, v14, v60
    s_cbranch_vccnz L_slow14
L_back14:
    v_add_f32 v9, v9, v14
    s_waitcnt vmcnt(8)
    s_barrier
    s_waitcnt lgkmcnt(4)
    v_mfma_f32_32x32x16_bf16 v[64:79], v[56:59], a[64:67], 0
    ds_read_b128 v[48:51], v29 offset:0
    v_exp_f32 v16, v80
    v_exp_f32 v17, v81
    s_waitcnt lgkmcnt(4)
    v_mfma_f32_32x32x16_bf16 v[64:79], v[32:35], a[68:71], v[64:79]
    ds_read_b128 v[52:55], v30 offset:0
    s_add_u32 m0, s42, 49152
    s_add_u32 s34, s28, 65536
    buffer_load_dwordx4 v8, s[12:15], s34 offen nt lds
    v_exp_f32 v18, v82
    v_exp_f32 v19, v83
    s_waitcnt lgkmcnt(4)
    v_mfma_f32_32x32x16_bf16 v[64:79], v[36:39], a[72:75], v[64:79]
    ds_read_b128 v[56:59], v31 offset:0
    v_mov_b32 v14, v16
    v_mov_b32 v15, v17
    v_cvt_pk_bf16_f32 v104, v16, v17
    s_waitcnt lgkmcnt(4)
    v_mfma_f32_32x32x16_bf16 v[64:79], v[40:43], a[76:79], v[64:79]
    ds_read_b64_tr_b16 v[32:33], v20 offset:32768
    ds_read_b64_tr_b16 v[34:35], v20 offset:33792
    v_exp_f32 v16, v84
    v_exp_f32 v17, v85
    s_waitcnt lgkmcnt(5)
    v_mfma_f32_32x32x16_bf16 v[64:79], v[44:47], a[80:83], v[64:79]
    ds_read_b64_tr_b16 v[36:37], v20 offset:36864
    ds_read_b64_tr_b16 v[38:39], v20 offset:37888
    s_add_u32 m0, s42, 57344
    s_add_u32 s34, s28, 73728
    buffer_load_dwordx4 v8, s[12:15], s34 offen nt lds
    v_add_f32 v14, v14, v18
    v_add_f32 v15, v15, v19
    v_cvt_pk_bf16_f32 v105, v18, v19
    s_waitcnt lgkmcnt(6)
    v_mfma_f32_32x32x16_bf16 v[64:79], v[48:51], a[84:87], v[64:79]
    ds_read_b64_tr_b16 v[40:41], v21 offset:32768
    ds_read_b64_tr_b16 v[42:43], v21 offset:33792
    v_exp_f32 v18, v86
    v_exp_f32 v19, v87
    s_waitcnt lgkmcnt(7)
    v_mfma_f32_32x32x16_bf16 v[64:79], v[52:55], a[88:91], v[64:79]
    ds_read_b64_tr_b16 v[44:45], v21 offset:36864
    ds_read_b64_tr_b16 v[46:47], v21 offset:37888
    v_add_f32 v14, v14, v16
    v_add_f32 v15, v15, v17
    v_cvt_pk_bf16_f32 v106, v16, v17
    s_waitcnt lgkmcnt(8)
    v_mfma_f32_32x32x16_bf16 v[64:79], v[56:59], a[92:95], v[64:79]
    ds_read_b64_tr_b16 v[48:49], v22 offset:32768
    ds_read_b64_tr_b16 v[50:51], v22 offset:33792
    v_exp_f32 v16, v88
    v_exp_f32 v17, v89
    s_waitcnt lgkmcnt(8)
    v_mfma_f32_32x32x16_bf16 a[0:15], v[32:35], v[96:99], a[0:15]
    ds_read_b64_tr_b16 v[52:53], v22 offset:36864
    ds_read_b64_tr_b16 v[54:55], v22 offset:37888
    s_add_u32 m0, s42, 65536
    s_add_u32 s34, s28, 49152
    buffer_load_dwordx4 v7, s[16:19], s34 offen nt lds
    v_add_f32 v14, v14, v18
    v_add_f32 v15, v15, v19
    v_cvt_pk_bf16_f32 v107, v18, v19
    v_exp_f32 v18, v90
    s_waitcnt lgkmcnt(8)
    v_mfma_f32_32x32x16_bf16 a[0:15], v[36:39], v[100:103], a[0:15]
    ds_read_b64_tr_b16 v[56:57], v23 offset:32768
    ds_read_b64_tr_b16 v[58:59], v23 offset:33792
    v_exp_f32 v19, v91
    v_add_f32 v14, v14, v16
    v_add_f32 v15, v15, v17
    s_waitcnt lgkmcnt(8)
    v_mfma_f32_32x32x16_bf16 a[16:31], v[40:43], v[96:99], a[16:31]
    ds_read_b64_tr_b16 v[32:33], v23 offset:36864
    ds_read_b64_tr_b16 v[34:35], v23 offset:37888
    v_cvt_pk_bf16_f32 v108, v16, v17
    v_exp_f32 v16, v92
    v_exp_f32 v17, v93
    s_waitcnt lgkmcnt(8)
    v_mfma_f32_32x32x16_bf16 a[16:31], v[44:47], v[100:103], a[16:31]
    ds_read_b64_tr_b16 v[36:37], v20 offset:40960
    ds_read_b64_tr_b16 v[38:39], v20 offset:41984
    v_add_f32 v14, v14, v18
    v_add_f32 v15, v15, v19
    v_cvt_pk_bf16_f32 v109, v18, v19
    v_exp_f32 v18, v94
    s_waitcnt lgkmcnt(8)
    v_mfma_f32_32x32x16_bf16 a[32:47], v[48:51], v[96:99], a[32:47]
    ds_read_b64_tr_b16 v[40:41], v20 offset:45056
    ds_read_b64_tr_b16 v[42:43], v20 offset:46080
    s_add_u32 m0, s42, 73728
    s_add_u32 s34, s28, 57344
    buffer_load_dwordx4 v7, s[16:19], s34 offen nt lds
    v_exp_f32 v19, v95
    v_add_f32 v14, v14, v16
    v_add_f32 v15, v15, v17
    s_waitcnt lgkmcnt(8)
    v_mfma_f32_32x32x16_bf16 a[32:47], v[52:55], v[100:103], a[32:47]
    ds_read_b64_tr_b16 v[44:45], v21 offset:40960
    ds_read_b64_tr_b16 v[46:47], v21 offset:41984
    v_cvt_pk_bf16_f32 v110, v16, v17
    s_nop 0
    v_add_f32 v14, v14, v18
    v_add_f32 v15, v15, v19
    s_waitcnt lgkmcnt(8)
    v_mfma_f32_32x32x16_bf16 a[48:63], v[56:59], v[96:99], a[48:63]
    ds_read_b64_tr_b16 v[48:49], v21 offset:45056
    ds_read_b64_tr_b16 v[50:51], v21 offset:46080
    v_cvt_pk_bf16_f32 v111, v18, v19
    v_add_f32 v14, v14, v15
    s_waitcnt lgkmcnt(8)
    v_mfma_f32_32x32x16_bf16 a[48:63], v[32:35], v[100:103], a[48:63]
    ds_read_b64_tr_b16 v[52:53], v22 offset:40960
    ds_read_b64_tr_b16 v[54:55], v22 offset:41984
    v_cmp_nle_f32 vcc, v14, v60
    s_cbranch_vccnz L_slow15
L_back15:
    v_add_f32 v9, v9, v14
    s_nop 1
    s_waitcnt lgkmcnt(8)
    v_mfma_f32_32x32x16_bf16 a[0:15], v[36:39], v[104:107], a[0:15]
    ds_read_b64_tr_b16 v[56:57], v22 offset:45056
    ds_read_b64_tr_b16 v[58:59], v22 offset:46080
    s_nop 7
    v_max3_f32 v16, v64, v65, v66
    v_max3_f32 v16, v16, v67, v68
    v_max3_f32 v16, v16, v69, v70
    v_max3_f32 v16, v16, v71, v72
    v_max3_f32 v16, v16, v73, v74
    v_max3_f32 v16, v16, v75, v76
    s_waitcnt lgkmcnt(8)
    v_mfma_f32_32x32x16_bf16 a[0:15], v[40:43], v[108:111], a[0:15]
    ds_read_b64_tr_b16 v[32:33], v23 offset:40960
    ds_read_b64_tr_b16 v[34:35], v23 offset:41984
    v_max3_f32 v16, v16, v77, v78
    v_max_f32 v16, v16, v79
    v_mov_b32 v17, v16
    s_nop 1
    v_permlane32_swap_b32 v16, v17
    s_nop 1
    v_max_f32 v16, v16, v17
    v_sub_f32 v13, 0, v16
    s_waitcnt lgkmcnt(8)
    v_mfma_f32_32x32x16_bf16 a[16:31], v[44:47], v[104:107], a[16:31]
    ds_read_b64_tr_b16 v[36:37], v23 offset:45056
    ds_read_b64_tr_b16 v[38:39], v23 offset:46080
    v_mov_b32 v112, v13
    v_mov_b32 v113, v13
    v_mov_b32 v114, v13
    v_mov_b32 v115, v13
    v_mov_b32 v116, v13
    v_mov_b32 v117, v13
    v_mov_b32 v118, v13
    v_mov_b32 v119, v13
    s_waitcnt lgkmcnt(8)
    v_mfma_f32_32x32x16_bf16 a[16:31], v[48:51], v[108:111], a[16:31]
    ds_read_b128 v[40:43], v24 offset:8192
    v_mov_b32 v120, v13
    v_mov_b32 v121, v13
    v_mov_b32 v122, v13
    v_mov_b32 v123, v13
    v_mov_b32 v124, v13
    v_mov_b32 v125, v13
    v_mov_b32 v126, v13
    v_mov_b32 v127, v13
    s_waitcnt lgkmcnt(7)
    v_mfma_f32_32x32x16_bf16 a[32:47], v[52:55], v[104:107], a[32:47]
    ds_read_b128 v[44:47], v25 offset:8192
    v_add_f32 v64, v64, v13
    v_add_f32 v65, v65, v13
    v_add_f32 v66, v66, v13
    v_add_f32 v67, v67, v13
    v_add_f32 v68, v68, v13
    v_add_f32 v69, v69, v13
    v_add_f32 v70, v70, v13
    v_add_f32 v71, v71, v13
    s_waitcnt lgkmcnt(6)
    v_mfma_f32_32x32x16_bf16 a[32:47], v[56:59], v[108:111], a[32:47]
    ds_read_b128 v[48:51], v26 offset:8192
    v_add_f32 v72, v72, v13
    v_add_f32 v73, v73, v13
    v_add_f32 v74, v74, v13
    v_add_f32 v75, v75, v13
    v_add_f32 v76, v76, v13
    v_add_f32 v77, v77, v13
    v_add_f32 v78, v78, v13
    v_add_f32 v79, v79, v13
    s_waitcnt lgkmcnt(5)
    v_mfma_f32_32x32x16_bf16 a[48:63], v[32:35], v[104:107], a[48:63]
    ds_read_b128 v[52:55], v27 offset:8192
    s_waitcnt lgkmcnt(4)
    v_mfma_f32_32x32x16_bf16 a[48:63], v[36:39], v[108:111], a[48:63]
    ds_read_b128 v[56:59], v28 offset:8192
    s_nop 1
    s_waitcnt lgkmcnt(4)
    v_mfma_f32_32x32x16_bf16 v[80:95], v[40:43], a[64:67], v[112:127]
    ds_read_b128 v[32:35], v29 offset:8192
    v_exp_f32 v16, v64
    v_exp_f32 v17, v65
    v_exp_f32 v18, v66
    v_exp_f32 v19, v67
    v_mov_b32 v14, v16
    v_mov_b32 v15, v17
    s_waitcnt lgkmcnt(4)
    v_mfma_f32_32x32x16_bf16 v[80:95], v[44:47], a[68:71], v[80:95]
    ds_read_b128 v[36:39], v30 offset:8192
    v_cvt_pk_bf16_f32 v96, v16, v17
    v_exp_f32 v16, v68
    v_exp_f32 v17, v69
    v_add_f32 v14, v14, v18
    v_add_f32 v15, v15, v19
    v_cvt_pk_bf16_f32 v97, v18, v19
    v_exp_f32 v18, v70
    s_waitcnt lgkmcnt(4)
    v_mfma_f32_32x32x16_bf16 v[80:95], v[48:51], a[72:75], v[80:95]
    ds_read_b128 v[40:43], v31 offset:8192
    v_exp_f32 v19, v71
    v_add_f32 v14, v14, v16
    v_add_f32 v15, v15, v17
    v_cvt_pk_bf16_f32 v98, v16, v17
    v_exp_f32 v16, v72
    v_exp_f32 v17, v73
    v_add_f32 v14, v14, v18
    s_waitcnt lgkmcnt(4)
    v_mfma_f32_32x32x16_bf16 v[80:95], v[52:55], a[76:79], v[80:95]
    ds_read_b128 v[44:47], v24 offset:32768
    v_add_f32 v15, v15, v19
    v_cvt_pk_bf16_f32 v99, v18, v19
    v_exp_f32 v18, v74
    v_exp_f32 v19, v75
    v_add_f32 v14, v14, v16
    v_add_f32 v15, v15, v17
    v_cvt_pk_bf16_f32 v100, v16, v17
    v_exp_f32 v16, v76
    s_waitcnt lgkmcnt(4)
    v_mfma_f32_32x32x16_bf16 v[80:95], v[56:59], a[80:83], v[80:95]
    ds_read_b128 v[48:51], v25 offset:32768
    v_exp_f32 v17, v77
    v_add_f32 v14, v14, v18
    v_add_f32 v15, v15, v19
    v_cvt_pk_bf16_f32 v101, v18, v19
    v_exp_f32 v18, v78
    v_exp_f32 v19, v79
    v_add_f32 v14, v14, v16
    s_waitcnt lgkmcnt(4)
    v_mfma_f32_32x32x16_bf16 v[80:95], v[32:35], a[84:87], v[80:95]
    ds_read_b128 v[52:55], v26 offset:32768
    v_add_f32 v15, v15, v17
    v_cvt_pk_bf16_f32 v102, v16, v17
    s_nop 0
    v_add_f32 v14, v14, v18
    v_add_f32 v15, v15, v19
    v_cvt_pk_bf16_f32 v103, v18, v19
    v_add_f32 v14, v14, v15
    s_nop 7
    v_mov_b32 v10, v9
    v_mov_b32 v63, v9
    s_nop 1
    v_permlane32_swap_b32 v10, v63
    s_nop 1
    v_add_f32 v10, v10, v63
    v_rcp_f32 v10, v10
    s_nop 0
    s_waitcnt lgkmcnt(4)
    v_mfma_f32_32x32x16_bf16 v[80:95], v[36:39], a[88:91], v[80:95]
    ds_read_b128 v[56:59], v27 offset:32768
    v_accvgpr_read_b32 v61, a0
    v_accvgpr_read_b32 v62, a1
    v_mul_f32 v61, v61, v10
    v_mul_f32 v62, v62, v10
    v_cvt_pk_bf16_f32 v128, v61, v62
    v_accvgpr_read_b32 v61, a2
    v_accvgpr_read_b32 v62, a3
    v_mul_f32 v61, v61, v10
    v_mul_f32 v62, v62, v10
    v_cvt_pk_bf16_f32 v129, v61, v62
    s_waitcnt lgkmcnt(4)
    v_mfma_f32_32x32x16_bf16 v[80:95], v[40:43], a[92:95], v[80:95]
    ds_read_b128 v[32:35], v28 offset:32768
    v_accvgpr_read_b32 v61, a4
    v_accvgpr_read_b32 v62, a5
    v_mul_f32 v61, v61, v10
    v_mul_f32 v62, v62, v10
    v_cvt_pk_bf16_f32 v130, v61, v62
    v_accvgpr_read_b32 v61, a6
    v_accvgpr_read_b32 v62, a7
    v_mul_f32 v61, v61, v10
    v_mul_f32 v62, v62, v10
    v_cvt_pk_bf16_f32 v131, v61, v62
    v_accvgpr_read_b32 v61, a8
    v_accvgpr_read_b32 v62, a9
    v_mul_f32 v61, v61, v10
    v_mul_f32 v62, v62, v10
    v_cvt_pk_bf16_f32 v132, v61, v62
    v_accvgpr_read_b32 v61, a10
    v_accvgpr_read_b32 v62, a11
    v_mul_f32 v61, v61, v10
    v_mul_f32 v62, v62, v10
    v_cvt_pk_bf16_f32 v133, v61, v62
    v_accvgpr_read_b32 v61, a12
    v_accvgpr_read_b32 v62, a13
    v_mul_f32 v61, v61, v10
    v_mul_f32 v62, v62, v10
    v_cvt_pk_bf16_f32 v134, v61, v62
    v_accvgpr_read_b32 v61, a14
    v_accvgpr_read_b32 v62, a15
    v_mul_f32 v61, v61, v10
    v_mul_f32 v62, v62, v10
    v_cvt_pk_bf16_f32 v135, v61, v62
    v_accvgpr_read_b32 v61, a16
    v_accvgpr_read_b32 v62, a17
    v_mul_f32 v61, v61, v10
    v_mul_f32 v62, v62, v10
    v_cvt_pk_bf16_f32 v136, v61, v62
    v_accvgpr_read_b32 v61, a18
    v_accvgpr_read_b32 v62, a19
    v_mul_f32 v61, v61, v10
    v_mul_f32 v62, v62, v10
    v_cvt_pk_bf16_f32 v137, v61, v62
    v_accvgpr_read_b32 v61, a20
    v_accvgpr_read_b32 v62, a21
    v_mul_f32 v61, v61, v10
    v_mul_f32 v62, v62, v10
    v_cvt_pk_bf16_f32 v138, v61, v62
    v_accvgpr_read_b32 v61, a22
    v_accvgpr_read_b32 v62, a23
    v_mul_f32 v61, v61, v10
    v_mul_f32 v62, v62, v10
    v_cvt_pk_bf16_f32 v139, v61, v62
    v_accvgpr_read_b32 v61, a24
    v_accvgpr_read_b32 v62, a25
    v_mul_f32 v61, v61, v10
    v_mul_f32 v62, v62, v10
    v_cvt_pk_bf16_f32 v140, v61, v62
    v_accvgpr_read_b32 v61, a26
    v_accvgpr_read_b32 v62, a27
    v_mul_f32 v61, v61, v10
    v_mul_f32 v62, v62, v10
    v_cvt_pk_bf16_f32 v141, v61, v62
    v_accvgpr_read_b32 v61, a28
    v_accvgpr_read_b32 v62, a29
    v_mul_f32 v61, v61, v10
    v_mul_f32 v62, v62, v10
    v_cvt_pk_bf16_f32 v142, v61, v62
    v_accvgpr_read_b32 v61, a30
    v_accvgpr_read_b32 v62, a31
    v_mul_f32 v61, v61, v10
    v_mul_f32 v62, v62, v10
    v_cvt_pk_bf16_f32 v143, v61, v62
    v_mov_b32 v12, v14
    s_waitcnt vmcnt(8)
    s_barrier
    s_waitcnt lgkmcnt(4)
    v_mfma_f32_32x32x16_bf16 v[64:79], v[44:47], a[64:67], v[112:127]
    ds_read_b128 v[36:39], v29 offset:32768
    v_accvgpr_read_b32 v61, a32
    v_accvgpr_read_b32 v62, a33
    v_mul_f32 v61, v61, v10
    v_mul_f32 v62, v62, v10
    v_cvt_pk_bf16_f32 v144, v61, v62
    v_accvgpr_read_b32 v61, a34
    v_accvgpr_read_b32 v62, a35
    v_mul_f32 v61, v61, v10
    v_mul_f32 v62, v62, v10
    v_cvt_pk_bf16_f32 v145, v61, v62
    s_waitcnt lgkmcnt(4)
    v_mfma_f32_32x32x16_bf16 v[64:79], v[48:51], a[68:71], v[64:79]
    ds_read_b128 v[40:43], v30 offset:32768
    s_add_u32 m0, s42, 81920
    s_add_u32 s34, s28, 81920
    buffer_load_dwordx4 v8, s[12:15], s34 offen nt lds
    v_accvgpr_read_b32 v61, a36
    v_accvgpr_read_b32 v62, a37
    v_mul_f32 v61, v61, v10
    v_mul_f32 v62, v62, v10
    v_cvt_pk_bf16_f32 v146, v61, v62
    v_accvgpr_read_b32 v61, a38
    v_accvgpr_read_b32 v62, a39
    v_mul_f32 v61, v61, v10
    v_mul_f32 v62, v62, v10
    v_cvt_pk_bf16_f32 v147, v61, v62
    s_waitcnt lgkmcnt(4)
    v_mfma_f32_32x32x16_bf16 v[64:79], v[52:55], a[72:75], v[64:79]
    ds_read_b128 v[44:47], v31 offset:32768
    v_accvgpr_read_b32 v61, a40
    v_accvgpr_read_b32 v62, a41
    v_mul_f32 v61, v61, v10
    v_mul_f32 v62, v62, v10
    v_cvt_pk_bf16_f32 v148, v61, v62
    v_accvgpr_read_b32 v61, a42
    v_accvgpr_read_b32 v62, a43
    v_mul_f32 v61, v61, v10
    v_mul_f32 v62, v62, v10
    v_cvt_pk_bf16_f32 v149, v61, v62
    s_waitcnt lgkmcnt(4)
    v_mfma_f32_32x32x16_bf16 v[64:79], v[56:59], a[76:79], v[64:79]
    v_add_u32 v20, 0x10000, v20
    v_add_u32 v21, 0x10000, v21
    v_add_u32 v22, 0x10000, v22
    v_add_u32 v23, 0x10000, v23
    ds_read_b64_tr_b16 v[48:49], v20 offset:0
    ds_read_b64_tr_b16 v[50:51], v20 offset:1024
    v_accvgpr_read_b32 v61, a44
    v_accvgpr_read_b32 v62, a45
    v_mul_f32 v61, v61, v10
    v_mul_f32 v62, v62, v10
    v_cvt_pk_bf16_f32 v150, v61, v62
    v_accvgpr_read_b32 v61, a46
    v_accvgpr_read_b32 v62, a47
    v_mul_f32 v61, v61, v10
    v_mul_f32 v62, v62, v10
    v_cvt_pk_bf16_f32 v151, v61, v62
    s_waitcnt lgkmcnt(5)
    v_mfma_f32_32x32x16_bf16 v[64:79], v[32:35], a[80:83], v[64:79]
    ds_read_b64_tr_b16 v[52:53], v20 offset:4096
    ds_read_b64_tr_b16 v[54:55], v20 offset:5120
    s_add_u32 m0, s42, 90112
    s_add_u32 s34, s28, 90112
    buffer_load_dwordx4 v8, s[12:15], s34 offen nt lds
    v_accvgpr_read_b32 v61, a48
    v_accvgpr_read_b32 v62, a49
    v_mul_f32 v61, v61, v10
    v_mul_f32 v62, v62, v10
    v_cvt_pk_bf16_f32 v152, v61, v62
    v_accvgpr_read_b32 v61, a50
    v_accvgpr_read_b32 v62, a51
    v_mul_f32 v61, v61, v10
    v_mul_f32 v62, v62, v10
    v_cvt_pk_bf16_f32 v153, v61, v62
    s_waitcnt lgkmcnt(6)
    v_mfma_f32_32x32x16_bf16 v[64:79], v[36:39], a[84:87], v[64:79]
    ds_read_b64_tr_b16 v[56:57], v21 offset:0
    ds_read_b64_tr_b16 v[58:59], v21 offset:1024
    v_accvgpr_read_b32 v61, a52
    v_accvgpr_read_b32 v62, a53
    v_mul_f32 v61, v61, v10
    v_mul_f32 v62, v62, v10
    v_cvt_pk_bf16_f32 v154, v61, v62
    v_accvgpr_read_b32 v61, a54
    v_accvgpr_read_b32 v62, a55
    v_mul_f32 v61, v61, v10
    v_mul_f32 v62, v62, v10
    v_cvt_pk_bf16_f32 v155, v61, v62
    s_waitcnt lgkmcnt(7)
    v_mfma_f32_32x32x16_bf16 v[64:79], v[40:43], a[88:91], v[64:79]
    ds_read_b64_tr_b16 v[32:33], v21 offset:4096
    ds_read_b64_tr_b16 v[34:35], v21 offset:5120
    v_accvgpr_read_b32 v61, a56
    v_accvgpr_read_b32 v62, a57
    v_mul_f32 v61, v61, v10
    v_mul_f32 v62, v62, v10
    v_cvt_pk_bf16_f32 v156, v61, v62
    v_accvgpr_read_b32 v61, a58
    v_accvgpr_read_b32 v62, a59
    v_mul_f32 v61, v61, v10
    v_mul_f32 v62, v62, v10
    v_cvt_pk_bf16_f32 v157, v61, v62
    s_waitcnt lgkmcnt(8)
    v_mfma_f32_32x32x16_bf16 v[64:79], v[44:47], a[92:95], v[64:79]
    ds_read_b64_tr_b16 v[36:37], v22 offset:0
    ds_read_b64_tr_b16 v[38:39], v22 offset:1024
    v_accvgpr_read_b32 v61, a60
    v_accvgpr_read_b32 v62, a61
    v_mul_f32 v61, v61, v10
    v_mul_f32 v62, v62, v10
    v_cvt_pk_bf16_f32 v158, v61, v62
    v_accvgpr_read_b32 v61, a62
    v_accvgpr_read_b32 v62, a63
    v_mul_f32 v61, v61, v10
    v_mul_f32 v62, v62, v10
    v_cvt_pk_bf16_f32 v159, v61, v62
    s_nop 1
    s_waitcnt lgkmcnt(8)
    v_mfma_f32_32x32x16_bf16 a[0:15], v[48:51], v[96:99], 0
    ds_read_b64_tr_b16 v[40:41], v22 offset:4096
    ds_read_b64_tr_b16 v[42:43], v22 offset:5120
    s_add_u32 m0, s42, 98304
    s_add_u32 s34, s28, 65536
    buffer_load_dwordx4 v7, s[16:19], s34 offen nt lds
    v_exp_f32 v16, v80
    v_exp_f32 v17, v81
    v_exp_f32 v18, v82
    s_waitcnt lgkmcnt(8)
    v_mfma_f32_32x32x16_bf16 a[0:15], v[52:55], v[100:103], a[0:15]
    ds_read_b64_tr_b16 v[44:45], v23 offset:0
    ds_read_b64_tr_b16 v[46:47], v23 offset:1024
    v_exp_f32 v19, v83
    v_mov_b32 v14, v16
    v_mov_b32 v15, v17
    v_cvt_pk_bf16_f32 v104, v16, v17
    v_exp_f32 v16, v84
    s_waitcnt lgkmcnt(8)
    v_mfma_f32_32x32x16_bf16 a[16:31], v[56:59], v[96:99], 0
    ds_read_b64_tr_b16 v[48:49], v23 offset:4096
    ds_read_b64_tr_b16 v[50:51], v23 offset:5120
    v_exp_f32 v17, v85
    v_add_f32 v14, v14, v18
    v_add_f32 v15, v15, v19
    v_cvt_pk_bf16_f32 v105, v18, v19
    v_exp_f32 v18, v86
    s_waitcnt lgkmcnt(8)
    v_mfma_f32_32x32x16_bf16 a[16:31], v[32:35], v[100:103], a[16:31]
    ds_read_b128 v[52:55], v24 offset:40960
    v_exp_f32 v19, v87
    v_add_f32 v14, v14, v16
    v_add_f32 v15, v15, v17
    v_cvt_pk_bf16_f32 v106, v16, v17
    v_exp_f32 v16, v88
    s_waitcnt lgkmcnt(7)
    v_mfma_f32_32x32x16_bf16 a[32:47], v[36:39], v[96:99], 0
    ds_read_b128 v[56:59], v25 offset:40960
    s_add_u32 m0, s42, 106496
    s_add_u32 s34, s28, 73728
    buffer_load_dwordx4 v7, s[16:19], s34 offen nt lds
    v_exp_f32 v17, v89
    v_add_f32 v14, v14, v18
    v_add_f32 v15, v15, v19
    v_cvt_pk_bf16_f32 v107, v18, v19
    v_exp_f32 v18, v90
    s_waitcnt lgkmcnt(6)
    v_mfma_f32_32x32x16_bf16 a[32:47], v[40:43], v[100:103], a[32:47]
    ds_read_b128 v[32:35], v26 offset:40960
    v_exp_f32 v19, v91
    v_add_f32 v14, v14, v16
    v_add_f32 v15, v15, v17
    v_cvt_pk_bf16_f32 v108, v16, v17
    v_exp_f32 v16, v92
    s_waitcnt lgkmcnt(5)
    v_mfma_f32_32x32x16_bf16 a[48:63], v[44:47], v[96:99], 0
    ds_read_b128 v[36:39], v27 offset:40960
    v_exp_f32 v17, v93
    v_add_f32 v14, v14, v18
    v_add_f32 v15, v15, v19
    v_cvt_pk_bf16_f32 v109, v18, v19
    v_exp_f32 v18, v94
    s_waitcnt lgkmcnt(4)
    v_mfma_f32_32x32x16_bf16 a[48:63], v[48:51], v[100:103], a[48:63]
    ds_read_b128 v[40:43], v28 offset:40960
    v_exp_f32 v19, v95
    v_add_f32 v14, v14, v16
    v_add_f32 v15, v15, v17
    v_cvt_pk_bf16_f32 v110, v16, v17
    s_nop 0
    v_add_f32 v14, v14, v18
    v_add_f32 v15, v15, v19
    v_cvt_pk_bf16_f32 v111, v18, v19
    v_add_f32 v14, v14, v15
    v_cmp_nle_f32 vcc, v14, v60
    s_cbranch_vccnz L_slow17
L_back17:
    v_add_f32 v12, v12, v14
    s_waitcnt lgkmcnt(4)
    v_mfma_f32_32x32x16_bf16 v[80:95], v[52:55], a[64:67], v[112:127]
    ds_read_b128 v[44:47], v29 offset:40960
    v_exp_f32 v16, v64
    v_exp_f32 v17, v65
    s_waitcnt lgkmcnt(4)
    v_mfma_f32_32x32x16_bf16 v[80:95], v[56:59], a[68:71], v[80:95]
    ds_read_b128 v[48:51], v30 offset:40960
    v_exp_f32 v18, v66
    v_exp_f32 v19, v67
    s_waitcnt lgkmcnt(4)
    v_mfma_f32_32x32x16_bf16 v[80:95], v[32:35], a[72:75], v[80:95]
    ds_read_b128 v[52:55], v31 offset:40960
    v_mov_b32 v14, v16
    v_mov_b32 v15, v17
    v_cvt_pk_bf16_f32 v96, v16, v17
    s_waitcnt lgkmcnt(4)
    v_mfma_f32_32x32x16_bf16 v[80:95], v[36:39], a[76:79], v[80:95]
    ds_read_b64_tr_b16 v[56:57], v20 offset:8192
    ds_read_b64_tr_b16 v[58:59], v20 offset:9216
    v_exp_f32 v16, v68
    v_exp_f32 v17, v69
    s_waitcnt lgkmcnt(5)
    v_mfma_f32_32x32x16_bf16 v[80:95], v[40:43], a[80:83], v[80:95]
    ds_read_b64_tr_b16 v[32:33], v20 offset:12288
    ds_read_b64_tr_b16 v[34:35], v20 offset:13312
    v_add_f32 v14, v14, v18
    v_add_f32 v15, v15, v19
    v_cvt_pk_bf16_f32 v97, v18, v19
    s_waitcnt lgkmcnt(6)
    v_mfma_f32_32x32x16_bf16 v[80:95], v[44:47], a[84:87], v[80:95]
    ds_read_b64_tr_b16 v[36:37], v21 offset:8192
    ds_read_b64_tr_b16 v[38:39], v21 offset:9216
    v_exp_f32 v18, v70
    v_exp_f32 v19, v71
    s_waitcnt lgkmcnt(7)
    v_mfma_f32_32x32x16_bf16 v[80:95], v[48:51], a[88:91], v[80:95]
    ds_read_b64_tr_b16 v[40:41], v21 offset:12288
    ds_read_b64_tr_b16 v[42:43], v21 offset:13312
    v_add_f32 v14, v14, v16
    v_add_f32 v15, v15, v17
    v_cvt_pk_bf16_f32 v98, v16, v17
    s_waitcnt lgkmcnt(8)
    v_mfma_f32_32x32x16_bf16 v[80:95], v[52:55], a[92:95], v[80:95]
    ds_read_b64_tr_b16 v[44:45], v22 offset:8192
    ds_read_b64_tr_b16 v[46:47], v22 offset:9216
    v_exp_f32 v16, v72
    v_exp_f32 v17, v73
    s_waitcnt lgkmcnt(8)
    v_mfma_f32_32x32x16_bf16 a[0:15], v[56:59], v[104:107], a[0:15]
    ds_read_b64_tr_b16 v[48:49], v22 offset:12288
    ds_read_b64_tr_b16 v[50:51], v22 offset:13312
    v_add_f32 v14, v14, v18
    v_add_f32 v15, v15, v19
    v_cvt_pk_bf16_f32 v99, v18, v19
    v_exp_f32 v18, v74
    s_waitcnt lgkmcnt(8)
    v_mfma_f32_32x32x16_bf16 a[0:15], v[32:35], v[108:111], a[0:15]
    ds_read_b64_tr_b16 v[52:53], v23 offset:8192
    ds_read_b64_tr_b16 v[54:55], v23 offset:9216
    v_exp_f32 v19, v75
    v_add_f32 v14, v14, v16
    v_add_f32 v15, v15, v17
    s_waitcnt lgkmcnt(8)
    v_mfma_f32_32x32x16_bf16 a[16:31], v[36:39], v[104:107], a[16:31]
    ds_read_b64_tr_b16 v[56:57], v23 offset:12288
    ds_read_b64_tr_b16 v[58:59], v23 offset:13312
    v_cvt_pk_bf16_f32 v100, v16, v17
    v_exp_f32 v16, v76
    v_exp_f32 v17, v77
    s_waitcnt lgkmcnt(8)
    v_mfma_f32_32x32x16_bf16 a[16:31], v[40:43], v[108:111], a[16:31]
    v_add_u32 v24, 0xfffec000, v24
    v_add_u32 v25, 0xfffec000, v25
    v_add_u32 v26, 0xfffec000, v26
    v_add_u32 v27, 0xfffec000, v27
    v_add_u32 v28, 0xfffec000, v28
    v_add_u32 v29, 0xfffec000, v29
    v_add_u32 v30, 0xfffec000, v30
    v_add_u32 v31, 0xfffec000, v31
    ds_read_b128 v[32:35], v24 offset:0
    v_add_f32 v14, v14, v18
    v_add_f32 v15, v15, v19
    v_cvt_pk_bf16_f32 v101, v18, v19
    v_exp_f32 v18, v78
    s_waitcnt lgkmcnt(7)
    v_mfma_f32_32x32x16_bf16 a[32:47], v[44:47], v[104:107], a[32:47]
    ds_read_b128 v[36:39], v25 offset:0
    v_exp_f32 v19, v79
    v_add_f32 v14, v14, v16
    v_add_f32 v15, v15, v17
    s_waitcnt lgkmcnt(6)
    v_mfma_f32_32x32x16_bf16 a[32:47], v[48:51], v[108:111], a[32:47]
    ds_read_b128 v[40:43], v26 offset:0
    v_cvt_pk_bf16_f32 v102, v16, v17
    s_nop 0
    v_add_f32 v14, v14, v18
    v_add_f32 v15, v15, v19
    s_waitcnt lgkmcnt(5)
    v_mfma_f32_32x32x16_bf16 a[48:63], v[52:55], v[104:107], a[48:63]
    ds_read_b128 v[44:47], v27 offset:0
    v_cvt_pk_bf16_f32 v103, v18, v19
    v_add_f32 v14, v14, v15
    s_waitcnt lgkmcnt(4)
    v_mfma_f32_32x32x16_bf16 a[48:63], v[56:59], v[108:111], a[48:63]
    ds_read_b128 v[48:51], v28 offset:0
    v_cmp_nle_f32 vcc, v14, v60
    s_cbranch_vccnz L_slow18
L_back18:
    v_add_f32 v12, v12, v14
    s_waitcnt vmcnt(8)
    s_barrier
    s_waitcnt lgkmcnt(4)
    v_mfma_f32_32x32x16_bf16 v[64:79], v[32:35], a[64:67], v[112:127]
    ds_read_b128 v[52:55], v29 offset:0
    v_exp_f32 v16, v80
    v_exp_f32 v17, v81
    s_waitcnt lgkmcnt(4)
    v_mfma_f32_32x32x16_bf16 v[64:79], v[36:39], a[68:71], v[64:79]
    ds_read_b128 v[56:59], v30 offset:0
    s_add_u32 m0, s42, 114688
    s_add_u32 s34, s28, 98304
    buffer_load_dwordx4 v8, s[12:15], s34 offen nt lds
    v_exp_f32 v18, v82
    v_exp_f32 v19, v83
    s_waitcnt lgkmcnt(4)
    v_mfma_f32_32x32x16_bf16 v[64:79], v[40:43], a[72:75], v[64:79]
    ds_read_b128 v[32:35], v31 offset:0
    v_mov_b32 v14, v16
    v_mov_b32 v15, v17
    v_cvt_pk_bf16_f32 v104, v16, v17
    s_waitcnt lgkmcnt(4)
    v_mfma_f32_32x32x16_bf16 v[64:79], v[44:47], a[76:79], v[64:79]
    ds_read_b64_tr_b16 v[36:37], v20 offset:16384
    ds_read_b64_tr_b16 v[38:39], v20 offset:17408
    v_exp_f32 v16, v84
    v_exp_f32 v17, v85
    s_waitcnt lgkmcnt(5)
    v_mfma_f32_32x32x16_bf16 v[64:79], v[48:51], a[80:83], v[64:79]
    ds_read_b64_tr_b16 v[40:41], v20 offset:20480
    ds_read_b64_tr_b16 v[42:43], v20 offset:21504
    s_add_u32 m0, s42, 122880
    s_add_u32 s34, s28, 106496
    buffer_load_dwordx4 v8, s[12:15], s34 offen nt lds
    v_add_f32 v14, v14, v18
    v_add_f32 v15, v15, v19
    v_cvt_pk_bf16_f32 v105, v18, v19
    s_waitcnt lgkmcnt(6)
    v_mfma_f32_32x32x16_bf16 v[64:79], v[52:55], a[84:87], v[64:79]
    ds_read_b64_tr_b16 v[44:45], v21 offset:16384
    ds_read_b64_tr_b16 v[46:47], v21 offset:17408
    v_exp_f32 v18, v86
    v_exp_f32 v19, v87
    s_waitcnt lgkmcnt(7)
    v_mfma_f32_32x32x16_bf16 v[64:79], v[56:59], a[88:91], v[64:79]
    ds_read_b64_tr_b16 v[48:49], v21 offset:20480
    ds_read_b64_tr_b16 v[50:51], v21 offset:21504
    v_add_f32 v14, v14, v16
    v_add_f32 v15, v15, v17
    v_cvt_pk_bf16_f32 v106, v16, v17
    s_waitcnt lgkmcnt(8)
    v_mfma_f32_32x32x16_bf16 v[64:79], v[32:35], a[92:95], v[64:79]
    ds_read_b64_tr_b16 v[52:53], v22 offset:16384
    ds_read_b64_tr_b16 v[54:55], v22 offset:17408
    v_exp_f32 v16, v88
    v_exp_f32 v17, v89
    s_waitcnt lgkmcnt(8)
    v_mfma_f32_32x32x16_bf16 a[0:15], v[36:39], v[96:99], a[0:15]
    ds_read_b64_tr_b16 v[56:57], v22 offset:20480
    ds_read_b64_tr_b16 v[58:59], v22 offset:21504
    s_add_u32 m0, s42, 131072
    s_add_u32 s34, s28, 81920
    buffer_load_dwordx4 v7, s[16:19], s34 offen nt lds
    v_add_f32 v14, v14, v18
    v_add_f32 v15, v15, v19
    v_cvt_pk_bf16_f32 v107, v18, v19
    v_exp_f32 v18, v90
    s_waitcnt lgkmcnt(8)
    v_mfma_f32_32x32x16_bf16 a[0:15], v[40:43], v[100:103], a[0:15]
    ds_read_b64_tr_b16 v[32:33], v23 offset:16384
    ds_read_b64_tr_b16 v[34:35], v23 offset:17408
    v_exp_f32 v19, v91
    v_add_f32 v14, v14, v16
    v_add_f32 v15, v15, v17
    s_waitcnt lgkmcnt(8)
    v_mfma_f32_32x32x16_bf16 a[16:31], v[44:47], v[96:99], a[16:31]
    ds_read_b64_tr_b16 v[36:37], v23 offset:20480
    ds_read_b64_tr_b16 v[38:39], v23 offset:21504
    v_cvt_pk_bf16_f32 v108, v16, v17
    v_exp_f32 v16, v92
    v_exp_f32 v17, v93
    s_waitcnt lgkmcnt(8)
    v_mfma_f32_32x32x16_bf16 a[16:31], v[48:51], v[100:103], a[16:31]
    ds_read_b128 v[40:43], v24 offset:8192
    v_add_f32 v14, v14, v18
    v_add_f32 v15, v15, v19
    v_cvt_pk_bf16_f32 v109, v18, v19
    v_exp_f32 v18, v94
    s_waitcnt lgkmcnt(7)
    v_mfma_f32_32x32x16_bf16 a[32:47], v[52:55], v[96:99], a[32:47]
    ds_read_b128 v[44:47], v25 offset:8192
    s_add_u32 m0, s42, 139264
    s_add_u32 s34, s28, 90112
    buffer_load_dwordx4 v7, s[16:19], s34 offen nt lds
    v_exp_f32 v19, v95
    v_add_f32 v14, v14, v16
    v_add_f32 v15, v15, v17
    s_waitcnt lgkmcnt(6)
    v_mfma_f32_32x32x16_bf16 a[32:47], v[56:59], v[100:103], a[32:47]
    ds_read_b128 v[48:51], v26 offset:8192
    v_cvt_pk_bf16_f32 v110, v16, v17
    s_nop 0
    v_add_f32 v14, v14, v18
    v_add_f32 v15, v15, v19
    s_waitcnt lgkmcnt(5)
    v_mfma_f32_32x32x16_bf16 a[48:63], v[32:35], v[96:99], a[48:63]
    ds_read_b128 v[52:55], v27 offset:8192
    v_cvt_pk_bf16_f32 v111, v18, v19
    v_add_f32 v14, v14, v15
    s_waitcnt lgkmcnt(4)
    v_mfma_f32_32x32x16_bf16 a[48:63], v[36:39], v[100:103], a[48:63]
    ds_read_b128 v[56:59], v28 offset:8192
    v_cmp_nle_f32 vcc, v14, v60
    s_cbranch_vccnz L_slow19
L_back19:
    v_add_f32 v12, v12, v14
    s_waitcnt lgkmcnt(4)
    v_mfma_f32_32x32x16_bf16 v[80:95], v[40:43], a[64:67], v[112:127]
    ds_read_b128 v[32:35], v29 offset:8192
    v_exp_f32 v16, v64
    v_exp_f32 v17, v65
    s_waitcnt lgkmcnt(4)
    v_mfma_f32_32x32x16_bf16 v[80:95], v[44:47], a[68:71], v[80:95]
    ds_read_b128 v[36:39], v30 offset:8192
    v_exp_f32 v18, v66
    v_exp_f32 v19, v67
    s_waitcnt lgkmcnt(4)
    v_mfma_f32_32x32x16_bf16 v[80:95], v[48:51], a[72:75], v[80:95]
    ds_read_b128 v[40:43], v31 offset:8192
    v_mov_b32 v14, v16
    v_mov_b32 v15, v17
    v_cvt_pk_bf16_f32 v96, v16, v17
    s_waitcnt lgkmcnt(4)
    v_mfma_f32_32x32x16_bf16 v[80:95], v[52:55], a[76:79], v[80:95]
    ds_read_b64_tr_b16 v[44:45], v20 offset:24576
    ds_read_b64_tr_b16 v[46:47], v20 offset:25600
    v_exp_f32 v16, v68
    v_exp_f32 v17, v69
    s_waitcnt lgkmcnt(5)
    v_mfma_f32_32x32x16_bf16 v[80:95], v[56:59], a[80:83], v[80:95]
    ds_read_b64_tr_b16 v[48:49], v20 offset:28672
    ds_read_b64_tr_b16 v[50:51], v20 offset:29696
    v_add_f32 v14, v14, v18
    v_add_f32 v15, v15, v19
    v_cvt_pk_bf16_f32 v97, v18, v19
    s_waitcnt lgkmcnt(6)
    v_mfma_f32_32x32x16_bf16 v[80:95], v[32:35], a[84:87], v[80:95]
    ds_read_b64_tr_b16 v[52:53], v21 offset:24576
    ds_read_b64_tr_b16 v[54:55], v21 offset:25600
    v_exp_f32 v18, v70
    v_exp_f32 v19, v71
    s_waitcnt lgkmcnt(7)
    v_mfma_f32_32x32x16_bf16 v[80:95], v[36:39], a[88:91], v[80:95]
    ds_read_b64_tr_b16 v[56:57], v21 offset:28672
    ds_read_b64_tr_b16 v[58:59], v21 offset:29696
    v_add_f32 v14, v14, v16
    v_add_f32 v15, v15, v17
    v_cvt_pk_bf16_f32 v98, v16, v17
    s_waitcnt lgkmcnt(8)
    v_mfma_f32_32x32x16_bf16 v[80:95], v[40:43], a[92:95], v[80:95]
    ds_read_b64_tr_b16 v[32:33], v22 offset:24576
    ds_read_b64_tr_b16 v[34:35], v22 offset:25600
    v_exp_f32 v16, v72
    v_exp_f32 v17, v73
    s_waitcnt lgkmcnt(8)
    v_mfma_f32_32x32x16_bf16 a[0:15], v[44:47], v[104:107], a[0:15]
    ds_read_b64_tr_b16 v[36:37], v22 offset:28672
    ds_read_b64_tr_b16 v[38:39], v22 offset:29696
    v_add_f32 v14, v14, v18
    v_add_f32 v15, v15, v19
    v_cvt_pk_bf16_f32 v99, v18, v19
    v_exp_f32 v18, v74
    s_waitcnt lgkmcnt(8)
    v_mfma_f32_32x32x16_bf16 a[0:15], v[48:51], v[108:111], a[0:15]
    ds_read_b64_tr_b16 v[40:41], v23 offset:24576
    ds_read_b64_tr_b16 v[42:43], v23 offset:25600
    v_exp_f32 v19, v75
    v_add_f32 v14, v14, v16
    v_add_f32 v15, v15, v17
    s_waitcnt lgkmcnt(8)
    v_mfma_f32_32x32x16_bf16 a[16:31], v[52:55], v[104:107], a[16:31]
    ds_read_b64_tr_b16 v[44:45], v23 offset:28672
    ds_read_b64_tr_b16 v[46:47], v23 offset:29696
    v_cvt_pk_bf16_f32 v100, v16, v17
    v_exp_f32 v16, v76
    v_exp_f32 v17, v77
    s_waitcnt lgkmcnt(8)
    v_mfma_f32_32x32x16_bf16 a[16:31], v[56:59], v[108:111], a[16:31]
    ds_read_b128 v[48:51], v24 offset:16384
    v_add_f32 v14, v14, v18
    v_add_f32 v15, v15, v19
    v_cvt_pk_bf16_f32 v101, v18, v19
    v_exp_f32 v18, v78
    s_waitcnt lgkmcnt(7)
    v_mfma_f32_32x32x16_bf16 a[32:47], v[32:35], v[104:107], a[32:47]
    ds_read_b128 v[52:55], v25 offset:16384
    v_exp_f32 v19, v79
    v_add_f32 v14, v14, v16
    v_add_f32 v15, v15, v17
    s_waitcnt lgkmcnt(6)
    v_mfma_f32_32x32x16_bf16 a[32:47], v[36:39], v[108:111], a[32:47]
    ds_read_b128 v[56:59], v26 offset:16384
    v_cvt_pk_bf16_f32 v102, v16, v17
    s_nop 0
    v_add_f32 v14, v14, v18
    v_add_f32 v15, v15, v19
    s_waitcnt lgkmcnt(5)
    v_mfma_f32_32x32x16_bf16 a[48:63], v[40:43], v[104:107], a[48:63]
    ds_read_b128 v[32:35], v27 offset:16384
    v_cvt_pk_bf16_f32 v103, v18, v19
    v_add_f32 v14, v14, v15
    s_waitcnt lgkmcnt(4)
    v_mfma_f32_32x32x16_bf16 a[48:63], v[44:47], v[108:111], a[48:63]
    ds_read_b128 v[36:39], v28 offset:16384
    v_cmp_nle_f32 vcc, v14, v60
    s_cbranch_vccnz L_slow20
L_back20:
    v_add_f32 v12, v12, v14
    s_waitcnt vmcnt(8)
    s_barrier
    s_waitcnt lgkmcnt(4)
    v_mfma_f32_32x32x16_bf16 v[64:79], v[48:51], a[64:67], v[112:127]
    ds_read_b128 v[40:43], v29 offset:16384
    v_exp_f32 v16, v80
    v_exp_f32 v17, v81
    s_waitcnt lgkmcnt(4)
    v_mfma_f32_32x32x16_bf16 v[64:79], v[52:55], a[68:71], v[64:79]
    ds_read_b128 v[44:47], v30 offset:16384
    s_add_u32 m0, s42, 0
    s_add_u32 s34, s28, 114688
    buffer_load_dwordx4 v8, s[12:15], s34 offen nt lds
    v_exp_f32 v18, v82
    v_exp_f32 v19, v83
    s_waitcnt lgkmcnt(4)
    v_mfma_f32_32x32x16_bf16 v[64:79], v[56:59], a[72:75], v[64:79]
    ds_read_b128 v[48:51], v31 offset:16384
    v_mov_b32 v14, v16
    v_mov_b32 v15, v17
    v_cvt_pk_bf16_f32 v104, v16, v17
    s_waitcnt lgkmcnt(4)
    v_mfma_f32_32x32x16_bf16 v[64:79], v[32:35], a[76:79], v[64:79]
    v_add_u32 v20, 0xfffe8000, v20
    v_add_u32 v21, 0xfffe8000, v21
    v_add_u32 v22, 0xfffe8000, v22
    v_add_u32 v23, 0xfffe8000, v23
    ds_read_b64_tr_b16 v[52:53], v20 offset:0
    ds_read_b64_tr_b16 v[54:55], v20 offset:1024
    v_exp_f32 v16, v84
    v_exp_f32 v17, v85
    s_waitcnt lgkmcnt(5)
    v_mfma_f32_32x32x16_bf16 v[64:79], v[36:39], a[80:83], v[64:79]
    ds_read_b64_tr_b16 v[56:57], v20 offset:4096
    ds_read_b64_tr_b16 v[58:59], v20 offset:5120
    s_add_u32 m0, s42, 8192
    s_add_u32 s34, s28, 122880
    buffer_load_dwordx4 v8, s[12:15], s34 offen nt lds
    v_add_f32 v14, v14, v18
    v_add_f32 v15, v15, v19
    v_cvt_pk_bf16_f32 v105, v18, v19
    s_waitcnt lgkmcnt(6)
    v_mfma_f32_32x32x16_bf16 v[64:79], v[40:43], a[84:87], v[64:79]
    ds_read_b64_tr_b16 v[32:33], v21 offset:0
    ds_read_b64_tr_b16 v[34:35], v21 offset:1024
    v_exp_f32 v18, v86
    v_exp_f32 v19, v87
    s_waitcnt lgkmcnt(7)
    v_mfma_f32_32x32x16_bf16 v[64:79], v[44:47], a[88:91], v[64:79]
    ds_read_b64_tr_b16 v[36:37], v21 offset:4096
    ds_read_b64_tr_b16 v[38:39], v21 offset:5120
    v_add_f32 v14, v14, v16
    v_add_f32 v15, v15, v17
    v_cvt_pk_bf16_f32 v106, v16, v17
    s_waitcnt lgkmcnt(8)
    v_mfma_f32_32x32x16_bf16 v[64:79], v[48:51], a[92:95], v[64:79]
    ds_read_b64_tr_b16 v[40:41], v22 offset:0
    ds_read_b64_tr_b16 v[42:43], v22 offset:1024
    v_exp_f32 v16, v88
    v_exp_f32 v17, v89
    s_waitcnt lgkmcnt(8)
    v_mfma_f32_32x32x16_bf16 a[0:15], v[52:55], v[96:99], a[0:15]
    ds_read_b64_tr_b16 v[44:45], v22 offset:4096
    ds_read_b64_tr_b16 v[46:47], v22 offset:5120
    s_add_u32 m0, s42, 147456
    s_add_u32 s34, s28, 98304
    buffer_load_dwordx4 v7, s[16:19], s34 offen nt lds
    v_add_f32 v14, v14, v18
    v_add_f32 v15, v15, v19
    v_cvt_pk_bf16_f32 v107, v18, v19
    v_exp_f32 v18, v90
    s_waitcnt lgkmcnt(8)
    v_mfma_f32_32x32x16_bf16 a[0:15], v[56:59], v[100:103], a[0:15]
    ds_read_b64_tr_b16 v[48:49], v23 offset:0
    ds_read_b64_tr_b16 v[50:51], v23 offset:1024
    v_exp_f32 v19, v91
    v_add_f32 v14, v14, v16
    v_add_f32 v15, v15, v17
    s_waitcnt lgkmcnt(8)
    v_mfma_f32_32x32x16_bf16 a[16:31], v[32:35], v[96:99], a[16:31]
    ds_read_b64_tr_b16 v[52:53], v23 offset:4096
    ds_read_b64_tr_b16 v[54:55], v23 offset:5120
    v_cvt_pk_bf16_f32 v108, v16, v17
    v_exp_f32 v16, v92
    v_exp_f32 v17, v93
    s_waitcnt lgkmcnt(8)
    v_mfma_f32_32x32x16_bf16 a[16:31], v[36:39], v[100:103], a[16:31]
    ds_read_b128 v[56:59], v24 offset:24576
    v_add_f32 v14, v14, v18
    v_add_f32 v15, v15, v19
    v_cvt_pk_bf16_f32 v109, v18, v19
    v_exp_f32 v18, v94
    s_waitcnt lgkmcnt(7)
    v_mfma_f32_32x32x16_bf16 a[32:47], v[40:43], v[96:99], a[32:47]
    ds_read_b128 v[32:35], v25 offset:24576
    s_add_u32 m0, s42, 155648
    s_add_u32 s34, s28, 106496
    buffer_load_dwordx4 v7, s[16:19], s34 offen nt lds
    v_exp_f32 v19, v95
    v_add_f32 v14, v14, v16
    v_add_f32 v15, v15, v17
    s_waitcnt lgkmcnt(6)
    v_mfma_f32_32x32x16_bf16 a[32:47], v[44:47], v[100:103], a[32:47]
    ds_read_b128 v[36:39], v26 offset:24576
    v_cvt_pk_bf16_f32 v110, v16, v17
    s_nop 0
    v_add_f32 v14, v14, v18
    v_add_f32 v15, v15, v19
    s_waitcnt lgkmcnt(5)
    v_mfma_f32_32x32x16_bf16 a[48:63], v[48:51], v[96:99], a[48:63]
    ds_read_b128 v[40:43], v27 offset:24576
    v_cvt_pk_bf16_f32 v111, v18, v19
    v_add_f32 v14, v14, v15
    s_waitcnt lgkmcnt(4)
    v_mfma_f32_32x32x16_bf16 a[48:63], v[52:55], v[100:103], a[48:63]
    ds_read_b128 v[44:47], v28 offset:24576
    v_cmp_nle_f32 vcc, v14, v60
    s_cbranch_vccnz L_slow21
L_back21:
    v_add_f32 v12, v12, v14
    s_waitcnt lgkmcnt(4)
    v_mfma_f32_32x32x16_bf16 v[80:95], v[56:59], a[64:67], v[112:127]
    ds_read_b128 v[48:51], v29 offset:24576
    v_exp_f32 v16, v64
    v_exp_f32 v17, v65
    s_waitcnt lgkmcnt(4)
    v_mfma_f32_32x32x16_bf16 v[80:95], v[32:35], a[68:71], v[80:95]
    ds_read_b128 v[52:55], v30 offset:24576
    v_exp_f32 v18, v66
    v_exp_f32 v19, v67
    s_waitcnt lgkmcnt(4)
    v_mfma_f32_32x32x16_bf16 v[80:95], v[36:39], a[72:75], v[80:95]
    ds_read_b128 v[56:59], v31 offset:24576
    v_mov_b32 v14, v16
    v_mov_b32 v15, v17
    v_cvt_pk_bf16_f32 v96, v16, v17
    s_waitcnt lgkmcnt(4)
    v_mfma_f32_32x32x16_bf16 v[80:95], v[40:43], a[76:79], v[80:95]
    ds_read_b64_tr_b16 v[32:33], v20 offset:8192
    ds_read_b64_tr_b16 v[34:35], v20 offset:9216
    v_exp_f32 v16, v68
    v_exp_f32 v17, v69
    s_waitcnt lgkmcnt(5)
    v_mfma_f32_32x32x16_bf16 v[80:95], v[44:47], a[80:83], v[80:95]
    ds_read_b64_tr_b16 v[36:37], v20 offset:12288
    ds_read_b64_tr_b16 v[38:39], v20 offset:13312
    v_add_f32 v14, v14, v18
    v_add_f32 v15, v15, v19
    v_cvt_pk_bf16_f32 v97, v18, v19
    s_waitcnt lgkmcnt(6)
    v_mfma_f32_32x32x16_bf16 v[80:95], v[48:51], a[84:87], v[80:95]
    ds_read_b64_tr_b16 v[40:41], v21 offset:8192
    ds_read_b64_tr_b16 v[42:43], v21 offset:9216
    v_exp_f32 v18, v70
    v_exp_f32 v19, v71
    s_waitcnt lgkmcnt(7)
    v_mfma_f32_32x32x16_bf16 v[80:95], v[52:55], a[88:91], v[80:95]
    ds_read_b64_tr_b16 v[44:45], v21 offset:12288
    ds_read_b64_tr_b16 v[46:47], v21 offset:13312
    v_add_f32 v14, v14, v16
    v_add_f32 v15, v15, v17
    v_cvt_pk_bf16_f32 v98, v16, v17
    s_waitcnt lgkmcnt(8)
    v_mfma_f32_32x32x16_bf16 v[80:95], v[56:59], a[92:95], v[80:95]
    ds_read_b64_tr_b16 v[48:49], v22 offset:8192
    ds_read_b64_tr_b16 v[50:51], v22 offset:9216
    v_exp_f32 v16, v72
    v_exp_f32 v17, v73
    s_waitcnt lgkmcnt(8)
    v_mfma_f32_32x32x16_bf16 a[0:15], v[32:35], v[104:107], a[0:15]
    ds_read_b64_tr_b16 v[52:53], v22 offset:12288
    ds_read_b64_tr_b16 v[54:55], v22 offset:13312
    v_add_f32 v14, v14, v18
    v_add_f32 v15, v15, v19
    v_cvt_pk_bf16_f32 v99, v18, v19
    v_exp_f32 v18, v74
    s_waitcnt lgkmcnt(8)
    v_mfma_f32_32x32x16_bf16 a[0:15], v[36:39], v[108:111], a[0:15]
    ds_read_b64_tr_b16 v[56:57], v23 offset:8192
    ds_read_b64_tr_b16 v[58:59], v23 offset:9216
    v_exp_f32 v19, v75
    v_add_f32 v14, v14, v16
    v_add_f32 v15, v15, v17
    s_waitcnt lgkmcnt(8)
    v_mfma_f32_32x32x16_bf16 a[16:31], v[40:43], v[104:107], a[16:31]
    ds_read_b64_tr_b16 v[32:33], v23 offset:12288
    ds_read_b64_tr_b16 v[34:35], v23 offset:13312
    v_cvt_pk_bf16_f32 v100, v16, v17
    v_exp_f32 v16, v76
    v_exp_f32 v17, v77
    s_waitcnt lgkmcnt(8)
    v_mfma_f32_32x32x16_bf16 a[16:31], v[44:47], v[108:111], a[16:31]
    ds_read_b128 v[36:39], v24 offset:49152
    v_add_f32 v14, v14, v18
    v_add_f32 v15, v15, v19
    v_cvt_pk_bf16_f32 v101, v18, v19
    v_exp_f32 v18, v78
    s_waitcnt lgkmcnt(7)
    v_mfma_f32_32x32x16_bf16 a[32:47], v[48:51], v[104:107], a[32:47]
    ds_read_b128 v[40:43], v25 offset:49152
    v_exp_f32 v19, v79
    v_add_f32 v14, v14, v16
    v_add_f32 v15, v15, v17
    s_waitcnt lgkmcnt(6)
    v_mfma_f32_32x32x16_bf16 a[32:47], v[52:55], v[108:111], a[32:47]
    ds_read_b128 v[44:47], v26 offset:49152
    v_cvt_pk_bf16_f32 v102, v16, v17
    s_nop 0
    v_add_f32 v14, v14, v18
    v_add_f32 v15, v15, v19
    s_waitcnt lgkmcnt(5)
    v_mfma_f32_32x32x16_bf16 a[48:63], v[56:59], v[104:107], a[48:63]
    ds_read_b128 v[48:51], v27 offset:49152
    v_cvt_pk_bf16_f32 v103, v18, v19
    v_add_f32 v14, v14, v15
    s_waitcnt lgkmcnt(4)
    v_mfma_f32_32x32x16_bf16 a[48:63], v[32:35], v[108:111], a[48:63]
    ds_read_b128 v[52:55], v28 offset:49152
    v_cmp_nle_f32 vcc, v14, v60
    s_cbranch_vccnz L_slow22
L_back22:
    v_add_f32 v12, v12, v14
    s_waitcnt vmcnt(8)
    s_barrier
    s_waitcnt lgkmcnt(4)
    v_mfma_f32_32x32x16_bf16 v[64:79], v[36:39], a[64:67], v[112:127]
    ds_read_b128 v[56:59], v29 offset:49152
    v_exp_f32 v16, v80
    v_exp_f32 v17, v81
    s_waitcnt lgkmcnt(4)
    v_mfma_f32_32x32x16_bf16 v[64:79], v[40:43], a[68:71], v[64:79]
    ds_read_b128 v[32:35], v30 offset:49152
    s_add_u32 m0, s42, 16384
    s_add_u32 s34, s28, 114688
    buffer_load_dwordx4 v7, s[16:19], s34 offen nt lds
    v_exp_f32 v18, v82
    v_exp_f32 v19, v83
    s_waitcnt lgkmcnt(4)
    v_mfma_f32_32x32x16_bf16 v[64:79], v[44:47], a[72:75], v[64:79]
    ds_read_b128 v[36:39], v31 offset:49152
    v_mov_b32 v14, v16
    v_mov_b32 v15, v17
    v_cvt_pk_bf16_f32 v104, v16, v17
    s_waitcnt lgkmcnt(4)
    v_mfma_f32_32x32x16_bf16 v[64:79], v[48:51], a[76:79], v[64:79]
    ds_read_b64_tr_b16 v[40:41], v20 offset:32768
    ds_read_b64_tr_b16 v[42:43], v20 offset:33792
    v_exp_f32 v16, v84
    v_exp_f32 v17, v85
    s_waitcnt lgkmcnt(5)
    v_mfma_f32_32x32x16_bf16 v[64:79], v[52:55], a[80:83], v[64:79]
    ds_read_b64_tr_b16 v[44:45], v20 offset:36864
    ds_read_b64_tr_b16 v[46:47], v20 offset:37888
    v_add_f32 v14, v14, v18
    v_add_f32 v15, v15, v19
    v_cvt_pk_bf16_f32 v105, v18, v19
    s_waitcnt lgkmcnt(6)
    v_mfma_f32_32x32x16_bf16 v[64:79], v[56:59], a[84:87], v[64:79]
    ds_read_b64_tr_b16 v[48:49], v21 offset:32768
    ds_read_b64_tr_b16 v[50:51], v21 offset:33792
    v_exp_f32 v18, v86
    v_exp_f32 v19, v87
    s_waitcnt lgkmcnt(7)
    v_mfma_f32_32x32x16_bf16 v[64:79], v[32:35], a[88:91], v[64:79]
    ds_read_b64_tr_b16 v[52:53], v21 offset:36864
    ds_read_b64_tr_b16 v[54:55], v21 offset:37888
    v_add_f32 v14, v14, v16
    v_add_f32 v15, v15, v17
    v_cvt_pk_bf16_f32 v106, v16, v17
    s_waitcnt lgkmcnt(8)
    v_mfma_f32_32x32x16_bf16 v[64:79], v[36:39], a[92:95], v[64:79]
    ds_read_b64_tr_b16 v[56:57], v22 offset:32768
    ds_read_b64_tr_b16 v[58:59], v22 offset:33792
    v_exp_f32 v16, v88
    v_exp_f32 v17, v89
    s_waitcnt lgkmcnt(8)
    v_mfma_f32_32x32x16_bf16 a[0:15], v[40:43], v[96:99], a[0:15]
    ds_read_b64_tr_b16 v[32:33], v22 offset:36864
    ds_read_b64_tr_b16 v[34:35], v22 offset:37888
    s_add_u32 m0, s42, 24576
    s_add_u32 s34, s28, 122880
    buffer_load_dwordx4 v7, s[16:19], s34 offen nt lds
    v_add_f32 v14, v14, v18
    v_add_f32 v15, v15, v19
    v_cvt_pk_bf16_f32 v107, v18, v19
    v_exp_f32 v18, v90
    s_waitcnt lgkmcnt(8)
    v_mfma_f32_32x32x16_bf16 a[0:15], v[44:47], v[100:103], a[0:15]
    ds_read_b64_tr_b16 v[36:37], v23 offset:32768
    ds_read_b64_tr_b16 v[38:39], v23 offset:33792
    v_exp_f32 v19, v91
    v_add_f32 v14, v14, v16
    v_add_f32 v15, v15, v17
    s_waitcnt lgkmcnt(8)
    v_mfma_f32_32x32x16_bf16 a[16:31], v[48:51], v[96:99], a[16:31]
    ds_read_b64_tr_b16 v[40:41], v23 offset:36864
    ds_read_b64_tr_b16 v[42:43], v23 offset:37888
    v_cvt_pk_bf16_f32 v108, v16, v17
    v_exp_f32 v16, v92
    v_exp_f32 v17, v93
    s_waitcnt lgkmcnt(8)
    v_mfma_f32_32x32x16_bf16 a[16:31], v[52:55], v[100:103], a[16:31]
    ds_read_b128 v[44:47], v24 offset:57344
    v_add_f32 v14, v14, v18
    v_add_f32 v15, v15, v19
    v_cvt_pk_bf16_f32 v109, v18, v19
    v_exp_f32 v18, v94
    s_waitcnt lgkmcnt(7)
    v_mfma_f32_32x32x16_bf16 a[32:47], v[56:59], v[96:99], a[32:47]
    ds_read_b128 v[48:51], v25 offset:57344
    v_exp_f32 v19, v95
    v_add_f32 v14, v14, v16
    v_add_f32 v15, v15, v17
    s_waitcnt lgkmcnt(6)
    v_mfma_f32_32x32x16_bf16 a[32:47], v[32:35], v[100:103], a[32:47]
    ds_read_b128 v[52:55], v26 offset:57344
    v_cvt_pk_bf16_f32 v110, v16, v17
    s_nop 0
    v_add_f32 v14, v14, v18
    v_add_f32 v15, v15, v19
    s_waitcnt lgkmcnt(5)
    v_mfma_f32_32x32x16_bf16 a[48:63], v[36:39], v[96:99], a[48:63]
    ds_read_b128 v[56:59], v27 offset:57344
    v_cvt_pk_bf16_f32 v111, v18, v19
    v_add_f32 v14, v14, v15
    s_waitcnt lgkmcnt(4)
    v_mfma_f32_32x32x16_bf16 a[48:63], v[40:43], v[100:103], a[48:63]
    ds_read_b128 v[32:35], v28 offset:57344
    v_cmp_nle_f32 vcc, v14, v60
    s_cbranch_vccnz L_slow23
L_back23:
    v_add_f32 v12, v12, v14
    s_waitcnt lgkmcnt(4)
    v_mfma_f32_32x32x16_bf16 v[80:95], v[44:47], a[64:67], v[112:127]
    ds_read_b128 v[36:39], v29 offset:57344
    v_exp_f32 v16, v64
    v_exp_f32 v17, v65
    s_waitcnt lgkmcnt(4)
    v_mfma_f32_32x32x16_bf16 v[80:95], v[48:51], a[68:71], v[80:95]
    ds_read_b128 v[40:43], v30 offset:57344
    v_exp_f32 v18, v66
    v_exp_f32 v19, v67
    s_waitcnt lgkmcnt(4)
    v_mfma_f32_32x32x16_bf16 v[80:95], v[52:55], a[72:75], v[80:95]
    ds_read_b128 v[44:47], v31 offset:57344
    v_mov_b32 v14, v16
    v_mov_b32 v15, v17
    v_cvt_pk_bf16_f32 v96, v16, v17
    s_waitcnt lgkmcnt(4)
    v_mfma_f32_32x32x16_bf16 v[80:95], v[56:59], a[76:79], v[80:95]
    ds_read_b64_tr_b16 v[48:49], v20 offset:40960
    ds_read_b64_tr_b16 v[50:51], v20 offset:41984
    v_exp_f32 v16, v68
    v_exp_f32 v17, v69
    s_waitcnt lgkmcnt(5)
    v_mfma_f32_32x32x16_bf16 v[80:95], v[32:35], a[80:83], v[80:95]
    ds_read_b64_tr_b16 v[52:53], v20 offset:45056
    ds_read_b64_tr_b16 v[54:55], v20 offset:46080
    v_add_f32 v14, v14, v18
    v_add_f32 v15, v15, v19
    v_cvt_pk_bf16_f32 v97, v18, v19
    s_waitcnt lgkmcnt(6)
    v_mfma_f32_32x32x16_bf16 v[80:95], v[36:39], a[84:87], v[80:95]
    ds_read_b64_tr_b16 v[56:57], v21 offset:40960
    ds_read_b64_tr_b16 v[58:59], v21 offset:41984
    v_exp_f32 v18, v70
    v_exp_f32 v19, v71
    s_waitcnt lgkmcnt(7)
    v_mfma_f32_32x32x16_bf16 v[80:95], v[40:43], a[88:91], v[80:95]
    ds_read_b64_tr_b16 v[32:33], v21 offset:45056
    ds_read_b64_tr_b16 v[34:35], v21 offset:46080
    v_add_f32 v14, v14, v16
    v_add_f32 v15, v15, v17
    v_cvt_pk_bf16_f32 v98, v16, v17
    s_waitcnt lgkmcnt(8)
    v_mfma_f32_32x32x16_bf16 v[80:95], v[44:47], a[92:95], v[80:95]
    ds_read_b64_tr_b16 v[36:37], v22 offset:40960
    ds_read_b64_tr_b16 v[38:39], v22 offset:41984
    v_exp_f32 v16, v72
    v_exp_f32 v17, v73
    s_waitcnt lgkmcnt(8)
    v_mfma_f32_32x32x16_bf16 a[0:15], v[48:51], v[104:107], a[0:15]
    ds_read_b64_tr_b16 v[40:41], v22 offset:45056
    ds_read_b64_tr_b16 v[42:43], v22 offset:46080
    v_add_f32 v14, v14, v18
    v_add_f32 v15, v15, v19
    v_cvt_pk_bf16_f32 v99, v18, v19
    v_exp_f32 v18, v74
    s_waitcnt lgkmcnt(8)
    v_mfma_f32_32x32x16_bf16 a[0:15], v[52:55], v[108:111], a[0:15]
    ds_read_b64_tr_b16 v[44:45], v23 offset:40960
    ds_read_b64_tr_b16 v[46:47], v23 offset:41984
    v_exp_f32 v19, v75
    v_add_f32 v14, v14, v16
    v_add_f32 v15, v15, v17
    s_waitcnt lgkmcnt(8)
    v_mfma_f32_32x32x16_bf16 a[16:31], v[56:59], v[104:107], a[16:31]
    ds_read_b64_tr_b16 v[48:49], v23 offset:45056
    ds_read_b64_tr_b16 v[50:51], v23 offset:46080
    v_cvt_pk_bf16_f32 v100, v16, v17
    v_exp_f32 v16, v76
    v_exp_f32 v17, v77
    s_waitcnt lgkmcnt(8)
    v_mfma_f32_32x32x16_bf16 a[16:31], v[32:35], v[108:111], a[16:31]
    v_add_u32 v24, 0x14000, v24
    v_add_u32 v25, 0x14000, v25
    v_add_u32 v26, 0x14000, v26
    v_add_u32 v27, 0x14000, v27
    v_add_u32 v28, 0x14000, v28
    v_add_u32 v29, 0x14000, v29
    v_add_u32 v30, 0x14000, v30
    v_add_u32 v31, 0x14000, v31
    ds_read_b128 v[52:55], v24 offset:0
    v_add_f32 v14, v14, v18
    v_add_f32 v15, v15, v19
    v_cvt_pk_bf16_f32 v101, v18, v19
    v_exp_f32 v18, v78
    s_waitcnt lgkmcnt(7)
    v_mfma_f32_32x32x16_bf16 a[32:47], v[36:39], v[104:107], a[32:47]
    ds_read_b128 v[56:59], v25 offset:0
    v_exp_f32 v19, v79
    v_add_f32 v14, v14, v16
    v_add_f32 v15, v15, v17
    s_waitcnt lgkmcnt(6)
    v_mfma_f32_32x32x16_bf16 a[32:47], v[40:43], v[108:111], a[32:47]
    ds_read_b128 v[32:35], v26 offset:0
    v_cvt_pk_bf16_f32 v102, v16, v17
    s_nop 0
    v_add_f32 v14, v14, v18
    v_add_f32 v15, v15, v19
    s_waitcnt lgkmcnt(5)
    v_mfma_f32_32x32x16_bf16 a[48:63], v[44:47], v[104:107], a[48:63]
    ds_read_b128 v[36:39], v27 offset:0
    v_cvt_pk_bf16_f32 v103, v18, v19
    v_add_f32 v14, v14, v15
    s_waitcnt lgkmcnt(4)
    v_mfma_f32_32x32x16_bf16 a[48:63], v[48:51], v[108:111], a[48:63]
    ds_read_b128 v[40:43], v28 offset:0
    v_cmp_nle_f32 vcc, v14, v60
    s_cbranch_vccnz L_slow24
L_back24:
    v_add_f32 v12, v12, v14
    s_waitcnt vmcnt(6)
    s_barrier
    s_waitcnt lgkmcnt(4)
    v_mfma_f32_32x32x16_bf16 v[64:79], v[52:55], a[64:67], v[112:127]
    ds_read_b128 v[44:47], v29 offset:0
    v_exp_f32 v16, v80
    v_exp_f32 v17, v81
    s_waitcnt lgkmcnt(4)
    v_mfma_f32_32x32x16_bf16 v[64:79], v[56:59], a[68:71], v[64:79]
    ds_read_b128 v[48:51], v30 offset:0
    v_lshlrev_b32 v1, 6, v0
    buffer_load_dword v1, v1, s[56:59], s50 offen
    v_exp_f32 v18, v82
    v_exp_f32 v19, v83
    s_waitcnt lgkmcnt(4)
    v_mfma_f32_32x32x16_bf16 v[64:79], v[32:35], a[72:75], v[64:79]
    ds_read_b128 v[52:55], v31 offset:0
    v_mov_b32 v14, v16
    v_mov_b32 v15, v17
    v_cvt_pk_bf16_f32 v104, v16, v17
    s_waitcnt lgkmcnt(4)
    v_mfma_f32_32x32x16_bf16 v[64:79], v[36:39], a[76:79], v[64:79]
    v_add_u32 v20, 0x10000, v20
    v_add_u32 v21, 0x10000, v21
    v_add_u32 v22, 0x10000, v22
    v_add_u32 v23, 0x10000, v23
    ds_read_b64_tr_b16 v[56:57], v20 offset:0
    ds_read_b64_tr_b16 v[58:59], v20 offset:1024
    v_exp_f32 v16, v84
    v_exp_f32 v17, v85
    s_waitcnt lgkmcnt(5)
    v_mfma_f32_32x32x16_bf16 v[64:79], v[40:43], a[80:83], v[64:79]
    ds_read_b64_tr_b16 v[32:33], v20 offset:4096
    ds_read_b64_tr_b16 v[34:35], v20 offset:5120
    buffer_store_dwordx4 v[128:131], v5, s[20:23], s43 offen offset:0
    v_add_f32 v14, v14, v18
    v_add_f32 v15, v15, v19
    v_cvt_pk_bf16_f32 v105, v18, v19
    s_waitcnt lgkmcnt(6)
    v_mfma_f32_32x32x16_bf16 v[64:79], v[44:47], a[84:87], v[64:79]
    ds_read_b64_tr_b16 v[36:37], v21 offset:0
    ds_read_b64_tr_b16 v[38:39], v21 offset:1024
    v_exp_f32 v18, v86
    v_exp_f32 v19, v87
    s_waitcnt lgkmcnt(7)
    v_mfma_f32_32x32x16_bf16 v[64:79], v[48:51], a[88:91], v[64:79]
    ds_read_b64_tr_b16 v[40:41], v21 offset:4096
    ds_read_b64_tr_b16 v[42:43], v21 offset:5120
    v_add_f32 v14, v14, v16
    v_add_f32 v15, v15, v17
    v_cvt_pk_bf16_f32 v106, v16, v17
    s_waitcnt lgkmcnt(8)
    v_mfma_f32_32x32x16_bf16 v[64:79], v[52:55], a[92:95], v[64:79]
    ds_read_b64_tr_b16 v[44:45], v22 offset:0
    ds_read_b64_tr_b16 v[46:47], v22 offset:1024
    buffer_store_dwordx4 v[132:135], v5, s[20:23], s43 offen offset:1024
    v_exp_f32 v16, v88
    v_exp_f32 v17, v89
    s_waitcnt lgkmcnt(8)
    v_mfma_f32_32x32x16_bf16 a[0:15], v[56:59], v[96:99], a[0:15]
    ds_read_b64_tr_b16 v[48:49], v22 offset:4096
    ds_read_b64_tr_b16 v[50:51], v22 offset:5120
    v_add_f32 v14, v14, v18
    v_add_f32 v15, v15, v19
    v_cvt_pk_bf16_f32 v107, v18, v19
    v_exp_f32 v18, v90
    s_waitcnt lgkmcnt(8)
    v_mfma_f32_32x32x16_bf16 a[0:15], v[32:35], v[100:103], a[0:15]
    ds_read_b64_tr_b16 v[52:53], v23 offset:0
    ds_read_b64_tr_b16 v[54:55], v23 offset:1024
    v_exp_f32 v19, v91
    v_add_f32 v14, v14, v16
    v_add_f32 v15, v15, v17
    s_waitcnt lgkmcnt(8)
    v_mfma_f32_32x32x16_bf16 a[16:31], v[36:39], v[96:99], a[16:31]
    ds_read_b64_tr_b16 v[56:57], v23 offset:4096
    ds_read_b64_tr_b16 v[58:59], v23 offset:5120
    buffer_store_dwordx4 v[136:139], v5, s[20:23], s43 offen offset:2048
    v_cvt_pk_bf16_f32 v108, v16, v17
    v_exp_f32 v16, v92
    v_exp_f32 v17, v93
    s_waitcnt lgkmcnt(8)
    v_mfma_f32_32x32x16_bf16 a[16:31], v[40:43], v[100:103], a[16:31]
    ds_read_b128 v[32:35], v24 offset:8192
    v_add_f32 v14, v14, v18
    v_add_f32 v15, v15, v19
    v_cvt_pk_bf16_f32 v109, v18, v19
    v_exp_f32 v18, v94
    s_waitcnt lgkmcnt(7)
    v_mfma_f32_32x32x16_bf16 a[32:47], v[44:47], v[96:99], a[32:47]
    ds_read_b128 v[36:39], v25 offset:8192
    v_exp_f32 v19, v95
    v_add_f32 v14, v14, v16
    v_add_f32 v15, v15, v17
    s_waitcnt lgkmcnt(6)
    v_mfma_f32_32x32x16_bf16 a[32:47], v[48:51], v[100:103], a[32:47]
    ds_read_b128 v[40:43], v26 offset:8192
    buffer_store_dwordx4 v[140:143], v5, s[20:23], s43 offen offset:3072
    v_cvt_pk_bf16_f32 v110, v16, v17
    s_nop 0
    v_add_f32 v14, v14, v18
    v_add_f32 v15, v15, v19
    s_waitcnt lgkmcnt(5)
    v_mfma_f32_32x32x16_bf16 a[48:63], v[52:55], v[96:99], a[48:63]
    ds_read_b128 v[44:47], v27 offset:8192
    v_cvt_pk_bf16_f32 v111, v18, v19
    v_add_f32 v14, v14, v15
    s_waitcnt lgkmcnt(4)
    v_mfma_f32_32x32x16_bf16 a[48:63], v[56:59], v[100:103], a[48:63]
    ds_read_b128 v[48:51], v28 offset:8192
    v_cmp_nle_f32 vcc, v14, v60
    s_cbranch_vccnz L_slow25
L_back25:
    v_add_f32 v12, v12, v14
    s_waitcnt lgkmcnt(4)
    v_mfma_f32_32x32x16_bf16 v[80:95], v[32:35], a[64:67], v[112:127]
    ds_read_b128 v[52:55], v29 offset:8192
    buffer_store_dwordx4 v[144:147], v5, s[20:23], s44 offen offset:0
    v_exp_f32 v16, v64
    v_exp_f32 v17, v65
    s_waitcnt lgkmcnt(4)
    v_mfma_f32_32x32x16_bf16 v[80:95], v[36:39], a[68:71], v[80:95]
    ds_read_b128 v[56:59], v30 offset:8192
    v_exp_f32 v18, v66
    v_exp_f32 v19, v67
    s_waitcnt lgkmcnt(4)
    v_mfma_f32_32x32x16_bf16 v[80:95], v[40:43], a[72:75], v[80:95]
    ds_read_b128 v[32:35], v31 offset:8192
    v_mov_b32 v14, v16
    v_mov_b32 v15, v17
    v_cvt_pk_bf16_f32 v96, v16, v17
    s_waitcnt lgkmcnt(4)
    v_mfma_f32_32x32x16_bf16 v[80:95], v[44:47], a[76:79], v[80:95]
    ds_read_b64_tr_b16 v[36:37], v20 offset:8192
    ds_read_b64_tr_b16 v[38:39], v20 offset:9216
    buffer_store_dwordx4 v[148:151], v5, s[20:23], s44 offen offset:1024
    v_exp_f32 v16, v68
    v_exp_f32 v17, v69
    s_waitcnt lgkmcnt(5)
    v_mfma_f32_32x32x16_bf16 v[80:95], v[48:51], a[80:83], v[80:95]
    ds_read_b64_tr_b16 v[40:41], v20 offset:12288
    ds_read_b64_tr_b16 v[42:43], v20 offset:13312
    v_add_f32 v14, v14, v18
    v_add_f32 v15, v15, v19
    v_cvt_pk_bf16_f32 v97, v18, v19
    s_waitcnt lgkmcnt(6)
    v_mfma_f32_32x32x16_bf16 v[80:95], v[52:55], a[84:87], v[80:95]
    ds_read_b64_tr_b16 v[44:45], v21 offset:8192
    ds_read_b64_tr_b16 v[46:47], v21 offset:9216
    v_exp_f32 v18, v70
    v_exp_f32 v19, v71
    s_waitcnt lgkmcnt(7)
    v_mfma_f32_32x32x16_bf16 v[80:95], v[56:59], a[88:91], v[80:95]
    ds_read_b64_tr_b16 v[48:49], v21 offset:12288
    ds_read_b64_tr_b16 v[50:51], v21 offset:13312
    buffer_store_dwordx4 v[152:155], v5, s[20:23], s44 offen offset:2048
    v_add_f32 v14, v14, v16
    v_add_f32 v15, v15, v17
    v_cvt_pk_bf16_f32 v98, v16, v17
    s_waitcnt lgkmcnt(8)
    v_mfma_f32_32x32x16_bf16 v[80:95], v[32:35], a[92:95], v[80:95]
    ds_read_b64_tr_b16 v[52:53], v22 offset:8192
    ds_read_b64_tr_b16 v[54:55], v22 offset:9216
    v_exp_f32 v16, v72
    v_exp_f32 v17, v73
    s_waitcnt lgkmcnt(8)
    v_mfma_f32_32x32x16_bf16 a[0:15], v[36:39], v[104:107], a[0:15]
    ds_read_b64_tr_b16 v[56:57], v22 offset:12288
    ds_read_b64_tr_b16 v[58:59], v22 offset:13312
    v_add_f32 v14, v14, v18
    v_add_f32 v15, v15, v19
    v_cvt_pk_bf16_f32 v99, v18, v19
    v_exp_f32 v18, v74
    s_waitcnt lgkmcnt(8)
    v_mfma_f32_32x32x16_bf16 a[0:15], v[40:43], v[108:111], a[0:15]
    ds_read_b64_tr_b16 v[32:33], v23 offset:8192
    ds_read_b64_tr_b16 v[34:35], v23 offset:9216
    buffer_store_dwordx4 v[156:159], v5, s[20:23], s44 offen offset:3072
    v_exp_f32 v19, v75
    v_add_f32 v14, v14, v16
    v_add_f32 v15, v15, v17
    s_waitcnt lgkmcnt(8)
    v_mfma_f32_32x32x16_bf16 a[16:31], v[44:47], v[104:107], a[16:31]
    ds_read_b64_tr_b16 v[36:37], v23 offset:12288
    ds_read_b64_tr_b16 v[38:39], v23 offset:13312
    v_cvt_pk_bf16_f32 v100, v16, v17
    v_exp_f32 v16, v76
    v_exp_f32 v17, v77
    s_waitcnt lgkmcnt(8)
    v_mfma_f32_32x32x16_bf16 a[16:31], v[48:51], v[108:111], a[16:31]
    ds_read_b128 v[40:43], v24 offset:32768
    v_add_f32 v14, v14, v18
    v_add_f32 v15, v15, v19
    v_cvt_pk_bf16_f32 v101, v18, v19
    v_exp_f32 v18, v78
    s_waitcnt lgkmcnt(7)
    v_mfma_f32_32x32x16_bf16 a[32:47], v[52:55], v[104:107], a[32:47]
    ds_read_b128 v[44:47], v25 offset:32768
    v_exp_f32 v19, v79
    v_add_f32 v14, v14, v16
    v_add_f32 v15, v15, v17
    s_waitcnt lgkmcnt(6)
    v_mfma_f32_32x32x16_bf16 a[32:47], v[56:59], v[108:111], a[32:47]
    ds_read_b128 v[48:51], v26 offset:32768
    v_cvt_pk_bf16_f32 v102, v16, v17
    s_nop 0
    v_add_f32 v14, v14, v18
    v_add_f32 v15, v15, v19
    s_waitcnt lgkmcnt(5)
    v_mfma_f32_32x32x16_bf16 a[48:63], v[32:35], v[104:107], a[48:63]
    ds_read_b128 v[52:55], v27 offset:32768
    v_cvt_pk_bf16_f32 v103, v18, v19
    v_add_f32 v14, v14, v15
    s_waitcnt lgkmcnt(4)
    v_mfma_f32_32x32x16_bf16 a[48:63], v[36:39], v[108:111], a[48:63]
    ds_read_b128 v[56:59], v28 offset:32768
    v_cmp_nle_f32 vcc, v14, v60
    s_cbranch_vccnz L_slow26
L_back26:
    v_add_f32 v12, v12, v14
    s_waitcnt vmcnt(11)
    s_barrier
    s_waitcnt lgkmcnt(4)
    v_mfma_f32_32x32x16_bf16 v[64:79], v[40:43], a[64:67], v[112:127]
    ds_read_b128 v[32:35], v29 offset:32768
    v_exp_f32 v16, v80
    v_exp_f32 v17, v81
    s_waitcnt lgkmcnt(4)
    v_mfma_f32_32x32x16_bf16 v[64:79], v[44:47], a[68:71], v[64:79]
    ds_read_b128 v[36:39], v30 offset:32768
    v_exp_f32 v18, v82
    v_exp_f32 v19, v83
    s_waitcnt lgkmcnt(4)
    v_mfma_f32_32x32x16_bf16 v[64:79], v[48:51], a[72:75], v[64:79]
    ds_read_b128 v[40:43], v31 offset:32768
    v_mov_b32 v14, v16
    v_mov_b32 v15, v17
    v_cvt_pk_bf16_f32 v104, v16, v17
    s_waitcnt lgkmcnt(4)
    v_mfma_f32_32x32x16_bf16 v[64:79], v[52:55], a[76:79], v[64:79]
    ds_read_b64_tr_b16 v[44:45], v20 offset:32768
    ds_read_b64_tr_b16 v[46:47], v20 offset:33792
    v_exp_f32 v16, v84
    v_exp_f32 v17, v85
    s_waitcnt lgkmcnt(5)
    v_mfma_f32_32x32x16_bf16 v[64:79], v[56:59], a[80:83], v[64:79]
    ds_read_b64_tr_b16 v[48:49], v20 offset:36864
    ds_read_b64_tr_b16 v[50:51], v20 offset:37888
    v_add_f32 v14, v14, v18
    v_add_f32 v15, v15, v19
    v_cvt_pk_bf16_f32 v105, v18, v19
    s_waitcnt lgkmcnt(6)
    v_mfma_f32_32x32x16_bf16 v[64:79], v[32:35], a[84:87], v[64:79]
    ds_read_b64_tr_b16 v[52:53], v21 offset:32768
    ds_read_b64_tr_b16 v[54:55], v21 offset:33792
    v_exp_f32 v18, v86
    v_exp_f32 v19, v87
    s_waitcnt lgkmcnt(7)
    v_mfma_f32_32x32x16_bf16 v[64:79], v[36:39], a[88:91], v[64:79]
    ds_read_b64_tr_b16 v[56:57], v21 offset:36864
    ds_read_b64_tr_b16 v[58:59], v21 offset:37888
    v_add_f32 v14, v14, v16
    v_add_f32 v15, v15, v17
    v_cvt_pk_bf16_f32 v106, v16, v17
    s_waitcnt lgkmcnt(8)
    v_mfma_f32_32x32x16_bf16 v[64:79], v[40:43], a[92:95], v[64:79]
    ds_read_b64_tr_b16 v[32:33], v22 offset:32768
    ds_read_b64_tr_b16 v[34:35], v22 offset:33792
    v_exp_f32 v16, v88
    v_exp_f32 v17, v89
    s_waitcnt lgkmcnt(8)
    v_mfma_f32_32x32x16_bf16 a[0:15], v[44:47], v[96:99], a[0:15]
    ds_read_b64_tr_b16 v[36:37], v22 offset:36864
    ds_read_b64_tr_b16 v[38:39], v22 offset:37888
    v_add_f32 v14, v14, v18
    v_add_f32 v15, v15, v19
    v_cvt_pk_bf16_f32 v107, v18, v19
    v_exp_f32 v18, v90
    s_waitcnt lgkmcnt(8)
    v_mfma_f32_32x32x16_bf16 a[0:15], v[48:51], v[100:103], a[0:15]
    ds_read_b64_tr_b16 v[40:41], v23 offset:32768
    ds_read_b64_tr_b16 v[42:43], v23 offset:33792
    v_exp_f32 v19, v91
    v_add_f32 v14, v14, v16
    v_add_f32 v15, v15, v17
    s_waitcnt lgkmcnt(8)
    v_mfma_f32_32x32x16_bf16 a[16:31], v[52:55], v[96:99], a[16:31]
    ds_read_b64_tr_b16 v[44:45], v23 offset:36864
    ds_read_b64_tr_b16 v[46:47], v23 offset:37888
    v_cvt_pk_bf16_f32 v108, v16, v17
    v_exp_f32 v16, v92
    v_exp_f32 v17, v93
    s_waitcnt lgkmcnt(8)
    v_mfma_f32_32x32x16_bf16 a[16:31], v[56:59], v[100:103], a[16:31]
    ds_read_b128 v[48:51], v24 offset:40960
    v_add_f32 v14, v14, v18
    v_add_f32 v15, v15, v19
    v_cvt_pk_bf16_f32 v109, v18, v19
    v_exp_f32 v18, v94
    s_waitcnt lgkmcnt(7)
    v_mfma_f32_32x32x16_bf16 a[32:47], v[32:35], v[96:99], a[32:47]
    ds_read_b128 v[52:55], v25 offset:40960
    v_exp_f32 v19, v95
    v_add_f32 v14, v14, v16
    v_add_f32 v15, v15, v17
    s_waitcnt lgkmcnt(6)
    v_mfma_f32_32x32x16_bf16 a[32:47], v[36:39], v[100:103], a[32:47]
    ds_read_b128 v[56:59], v26 offset:40960
    v_cvt_pk_bf16_f32 v110, v16, v17
    s_nop 0
    v_add_f32 v14, v14, v18
    v_add_f32 v15, v15, v19
    s_waitcnt lgkmcnt(5)
    v_mfma_f32_32x32x16_bf16 a[48:63], v[40:43], v[96:99], a[48:63]
    ds_read_b128 v[32:35], v27 offset:40960
    v_cvt_pk_bf16_f32 v111, v18, v19
    v_add_f32 v14, v14, v15
    s_waitcnt lgkmcnt(4)
    v_mfma_f32_32x32x16_bf16 a[48:63], v[44:47], v[100:103], a[48:63]
    ds_read_b128 v[36:39], v28 offset:40960
    v_cmp_nle_f32 vcc, v14, v60
    s_cbranch_vccnz L_slow27
L_back27:
    v_add_f32 v12, v12, v14
    s_waitcnt lgkmcnt(4)
    v_mfma_f32_32x32x16_bf16 v[80:95], v[48:51], a[64:67], v[112:127]
    ds_read_b128 v[40:43], v29 offset:40960
    v_exp_f32 v16, v64
    v_exp_f32 v17, v65
    s_waitcnt lgkmcnt(4)
    v_mfma_f32_32x32x16_bf16 v[80:95], v[52:55], a[68:71], v[80:95]
    ds_read_b128 v[44:47], v30 offset:40960
    v_exp_f32 v18, v66
    v_exp_f32 v19, v67
    s_waitcnt lgkmcnt(4)
    v_mfma_f32_32x32x16_bf16 v[80:95], v[56:59], a[72:75], v[80:95]
    ds_read_b128 v[48:51], v31 offset:40960
    v_mov_b32 v14, v16
    v_mov_b32 v15, v17
    v_cvt_pk_bf16_f32 v96, v16, v17
    s_waitcnt lgkmcnt(4)
    v_mfma_f32_32x32x16_bf16 v[80:95], v[32:35], a[76:79], v[80:95]
    ds_read_b64_tr_b16 v[52:53], v20 offset:40960
    ds_read_b64_tr_b16 v[54:55], v20 offset:41984
    v_exp_f32 v16, v68
    v_exp_f32 v17, v69
    s_waitcnt lgkmcnt(5)
    v_mfma_f32_32x32x16_bf16 v[80:95], v[36:39], a[80:83], v[80:95]
    ds_read_b64_tr_b16 v[56:57], v20 offset:45056
    ds_read_b64_tr_b16 v[58:59], v20 offset:46080
    v_add_f32 v14, v14, v18
    v_add_f32 v15, v15, v19
    v_cvt_pk_bf16_f32 v97, v18, v19
    s_waitcnt lgkmcnt(6)
    v_mfma_f32_32x32x16_bf16 v[80:95], v[40:43], a[84:87], v[80:95]
    ds_read_b64_tr_b16 v[32:33], v21 offset:40960
    ds_read_b64_tr_b16 v[34:35], v21 offset:41984
    v_exp_f32 v18, v70
    v_exp_f32 v19, v71
    s_waitcnt lgkmcnt(7)
    v_mfma_f32_32x32x16_bf16 v[80:95], v[44:47], a[88:91], v[80:95]
    ds_read_b64_tr_b16 v[36:37], v21 offset:45056
    ds_read_b64_tr_b16 v[38:39], v21 offset:46080
    v_add_f32 v14, v14, v16
    v_add_f32 v15, v15, v17
    v_cvt_pk_bf16_f32 v98, v16, v17
    s_waitcnt lgkmcnt(8)
    v_mfma_f32_32x32x16_bf16 v[80:95], v[48:51], a[92:95], v[80:95]
    ds_read_b64_tr_b16 v[40:41], v22 offset:40960
    ds_read_b64_tr_b16 v[42:43], v22 offset:41984
    v_exp_f32 v16, v72
    v_exp_f32 v17, v73
    s_waitcnt lgkmcnt(8)
    v_mfma_f32_32x32x16_bf16 a[0:15], v[52:55], v[104:107], a[0:15]
    ds_read_b64_tr_b16 v[44:45], v22 offset:45056
    ds_read_b64_tr_b16 v[46:47], v22 offset:46080
    v_add_f32 v14, v14, v18
    v_add_f32 v15, v15, v19
    v_cvt_pk_bf16_f32 v99, v18, v19
    v_exp_f32 v18, v74
    s_waitcnt lgkmcnt(8)
    v_mfma_f32_32x32x16_bf16 a[0:15], v[56:59], v[108:111], a[0:15]
    ds_read_b64_tr_b16 v[48:49], v23 offset:40960
    ds_read_b64_tr_b16 v[50:51], v23 offset:41984
    v_exp_f32 v19, v75
    v_add_f32 v14, v14, v16
    v_add_f32 v15, v15, v17
    s_waitcnt lgkmcnt(8)
    v_mfma_f32_32x32x16_bf16 a[16:31], v[32:35], v[104:107], a[16:31]
    ds_read_b64_tr_b16 v[52:53], v23 offset:45056
    ds_read_b64_tr_b16 v[54:55], v23 offset:46080
    v_cvt_pk_bf16_f32 v100, v16, v17
    v_exp_f32 v16, v76
    v_exp_f32 v17, v77
    s_waitcnt lgkmcnt(8)
    v_mfma_f32_32x32x16_bf16 a[16:31], v[36:39], v[108:111], a[16:31]
    v_add_u32 v24, 0xfffec000, v24
    v_add_u32 v25, 0xfffec000, v25
    v_add_u32 v26, 0xfffec000, v26
    v_add_u32 v27, 0xfffec000, v27
    v_add_u32 v28, 0xfffec000, v28
    v_add_u32 v29, 0xfffec000, v29
    v_add_u32 v30, 0xfffec000, v30
    v_add_u32 v31, 0xfffec000, v31
    ds_read_b128 v[56:59], v24 offset:0
    v_add_f32 v14, v14, v18
    v_add_f32 v15, v15, v19
    v_cvt_pk_bf16_f32 v101, v18, v19
    v_exp_f32 v18, v78
    s_waitcnt lgkmcnt(7)
    v_mfma_f32_32x32x16_bf16 a[32:47], v[40:43], v[104:107], a[32:47]
    ds_read_b128 v[32:35], v25 offset:0
    v_exp_f32 v19, v79
    v_add_f32 v14, v14, v16
    v_add_f32 v15, v15, v17
    s_waitcnt lgkmcnt(6)
    v_mfma_f32_32x32x16_bf16 a[32:47], v[44:47], v[108:111], a[32:47]
    ds_read_b128 v[36:39], v26 offset:0
    v_cvt_pk_bf16_f32 v102, v16, v17
    s_nop 0
    v_add_f32 v14, v14, v18
    v_add_f32 v15, v15, v19
    s_waitcnt lgkmcnt(5)
    v_mfma_f32_32x32x16_bf16 a[48:63], v[48:51], v[104:107], a[48:63]
    ds_read_b128 v[40:43], v27 offset:0
    v_cvt_pk_bf16_f32 v103, v18, v19
    v_add_f32 v14, v14, v15
    s_waitcnt lgkmcnt(4)
    v_mfma_f32_32x32x16_bf16 a[48:63], v[52:55], v[108:111], a[48:63]
    ds_read_b128 v[44:47], v28 offset:0
    v_cmp_nle_f32 vcc, v14, v60
    s_cbranch_vccnz L_slow28
L_back28:
    v_add_f32 v12, v12, v14
    s_waitcnt vmcnt(9)
    s_barrier
    s_waitcnt lgkmcnt(4)
    v_mfma_f32_32x32x16_bf16 v[64:79], v[56:59], a[64:67], v[112:127]
    ds_read_b128 v[48:51], v29 offset:0
    v_exp_f32 v16, v80
    v_exp_f32 v17, v81
    s_waitcnt lgkmcnt(4)
    v_mfma_f32_32x32x16_bf16 v[64:79], v[32:35], a[68:71], v[64:79]
    ds_read_b128 v[52:55], v30 offset:0
    v_exp_f32 v18, v82
    v_exp_f32 v19, v83
    s_waitcnt lgkmcnt(4)
    v_mfma_f32_32x32x16_bf16 v[64:79], v[36:39], a[72:75], v[64:79]
    ds_read_b128 v[56:59], v31 offset:0
    v_mov_b32 v14, v16
    v_mov_b32 v15, v17
    v_cvt_pk_bf16_f32 v104, v16, v17
    s_waitcnt lgkmcnt(4)
    v_mfma_f32_32x32x16_bf16 v[64:79], v[40:43], a[76:79], v[64:79]
    ds_read_b64_tr_b16 v[32:33], v20 offset:49152
    ds_read_b64_tr_b16 v[34:35], v20 offset:50176
    v_exp_f32 v16, v84
    v_exp_f32 v17, v85
    s_waitcnt lgkmcnt(5)
    v_mfma_f32_32x32x16_bf16 v[64:79], v[44:47], a[80:83], v[64:79]
    ds_read_b64_tr_b16 v[36:37], v20 offset:53248
    ds_read_b64_tr_b16 v[38:39], v20 offset:54272
    v_add_f32 v14, v14, v18
    v_add_f32 v15, v15, v19
    v_cvt_pk_bf16_f32 v105, v18, v19
    s_waitcnt lgkmcnt(6)
    v_mfma_f32_32x32x16_bf16 v[64:79], v[48:51], a[84:87], v[64:79]
    ds_read_b64_tr_b16 v[40:41], v21 offset:49152
    ds_read_b64_tr_b16 v[42:43], v21 offset:50176
    v_exp_f32 v18, v86
    v_exp_f32 v19, v87
    s_waitcnt lgkmcnt(7)
    v_mfma_f32_32x32x16_bf16 v[64:79], v[52:55], a[88:91], v[64:79]
    ds_read_b64_tr_b16 v[44:45], v21 offset:53248
    ds_read_b64_tr_b16 v[46:47], v21 offset:54272
    v_add_f32 v14, v14, v16
    v_add_f32 v15, v15, v17
    v_cvt_pk_bf16_f32 v106, v16, v17
    s_waitcnt lgkmcnt(8)
    v_mfma_f32_32x32x16_bf16 v[64:79], v[56:59], a[92:95], v[64:79]
    ds_read_b64_tr_b16 v[48:49], v22 offset:49152
    ds_read_b64_tr_b16 v[50:51], v22 offset:50176
    v_exp_f32 v16, v88
    v_exp_f32 v17, v89
    s_waitcnt lgkmcnt(8)
    v_mfma_f32_32x32x16_bf16 a[0:15], v[32:35], v[96:99], a[0:15]
    ds_read_b64_tr_b16 v[52:53], v22 offset:53248
    ds_read_b64_tr_b16 v[54:55], v22 offset:54272
    v_add_f32 v14, v14, v18
    v_add_f32 v15, v15, v19
    v_cvt_pk_bf16_f32 v107, v18, v19
    v_exp_f32 v18, v90
    s_waitcnt lgkmcnt(8)
    v_mfma_f32_32x32x16_bf16 a[0:15], v[36:39], v[100:103], a[0:15]
    ds_read_b64_tr_b16 v[56:57], v23 offset:49152
    ds_read_b64_tr_b16 v[58:59], v23 offset:50176
    v_exp_f32 v19, v91
    v_add_f32 v14, v14, v16
    v_add_f32 v15, v15, v17
    s_waitcnt lgkmcnt(8)
    v_mfma_f32_32x32x16_bf16 a[16:31], v[40:43], v[96:99], a[16:31]
    ds_read_b64_tr_b16 v[32:33], v23 offset:53248
    ds_read_b64_tr_b16 v[34:35], v23 offset:54272
    v_cvt_pk_bf16_f32 v108, v16, v17
    v_exp_f32 v16, v92
    v_exp_f32 v17, v93
    s_waitcnt lgkmcnt(8)
    v_mfma_f32_32x32x16_bf16 a[16:31], v[44:47], v[100:103], a[16:31]
    ds_read_b128 v[36:39], v24 offset:8192
    v_add_f32 v14, v14, v18
    v_add_f32 v15, v15, v19
    v_cvt_pk_bf16_f32 v109, v18, v19
    v_exp_f32 v18, v94
    s_waitcnt lgkmcnt(7)
    v_mfma_f32_32x32x16_bf16 a[32:47], v[48:51], v[96:99], a[32:47]
    ds_read_b128 v[40:43], v25 offset:8192
    v_exp_f32 v19, v95
    v_add_f32 v14, v14, v16
    v_add_f32 v15, v15, v17
    s_waitcnt lgkmcnt(6)
    v_mfma_f32_32x32x16_bf16 a[32:47], v[52:55], v[100:103], a[32:47]
    ds_read_b128 v[44:47], v26 offset:8192
    v_cvt_pk_bf16_f32 v110, v16, v17
    s_nop 0
    v_add_f32 v14, v14, v18
    v_add_f32 v15, v15, v19
    s_waitcnt lgkmcnt(5)
    v_mfma_f32_32x32x16_bf16 a[48:63], v[56:59], v[96:99], a[48:63]
    ds_read_b128 v[48:51], v27 offset:8192
    v_cvt_pk_bf16_f32 v111, v18, v19
    v_add_f32 v14, v14, v15
    s_waitcnt lgkmcnt(4)
    v_mfma_f32_32x32x16_bf16 a[48:63], v[32:35], v[100:103], a[48:63]
    ds_read_b128 v[52:55], v28 offset:8192
    v_cmp_nle_f32 vcc, v14, v60
    s_cbranch_vccnz L_slow29
L_back29:
    v_add_f32 v12, v12, v14
    s_waitcnt lgkmcnt(4)
    v_mfma_f32_32x32x16_bf16 v[80:95], v[36:39], a[64:67], v[112:127]
    ds_read_b128 v[56:59], v29 offset:8192
    v_exp_f32 v16, v64
    v_exp_f32 v17, v65
    s_waitcnt lgkmcnt(4)
    v_mfma_f32_32x32x16_bf16 v[80:95], v[40:43], a[68:71], v[80:95]
    ds_read_b128 v[32:35], v30 offset:8192
    v_exp_f32 v18, v66
    v_exp_f32 v19, v67
    s_waitcnt lgkmcnt(4)
    v_mfma_f32_32x32x16_bf16 v[80:95], v[44:47], a[72:75], v[80:95]
    ds_read_b128 v[36:39], v31 offset:8192
    v_mov_b32 v14, v16
    v_mov_b32 v15, v17
    v_cvt_pk_bf16_f32 v96, v16, v17
    s_waitcnt lgkmcnt(4)
    v_mfma_f32_32x32x16_bf16 v[80:95], v[48:51], a[76:79], v[80:95]
    ds_read_b64_tr_b16 v[40:41], v20 offset:57344
    ds_read_b64_tr_b16 v[42:43], v20 offset:58368
    v_exp_f32 v16, v68
    v_exp_f32 v17, v69
    s_waitcnt lgkmcnt(5)
    v_mfma_f32_32x32x16_bf16 v[80:95], v[52:55], a[80:83], v[80:95]
    ds_read_b64_tr_b16 v[44:45], v20 offset:61440
    ds_read_b64_tr_b16 v[46:47], v20 offset:62464
    v_add_f32 v14, v14, v18
    v_add_f32 v15, v15, v19
    v_cvt_pk_bf16_f32 v97, v18, v19
    s_waitcnt lgkmcnt(6)
    v_mfma_f32_32x32x16_bf16 v[80:95], v[56:59], a[84:87], v[80:95]
    ds_read_b64_tr_b16 v[48:49], v21 offset:57344
    ds_read_b64_tr_b16 v[50:51], v21 offset:58368
    v_exp_f32 v18, v70
    v_exp_f32 v19, v71
    s_waitcnt lgkmcnt(7)
    v_mfma_f32_32x32x16_bf16 v[80:95], v[32:35], a[88:91], v[80:95]
    ds_read_b64_tr_b16 v[52:53], v21 offset:61440
    ds_read_b64_tr_b16 v[54:55], v21 offset:62464
    v_add_f32 v14, v14, v16
    v_add_f32 v15, v15, v17
    v_cvt_pk_bf16_f32 v98, v16, v17
    s_waitcnt lgkmcnt(8)
    v_mfma_f32_32x32x16_bf16 v[80:95], v[36:39], a[92:95], v[80:95]
    ds_read_b64_tr_b16 v[56:57], v22 offset:57344
    ds_read_b64_tr_b16 v[58:59], v22 offset:58368
    v_exp_f32 v16, v72
    v_exp_f32 v17, v73
    s_waitcnt lgkmcnt(8)
    v_mfma_f32_32x32x16_bf16 a[0:15], v[40:43], v[104:107], a[0:15]
    ds_read_b64_tr_b16 v[32:33], v22 offset:61440
    ds_read_b64_tr_b16 v[34:35], v22 offset:62464
    v_add_f32 v14, v14, v18
    v_add_f32 v15, v15, v19
    v_cvt_pk_bf16_f32 v99, v18, v19
    v_exp_f32 v18, v74
    s_waitcnt lgkmcnt(8)
    v_mfma_f32_32x32x16_bf16 a[0:15], v[44:47], v[108:111], a[0:15]
    ds_read_b64_tr_b16 v[36:37], v23 offset:57344
    ds_read_b64_tr_b16 v[38:39], v23 offset:58368
    v_exp_f32 v19, v75
    v_add_f32 v14, v14, v16
    v_add_f32 v15, v15, v17
    s_waitcnt lgkmcnt(8)
    v_mfma_f32_32x32x16_bf16 a[16:31], v[48:51], v[104:107], a[16:31]
    ds_read_b64_tr_b16 v[40:41], v23 offset:61440
    ds_read_b64_tr_b16 v[42:43], v23 offset:62464
    v_cvt_pk_bf16_f32 v100, v16, v17
    v_exp_f32 v16, v76
    v_exp_f32 v17, v77
    s_waitcnt lgkmcnt(8)
    v_mfma_f32_32x32x16_bf16 a[16:31], v[52:55], v[108:111], a[16:31]
    v_add_u32 v20, 0xfffec000, v20
    v_add_u32 v21, 0xfffec000, v21
    v_add_u32 v22, 0xfffec000, v22
    v_add_u32 v23, 0xfffec000, v23
    ds_read_b64_tr_b16 v[44:45], v20 offset:0
    ds_read_b64_tr_b16 v[46:47], v20 offset:1024
    v_add_f32 v14, v14, v18
    v_add_f32 v15, v15, v19
    v_cvt_pk_bf16_f32 v101, v18, v19
    v_exp_f32 v18, v78
    s_waitcnt lgkmcnt(8)
    v_mfma_f32_32x32x16_bf16 a[32:47], v[56:59], v[104:107], a[32:47]
    ds_read_b64_tr_b16 v[48:49], v20 offset:4096
    ds_read_b64_tr_b16 v[50:51], v20 offset:5120
    v_exp_f32 v19, v79
    v_add_f32 v14, v14, v16
    v_add_f32 v15, v15, v17
    s_waitcnt lgkmcnt(8)
    v_mfma_f32_32x32x16_bf16 a[32:47], v[32:35], v[108:111], a[32:47]
    ds_read_b64_tr_b16 v[52:53], v21 offset:0
    ds_read_b64_tr_b16 v[54:55], v21 offset:1024
    v_cvt_pk_bf16_f32 v102, v16, v17
    s_nop 0
    v_add_f32 v14, v14, v18
    v_add_f32 v15, v15, v19
    s_waitcnt lgkmcnt(8)
    v_mfma_f32_32x32x16_bf16 a[48:63], v[36:39], v[104:107], a[48:63]
    ds_read_b64_tr_b16 v[56:57], v21 offset:4096
    ds_read_b64_tr_b16 v[58:59], v21 offset:5120
    v_cvt_pk_bf16_f32 v103, v18, v19
    v_add_f32 v14, v14, v15
    s_waitcnt lgkmcnt(8)
    v_mfma_f32_32x32x16_bf16 a[48:63], v[40:43], v[108:111], a[48:63]
    ds_read_b64_tr_b16 v[32:33], v22 offset:0
    ds_read_b64_tr_b16 v[34:35], v22 offset:1024
    v_cmp_nle_f32 vcc, v14, v60
    s_cbranch_vccnz L_slow30
L_back30:
    v_add_f32 v12, v12, v14
    s_barrier
    s_waitcnt lgkmcnt(8)
    v_mfma_f32_32x32x16_bf16 a[0:15], v[44:47], v[96:99], a[0:15]
    ds_read_b64_tr_b16 v[36:37], v22 offset:4096
    ds_read_b64_tr_b16 v[38:39], v22 offset:5120
    v_exp_f32 v16, v80
    v_exp_f32 v17, v81
    v_exp_f32 v18, v82
    v_exp_f32 v19, v83
    s_waitcnt lgkmcnt(8)
    v_mfma_f32_32x32x16_bf16 a[0:15], v[48:51], v[100:103], a[0:15]
    ds_read_b64_tr_b16 v[40:41], v23 offset:0
    ds_read_b64_tr_b16 v[42:43], v23 offset:1024
    v_mov_b32 v14, v16
    v_mov_b32 v15, v17
    v_cvt_pk_bf16_f32 v104, v16, v17
    v_exp_f32 v16, v84
    v_exp_f32 v17, v85
    v_add_f32 v14, v14, v18
    s_waitcnt lgkmcnt(8)
    v_mfma_f32_32x32x16_bf16 a[16:31], v[52:55], v[96:99], a[16:31]
    ds_read_b64_tr_b16 v[44:45], v23 offset:4096
    ds_read_b64_tr_b16 v[46:47], v23 offset:5120
    v_add_f32 v15, v15, v19
    v_cvt_pk_bf16_f32 v105, v18, v19
    v_exp_f32 v18, v86
    v_exp_f32 v19, v87
    v_add_f32 v14, v14, v16
    v_add_f32 v15, v15, v17
    s_waitcnt lgkmcnt(8)
    v_mfma_f32_32x32x16_bf16 a[16:31], v[56:59], v[100:103], a[16:31]
    ds_read_b64_tr_b16 v[48:49], v20 offset:8192
    ds_read_b64_tr_b16 v[50:51], v20 offset:9216
    v_cvt_pk_bf16_f32 v106, v16, v17
    v_exp_f32 v16, v88
    v_exp_f32 v17, v89
    v_add_f32 v14, v14, v18
    v_add_f32 v15, v15, v19
    v_cvt_pk_bf16_f32 v107, v18, v19
    s_waitcnt lgkmcnt(8)
    v_mfma_f32_32x32x16_bf16 a[32:47], v[32:35], v[96:99], a[32:47]
    ds_read_b64_tr_b16 v[52:53], v20 offset:12288
    ds_read_b64_tr_b16 v[54:55], v20 offset:13312
    v_exp_f32 v18, v90
    v_exp_f32 v19, v91
    v_add_f32 v14, v14, v16
    v_add_f32 v15, v15, v17
    v_cvt_pk_bf16_f32 v108, v16, v17
    v_exp_f32 v16, v92
    s_waitcnt lgkmcnt(8)
    v_mfma_f32_32x32x16_bf16 a[32:47], v[36:39], v[100:103], a[32:47]
    ds_read_b64_tr_b16 v[56:57], v21 offset:8192
    ds_read_b64_tr_b16 v[58:59], v21 offset:9216
    v_exp_f32 v17, v93
    v_add_f32 v14, v14, v18
    v_add_f32 v15, v15, v19
    v_cvt_pk_bf16_f32 v109, v18, v19
    v_exp_f32 v18, v94
    v_exp_f32 v19, v95
    s_waitcnt lgkmcnt(8)
    v_mfma_f32_32x32x16_bf16 a[48:63], v[40:43], v[96:99], a[48:63]
    ds_read_b64_tr_b16 v[32:33], v21 offset:12288
    ds_read_b64_tr_b16 v[34:35], v21 offset:13312
    v_add_f32 v14, v14, v16
    v_add_f32 v15, v15, v17
    v_cvt_pk_bf16_f32 v110, v16, v17
    s_nop 0
    v_add_f32 v14, v14, v18
    v_add_f32 v15, v15, v19
    v_cvt_pk_bf16_f32 v111, v18, v19
    v_add_f32 v14, v14, v15
    s_waitcnt lgkmcnt(8)
    v_mfma_f32_32x32x16_bf16 a[48:63], v[44:47], v[100:103], a[48:63]
    ds_read_b64_tr_b16 v[36:37], v22 offset:8192
    ds_read_b64_tr_b16 v[38:39], v22 offset:9216
    v_cmp_nle_f32 vcc, v14, v60
    s_cbranch_vccnz L_slow31
L_back31:
    v_add_f32 v12, v12, v14
    s_nop 1
    s_waitcnt lgkmcnt(8)
    v_mfma_f32_32x32x16_bf16 a[0:15], v[48:51], v[104:107], a[0:15]
    ds_read_b64_tr_b16 v[40:41], v22 offset:12288
    ds_read_b64_tr_b16 v[42:43], v22 offset:13312
    s_waitcnt lgkmcnt(8)
    v_mfma_f32_32x32x16_bf16 a[0:15], v[52:55], v[108:111], a[0:15]
    ds_read_b64_tr_b16 v[44:45], v23 offset:8192
    ds_read_b64_tr_b16 v[46:47], v23 offset:9216
    s_waitcnt lgkmcnt(8)
    v_mfma_f32_32x32x16_bf16 a[16:31], v[56:59], v[104:107], a[16:31]
    ds_read_b64_tr_b16 v[48:49], v23 offset:12288
    ds_read_b64_tr_b16 v[50:51], v23 offset:13312
    s_waitcnt lgkmcnt(8)
    v_mfma_f32_32x32x16_bf16 a[16:31], v[32:35], v[108:111], a[16:31]
    s_waitcnt lgkmcnt(6)
    v_mfma_f32_32x32x16_bf16 a[32:47], v[36:39], v[104:107], a[32:47]
    s_waitcnt lgkmcnt(4)
    v_mfma_f32_32x32x16_bf16 a[32:47], v[40:43], v[108:111], a[32:47]
    s_waitcnt lgkmcnt(2)
    v_mfma_f32_32x32x16_bf16 a[48:63], v[44:47], v[104:107], a[48:63]
    s_waitcnt lgkmcnt(0)
    v_mfma_f32_32x32x16_bf16 a[48:63], v[48:51], v[108:111], a[48:63]
    s_nop 15
    v_mov_b32 v10, v12
    v_mov_b32 v63, v12
    s_nop 1
    v_permlane32_swap_b32 v10, v63
    s_nop 1
    v_add_f32 v10, v10, v63
    v_rcp_f32 v10, v10
    s_nop 0
    v_accvgpr_read_b32 v64, a0
    v_accvgpr_read_b32 v65, a1
    v_accvgpr_read_b32 v66, a2
    v_accvgpr_read_b32 v67, a3
    v_accvgpr_read_b32 v68, a4
    v_accvgpr_read_b32 v69, a5
    v_accvgpr_read_b32 v70, a6
    v_accvgpr_read_b32 v71, a7
    v_mul_f32 v64, v64, v10
    v_mul_f32 v65, v65, v10
    v_mul_f32 v66, v66, v10
    v_mul_f32 v67, v67, v10
    v_mul_f32 v68, v68, v10
    v_mul_f32 v69, v69, v10
    v_mul_f32 v70, v70, v10
    v_mul_f32 v71, v71, v10
    v_cvt_pk_bf16_f32 v72, v64, v65
    v_cvt_pk_bf16_f32 v73, v66, v67
    v_cvt_pk_bf16_f32 v74, v68, v69
    v_cvt_pk_bf16_f32 v75, v70, v71
    buffer_store_dwordx4 v[72:75], v5, s[20:23], s45 offen offset:0
    v_accvgpr_read_b32 v76, a8
    v_accvgpr_read_b32 v77, a9
    v_accvgpr_read_b32 v78, a10
    v_accvgpr_read_b32 v79, a11
    v_accvgpr_read_b32 v80, a12
    v_accvgpr_read_b32 v81, a13
    v_accvgpr_read_b32 v82, a14
    v_accvgpr_read_b32 v83, a15
    v_mul_f32 v76, v76, v10
    v_mul_f32 v77, v77, v10
    v_mul_f32 v78, v78, v10
    v_mul_f32 v79, v79, v10
    v_mul_f32 v80, v80, v10
    v_mul_f32 v81, v81, v10
    v_mul_f32 v82, v82, v10
    v_mul_f32 v83, v83, v10
    v_cvt_pk_bf16_f32 v84, v76, v77
    v_cvt_pk_bf16_f32 v85, v78, v79
    v_cvt_pk_bf16_f32 v86, v80, v81
    v_cvt_pk_bf16_f32 v87, v82, v83
    buffer_store_dwordx4 v[84:87], v5, s[20:23], s45 offen offset:1024
    v_accvgpr_read_b32 v88, a16
    v_accvgpr_read_b32 v89, a17
    v_accvgpr_read_b32 v90, a18
    v_accvgpr_read_b32 v91, a19
    v_accvgpr_read_b32 v92, a20
    v_accvgpr_read_b32 v93, a21
    v_accvgpr_read_b32 v94, a22
    v_accvgpr_read_b32 v95, a23
    v_mul_f32 v88, v88, v10
    v_mul_f32 v89, v89, v10
    v_mul_f32 v90, v90, v10
    v_mul_f32 v91, v91, v10
    v_mul_f32 v92, v92, v10
    v_mul_f32 v93, v93, v10
    v_mul_f32 v94, v94, v10
    v_mul_f32 v95, v95, v10
    v_cvt_pk_bf16_f32 v96, v88, v89
    v_cvt_pk_bf16_f32 v97, v90, v91
    v_cvt_pk_bf16_f32 v98, v92, v93
    v_cvt_pk_bf16_f32 v99, v94, v95
    buffer_store_dwordx4 v[96:99], v5, s[20:23], s45 offen offset:2048
    v_accvgpr_read_b32 v100, a24
    v_accvgpr_read_b32 v101, a25
    v_accvgpr_read_b32 v102, a26
    v_accvgpr_read_b32 v103, a27
    v_accvgpr_read_b32 v104, a28
    v_accvgpr_read_b32 v105, a29
    v_accvgpr_read_b32 v106, a30
    v_accvgpr_read_b32 v107, a31
    v_mul_f32 v100, v100, v10
    v_mul_f32 v101, v101, v10
    v_mul_f32 v102, v102, v10
    v_mul_f32 v103, v103, v10
    v_mul_f32 v104, v104, v10
    v_mul_f32 v105, v105, v10
    v_mul_f32 v106, v106, v10
    v_mul_f32 v107, v107, v10
    v_cvt_pk_bf16_f32 v108, v100, v101
    v_cvt_pk_bf16_f32 v109, v102, v103
    v_cvt_pk_bf16_f32 v110, v104, v105
    v_cvt_pk_bf16_f32 v111, v106, v107
    buffer_store_dwordx4 v[108:111], v5, s[20:23], s45 offen offset:3072
    v_accvgpr_read_b32 v64, a32
    v_accvgpr_read_b32 v65, a33
    v_accvgpr_read_b32 v66, a34
    v_accvgpr_read_b32 v67, a35
    v_accvgpr_read_b32 v68, a36
    v_accvgpr_read_b32 v69, a37
    v_accvgpr_read_b32 v70, a38
    v_accvgpr_read_b32 v71, a39
    v_mul_f32 v64, v64, v10
    v_mul_f32 v65, v65, v10
    v_mul_f32 v66, v66, v10
    v_mul_f32 v67, v67, v10
    v_mul_f32 v68, v68, v10
    v_mul_f32 v69, v69, v10
    v_mul_f32 v70, v70, v10
    v_mul_f32 v71, v71, v10
    v_cvt_pk_bf16_f32 v72, v64, v65
    v_cvt_pk_bf16_f32 v73, v66, v67
    v_cvt_pk_bf16_f32 v74, v68, v69
    v_cvt_pk_bf16_f32 v75, v70, v71
    buffer_store_dwordx4 v[72:75], v5, s[20:23], s46 offen offset:0
    v_accvgpr_read_b32 v76, a40
    v_accvgpr_read_b32 v77, a41
    v_accvgpr_read_b32 v78, a42
    v_accvgpr_read_b32 v79, a43
    v_accvgpr_read_b32 v80, a44
    v_accvgpr_read_b32 v81, a45
    v_accvgpr_read_b32 v82, a46
    v_accvgpr_read_b32 v83, a47
    v_mul_f32 v76, v76, v10
    v_mul_f32 v77, v77, v10
    v_mul_f32 v78, v78, v10
    v_mul_f32 v79, v79, v10
    v_mul_f32 v80, v80, v10
    v_mul_f32 v81, v81, v10
    v_mul_f32 v82, v82, v10
    v_mul_f32 v83, v83, v10
    v_cvt_pk_bf16_f32 v84, v76, v77
    v_cvt_pk_bf16_f32 v85, v78, v79
    v_cvt_pk_bf16_f32 v86, v80, v81
    v_cvt_pk_bf16_f32 v87, v82, v83
    buffer_store_dwordx4 v[84:87], v5, s[20:23], s46 offen offset:1024
    v_accvgpr_read_b32 v88, a48
    v_accvgpr_read_b32 v89, a49
    v_accvgpr_read_b32 v90, a50
    v_accvgpr_read_b32 v91, a51
    v_accvgpr_read_b32 v92, a52
    v_accvgpr_read_b32 v93, a53
    v_accvgpr_read_b32 v94, a54
    v_accvgpr_read_b32 v95, a55
    v_mul_f32 v88, v88, v10
    v_mul_f32 v89, v89, v10
    v_mul_f32 v90, v90, v10
    v_mul_f32 v91, v91, v10
    v_mul_f32 v92, v92, v10
    v_mul_f32 v93, v93, v10
    v_mul_f32 v94, v94, v10
    v_mul_f32 v95, v95, v10
    v_cvt_pk_bf16_f32 v96, v88, v89
    v_cvt_pk_bf16_f32 v97, v90, v91
    v_cvt_pk_bf16_f32 v98, v92, v93
    v_cvt_pk_bf16_f32 v99, v94, v95
    buffer_store_dwordx4 v[96:99], v5, s[20:23], s46 offen offset:2048
    v_accvgpr_read_b32 v100, a56
    v_accvgpr_read_b32 v101, a57
    v_accvgpr_read_b32 v102, a58
    v_accvgpr_read_b32 v103, a59
    v_accvgpr_read_b32 v104, a60
    v_accvgpr_read_b32 v105, a61
    v_accvgpr_read_b32 v106, a62
    v_accvgpr_read_b32 v107, a63
    v_mul_f32 v100, v100, v10
    v_mul_f32 v101, v101, v10
    v_mul_f32 v102, v102, v10
    v_mul_f32 v103, v103, v10
    v_mul_f32 v104, v104, v10
    v_mul_f32 v105, v105, v10
    v_mul_f32 v106, v106, v10
    v_mul_f32 v107, v107, v10
    v_cvt_pk_bf16_f32 v108, v100, v101
    v_cvt_pk_bf16_f32 v109, v102, v103
    v_cvt_pk_bf16_f32 v110, v104, v105
    v_cvt_pk_bf16_f32 v111, v106, v107
    buffer_store_dwordx4 v[108:111], v5, s[20:23], s46 offen offset:3072
L_end:
    s_endpgm
L_slow1:
    s_nop 15
    s_nop 15
    v_max3_f32 v16, v80, v81, v82
    v_max3_f32 v16, v16, v83, v84
    v_max3_f32 v16, v16, v85, v86
    v_max3_f32 v16, v16, v87, v88
    v_max3_f32 v16, v16, v89, v90
    v_max3_f32 v16, v16, v91, v92
    v_max3_f32 v16, v16, v93, v94
    v_max_f32 v16, v16, v95
    v_mov_b32 v17, v16
    s_nop 1
    v_permlane32_swap_b32 v16, v17
    s_nop 1
    v_max3_f32 v16, v16, v17, 0
    v_exp_f32 v17, -v16
    s_nop 1
    v_sub_f32 v13, v13, v16
    v_mov_b32 v112, v13
    v_mov_b32 v113, v13
    v_mov_b32 v114, v13
    v_mov_b32 v115, v13
    v_mov_b32 v116, v13
    v_mov_b32 v117, v13
    v_mov_b32 v118, v13
    v_mov_b32 v119, v13
    v_mov_b32 v120, v13
    v_mov_b32 v121, v13
    v_mov_b32 v122, v13
    v_mov_b32 v123, v13
    v_mov_b32 v124, v13
    v_mov_b32 v125, v13
    v_mov_b32 v126, v13
    v_mov_b32 v127, v13
    v_sub_f32 v64, v64, v16
    v_sub_f32 v65, v65, v16
    v_sub_f32 v66, v66, v16
    v_sub_f32 v67, v67, v16
    v_sub_f32 v68, v68, v16
    v_sub_f32 v69, v69, v16
    v_sub_f32 v70, v70, v16
    v_sub_f32 v71, v71, v16
    v_sub_f32 v72, v72, v16
    v_sub_f32 v73, v73, v16
    v_sub_f32 v74, v74, v16
    v_sub_f32 v75, v75, v16
    v_sub_f32 v76, v76, v16
    v_sub_f32 v77, v77, v16
    v_sub_f32 v78, v78, v16
    v_sub_f32 v79, v79, v16
    v_mul_f32 v9, v9, v17
    v_accvgpr_read_b32 v18, a0
    v_mul_f32 v19, v18, v17
    v_accvgpr_write_b32 a0, v19
    v_accvgpr_read_b32 v18, a1
    v_mul_f32 v19, v18, v17
    v_accvgpr_write_b32 a1, v19
    v_accvgpr_read_b32 v18, a2
    v_mul_f32 v19, v18, v17
    v_accvgpr_write_b32 a2, v19
    v_accvgpr_read_b32 v18, a3
    v_mul_f32 v19, v18, v17
    v_accvgpr_write_b32 a3, v19
    v_accvgpr_read_b32 v18, a4
    v_mul_f32 v19, v18, v17
    v_accvgpr_write_b32 a4, v19
    v_accvgpr_read_b32 v18, a5
    v_mul_f32 v19, v18, v17
    v_accvgpr_write_b32 a5, v19
    v_accvgpr_read_b32 v18, a6
    v_mul_f32 v19, v18, v17
    v_accvgpr_write_b32 a6, v19
    v_accvgpr_read_b32 v18, a7
    v_mul_f32 v19, v18, v17
    v_accvgpr_write_b32 a7, v19
    v_accvgpr_read_b32 v18, a8
    v_mul_f32 v19, v18, v17
    v_accvgpr_write_b32 a8, v19
    v_accvgpr_read_b32 v18, a9
    v_mul_f32 v19, v18, v17
    v_accvgpr_write_b32 a9, v19
    v_accvgpr_read_b32 v18, a10
    v_mul_f32 v19, v18, v17
    v_accvgpr_write_b32 a10, v19
    v_accvgpr_read_b32 v18, a11
    v_mul_f32 v19, v18, v17
    v_accvgpr_write_b32 a11, v19
    v_accvgpr_read_b32 v18, a12
    v_mul_f32 v19, v18, v17
    v_accvgpr_write_b32 a12, v19
    v_accvgpr_read_b32 v18, a13
    v_mul_f32 v19, v18, v17
    v_accvgpr_write_b32 a13, v19
    v_accvgpr_read_b32 v18, a14
    v_mul_f32 v19, v18, v17
    v_accvgpr_write_b32 a14, v19
    v_accvgpr_read_b32 v18, a15
    v_mul_f32 v19, v18, v17
    v_accvgpr_write_b32 a15, v19
    v_accvgpr_read_b32 v18, a16
    v_mul_f32 v19, v18, v17
    v_accvgpr_write_b32 a16, v19
    v_accvgpr_read_b32 v18, a17
    v_mul_f32 v19, v18, v17
    v_accvgpr_write_b32 a17, v19
    v_accvgpr_read_b32 v18, a18
    v_mul_f32 v19, v18, v17
    v_accvgpr_write_b32 a18, v19
    v_accvgpr_read_b32 v18, a19
    v_mul_f32 v19, v18, v17
    v_accvgpr_write_b32 a19, v19
    v_accvgpr_read_b32 v18, a20
    v_mul_f32 v19, v18, v17
    v_accvgpr_write_b32 a20, v19
    v_accvgpr_read_b32 v18, a21
    v_mul_f32 v19, v18, v17
    v_accvgpr_write_b32 a21, v19
    v_accvgpr_read_b32 v18, a22
    v_mul_f32 v19, v18, v17
    v_accvgpr_write_b32 a22, v19
    v_accvgpr_read_b32 v18, a23
    v_mul_f32 v19, v18, v17
    v_accvgpr_write_b32 a23, v19
    v_accvgpr_read_b32 v18, a24
    v_mul_f32 v19, v18, v17
    v_accvgpr_write_b32 a24, v19
    v_accvgpr_read_b32 v18, a25
    v_mul_f32 v19, v18, v17
    v_accvgpr_write_b32 a25, v19
    v_accvgpr_read_b32 v18, a26
    v_mul_f32 v19, v18, v17
    v_accvgpr_write_b32 a26, v19
    v_accvgpr_read_b32 v18, a27
    v_mul_f32 v19, v18, v17
    v_accvgpr_write_b32 a27, v19
    v_accvgpr_read_b32 v18, a28
    v_mul_f32 v19, v18, v17
    v_accvgpr_write_b32 a28, v19
    v_accvgpr_read_b32 v18, a29
    v_mul_f32 v19, v18, v17
    v_accvgpr_write_b32 a29, v19
    v_accvgpr_read_b32 v18, a30
    v_mul_f32 v19, v18, v17
    v_accvgpr_write_b32 a30, v19
    v_accvgpr_read_b32 v18, a31
    v_mul_f32 v19, v18, v17
    v_accvgpr_write_b32 a31, v19
    v_accvgpr_read_b32 v18, a32
    v_mul_f32 v19, v18, v17
    v_accvgpr_write_b32 a32, v19
    v_accvgpr_read_b32 v18, a33
    v_mul_f32 v19, v18, v17
    v_accvgpr_write_b32 a33, v19
    v_accvgpr_read_b32 v18, a34
    v_mul_f32 v19, v18, v17
    v_accvgpr_write_b32 a34, v19
    v_accvgpr_read_b32 v18, a35
    v_mul_f32 v19, v18, v17
    v_accvgpr_write_b32 a35, v19
    v_accvgpr_read_b32 v18, a36
    v_mul_f32 v19, v18, v17
    v_accvgpr_write_b32 a36, v19
    v_accvgpr_read_b32 v18, a37
    v_mul_f32 v19, v18, v17
    v_accvgpr_write_b32 a37, v19
    v_accvgpr_read_b32 v18, a38
    v_mul_f32 v19, v18, v17
    v_accvgpr_write_b32 a38, v19
    v_accvgpr_read_b32 v18, a39
    v_mul_f32 v19, v18, v17
    v_accvgpr_write_b32 a39, v19
    v_accvgpr_read_b32 v18, a40
    v_mul_f32 v19, v18, v17
    v_accvgpr_write_b32 a40, v19
    v_accvgpr_read_b32 v18, a41
    v_mul_f32 v19, v18, v17
    v_accvgpr_write_b32 a41, v19
    v_accvgpr_read_b32 v18, a42
    v_mul_f32 v19, v18, v17
    v_accvgpr_write_b32 a42, v19
    v_accvgpr_read_b32 v18, a43
    v_mul_f32 v19, v18, v17
    v_accvgpr_write_b32 a43, v19
    v_accvgpr_read_b32 v18, a44
    v_mul_f32 v19, v18, v17
    v_accvgpr_write_b32 a44, v19
    v_accvgpr_read_b32 v18, a45
    v_mul_f32 v19, v18, v17
    v_accvgpr_write_b32 a45, v19
    v_accvgpr_read_b32 v18, a46
    v_mul_f32 v19, v18, v17
    v_accvgpr_write_b32 a46, v19
    v_accvgpr_read_b32 v18, a47
    v_mul_f32 v19, v18, v17
    v_accvgpr_write_b32 a47, v19
    v_accvgpr_read_b32 v18, a48
    v_mul_f32 v19, v18, v17
    v_accvgpr_write_b32 a48, v19
    v_accvgpr_read_b32 v18, a49
    v_mul_f32 v19, v18, v17
    v_accvgpr_write_b32 a49, v19
    v_accvgpr_read_b32 v18, a50
    v_mul_f32 v19, v18, v17
    v_accvgpr_write_b32 a50, v19
    v_accvgpr_read_b32 v18, a51
    v_mul_f32 v19, v18, v17
    v_accvgpr_write_b32 a51, v19
    v_accvgpr_read_b32 v18, a52
    v_mul_f32 v19, v18, v17
    v_accvgpr_write_b32 a52, v19
    v_accvgpr_read_b32 v18, a53
    v_mul_f32 v19, v18, v17
    v_accvgpr_write_b32 a53, v19
    v_accvgpr_read_b32 v18, a54
    v_mul_f32 v19, v18, v17
    v_accvgpr_write_b32 a54, v19
    v_accvgpr_read_b32 v18, a55
    v_mul_f32 v19, v18, v17
    v_accvgpr_write_b32 a55, v19
    v_accvgpr_read_b32 v18, a56
    v_mul_f32 v19, v18, v17
    v_accvgpr_write_b32 a56, v19
    v_accvgpr_read_b32 v18, a57
    v_mul_f32 v19, v18, v17
    v_accvgpr_write_b32 a57, v19
    v_accvgpr_read_b32 v18, a58
    v_mul_f32 v19, v18, v17
    v_accvgpr_write_b32 a58, v19
    v_accvgpr_read_b32 v18, a59
    v_mul_f32 v19, v18, v17
    v_accvgpr_write_b32 a59, v19
    v_accvgpr_read_b32 v18, a60
    v_mul_f32 v19, v18, v17
    v_accvgpr_write_b32 a60, v19
    v_accvgpr_read_b32 v18, a61
    v_mul_f32 v19, v18, v17
    v_accvgpr_write_b32 a61, v19
    v_accvgpr_read_b32 v18, a62
    v_mul_f32 v19, v18, v17
    v_accvgpr_write_b32 a62, v19
    v_accvgpr_read_b32 v18, a63
    v_mul_f32 v19, v18, v17
    v_accvgpr_write_b32 a63, v19
    v_mov_b32 v14, 0
    v_sub_f32 v18, v80, v16
    v_sub_f32 v19, v81, v16
    v_exp_f32 v18, v18
    v_exp_f32 v19, v19
    s_nop 0
    v_add_f32 v14, v14, v18
    v_add_f32 v14, v14, v19
    v_cvt_pk_bf16_f32 v104, v18, v19
    v_sub_f32 v18, v82, v16
    v_sub_f32 v19, v83, v16
    v_exp_f32 v18, v18
    v_exp_f32 v19, v19
    s_nop 0
    v_add_f32 v14, v14, v18
    v_add_f32 v14, v14, v19
    v_cvt_pk_bf16_f32 v105, v18, v19
    v_sub_f32 v18, v84, v16
    v_sub_f32 v19, v85, v16
    v_exp_f32 v18, v18
    v_exp_f32 v19, v19
    s_nop 0
    v_add_f32 v14, v14, v18
    v_add_f32 v14, v14, v19
    v_cvt_pk_bf16_f32 v106, v18, v19
    v_sub_f32 v18, v86, v16
    v_sub_f32 v19, v87, v16
    v_exp_f32 v18, v18
    v_exp_f32 v19, v19
    s_nop 0
    v_add_f32 v14, v14, v18
    v_add_f32 v14, v14, v19
    v_cvt_pk_bf16_f32 v107, v18, v19
    v_sub_f32 v18, v88, v16
    v_sub_f32 v19, v89, v16
    v_exp_f32 v18, v18
    v_exp_f32 v19, v19
    s_nop 0
    v_add_f32 v14, v14, v18
    v_add_f32 v14, v14, v19
    v_cvt_pk_bf16_f32 v108, v18, v19
    v_sub_f32 v18, v90, v16
    v_sub_f32 v19, v91, v16
    v_exp_f32 v18, v18
    v_exp_f32 v19, v19
    s_nop 0
    v_add_f32 v14, v14, v18
    v_add_f32 v14, v14, v19
    v_cvt_pk_bf16_f32 v109, v18, v19
    v_sub_f32 v18, v92, v16
    v_sub_f32 v19, v93, v16
    v_exp_f32 v18, v18
    v_exp_f32 v19, v19
    s_nop 0
    v_add_f32 v14, v14, v18
    v_add_f32 v14, v14, v19
    v_cvt_pk_bf16_f32 v110, v18, v19
    v_sub_f32 v18, v94, v16
    v_sub_f32 v19, v95, v16
    v_exp_f32 v18, v18
    v_exp_f32 v19, v19
    s_nop 0
    v_add_f32 v14, v14, v18
    v_add_f32 v14, v14, v19
    v_cvt_pk_bf16_f32 v111, v18, v19
    s_nop 3
    s_branch L_back1
L_slow2:
    s_nop 15
    s_nop 15
    v_max3_f32 v16, v64, v65, v66
    v_max3_f32 v16, v16, v67, v68
    v_max3_f32 v16, v16, v69, v70
    v_max3_f32 v16, v16, v71, v72
    v_max3_f32 v16, v16, v73, v74
    v_max3_f32 v16, v16, v75, v76
    v_max3_f32 v16, v16, v77, v78
    v_max_f32 v16, v16, v79
    v_mov_b32 v17, v16
    s_nop 1
    v_permlane32_swap_b32 v16, v17
    s_nop 1
    v_max3_f32 v16, v16, v17, 0
    v_exp_f32 v17, -v16
    s_nop 1
    v_sub_f32 v13, v13, v16
    v_mov_b32 v112, v13
    v_mov_b32 v113, v13
    v_mov_b32 v114, v13
    v_mov_b32 v115, v13
    v_mov_b32 v116, v13
    v_mov_b32 v117, v13
    v_mov_b32 v118, v13
    v_mov_b32 v119, v13
    v_mov_b32 v120, v13
    v_mov_b32 v121, v13
    v_mov_b32 v122, v13
    v_mov_b32 v123, v13
    v_mov_b32 v124, v13
    v_mov_b32 v125, v13
    v_mov_b32 v126, v13
    v_mov_b32 v127, v13
    v_sub_f32 v80, v80, v16
    v_sub_f32 v81, v81, v16
    v_sub_f32 v82, v82, v16
    v_sub_f32 v83, v83, v16
    v_sub_f32 v84, v84, v16
    v_sub_f32 v85, v85, v16
    v_sub_f32 v86, v86, v16
    v_sub_f32 v87, v87, v16
    v_sub_f32 v88, v88, v16
    v_sub_f32 v89, v89, v16
    v_sub_f32 v90, v90, v16
    v_sub_f32 v91, v91, v16
    v_sub_f32 v92, v92, v16
    v_sub_f32 v93, v93, v16
    v_sub_f32 v94, v94, v16
    v_sub_f32 v95, v95, v16
    v_mul_f32 v9, v9, v17
    v_accvgpr_read_b32 v18, a0
    v_mul_f32 v19, v18, v17
    v_accvgpr_write_b32 a0, v19
    v_accvgpr_read_b32 v18, a1
    v_mul_f32 v19, v18, v17
    v_accvgpr_write_b32 a1, v19
    v_accvgpr_read_b32 v18, a2
    v_mul_f32 v19, v18, v17
    v_accvgpr_write_b32 a2, v19
    v_accvgpr_read_b32 v18, a3
    v_mul_f32 v19, v18, v17
    v_accvgpr_write_b32 a3, v19
    v_accvgpr_read_b32 v18, a4
    v_mul_f32 v19, v18, v17
    v_accvgpr_write_b32 a4, v19
    v_accvgpr_read_b32 v18, a5
    v_mul_f32 v19, v18, v17
    v_accvgpr_write_b32 a5, v19
    v_accvgpr_read_b32 v18, a6
    v_mul_f32 v19, v18, v17
    v_accvgpr_write_b32 a6, v19
    v_accvgpr_read_b32 v18, a7
    v_mul_f32 v19, v18, v17
    v_accvgpr_write_b32 a7, v19
    v_accvgpr_read_b32 v18, a8
    v_mul_f32 v19, v18, v17
    v_accvgpr_write_b32 a8, v19
    v_accvgpr_read_b32 v18, a9
    v_mul_f32 v19, v18, v17
    v_accvgpr_write_b32 a9, v19
    v_accvgpr_read_b32 v18, a10
    v_mul_f32 v19, v18, v17
    v_accvgpr_write_b32 a10, v19
    v_accvgpr_read_b32 v18, a11
    v_mul_f32 v19, v18, v17
    v_accvgpr_write_b32 a11, v19
    v_accvgpr_read_b32 v18, a12
    v_mul_f32 v19, v18, v17
    v_accvgpr_write_b32 a12, v19
    v_accvgpr_read_b32 v18, a13
    v_mul_f32 v19, v18, v17
    v_accvgpr_write_b32 a13, v19
    v_accvgpr_read_b32 v18, a14
    v_mul_f32 v19, v18, v17
    v_accvgpr_write_b32 a14, v19
    v_accvgpr_read_b32 v18, a15
    v_mul_f32 v19, v18, v17
    v_accvgpr_write_b32 a15, v19
    v_accvgpr_read_b32 v18, a16
    v_mul_f32 v19, v18, v17
    v_accvgpr_write_b32 a16, v19
    v_accvgpr_read_b32 v18, a17
    v_mul_f32 v19, v18, v17
    v_accvgpr_write_b32 a17, v19
    v_accvgpr_read_b32 v18, a18
    v_mul_f32 v19, v18, v17
    v_accvgpr_write_b32 a18, v19
    v_accvgpr_read_b32 v18, a19
    v_mul_f32 v19, v18, v17
    v_accvgpr_write_b32 a19, v19
    v_accvgpr_read_b32 v18, a20
    v_mul_f32 v19, v18, v17
    v_accvgpr_write_b32 a20, v19
    v_accvgpr_read_b32 v18, a21
    v_mul_f32 v19, v18, v17
    v_accvgpr_write_b32 a21, v19
    v_accvgpr_read_b32 v18, a22
    v_mul_f32 v19, v18, v17
    v_accvgpr_write_b32 a22, v19
    v_accvgpr_read_b32 v18, a23
    v_mul_f32 v19, v18, v17
    v_accvgpr_write_b32 a23, v19
    v_accvgpr_read_b32 v18, a24
    v_mul_f32 v19, v18, v17
    v_accvgpr_write_b32 a24, v19
    v_accvgpr_read_b32 v18, a25
    v_mul_f32 v19, v18, v17
    v_accvgpr_write_b32 a25, v19
    v_accvgpr_read_b32 v18, a26
    v_mul_f32 v19, v18, v17
    v_accvgpr_write_b32 a26, v19
    v_accvgpr_read_b32 v18, a27
    v_mul_f32 v19, v18, v17
    v_accvgpr_write_b32 a27, v19
    v_accvgpr_read_b32 v18, a28
    v_mul_f32 v19, v18, v17
    v_accvgpr_write_b32 a28, v19
    v_accvgpr_read_b32 v18, a29
    v_mul_f32 v19, v18, v17
    v_accvgpr_write_b32 a29, v19
    v_accvgpr_read_b32 v18, a30
    v_mul_f32 v19, v18, v17
    v_accvgpr_write_b32 a30, v19
    v_accvgpr_read_b32 v18, a31
    v_mul_f32 v19, v18, v17
    v_accvgpr_write_b32 a31, v19
    v_accvgpr_read_b32 v18, a32
    v_mul_f32 v19, v18, v17
    v_accvgpr_write_b32 a32, v19
    v_accvgpr_read_b32 v18, a33
    v_mul_f32 v19, v18, v17
    v_accvgpr_write_b32 a33, v19
    v_accvgpr_read_b32 v18, a34
    v_mul_f32 v19, v18, v17
    v_accvgpr_write_b32 a34, v19
    v_accvgpr_read_b32 v18, a35
    v_mul_f32 v19, v18, v17
    v_accvgpr_write_b32 a35, v19
    v_accvgpr_read_b32 v18, a36
    v_mul_f32 v19, v18, v17
    v_accvgpr_write_b32 a36, v19
    v_accvgpr_read_b32 v18, a37
    v_mul_f32 v19, v18, v17
    v_accvgpr_write_b32 a37, v19
    v_accvgpr_read_b32 v18, a38
    v_mul_f32 v19, v18, v17
    v_accvgpr_write_b32 a38, v19
    v_accvgpr_read_b32 v18, a39
    v_mul_f32 v19, v18, v17
    v_accvgpr_write_b32 a39, v19
    v_accvgpr_read_b32 v18, a40
    v_mul_f32 v19, v18, v17
    v_accvgpr_write_b32 a40, v19
    v_accvgpr_read_b32 v18, a41
    v_mul_f32 v19, v18, v17
    v_accvgpr_write_b32 a41, v19
    v_accvgpr_read_b32 v18, a42
    v_mul_f32 v19, v18, v17
    v_accvgpr_write_b32 a42, v19
    v_accvgpr_read_b32 v18, a43
    v_mul_f32 v19, v18, v17
    v_accvgpr_write_b32 a43, v19
    v_accvgpr_read_b32 v18, a44
    v_mul_f32 v19, v18, v17
    v_accvgpr_write_b32 a44, v19
    v_accvgpr_read_b32 v18, a45
    v_mul_f32 v19, v18, v17
    v_accvgpr_write_b32 a45, v19
    v_accvgpr_read_b32 v18, a46
    v_mul_f32 v19, v18, v17
    v_accvgpr_write_b32 a46, v19
    v_accvgpr_read_b32 v18, a47
    v_mul_f32 v19, v18, v17
    v_accvgpr_write_b32 a47, v19
    v_accvgpr_read_b32 v18, a48
    v_mul_f32 v19, v18, v17
    v_accvgpr_write_b32 a48, v19
    v_accvgpr_read_b32 v18, a49
    v_mul_f32 v19, v18, v17
    v_accvgpr_write_b32 a49, v19
    v_accvgpr_read_b32 v18, a50
    v_mul_f32 v19, v18, v17
    v_accvgpr_write_b32 a50, v19
    v_accvgpr_read_b32 v18, a51
    v_mul_f32 v19, v18, v17
    v_accvgpr_write_b32 a51, v19
    v_accvgpr_read_b32 v18, a52
    v_mul_f32 v19, v18, v17
    v_accvgpr_write_b32 a52, v19
    v_accvgpr_read_b32 v18, a53
    v_mul_f32 v19, v18, v17
    v_accvgpr_write_b32 a53, v19
    v_accvgpr_read_b32 v18, a54
    v_mul_f32 v19, v18, v17
    v_accvgpr_write_b32 a54, v19
    v_accvgpr_read_b32 v18, a55
    v_mul_f32 v19, v18, v17
    v_accvgpr_write_b32 a55, v19
    v_accvgpr_read_b32 v18, a56
    v_mul_f32 v19, v18, v17
    v_accvgpr_write_b32 a56, v19
    v_accvgpr_read_b32 v18, a57
    v_mul_f32 v19, v18, v17
    v_accvgpr_write_b32 a57, v19
    v_accvgpr_read_b32 v18, a58
    v_mul_f32 v19, v18, v17
    v_accvgpr_write_b32 a58, v19
    v_accvgpr_read_b32 v18, a59
    v_mul_f32 v19, v18, v17
    v_accvgpr_write_b32 a59, v19
    v_accvgpr_read_b32 v18, a60
    v_mul_f32 v19, v18, v17
    v_accvgpr_write_b32 a60, v19
    v_accvgpr_read_b32 v18, a61
    v_mul_f32 v19, v18, v17
    v_accvgpr_write_b32 a61, v19
    v_accvgpr_read_b32 v18, a62
    v_mul_f32 v19, v18, v17
    v_accvgpr_write_b32 a62, v19
    v_accvgpr_read_b32 v18, a63
    v_mul_f32 v19, v18, v17
    v_accvgpr_write_b32 a63, v19
    v_mov_b32 v14, 0
    v_sub_f32 v18, v64, v16
    v_sub_f32 v19, v65, v16
    v_exp_f32 v18, v18
    v_exp_f32 v19, v19
    s_nop 0
    v_add_f32 v14, v14, v18
    v_add_f32 v14, v14, v19
    v_cvt_pk_bf16_f32 v96, v18, v19
    v_sub_f32 v18, v66, v16
    v_sub_f32 v19, v67, v16
    v_exp_f32 v18, v18
    v_exp_f32 v19, v19
    s_nop 0
    v_add_f32 v14, v14, v18
    v_add_f32 v14, v14, v19
    v_cvt_pk_bf16_f32 v97, v18, v19
    v_sub_f32 v18, v68, v16
    v_sub_f32 v19, v69, v16
    v_exp_f32 v18, v18
    v_exp_f32 v19, v19
    s_nop 0
    v_add_f32 v14, v14, v18
    v_add_f32 v14, v14, v19
    v_cvt_pk_bf16_f32 v98, v18, v19
    v_sub_f32 v18, v70, v16
    v_sub_f32 v19, v71, v16
    v_exp_f32 v18, v18
    v_exp_f32 v19, v19
    s_nop 0
    v_add_f32 v14, v14, v18
    v_add_f32 v14, v14, v19
    v_cvt_pk_bf16_f32 v99, v18, v19
    v_sub_f32 v18, v72, v16
    v_sub_f32 v19, v73, v16
    v_exp_f32 v18, v18
    v_exp_f32 v19, v19
    s_nop 0
    v_add_f32 v14, v14, v18
    v_add_f32 v14, v14, v19
    v_cvt_pk_bf16_f32 v100, v18, v19
    v_sub_f32 v18, v74, v16
    v_sub_f32 v19, v75, v16
    v_exp_f32 v18, v18
    v_exp_f32 v19, v19
    s_nop 0
    v_add_f32 v14, v14, v18
    v_add_f32 v14, v14, v19
    v_cvt_pk_bf16_f32 v101, v18, v19
    v_sub_f32 v18, v76, v16
    v_sub_f32 v19, v77, v16
    v_exp_f32 v18, v18
    v_exp_f32 v19, v19
    s_nop 0
    v_add_f32 v14, v14, v18
    v_add_f32 v14, v14, v19
    v_cvt_pk_bf16_f32 v102, v18, v19
    v_sub_f32 v18, v78, v16
    v_sub_f32 v19, v79, v16
    v_exp_f32 v18, v18
    v_exp_f32 v19, v19
    s_nop 0
    v_add_f32 v14, v14, v18
    v_add_f32 v14, v14, v19
    v_cvt_pk_bf16_f32 v103, v18, v19
    s_nop 3
    s_branch L_back2
L_slow3:
    s_nop 15
    s_nop 15
    v_max3_f32 v16, v80, v81, v82
    v_max3_f32 v16, v16, v83, v84
    v_max3_f32 v16, v16, v85, v86
    v_max3_f32 v16, v16, v87, v88
    v_max3_f32 v16, v16, v89, v90
    v_max3_f32 v16, v16, v91, v92
    v_max3_f32 v16, v16, v93, v94
    v_max_f32 v16, v16, v95
    v_mov_b32 v17, v16
    s_nop 1
    v_permlane32_swap_b32 v16, v17
    s_nop 1
    v_max3_f32 v16, v16, v17, 0
    v_exp_f32 v17, -v16
    s_nop 1
    v_sub_f32 v13, v13, v16
    v_mov_b32 v112, v13
    v_mov_b32 v113, v13
    v_mov_b32 v114, v13
    v_mov_b32 v115, v13
    v_mov_b32 v116, v13
    v_mov_b32 v117, v13
    v_mov_b32 v118, v13
    v_mov_b32 v119, v13
    v_mov_b32 v120, v13
    v_mov_b32 v121, v13
    v_mov_b32 v122, v13
    v_mov_b32 v123, v13
    v_mov_b32 v124, v13
    v_mov_b32 v125, v13
    v_mov_b32 v126, v13
    v_mov_b32 v127, v13
    v_sub_f32 v64, v64, v16
    v_sub_f32 v65, v65, v16
    v_sub_f32 v66, v66, v16
    v_sub_f32 v67, v67, v16
    v_sub_f32 v68, v68, v16
    v_sub_f32 v69, v69, v16
    v_sub_f32 v70, v70, v16
    v_sub_f32 v71, v71, v16
    v_sub_f32 v72, v72, v16
    v_sub_f32 v73, v73, v16
    v_sub_f32 v74, v74, v16
    v_sub_f32 v75, v75, v16
    v_sub_f32 v76, v76, v16
    v_sub_f32 v77, v77, v16
    v_sub_f32 v78, v78, v16
    v_sub_f32 v79, v79, v16
    v_mul_f32 v9, v9, v17
    v_accvgpr_read_b32 v18, a0
    v_mul_f32 v19, v18, v17
    v_accvgpr_write_b32 a0, v19
    v_accvgpr_read_b32 v18, a1
    v_mul_f32 v19, v18, v17
    v_accvgpr_write_b32 a1, v19
    v_accvgpr_read_b32 v18, a2
    v_mul_f32 v19, v18, v17
    v_accvgpr_write_b32 a2, v19
    v_accvgpr_read_b32 v18, a3
    v_mul_f32 v19, v18, v17
    v_accvgpr_write_b32 a3, v19
    v_accvgpr_read_b32 v18, a4
    v_mul_f32 v19, v18, v17
    v_accvgpr_write_b32 a4, v19
    v_accvgpr_read_b32 v18, a5
    v_mul_f32 v19, v18, v17
    v_accvgpr_write_b32 a5, v19
    v_accvgpr_read_b32 v18, a6
    v_mul_f32 v19, v18, v17
    v_accvgpr_write_b32 a6, v19
    v_accvgpr_read_b32 v18, a7
    v_mul_f32 v19, v18, v17
    v_accvgpr_write_b32 a7, v19
    v_accvgpr_read_b32 v18, a8
    v_mul_f32 v19, v18, v17
    v_accvgpr_write_b32 a8, v19
    v_accvgpr_read_b32 v18, a9
    v_mul_f32 v19, v18, v17
    v_accvgpr_write_b32 a9, v19
    v_accvgpr_read_b32 v18, a10
    v_mul_f32 v19, v18, v17
    v_accvgpr_write_b32 a10, v19
    v_accvgpr_read_b32 v18, a11
    v_mul_f32 v19, v18, v17
    v_accvgpr_write_b32 a11, v19
    v_accvgpr_read_b32 v18, a12
    v_mul_f32 v19, v18, v17
    v_accvgpr_write_b32 a12, v19
    v_accvgpr_read_b32 v18, a13
    v_mul_f32 v19, v18, v17
    v_accvgpr_write_b32 a13, v19
    v_accvgpr_read_b32 v18, a14
    v_mul_f32 v19, v18, v17
    v_accvgpr_write_b32 a14, v19
    v_accvgpr_read_b32 v18, a15
    v_mul_f32 v19, v18, v17
    v_accvgpr_write_b32 a15, v19
    v_accvgpr_read_b32 v18, a16
    v_mul_f32 v19, v18, v17
    v_accvgpr_write_b32 a16, v19
    v_accvgpr_read_b32 v18, a17
    v_mul_f32 v19, v18, v17
    v_accvgpr_write_b32 a17, v19
    v_accvgpr_read_b32 v18, a18
    v_mul_f32 v19, v18, v17
    v_accvgpr_write_b32 a18, v19
    v_accvgpr_read_b32 v18, a19
    v_mul_f32 v19, v18, v17
    v_accvgpr_write_b32 a19, v19
    v_accvgpr_read_b32 v18, a20
    v_mul_f32 v19, v18, v17
    v_accvgpr_write_b32 a20, v19
    v_accvgpr_read_b32 v18, a21
    v_mul_f32 v19, v18, v17
    v_accvgpr_write_b32 a21, v19
    v_accvgpr_read_b32 v18, a22
    v_mul_f32 v19, v18, v17
    v_accvgpr_write_b32 a22, v19
    v_accvgpr_read_b32 v18, a23
    v_mul_f32 v19, v18, v17
    v_accvgpr_write_b32 a23, v19
    v_accvgpr_read_b32 v18, a24
    v_mul_f32 v19, v18, v17
    v_accvgpr_write_b32 a24, v19
    v_accvgpr_read_b32 v18, a25
    v_mul_f32 v19, v18, v17
    v_accvgpr_write_b32 a25, v19
    v_accvgpr_read_b32 v18, a26
    v_mul_f32 v19, v18, v17
    v_accvgpr_write_b32 a26, v19
    v_accvgpr_read_b32 v18, a27
    v_mul_f32 v19, v18, v17
    v_accvgpr_write_b32 a27, v19
    v_accvgpr_read_b32 v18, a28
    v_mul_f32 v19, v18, v17
    v_accvgpr_write_b32 a28, v19
    v_accvgpr_read_b32 v18, a29
    v_mul_f32 v19, v18, v17
    v_accvgpr_write_b32 a29, v19
    v_accvgpr_read_b32 v18, a30
    v_mul_f32 v19, v18, v17
    v_accvgpr_write_b32 a30, v19
    v_accvgpr_read_b32 v18, a31
    v_mul_f32 v19, v18, v17
    v_accvgpr_write_b32 a31, v19
    v_accvgpr_read_b32 v18, a32
    v_mul_f32 v19, v18, v17
    v_accvgpr_write_b32 a32, v19
    v_accvgpr_read_b32 v18, a33
    v_mul_f32 v19, v18, v17
    v_accvgpr_write_b32 a33, v19
    v_accvgpr_read_b32 v18, a34
    v_mul_f32 v19, v18, v17
    v_accvgpr_write_b32 a34, v19
    v_accvgpr_read_b32 v18, a35
    v_mul_f32 v19, v18, v17
    v_accvgpr_write_b32 a35, v19
    v_accvgpr_read_b32 v18, a36
    v_mul_f32 v19, v18, v17
    v_accvgpr_write_b32 a36, v19
    v_accvgpr_read_b32 v18, a37
    v_mul_f32 v19, v18, v17
    v_accvgpr_write_b32 a37, v19
    v_accvgpr_read_b32 v18, a38
    v_mul_f32 v19, v18, v17
    v_accvgpr_write_b32 a38, v19
    v_accvgpr_read_b32 v18, a39
    v_mul_f32 v19, v18, v17
    v_accvgpr_write_b32 a39, v19
    v_accvgpr_read_b32 v18, a40
    v_mul_f32 v19, v18, v17
    v_accvgpr_write_b32 a40, v19
    v_accvgpr_read_b32 v18, a41
    v_mul_f32 v19, v18, v17
    v_accvgpr_write_b32 a41, v19
    v_accvgpr_read_b32 v18, a42
    v_mul_f32 v19, v18, v17
    v_accvgpr_write_b32 a42, v19
    v_accvgpr_read_b32 v18, a43
    v_mul_f32 v19, v18, v17
    v_accvgpr_write_b32 a43, v19
    v_accvgpr_read_b32 v18, a44
    v_mul_f32 v19, v18, v17
    v_accvgpr_write_b32 a44, v19
    v_accvgpr_read_b32 v18, a45
    v_mul_f32 v19, v18, v17
    v_accvgpr_write_b32 a45, v19
    v_accvgpr_read_b32 v18, a46
    v_mul_f32 v19, v18, v17
    v_accvgpr_write_b32 a46, v19
    v_accvgpr_read_b32 v18, a47
    v_mul_f32 v19, v18, v17
    v_accvgpr_write_b32 a47, v19
    v_accvgpr_read_b32 v18, a48
    v_mul_f32 v19, v18, v17
    v_accvgpr_write_b32 a48, v19
    v_accvgpr_read_b32 v18, a49
    v_mul_f32 v19, v18, v17
    v_accvgpr_write_b32 a49, v19
    v_accvgpr_read_b32 v18, a50
    v_mul_f32 v19, v18, v17
    v_accvgpr_write_b32 a50, v19
    v_accvgpr_read_b32 v18, a51
    v_mul_f32 v19, v18, v17
    v_accvgpr_write_b32 a51, v19
    v_accvgpr_read_b32 v18, a52
    v_mul_f32 v19, v18, v17
    v_accvgpr_write_b32 a52, v19
    v_accvgpr_read_b32 v18, a53
    v_mul_f32 v19, v18, v17
    v_accvgpr_write_b32 a53, v19
    v_accvgpr_read_b32 v18, a54
    v_mul_f32 v19, v18, v17
    v_accvgpr_write_b32 a54, v19
    v_accvgpr_read_b32 v18, a55
    v_mul_f32 v19, v18, v17
    v_accvgpr_write_b32 a55, v19
    v_accvgpr_read_b32 v18, a56
    v_mul_f32 v19, v18, v17
    v_accvgpr_write_b32 a56, v19
    v_accvgpr_read_b32 v18, a57
    v_mul_f32 v19, v18, v17
    v_accvgpr_write_b32 a57, v19
    v_accvgpr_read_b32 v18, a58
    v_mul_f32 v19, v18, v17
    v_accvgpr_write_b32 a58, v19
    v_accvgpr_read_b32 v18, a59
    v_mul_f32 v19, v18, v17
    v_accvgpr_write_b32 a59, v19
    v_accvgpr_read_b32 v18, a60
    v_mul_f32 v19, v18, v17
    v_accvgpr_write_b32 a60, v19
    v_accvgpr_read_b32 v18, a61
    v_mul_f32 v19, v18, v17
    v_accvgpr_write_b32 a61, v19
    v_accvgpr_read_b32 v18, a62
    v_mul_f32 v19, v18, v17
    v_accvgpr_write_b32 a62, v19
    v_accvgpr_read_b32 v18, a63
    v_mul_f32 v19, v18, v17
    v_accvgpr_write_b32 a63, v19
    v_mov_b32 v14, 0
    v_sub_f32 v18, v80, v16
    v_sub_f32 v19, v81, v16
    v_exp_f32 v18, v18
    v_exp_f32 v19, v19
    s_nop 0
    v_add_f32 v14, v14, v18
    v_add_f32 v14, v14, v19
    v_cvt_pk_bf16_f32 v104, v18, v19
    v_sub_f32 v18, v82, v16
    v_sub_f32 v19, v83, v16
    v_exp_f32 v18, v18
    v_exp_f32 v19, v19
    s_nop 0
    v_add_f32 v14, v14, v18
    v_add_f32 v14, v14, v19
    v_cvt_pk_bf16_f32 v105, v18, v19
    v_sub_f32 v18, v84, v16
    v_sub_f32 v19, v85, v16
    v_exp_f32 v18, v18
    v_exp_f32 v19, v19
    s_nop 0
    v_add_f32 v14, v14, v18
    v_add_f32 v14, v14, v19
    v_cvt_pk_bf16_f32 v106, v18, v19
    v_sub_f32 v18, v86, v16
    v_sub_f32 v19, v87, v16
    v_exp_f32 v18, v18
    v_exp_f32 v19, v19
    s_nop 0
    v_add_f32 v14, v14, v18
    v_add_f32 v14, v14, v19
    v_cvt_pk_bf16_f32 v107, v18, v19
    v_sub_f32 v18, v88, v16
    v_sub_f32 v19, v89, v16
    v_exp_f32 v18, v18
    v_exp_f32 v19, v19
    s_nop 0
    v_add_f32 v14, v14, v18
    v_add_f32 v14, v14, v19
    v_cvt_pk_bf16_f32 v108, v18, v19
    v_sub_f32 v18, v90, v16
    v_sub_f32 v19, v91, v16
    v_exp_f32 v18, v18
    v_exp_f32 v19, v19
    s_nop 0
    v_add_f32 v14, v14, v18
    v_add_f32 v14, v14, v19
    v_cvt_pk_bf16_f32 v109, v18, v19
    v_sub_f32 v18, v92, v16
    v_sub_f32 v19, v93, v16
    v_exp_f32 v18, v18
    v_exp_f32 v19, v19
    s_nop 0
    v_add_f32 v14, v14, v18
    v_add_f32 v14, v14, v19
    v_cvt_pk_bf16_f32 v110, v18, v19
    v_sub_f32 v18, v94, v16
    v_sub_f32 v19, v95, v16
    v_exp_f32 v18, v18
    v_exp_f32 v19, v19
    s_nop 0
    v_add_f32 v14, v14, v18
    v_add_f32 v14, v14, v19
    v_cvt_pk_bf16_f32 v111, v18, v19
    s_nop 3
    s_branch L_back3
L_slow4:
    s_nop 15
    s_nop 15
    v_max3_f32 v16, v64, v65, v66
    v_max3_f32 v16, v16, v67, v68
    v_max3_f32 v16, v16, v69, v70
    v_max3_f32 v16, v16, v71, v72
    v_max3_f32 v16, v16, v73, v74
    v_max3_f32 v16, v16, v75, v76
    v_max3_f32 v16, v16, v77, v78
    v_max_f32 v16, v16, v79
    v_mov_b32 v17, v16
    s_nop 1
    v_permlane32_swap_b32 v16, v17
    s_nop 1
    v_max3_f32 v16, v16, v17, 0
    v_exp_f32 v17, -v16
    s_nop 1
    v_sub_f32 v13, v13, v16
    v_mov_b32 v112, v13
    v_mov_b32 v113, v13
    v_mov_b32 v114, v13
    v_mov_b32 v115, v13
    v_mov_b32 v116, v13
    v_mov_b32 v117, v13
    v_mov_b32 v118, v13
    v_mov_b32 v119, v13
    v_mov_b32 v120, v13
    v_mov_b32 v121, v13
    v_mov_b32 v122, v13
    v_mov_b32 v123, v13
    v_mov_b32 v124, v13
    v_mov_b32 v125, v13
    v_mov_b32 v126, v13
    v_mov_b32 v127, v13
    v_sub_f32 v80, v80, v16
    v_sub_f32 v81, v81, v16
    v_sub_f32 v82, v82, v16
    v_sub_f32 v83, v83, v16
    v_sub_f32 v84, v84, v16
    v_sub_f32 v85, v85, v16
    v_sub_f32 v86, v86, v16
    v_sub_f32 v87, v87, v16
    v_sub_f32 v88, v88, v16
    v_sub_f32 v89, v89, v16
    v_sub_f32 v90, v90, v16
    v_sub_f32 v91, v91, v16
    v_sub_f32 v92, v92, v16
    v_sub_f32 v93, v93, v16
    v_sub_f32 v94, v94, v16
    v_sub_f32 v95, v95, v16
    v_mul_f32 v9, v9, v17
    v_accvgpr_read_b32 v18, a0
    v_mul_f32 v19, v18, v17
    v_accvgpr_write_b32 a0, v19
    v_accvgpr_read_b32 v18, a1
    v_mul_f32 v19, v18, v17
    v_accvgpr_write_b32 a1, v19
    v_accvgpr_read_b32 v18, a2
    v_mul_f32 v19, v18, v17
    v_accvgpr_write_b32 a2, v19
    v_accvgpr_read_b32 v18, a3
    v_mul_f32 v19, v18, v17
    v_accvgpr_write_b32 a3, v19
    v_accvgpr_read_b32 v18, a4
    v_mul_f32 v19, v18, v17
    v_accvgpr_write_b32 a4, v19
    v_accvgpr_read_b32 v18, a5
    v_mul_f32 v19, v18, v17
    v_accvgpr_write_b32 a5, v19
    v_accvgpr_read_b32 v18, a6
    v_mul_f32 v19, v18, v17
    v_accvgpr_write_b32 a6, v19
    v_accvgpr_read_b32 v18, a7
    v_mul_f32 v19, v18, v17
    v_accvgpr_write_b32 a7, v19
    v_accvgpr_read_b32 v18, a8
    v_mul_f32 v19, v18, v17
    v_accvgpr_write_b32 a8, v19
    v_accvgpr_read_b32 v18, a9
    v_mul_f32 v19, v18, v17
    v_accvgpr_write_b32 a9, v19
    v_accvgpr_read_b32 v18, a10
    v_mul_f32 v19, v18, v17
    v_accvgpr_write_b32 a10, v19
    v_accvgpr_read_b32 v18, a11
    v_mul_f32 v19, v18, v17
    v_accvgpr_write_b32 a11, v19
    v_accvgpr_read_b32 v18, a12
    v_mul_f32 v19, v18, v17
    v_accvgpr_write_b32 a12, v19
    v_accvgpr_read_b32 v18, a13
    v_mul_f32 v19, v18, v17
    v_accvgpr_write_b32 a13, v19
    v_accvgpr_read_b32 v18, a14
    v_mul_f32 v19, v18, v17
    v_accvgpr_write_b32 a14, v19
    v_accvgpr_read_b32 v18, a15
    v_mul_f32 v19, v18, v17
    v_accvgpr_write_b32 a15, v19
    v_accvgpr_read_b32 v18, a16
    v_mul_f32 v19, v18, v17
    v_accvgpr_write_b32 a16, v19
    v_accvgpr_read_b32 v18, a17
    v_mul_f32 v19, v18, v17
    v_accvgpr_write_b32 a17, v19
    v_accvgpr_read_b32 v18, a18
    v_mul_f32 v19, v18, v17
    v_accvgpr_write_b32 a18, v19
    v_accvgpr_read_b32 v18, a19
    v_mul_f32 v19, v18, v17
    v_accvgpr_write_b32 a19, v19
    v_accvgpr_read_b32 v18, a20
    v_mul_f32 v19, v18, v17
    v_accvgpr_write_b32 a20, v19
    v_accvgpr_read_b32 v18, a21
    v_mul_f32 v19, v18, v17
    v_accvgpr_write_b32 a21, v19
    v_accvgpr_read_b32 v18, a22
    v_mul_f32 v19, v18, v17
    v_accvgpr_write_b32 a22, v19
    v_accvgpr_read_b32 v18, a23
    v_mul_f32 v19, v18, v17
    v_accvgpr_write_b32 a23, v19
    v_accvgpr_read_b32 v18, a24
    v_mul_f32 v19, v18, v17
    v_accvgpr_write_b32 a24, v19
    v_accvgpr_read_b32 v18, a25
    v_mul_f32 v19, v18, v17
    v_accvgpr_write_b32 a25, v19
    v_accvgpr_read_b32 v18, a26
    v_mul_f32 v19, v18, v17
    v_accvgpr_write_b32 a26, v19
    v_accvgpr_read_b32 v18, a27
    v_mul_f32 v19, v18, v17
    v_accvgpr_write_b32 a27, v19
    v_accvgpr_read_b32 v18, a28
    v_mul_f32 v19, v18, v17
    v_accvgpr_write_b32 a28, v19
    v_accvgpr_read_b32 v18, a29
    v_mul_f32 v19, v18, v17
    v_accvgpr_write_b32 a29, v19
    v_accvgpr_read_b32 v18, a30
    v_mul_f32 v19, v18, v17
    v_accvgpr_write_b32 a30, v19
    v_accvgpr_read_b32 v18, a31
    v_mul_f32 v19, v18, v17
    v_accvgpr_write_b32 a31, v19
    v_accvgpr_read_b32 v18, a32
    v_mul_f32 v19, v18, v17
    v_accvgpr_write_b32 a32, v19
    v_accvgpr_read_b32 v18, a33
    v_mul_f32 v19, v18, v17
    v_accvgpr_write_b32 a33, v19
    v_accvgpr_read_b32 v18, a34
    v_mul_f32 v19, v18, v17
    v_accvgpr_write_b32 a34, v19
    v_accvgpr_read_b32 v18, a35
    v_mul_f32 v19, v18, v17
    v_accvgpr_write_b32 a35, v19
    v_accvgpr_read_b32 v18, a36
    v_mul_f32 v19, v18, v17
    v_accvgpr_write_b32 a36, v19
    v_accvgpr_read_b32 v18, a37
    v_mul_f32 v19, v18, v17
    v_accvgpr_write_b32 a37, v19
    v_accvgpr_read_b32 v18, a38
    v_mul_f32 v19, v18, v17
    v_accvgpr_write_b32 a38, v19
    v_accvgpr_read_b32 v18, a39
    v_mul_f32 v19, v18, v17
    v_accvgpr_write_b32 a39, v19
    v_accvgpr_read_b32 v18, a40
    v_mul_f32 v19, v18, v17
    v_accvgpr_write_b32 a40, v19
    v_accvgpr_read_b32 v18, a41
    v_mul_f32 v19, v18, v17
    v_accvgpr_write_b32 a41, v19
    v_accvgpr_read_b32 v18, a42
    v_mul_f32 v19, v18, v17
    v_accvgpr_write_b32 a42, v19
    v_accvgpr_read_b32 v18, a43
    v_mul_f32 v19, v18, v17
    v_accvgpr_write_b32 a43, v19
    v_accvgpr_read_b32 v18, a44
    v_mul_f32 v19, v18, v17
    v_accvgpr_write_b32 a44, v19
    v_accvgpr_read_b32 v18, a45
    v_mul_f32 v19, v18, v17
    v_accvgpr_write_b32 a45, v19
    v_accvgpr_read_b32 v18, a46
    v_mul_f32 v19, v18, v17
    v_accvgpr_write_b32 a46, v19
    v_accvgpr_read_b32 v18, a47
    v_mul_f32 v19, v18, v17
    v_accvgpr_write_b32 a47, v19
    v_accvgpr_read_b32 v18, a48
    v_mul_f32 v19, v18, v17
    v_accvgpr_write_b32 a48, v19
    v_accvgpr_read_b32 v18, a49
    v_mul_f32 v19, v18, v17
    v_accvgpr_write_b32 a49, v19
    v_accvgpr_read_b32 v18, a50
    v_mul_f32 v19, v18, v17
    v_accvgpr_write_b32 a50, v19
    v_accvgpr_read_b32 v18, a51
    v_mul_f32 v19, v18, v17
    v_accvgpr_write_b32 a51, v19
    v_accvgpr_read_b32 v18, a52
    v_mul_f32 v19, v18, v17
    v_accvgpr_write_b32 a52, v19
    v_accvgpr_read_b32 v18, a53
    v_mul_f32 v19, v18, v17
    v_accvgpr_write_b32 a53, v19
    v_accvgpr_read_b32 v18, a54
    v_mul_f32 v19, v18, v17
    v_accvgpr_write_b32 a54, v19
    v_accvgpr_read_b32 v18, a55
    v_mul_f32 v19, v18, v17
    v_accvgpr_write_b32 a55, v19
    v_accvgpr_read_b32 v18, a56
    v_mul_f32 v19, v18, v17
    v_accvgpr_write_b32 a56, v19
    v_accvgpr_read_b32 v18, a57
    v_mul_f32 v19, v18, v17
    v_accvgpr_write_b32 a57, v19
    v_accvgpr_read_b32 v18, a58
    v_mul_f32 v19, v18, v17
    v_accvgpr_write_b32 a58, v19
    v_accvgpr_read_b32 v18, a59
    v_mul_f32 v19, v18, v17
    v_accvgpr_write_b32 a59, v19
    v_accvgpr_read_b32 v18, a60
    v_mul_f32 v19, v18, v17
    v_accvgpr_write_b32 a60, v19
    v_accvgpr_read_b32 v18, a61
    v_mul_f32 v19, v18, v17
    v_accvgpr_write_b32 a61, v19
    v_accvgpr_read_b32 v18, a62
    v_mul_f32 v19, v18, v17
    v_accvgpr_write_b32 a62, v19
    v_accvgpr_read_b32 v18, a63
    v_mul_f32 v19, v18, v17
    v_accvgpr_write_b32 a63, v19
    v_mov_b32 v14, 0
    v_sub_f32 v18, v64, v16
    v_sub_f32 v19, v65, v16
    v_exp_f32 v18, v18
    v_exp_f32 v19, v19
    s_nop 0
    v_add_f32 v14, v14, v18
    v_add_f32 v14, v14, v19
    v_cvt_pk_bf16_f32 v96, v18, v19
    v_sub_f32 v18, v66, v16
    v_sub_f32 v19, v67, v16
    v_exp_f32 v18, v18
    v_exp_f32 v19, v19
    s_nop 0
    v_add_f32 v14, v14, v18
    v_add_f32 v14, v14, v19
    v_cvt_pk_bf16_f32 v97, v18, v19
    v_sub_f32 v18, v68, v16
    v_sub_f32 v19, v69, v16
    v_exp_f32 v18, v18
    v_exp_f32 v19, v19
    s_nop 0
    v_add_f32 v14, v14, v18
    v_add_f32 v14, v14, v19
    v_cvt_pk_bf16_f32 v98, v18, v19
    v_sub_f32 v18, v70, v16
    v_sub_f32 v19, v71, v16
    v_exp_f32 v18, v18
    v_exp_f32 v19, v19
    s_nop 0
    v_add_f32 v14, v14, v18
    v_add_f32 v14, v14, v19
    v_cvt_pk_bf16_f32 v99, v18, v19
    v_sub_f32 v18, v72, v16
    v_sub_f32 v19, v73, v16
    v_exp_f32 v18, v18
    v_exp_f32 v19, v19
    s_nop 0
    v_add_f32 v14, v14, v18
    v_add_f32 v14, v14, v19
    v_cvt_pk_bf16_f32 v100, v18, v19
    v_sub_f32 v18, v74, v16
    v_sub_f32 v19, v75, v16
    v_exp_f32 v18, v18
    v_exp_f32 v19, v19
    s_nop 0
    v_add_f32 v14, v14, v18
    v_add_f32 v14, v14, v19
    v_cvt_pk_bf16_f32 v101, v18, v19
    v_sub_f32 v18, v76, v16
    v_sub_f32 v19, v77, v16
    v_exp_f32 v18, v18
    v_exp_f32 v19, v19
    s_nop 0
    v_add_f32 v14, v14, v18
    v_add_f32 v14, v14, v19
    v_cvt_pk_bf16_f32 v102, v18, v19
    v_sub_f32 v18, v78, v16
    v_sub_f32 v19, v79, v16
    v_exp_f32 v18, v18
    v_exp_f32 v19, v19
    s_nop 0
    v_add_f32 v14, v14, v18
    v_add_f32 v14, v14, v19
    v_cvt_pk_bf16_f32 v103, v18, v19
    s_nop 3
    s_branch L_back4
L_slow5:
    s_nop 15
    s_nop 15
    v_max3_f32 v16, v80, v81, v82
    v_max3_f32 v16, v16, v83, v84
    v_max3_f32 v16, v16, v85, v86
    v_max3_f32 v16, v16, v87, v88
    v_max3_f32 v16, v16, v89, v90
    v_max3_f32 v16, v16, v91, v92
    v_max3_f32 v16, v16, v93, v94
    v_max_f32 v16, v16, v95
    v_mov_b32 v17, v16
    s_nop 1
    v_permlane32_swap_b32 v16, v17
    s_nop 1
    v_max3_f32 v16, v16, v17, 0
    v_exp_f32 v17, -v16
    s_nop 1
    v_sub_f32 v13, v13, v16
    v_mov_b32 v112, v13
    v_mov_b32 v113, v13
    v_mov_b32 v114, v13
    v_mov_b32 v115, v13
    v_mov_b32 v116, v13
    v_mov_b32 v117, v13
    v_mov_b32 v118, v13
    v_mov_b32 v119, v13
    v_mov_b32 v120, v13
    v_mov_b32 v121, v13
    v_mov_b32 v122, v13
    v_mov_b32 v123, v13
    v_mov_b32 v124, v13
    v_mov_b32 v125, v13
    v_mov_b32 v126, v13
    v_mov_b32 v127, v13
    v_sub_f32 v64, v64, v16
    v_sub_f32 v65, v65, v16
    v_sub_f32 v66, v66, v16
    v_sub_f32 v67, v67, v16
    v_sub_f32 v68, v68, v16
    v_sub_f32 v69, v69, v16
    v_sub_f32 v70, v70, v16
    v_sub_f32 v71, v71, v16
    v_sub_f32 v72, v72, v16
    v_sub_f32 v73, v73, v16
    v_sub_f32 v74, v74, v16
    v_sub_f32 v75, v75, v16
    v_sub_f32 v76, v76, v16
    v_sub_f32 v77, v77, v16
    v_sub_f32 v78, v78, v16
    v_sub_f32 v79, v79, v16
    v_mul_f32 v9, v9, v17
    v_accvgpr_read_b32 v18, a0
    v_mul_f32 v19, v18, v17
    v_accvgpr_write_b32 a0, v19
    v_accvgpr_read_b32 v18, a1
    v_mul_f32 v19, v18, v17
    v_accvgpr_write_b32 a1, v19
    v_accvgpr_read_b32 v18, a2
    v_mul_f32 v19, v18, v17
    v_accvgpr_write_b32 a2, v19
    v_accvgpr_read_b32 v18, a3
    v_mul_f32 v19, v18, v17
    v_accvgpr_write_b32 a3, v19
    v_accvgpr_read_b32 v18, a4
    v_mul_f32 v19, v18, v17
    v_accvgpr_write_b32 a4, v19
    v_accvgpr_read_b32 v18, a5
    v_mul_f32 v19, v18, v17
    v_accvgpr_write_b32 a5, v19
    v_accvgpr_read_b32 v18, a6
    v_mul_f32 v19, v18, v17
    v_accvgpr_write_b32 a6, v19
    v_accvgpr_read_b32 v18, a7
    v_mul_f32 v19, v18, v17
    v_accvgpr_write_b32 a7, v19
    v_accvgpr_read_b32 v18, a8
    v_mul_f32 v19, v18, v17
    v_accvgpr_write_b32 a8, v19
    v_accvgpr_read_b32 v18, a9
    v_mul_f32 v19, v18, v17
    v_accvgpr_write_b32 a9, v19
    v_accvgpr_read_b32 v18, a10
    v_mul_f32 v19, v18, v17
    v_accvgpr_write_b32 a10, v19
    v_accvgpr_read_b32 v18, a11
    v_mul_f32 v19, v18, v17
    v_accvgpr_write_b32 a11, v19
    v_accvgpr_read_b32 v18, a12
    v_mul_f32 v19, v18, v17
    v_accvgpr_write_b32 a12, v19
    v_accvgpr_read_b32 v18, a13
    v_mul_f32 v19, v18, v17
    v_accvgpr_write_b32 a13, v19
    v_accvgpr_read_b32 v18, a14
    v_mul_f32 v19, v18, v17
    v_accvgpr_write_b32 a14, v19
    v_accvgpr_read_b32 v18, a15
    v_mul_f32 v19, v18, v17
    v_accvgpr_write_b32 a15, v19
    v_accvgpr_read_b32 v18, a16
    v_mul_f32 v19, v18, v17
    v_accvgpr_write_b32 a16, v19
    v_accvgpr_read_b32 v18, a17
    v_mul_f32 v19, v18, v17
    v_accvgpr_write_b32 a17, v19
    v_accvgpr_read_b32 v18, a18
    v_mul_f32 v19, v18, v17
    v_accvgpr_write_b32 a18, v19
    v_accvgpr_read_b32 v18, a19
    v_mul_f32 v19, v18, v17
    v_accvgpr_write_b32 a19, v19
    v_accvgpr_read_b32 v18, a20
    v_mul_f32 v19, v18, v17
    v_accvgpr_write_b32 a20, v19
    v_accvgpr_read_b32 v18, a21
    v_mul_f32 v19, v18, v17
    v_accvgpr_write_b32 a21, v19
    v_accvgpr_read_b32 v18, a22
    v_mul_f32 v19, v18, v17
    v_accvgpr_write_b32 a22, v19
    v_accvgpr_read_b32 v18, a23
    v_mul_f32 v19, v18, v17
    v_accvgpr_write_b32 a23, v19
    v_accvgpr_read_b32 v18, a24
    v_mul_f32 v19, v18, v17
    v_accvgpr_write_b32 a24, v19
    v_accvgpr_read_b32 v18, a25
    v_mul_f32 v19, v18, v17
    v_accvgpr_write_b32 a25, v19
    v_accvgpr_read_b32 v18, a26
    v_mul_f32 v19, v18, v17
    v_accvgpr_write_b32 a26, v19
    v_accvgpr_read_b32 v18, a27
    v_mul_f32 v19, v18, v17
    v_accvgpr_write_b32 a27, v19
    v_accvgpr_read_b32 v18, a28
    v_mul_f32 v19, v18, v17
    v_accvgpr_write_b32 a28, v19
    v_accvgpr_read_b32 v18, a29
    v_mul_f32 v19, v18, v17
    v_accvgpr_write_b32 a29, v19
    v_accvgpr_read_b32 v18, a30
    v_mul_f32 v19, v18, v17
    v_accvgpr_write_b32 a30, v19
    v_accvgpr_read_b32 v18, a31
    v_mul_f32 v19, v18, v17
    v_accvgpr_write_b32 a31, v19
    v_accvgpr_read_b32 v18, a32
    v_mul_f32 v19, v18, v17
    v_accvgpr_write_b32 a32, v19
    v_accvgpr_read_b32 v18, a33
    v_mul_f32 v19, v18, v17
    v_accvgpr_write_b32 a33, v19
    v_accvgpr_read_b32 v18, a34
    v_mul_f32 v19, v18, v17
    v_accvgpr_write_b32 a34, v19
    v_accvgpr_read_b32 v18, a35
    v_mul_f32 v19, v18, v17
    v_accvgpr_write_b32 a35, v19
    v_accvgpr_read_b32 v18, a36
    v_mul_f32 v19, v18, v17
    v_accvgpr_write_b32 a36, v19
    v_accvgpr_read_b32 v18, a37
    v_mul_f32 v19, v18, v17
    v_accvgpr_write_b32 a37, v19
    v_accvgpr_read_b32 v18, a38
    v_mul_f32 v19, v18, v17
    v_accvgpr_write_b32 a38, v19
    v_accvgpr_read_b32 v18, a39
    v_mul_f32 v19, v18, v17
    v_accvgpr_write_b32 a39, v19
    v_accvgpr_read_b32 v18, a40
    v_mul_f32 v19, v18, v17
    v_accvgpr_write_b32 a40, v19
    v_accvgpr_read_b32 v18, a41
    v_mul_f32 v19, v18, v17
    v_accvgpr_write_b32 a41, v19
    v_accvgpr_read_b32 v18, a42
    v_mul_f32 v19, v18, v17
    v_accvgpr_write_b32 a42, v19
    v_accvgpr_read_b32 v18, a43
    v_mul_f32 v19, v18, v17
    v_accvgpr_write_b32 a43, v19
    v_accvgpr_read_b32 v18, a44
    v_mul_f32 v19, v18, v17
    v_accvgpr_write_b32 a44, v19
    v_accvgpr_read_b32 v18, a45
    v_mul_f32 v19, v18, v17
    v_accvgpr_write_b32 a45, v19
    v_accvgpr_read_b32 v18, a46
    v_mul_f32 v19, v18, v17
    v_accvgpr_write_b32 a46, v19
    v_accvgpr_read_b32 v18, a47
    v_mul_f32 v19, v18, v17
    v_accvgpr_write_b32 a47, v19
    v_accvgpr_read_b32 v18, a48
    v_mul_f32 v19, v18, v17
    v_accvgpr_write_b32 a48, v19
    v_accvgpr_read_b32 v18, a49
    v_mul_f32 v19, v18, v17
    v_accvgpr_write_b32 a49, v19
    v_accvgpr_read_b32 v18, a50
    v_mul_f32 v19, v18, v17
    v_accvgpr_write_b32 a50, v19
    v_accvgpr_read_b32 v18, a51
    v_mul_f32 v19, v18, v17
    v_accvgpr_write_b32 a51, v19
    v_accvgpr_read_b32 v18, a52
    v_mul_f32 v19, v18, v17
    v_accvgpr_write_b32 a52, v19
    v_accvgpr_read_b32 v18, a53
    v_mul_f32 v19, v18, v17
    v_accvgpr_write_b32 a53, v19
    v_accvgpr_read_b32 v18, a54
    v_mul_f32 v19, v18, v17
    v_accvgpr_write_b32 a54, v19
    v_accvgpr_read_b32 v18, a55
    v_mul_f32 v19, v18, v17
    v_accvgpr_write_b32 a55, v19
    v_accvgpr_read_b32 v18, a56
    v_mul_f32 v19, v18, v17
    v_accvgpr_write_b32 a56, v19
    v_accvgpr_read_b32 v18, a57
    v_mul_f32 v19, v18, v17
    v_accvgpr_write_b32 a57, v19
    v_accvgpr_read_b32 v18, a58
    v_mul_f32 v19, v18, v17
    v_accvgpr_write_b32 a58, v19
    v_accvgpr_read_b32 v18, a59
    v_mul_f32 v19, v18, v17
    v_accvgpr_write_b32 a59, v19
    v_accvgpr_read_b32 v18, a60
    v_mul_f32 v19, v18, v17
    v_accvgpr_write_b32 a60, v19
    v_accvgpr_read_b32 v18, a61
    v_mul_f32 v19, v18, v17
    v_accvgpr_write_b32 a61, v19
    v_accvgpr_read_b32 v18, a62
    v_mul_f32 v19, v18, v17
    v_accvgpr_write_b32 a62, v19
    v_accvgpr_read_b32 v18, a63
    v_mul_f32 v19, v18, v17
    v_accvgpr_write_b32 a63, v19
    v_mov_b32 v14, 0
    v_sub_f32 v18, v80, v16
    v_sub_f32 v19, v81, v16
    v_exp_f32 v18, v18
    v_exp_f32 v19, v19
    s_nop 0
    v_add_f32 v14, v14, v18
    v_add_f32 v14, v14, v19
    v_cvt_pk_bf16_f32 v104, v18, v19
    v_sub_f32 v18, v82, v16
    v_sub_f32 v19, v83, v16
    v_exp_f32 v18, v18
    v_exp_f32 v19, v19
    s_nop 0
    v_add_f32 v14, v14, v18
    v_add_f32 v14, v14, v19
    v_cvt_pk_bf16_f32 v105, v18, v19
    v_sub_f32 v18, v84, v16
    v_sub_f32 v19, v85, v16
    v_exp_f32 v18, v18
    v_exp_f32 v19, v19
    s_nop 0
    v_add_f32 v14, v14, v18
    v_add_f32 v14, v14, v19
    v_cvt_pk_bf16_f32 v106, v18, v19
    v_sub_f32 v18, v86, v16
    v_sub_f32 v19, v87, v16
    v_exp_f32 v18, v18
    v_exp_f32 v19, v19
    s_nop 0
    v_add_f32 v14, v14, v18
    v_add_f32 v14, v14, v19
    v_cvt_pk_bf16_f32 v107, v18, v19
    v_sub_f32 v18, v88, v16
    v_sub_f32 v19, v89, v16
    v_exp_f32 v18, v18
    v_exp_f32 v19, v19
    s_nop 0
    v_add_f32 v14, v14, v18
    v_add_f32 v14, v14, v19
    v_cvt_pk_bf16_f32 v108, v18, v19
    v_sub_f32 v18, v90, v16
    v_sub_f32 v19, v91, v16
    v_exp_f32 v18, v18
    v_exp_f32 v19, v19
    s_nop 0
    v_add_f32 v14, v14, v18
    v_add_f32 v14, v14, v19
    v_cvt_pk_bf16_f32 v109, v18, v19
    v_sub_f32 v18, v92, v16
    v_sub_f32 v19, v93, v16
    v_exp_f32 v18, v18
    v_exp_f32 v19, v19
    s_nop 0
    v_add_f32 v14, v14, v18
    v_add_f32 v14, v14, v19
    v_cvt_pk_bf16_f32 v110, v18, v19
    v_sub_f32 v18, v94, v16
    v_sub_f32 v19, v95, v16
    v_exp_f32 v18, v18
    v_exp_f32 v19, v19
    s_nop 0
    v_add_f32 v14, v14, v18
    v_add_f32 v14, v14, v19
    v_cvt_pk_bf16_f32 v111, v18, v19
    s_nop 3
    s_branch L_back5
L_slow6:
    s_nop 15
    s_nop 15
    v_max3_f32 v16, v64, v65, v66
    v_max3_f32 v16, v16, v67, v68
    v_max3_f32 v16, v16, v69, v70
    v_max3_f32 v16, v16, v71, v72
    v_max3_f32 v16, v16, v73, v74
    v_max3_f32 v16, v16, v75, v76
    v_max3_f32 v16, v16, v77, v78
    v_max_f32 v16, v16, v79
    v_mov_b32 v17, v16
    s_nop 1
    v_permlane32_swap_b32 v16, v17
    s_nop 1
    v_max3_f32 v16, v16, v17, 0
    v_exp_f32 v17, -v16
    s_nop 1
    v_sub_f32 v13, v13, v16
    v_mov_b32 v112, v13
    v_mov_b32 v113, v13
    v_mov_b32 v114, v13
    v_mov_b32 v115, v13
    v_mov_b32 v116, v13
    v_mov_b32 v117, v13
    v_mov_b32 v118, v13
    v_mov_b32 v119, v13
    v_mov_b32 v120, v13
    v_mov_b32 v121, v13
    v_mov_b32 v122, v13
    v_mov_b32 v123, v13
    v_mov_b32 v124, v13
    v_mov_b32 v125, v13
    v_mov_b32 v126, v13
    v_mov_b32 v127, v13
    v_sub_f32 v80, v80, v16
    v_sub_f32 v81, v81, v16
    v_sub_f32 v82, v82, v16
    v_sub_f32 v83, v83, v16
    v_sub_f32 v84, v84, v16
    v_sub_f32 v85, v85, v16
    v_sub_f32 v86, v86, v16
    v_sub_f32 v87, v87, v16
    v_sub_f32 v88, v88, v16
    v_sub_f32 v89, v89, v16
    v_sub_f32 v90, v90, v16
    v_sub_f32 v91, v91, v16
    v_sub_f32 v92, v92, v16
    v_sub_f32 v93, v93, v16
    v_sub_f32 v94, v94, v16
    v_sub_f32 v95, v95, v16
    v_mul_f32 v9, v9, v17
    v_accvgpr_read_b32 v18, a0
    v_mul_f32 v19, v18, v17
    v_accvgpr_write_b32 a0, v19
    v_accvgpr_read_b32 v18, a1
    v_mul_f32 v19, v18, v17
    v_accvgpr_write_b32 a1, v19
    v_accvgpr_read_b32 v18, a2
    v_mul_f32 v19, v18, v17
    v_accvgpr_write_b32 a2, v19
    v_accvgpr_read_b32 v18, a3
    v_mul_f32 v19, v18, v17
    v_accvgpr_write_b32 a3, v19
    v_accvgpr_read_b32 v18, a4
    v_mul_f32 v19, v18, v17
    v_accvgpr_write_b32 a4, v19
    v_accvgpr_read_b32 v18, a5
    v_mul_f32 v19, v18, v17
    v_accvgpr_write_b32 a5, v19
    v_accvgpr_read_b32 v18, a6
    v_mul_f32 v19, v18, v17
    v_accvgpr_write_b32 a6, v19
    v_accvgpr_read_b32 v18, a7
    v_mul_f32 v19, v18, v17
    v_accvgpr_write_b32 a7, v19
    v_accvgpr_read_b32 v18, a8
    v_mul_f32 v19, v18, v17
    v_accvgpr_write_b32 a8, v19
    v_accvgpr_read_b32 v18, a9
    v_mul_f32 v19, v18, v17
    v_accvgpr_write_b32 a9, v19
    v_accvgpr_read_b32 v18, a10
    v_mul_f32 v19, v18, v17
    v_accvgpr_write_b32 a10, v19
    v_accvgpr_read_b32 v18, a11
    v_mul_f32 v19, v18, v17
    v_accvgpr_write_b32 a11, v19
    v_accvgpr_read_b32 v18, a12
    v_mul_f32 v19, v18, v17
    v_accvgpr_write_b32 a12, v19
    v_accvgpr_read_b32 v18, a13
    v_mul_f32 v19, v18, v17
    v_accvgpr_write_b32 a13, v19
    v_accvgpr_read_b32 v18, a14
    v_mul_f32 v19, v18, v17
    v_accvgpr_write_b32 a14, v19
    v_accvgpr_read_b32 v18, a15
    v_mul_f32 v19, v18, v17
    v_accvgpr_write_b32 a15, v19
    v_accvgpr_read_b32 v18, a16
    v_mul_f32 v19, v18, v17
    v_accvgpr_write_b32 a16, v19
    v_accvgpr_read_b32 v18, a17
    v_mul_f32 v19, v18, v17
    v_accvgpr_write_b32 a17, v19
    v_accvgpr_read_b32 v18, a18
    v_mul_f32 v19, v18, v17
    v_accvgpr_write_b32 a18, v19
    v_accvgpr_read_b32 v18, a19
    v_mul_f32 v19, v18, v17
    v_accvgpr_write_b32 a19, v19
    v_accvgpr_read_b32 v18, a20
    v_mul_f32 v19, v18, v17
    v_accvgpr_write_b32 a20, v19
    v_accvgpr_read_b32 v18, a21
    v_mul_f32 v19, v18, v17
    v_accvgpr_write_b32 a21, v19
    v_accvgpr_read_b32 v18, a22
    v_mul_f32 v19, v18, v17
    v_accvgpr_write_b32 a22, v19
    v_accvgpr_read_b32 v18, a23
    v_mul_f32 v19, v18, v17
    v_accvgpr_write_b32 a23, v19
    v_accvgpr_read_b32 v18, a24
    v_mul_f32 v19, v18, v17
    v_accvgpr_write_b32 a24, v19
    v_accvgpr_read_b32 v18, a25
    v_mul_f32 v19, v18, v17
    v_accvgpr_write_b32 a25, v19
    v_accvgpr_read_b32 v18, a26
    v_mul_f32 v19, v18, v17
    v_accvgpr_write_b32 a26, v19
    v_accvgpr_read_b32 v18, a27
    v_mul_f32 v19, v18, v17
    v_accvgpr_write_b32 a27, v19
    v_accvgpr_read_b32 v18, a28
    v_mul_f32 v19, v18, v17
    v_accvgpr_write_b32 a28, v19
    v_accvgpr_read_b32 v18, a29
    v_mul_f32 v19, v18, v17
    v_accvgpr_write_b32 a29, v19
    v_accvgpr_read_b32 v18, a30
    v_mul_f32 v19, v18, v17
    v_accvgpr_write_b32 a30, v19
    v_accvgpr_read_b32 v18, a31
    v_mul_f32 v19, v18, v17
    v_accvgpr_write_b32 a31, v19
    v_accvgpr_read_b32 v18, a32
    v_mul_f32 v19, v18, v17
    v_accvgpr_write_b32 a32, v19
    v_accvgpr_read_b32 v18, a33
    v_mul_f32 v19, v18, v17
    v_accvgpr_write_b32 a33, v19
    v_accvgpr_read_b32 v18, a34
    v_mul_f32 v19, v18, v17
    v_accvgpr_write_b32 a34, v19
    v_accvgpr_read_b32 v18, a35
    v_mul_f32 v19, v18, v17
    v_accvgpr_write_b32 a35, v19
    v_accvgpr_read_b32 v18, a36
    v_mul_f32 v19, v18, v17
    v_accvgpr_write_b32 a36, v19
    v_accvgpr_read_b32 v18, a37
    v_mul_f32 v19, v18, v17
    v_accvgpr_write_b32 a37, v19
    v_accvgpr_read_b32 v18, a38
    v_mul_f32 v19, v18, v17
    v_accvgpr_write_b32 a38, v19
    v_accvgpr_read_b32 v18, a39
    v_mul_f32 v19, v18, v17
    v_accvgpr_write_b32 a39, v19
    v_accvgpr_read_b32 v18, a40
    v_mul_f32 v19, v18, v17
    v_accvgpr_write_b32 a40, v19
    v_accvgpr_read_b32 v18, a41
    v_mul_f32 v19, v18, v17
    v_accvgpr_write_b32 a41, v19
    v_accvgpr_read_b32 v18, a42
    v_mul_f32 v19, v18, v17
    v_accvgpr_write_b32 a42, v19
    v_accvgpr_read_b32 v18, a43
    v_mul_f32 v19, v18, v17
    v_accvgpr_write_b32 a43, v19
    v_accvgpr_read_b32 v18, a44
    v_mul_f32 v19, v18, v17
    v_accvgpr_write_b32 a44, v19
    v_accvgpr_read_b32 v18, a45
    v_mul_f32 v19, v18, v17
    v_accvgpr_write_b32 a45, v19
    v_accvgpr_read_b32 v18, a46
    v_mul_f32 v19, v18, v17
    v_accvgpr_write_b32 a46, v19
    v_accvgpr_read_b32 v18, a47
    v_mul_f32 v19, v18, v17
    v_accvgpr_write_b32 a47, v19
    v_accvgpr_read_b32 v18, a48
    v_mul_f32 v19, v18, v17
    v_accvgpr_write_b32 a48, v19
    v_accvgpr_read_b32 v18, a49
    v_mul_f32 v19, v18, v17
    v_accvgpr_write_b32 a49, v19
    v_accvgpr_read_b32 v18, a50
    v_mul_f32 v19, v18, v17
    v_accvgpr_write_b32 a50, v19
    v_accvgpr_read_b32 v18, a51
    v_mul_f32 v19, v18, v17
    v_accvgpr_write_b32 a51, v19
    v_accvgpr_read_b32 v18, a52
    v_mul_f32 v19, v18, v17
    v_accvgpr_write_b32 a52, v19
    v_accvgpr_read_b32 v18, a53
    v_mul_f32 v19, v18, v17
    v_accvgpr_write_b32 a53, v19
    v_accvgpr_read_b32 v18, a54
    v_mul_f32 v19, v18, v17
    v_accvgpr_write_b32 a54, v19
    v_accvgpr_read_b32 v18, a55
    v_mul_f32 v19, v18, v17
    v_accvgpr_write_b32 a55, v19
    v_accvgpr_read_b32 v18, a56
    v_mul_f32 v19, v18, v17
    v_accvgpr_write_b32 a56, v19
    v_accvgpr_read_b32 v18, a57
    v_mul_f32 v19, v18, v17
    v_accvgpr_write_b32 a57, v19
    v_accvgpr_read_b32 v18, a58
    v_mul_f32 v19, v18, v17
    v_accvgpr_write_b32 a58, v19
    v_accvgpr_read_b32 v18, a59
    v_mul_f32 v19, v18, v17
    v_accvgpr_write_b32 a59, v19
    v_accvgpr_read_b32 v18, a60
    v_mul_f32 v19, v18, v17
    v_accvgpr_write_b32 a60, v19
    v_accvgpr_read_b32 v18, a61
    v_mul_f32 v19, v18, v17
    v_accvgpr_write_b32 a61, v19
    v_accvgpr_read_b32 v18, a62
    v_mul_f32 v19, v18, v17
    v_accvgpr_write_b32 a62, v19
    v_accvgpr_read_b32 v18, a63
    v_mul_f32 v19, v18, v17
    v_accvgpr_write_b32 a63, v19
    v_mov_b32 v14, 0
    v_sub_f32 v18, v64, v16
    v_sub_f32 v19, v65, v16
    v_exp_f32 v18, v18
    v_exp_f32 v19, v19
    s_nop 0
    v_add_f32 v14, v14, v18
    v_add_f32 v14, v14, v19
    v_cvt_pk_bf16_f32 v96, v18, v19
    v_sub_f32 v18, v66, v16
    v_sub_f32 v19, v67, v16
    v_exp_f32 v18, v18
    v_exp_f32 v19, v19
    s_nop 0
    v_add_f32 v14, v14, v18
    v_add_f32 v14, v14, v19
    v_cvt_pk_bf16_f32 v97, v18, v19
    v_sub_f32 v18, v68, v16
    v_sub_f32 v19, v69, v16
    v_exp_f32 v18, v18
    v_exp_f32 v19, v19
    s_nop 0
    v_add_f32 v14, v14, v18
    v_add_f32 v14, v14, v19
    v_cvt_pk_bf16_f32 v98, v18, v19
    v_sub_f32 v18, v70, v16
    v_sub_f32 v19, v71, v16
    v_exp_f32 v18, v18
    v_exp_f32 v19, v19
    s_nop 0
    v_add_f32 v14, v14, v18
    v_add_f32 v14, v14, v19
    v_cvt_pk_bf16_f32 v99, v18, v19
    v_sub_f32 v18, v72, v16
    v_sub_f32 v19, v73, v16
    v_exp_f32 v18, v18
    v_exp_f32 v19, v19
    s_nop 0
    v_add_f32 v14, v14, v18
    v_add_f32 v14, v14, v19
    v_cvt_pk_bf16_f32 v100, v18, v19
    v_sub_f32 v18, v74, v16
    v_sub_f32 v19, v75, v16
    v_exp_f32 v18, v18
    v_exp_f32 v19, v19
    s_nop 0
    v_add_f32 v14, v14, v18
    v_add_f32 v14, v14, v19
    v_cvt_pk_bf16_f32 v101, v18, v19
    v_sub_f32 v18, v76, v16
    v_sub_f32 v19, v77, v16
    v_exp_f32 v18, v18
    v_exp_f32 v19, v19
    s_nop 0
    v_add_f32 v14, v14, v18
    v_add_f32 v14, v14, v19
    v_cvt_pk_bf16_f32 v102, v18, v19
    v_sub_f32 v18, v78, v16
    v_sub_f32 v19, v79, v16
    v_exp_f32 v18, v18
    v_exp_f32 v19, v19
    s_nop 0
    v_add_f32 v14, v14, v18
    v_add_f32 v14, v14, v19
    v_cvt_pk_bf16_f32 v103, v18, v19
    s_nop 3
    s_branch L_back6
L_slow7:
    s_nop 15
    s_nop 15
    v_max3_f32 v16, v80, v81, v82
    v_max3_f32 v16, v16, v83, v84
    v_max3_f32 v16, v16, v85, v86
    v_max3_f32 v16, v16, v87, v88
    v_max3_f32 v16, v16, v89, v90
    v_max3_f32 v16, v16, v91, v92
    v_max3_f32 v16, v16, v93, v94
    v_max_f32 v16, v16, v95
    v_mov_b32 v17, v16
    s_nop 1
    v_permlane32_swap_b32 v16, v17
    s_nop 1
    v_max3_f32 v16, v16, v17, 0
    v_exp_f32 v17, -v16
    s_nop 1
    v_sub_f32 v13, v13, v16
    v_mov_b32 v112, v13
    v_mov_b32 v113, v13
    v_mov_b32 v114, v13
    v_mov_b32 v115, v13
    v_mov_b32 v116, v13
    v_mov_b32 v117, v13
    v_mov_b32 v118, v13
    v_mov_b32 v119, v13
    v_mov_b32 v120, v13
    v_mov_b32 v121, v13
    v_mov_b32 v122, v13
    v_mov_b32 v123, v13
    v_mov_b32 v124, v13
    v_mov_b32 v125, v13
    v_mov_b32 v126, v13
    v_mov_b32 v127, v13
    v_sub_f32 v64, v64, v16
    v_sub_f32 v65, v65, v16
    v_sub_f32 v66, v66, v16
    v_sub_f32 v67, v67, v16
    v_sub_f32 v68, v68, v16
    v_sub_f32 v69, v69, v16
    v_sub_f32 v70, v70, v16
    v_sub_f32 v71, v71, v16
    v_sub_f32 v72, v72, v16
    v_sub_f32 v73, v73, v16
    v_sub_f32 v74, v74, v16
    v_sub_f32 v75, v75, v16
    v_sub_f32 v76, v76, v16
    v_sub_f32 v77, v77, v16
    v_sub_f32 v78, v78, v16
    v_sub_f32 v79, v79, v16
    v_mul_f32 v9, v9, v17
    v_accvgpr_read_b32 v18, a0
    v_mul_f32 v19, v18, v17
    v_accvgpr_write_b32 a0, v19
    v_accvgpr_read_b32 v18, a1
    v_mul_f32 v19, v18, v17
    v_accvgpr_write_b32 a1, v19
    v_accvgpr_read_b32 v18, a2
    v_mul_f32 v19, v18, v17
    v_accvgpr_write_b32 a2, v19
    v_accvgpr_read_b32 v18, a3
    v_mul_f32 v19, v18, v17
    v_accvgpr_write_b32 a3, v19
    v_accvgpr_read_b32 v18, a4
    v_mul_f32 v19, v18, v17
    v_accvgpr_write_b32 a4, v19
    v_accvgpr_read_b32 v18, a5
    v_mul_f32 v19, v18, v17
    v_accvgpr_write_b32 a5, v19
    v_accvgpr_read_b32 v18, a6
    v_mul_f32 v19, v18, v17
    v_accvgpr_write_b32 a6, v19
    v_accvgpr_read_b32 v18, a7
    v_mul_f32 v19, v18, v17
    v_accvgpr_write_b32 a7, v19
    v_accvgpr_read_b32 v18, a8
    v_mul_f32 v19, v18, v17
    v_accvgpr_write_b32 a8, v19
    v_accvgpr_read_b32 v18, a9
    v_mul_f32 v19, v18, v17
    v_accvgpr_write_b32 a9, v19
    v_accvgpr_read_b32 v18, a10
    v_mul_f32 v19, v18, v17
    v_accvgpr_write_b32 a10, v19
    v_accvgpr_read_b32 v18, a11
    v_mul_f32 v19, v18, v17
    v_accvgpr_write_b32 a11, v19
    v_accvgpr_read_b32 v18, a12
    v_mul_f32 v19, v18, v17
    v_accvgpr_write_b32 a12, v19
    v_accvgpr_read_b32 v18, a13
    v_mul_f32 v19, v18, v17
    v_accvgpr_write_b32 a13, v19
    v_accvgpr_read_b32 v18, a14
    v_mul_f32 v19, v18, v17
    v_accvgpr_write_b32 a14, v19
    v_accvgpr_read_b32 v18, a15
    v_mul_f32 v19, v18, v17
    v_accvgpr_write_b32 a15, v19
    v_accvgpr_read_b32 v18, a16
    v_mul_f32 v19, v18, v17
    v_accvgpr_write_b32 a16, v19
    v_accvgpr_read_b32 v18, a17
    v_mul_f32 v19, v18, v17
    v_accvgpr_write_b32 a17, v19
    v_accvgpr_read_b32 v18, a18
    v_mul_f32 v19, v18, v17
    v_accvgpr_write_b32 a18, v19
    v_accvgpr_read_b32 v18, a19
    v_mul_f32 v19, v18, v17
    v_accvgpr_write_b32 a19, v19
    v_accvgpr_read_b32 v18, a20
    v_mul_f32 v19, v18, v17
    v_accvgpr_write_b32 a20, v19
    v_accvgpr_read_b32 v18, a21
    v_mul_f32 v19, v18, v17
    v_accvgpr_write_b32 a21, v19
    v_accvgpr_read_b32 v18, a22
    v_mul_f32 v19, v18, v17
    v_accvgpr_write_b32 a22, v19
    v_accvgpr_read_b32 v18, a23
    v_mul_f32 v19, v18, v17
    v_accvgpr_write_b32 a23, v19
    v_accvgpr_read_b32 v18, a24
    v_mul_f32 v19, v18, v17
    v_accvgpr_write_b32 a24, v19
    v_accvgpr_read_b32 v18, a25
    v_mul_f32 v19, v18, v17
    v_accvgpr_write_b32 a25, v19
    v_accvgpr_read_b32 v18, a26
    v_mul_f32 v19, v18, v17
    v_accvgpr_write_b32 a26, v19
    v_accvgpr_read_b32 v18, a27
    v_mul_f32 v19, v18, v17
    v_accvgpr_write_b32 a27, v19
    v_accvgpr_read_b32 v18, a28
    v_mul_f32 v19, v18, v17
    v_accvgpr_write_b32 a28, v19
    v_accvgpr_read_b32 v18, a29
    v_mul_f32 v19, v18, v17
    v_accvgpr_write_b32 a29, v19
    v_accvgpr_read_b32 v18, a30
    v_mul_f32 v19, v18, v17
    v_accvgpr_write_b32 a30, v19
    v_accvgpr_read_b32 v18, a31
    v_mul_f32 v19, v18, v17
    v_accvgpr_write_b32 a31, v19
    v_accvgpr_read_b32 v18, a32
    v_mul_f32 v19, v18, v17
    v_accvgpr_write_b32 a32, v19
    v_accvgpr_read_b32 v18, a33
    v_mul_f32 v19, v18, v17
    v_accvgpr_write_b32 a33, v19
    v_accvgpr_read_b32 v18, a34
    v_mul_f32 v19, v18, v17
    v_accvgpr_write_b32 a34, v19
    v_accvgpr_read_b32 v18, a35
    v_mul_f32 v19, v18, v17
    v_accvgpr_write_b32 a35, v19
    v_accvgpr_read_b32 v18, a36
    v_mul_f32 v19, v18, v17
    v_accvgpr_write_b32 a36, v19
    v_accvgpr_read_b32 v18, a37
    v_mul_f32 v19, v18, v17
    v_accvgpr_write_b32 a37, v19
    v_accvgpr_read_b32 v18, a38
    v_mul_f32 v19, v18, v17
    v_accvgpr_write_b32 a38, v19
    v_accvgpr_read_b32 v18, a39
    v_mul_f32 v19, v18, v17
    v_accvgpr_write_b32 a39, v19
    v_accvgpr_read_b32 v18, a40
    v_mul_f32 v19, v18, v17
    v_accvgpr_write_b32 a40, v19
    v_accvgpr_read_b32 v18, a41
    v_mul_f32 v19, v18, v17
    v_accvgpr_write_b32 a41, v19
    v_accvgpr_read_b32 v18, a42
    v_mul_f32 v19, v18, v17
    v_accvgpr_write_b32 a42, v19
    v_accvgpr_read_b32 v18, a43
    v_mul_f32 v19, v18, v17
    v_accvgpr_write_b32 a43, v19
    v_accvgpr_read_b32 v18, a44
    v_mul_f32 v19, v18, v17
    v_accvgpr_write_b32 a44, v19
    v_accvgpr_read_b32 v18, a45
    v_mul_f32 v19, v18, v17
    v_accvgpr_write_b32 a45, v19
    v_accvgpr_read_b32 v18, a46
    v_mul_f32 v19, v18, v17
    v_accvgpr_write_b32 a46, v19
    v_accvgpr_read_b32 v18, a47
    v_mul_f32 v19, v18, v17
    v_accvgpr_write_b32 a47, v19
    v_accvgpr_read_b32 v18, a48
    v_mul_f32 v19, v18, v17
    v_accvgpr_write_b32 a48, v19
    v_accvgpr_read_b32 v18, a49
    v_mul_f32 v19, v18, v17
    v_accvgpr_write_b32 a49, v19
    v_accvgpr_read_b32 v18, a50
    v_mul_f32 v19, v18, v17
    v_accvgpr_write_b32 a50, v19
    v_accvgpr_read_b32 v18, a51
    v_mul_f32 v19, v18, v17
    v_accvgpr_write_b32 a51, v19
    v_accvgpr_read_b32 v18, a52
    v_mul_f32 v19, v18, v17
    v_accvgpr_write_b32 a52, v19
    v_accvgpr_read_b32 v18, a53
    v_mul_f32 v19, v18, v17
    v_accvgpr_write_b32 a53, v19
    v_accvgpr_read_b32 v18, a54
    v_mul_f32 v19, v18, v17
    v_accvgpr_write_b32 a54, v19
    v_accvgpr_read_b32 v18, a55
    v_mul_f32 v19, v18, v17
    v_accvgpr_write_b32 a55, v19
    v_accvgpr_read_b32 v18, a56
    v_mul_f32 v19, v18, v17
    v_accvgpr_write_b32 a56, v19
    v_accvgpr_read_b32 v18, a57
    v_mul_f32 v19, v18, v17
    v_accvgpr_write_b32 a57, v19
    v_accvgpr_read_b32 v18, a58
    v_mul_f32 v19, v18, v17
    v_accvgpr_write_b32 a58, v19
    v_accvgpr_read_b32 v18, a59
    v_mul_f32 v19, v18, v17
    v_accvgpr_write_b32 a59, v19
    v_accvgpr_read_b32 v18, a60
    v_mul_f32 v19, v18, v17
    v_accvgpr_write_b32 a60, v19
    v_accvgpr_read_b32 v18, a61
    v_mul_f32 v19, v18, v17
    v_accvgpr_write_b32 a61, v19
    v_accvgpr_read_b32 v18, a62
    v_mul_f32 v19, v18, v17
    v_accvgpr_write_b32 a62, v19
    v_accvgpr_read_b32 v18, a63
    v_mul_f32 v19, v18, v17
    v_accvgpr_write_b32 a63, v19
    v_mov_b32 v14, 0
    v_sub_f32 v18, v80, v16
    v_sub_f32 v19, v81, v16
    v_exp_f32 v18, v18
    v_exp_f32 v19, v19
    s_nop 0
    v_add_f32 v14, v14, v18
    v_add_f32 v14, v14, v19
    v_cvt_pk_bf16_f32 v104, v18, v19
    v_sub_f32 v18, v82, v16
    v_sub_f32 v19, v83, v16
    v_exp_f32 v18, v18
    v_exp_f32 v19, v19
    s_nop 0
    v_add_f32 v14, v14, v18
    v_add_f32 v14, v14, v19
    v_cvt_pk_bf16_f32 v105, v18, v19
    v_sub_f32 v18, v84, v16
    v_sub_f32 v19, v85, v16
    v_exp_f32 v18, v18
    v_exp_f32 v19, v19
    s_nop 0
    v_add_f32 v14, v14, v18
    v_add_f32 v14, v14, v19
    v_cvt_pk_bf16_f32 v106, v18, v19
    v_sub_f32 v18, v86, v16
    v_sub_f32 v19, v87, v16
    v_exp_f32 v18, v18
    v_exp_f32 v19, v19
    s_nop 0
    v_add_f32 v14, v14, v18
    v_add_f32 v14, v14, v19
    v_cvt_pk_bf16_f32 v107, v18, v19
    v_sub_f32 v18, v88, v16
    v_sub_f32 v19, v89, v16
    v_exp_f32 v18, v18
    v_exp_f32 v19, v19
    s_nop 0
    v_add_f32 v14, v14, v18
    v_add_f32 v14, v14, v19
    v_cvt_pk_bf16_f32 v108, v18, v19
    v_sub_f32 v18, v90, v16
    v_sub_f32 v19, v91, v16
    v_exp_f32 v18, v18
    v_exp_f32 v19, v19
    s_nop 0
    v_add_f32 v14, v14, v18
    v_add_f32 v14, v14, v19
    v_cvt_pk_bf16_f32 v109, v18, v19
    v_sub_f32 v18, v92, v16
    v_sub_f32 v19, v93, v16
    v_exp_f32 v18, v18
    v_exp_f32 v19, v19
    s_nop 0
    v_add_f32 v14, v14, v18
    v_add_f32 v14, v14, v19
    v_cvt_pk_bf16_f32 v110, v18, v19
    v_sub_f32 v18, v94, v16
    v_sub_f32 v19, v95, v16
    v_exp_f32 v18, v18
    v_exp_f32 v19, v19
    s_nop 0
    v_add_f32 v14, v14, v18
    v_add_f32 v14, v14, v19
    v_cvt_pk_bf16_f32 v111, v18, v19
    s_nop 3
    s_branch L_back7
L_slow8:
    s_nop 15
    s_nop 15
    v_max3_f32 v16, v64, v65, v66
    v_max3_f32 v16, v16, v67, v68
    v_max3_f32 v16, v16, v69, v70
    v_max3_f32 v16, v16, v71, v72
    v_max3_f32 v16, v16, v73, v74
    v_max3_f32 v16, v16, v75, v76
    v_max3_f32 v16, v16, v77, v78
    v_max_f32 v16, v16, v79
    v_mov_b32 v17, v16
    s_nop 1
    v_permlane32_swap_b32 v16, v17
    s_nop 1
    v_max3_f32 v16, v16, v17, 0
    v_exp_f32 v17, -v16
    s_nop 1
    v_sub_f32 v13, v13, v16
    v_mov_b32 v112, v13
    v_mov_b32 v113, v13
    v_mov_b32 v114, v13
    v_mov_b32 v115, v13
    v_mov_b32 v116, v13
    v_mov_b32 v117, v13
    v_mov_b32 v118, v13
    v_mov_b32 v119, v13
    v_mov_b32 v120, v13
    v_mov_b32 v121, v13
    v_mov_b32 v122, v13
    v_mov_b32 v123, v13
    v_mov_b32 v124, v13
    v_mov_b32 v125, v13
    v_mov_b32 v126, v13
    v_mov_b32 v127, v13
    v_sub_f32 v80, v80, v16
    v_sub_f32 v81, v81, v16
    v_sub_f32 v82, v82, v16
    v_sub_f32 v83, v83, v16
    v_sub_f32 v84, v84, v16
    v_sub_f32 v85, v85, v16
    v_sub_f32 v86, v86, v16
    v_sub_f32 v87, v87, v16
    v_sub_f32 v88, v88, v16
    v_sub_f32 v89, v89, v16
    v_sub_f32 v90, v90, v16
    v_sub_f32 v91, v91, v16
    v_sub_f32 v92, v92, v16
    v_sub_f32 v93, v93, v16
    v_sub_f32 v94, v94, v16
    v_sub_f32 v95, v95, v16
    v_mul_f32 v9, v9, v17
    v_accvgpr_read_b32 v18, a0
    v_mul_f32 v19, v18, v17
    v_accvgpr_write_b32 a0, v19
    v_accvgpr_read_b32 v18, a1
    v_mul_f32 v19, v18, v17
    v_accvgpr_write_b32 a1, v19
    v_accvgpr_read_b32 v18, a2
    v_mul_f32 v19, v18, v17
    v_accvgpr_write_b32 a2, v19
    v_accvgpr_read_b32 v18, a3
    v_mul_f32 v19, v18, v17
    v_accvgpr_write_b32 a3, v19
    v_accvgpr_read_b32 v18, a4
    v_mul_f32 v19, v18, v17
    v_accvgpr_write_b32 a4, v19
    v_accvgpr_read_b32 v18, a5
    v_mul_f32 v19, v18, v17
    v_accvgpr_write_b32 a5, v19
    v_accvgpr_read_b32 v18, a6
    v_mul_f32 v19, v18, v17
    v_accvgpr_write_b32 a6, v19
    v_accvgpr_read_b32 v18, a7
    v_mul_f32 v19, v18, v17
    v_accvgpr_write_b32 a7, v19
    v_accvgpr_read_b32 v18, a8
    v_mul_f32 v19, v18, v17
    v_accvgpr_write_b32 a8, v19
    v_accvgpr_read_b32 v18, a9
    v_mul_f32 v19, v18, v17
    v_accvgpr_write_b32 a9, v19
    v_accvgpr_read_b32 v18, a10
    v_mul_f32 v19, v18, v17
    v_accvgpr_write_b32 a10, v19
    v_accvgpr_read_b32 v18, a11
    v_mul_f32 v19, v18, v17
    v_accvgpr_write_b32 a11, v19
    v_accvgpr_read_b32 v18, a12
    v_mul_f32 v19, v18, v17
    v_accvgpr_write_b32 a12, v19
    v_accvgpr_read_b32 v18, a13
    v_mul_f32 v19, v18, v17
    v_accvgpr_write_b32 a13, v19
    v_accvgpr_read_b32 v18, a14
    v_mul_f32 v19, v18, v17
    v_accvgpr_write_b32 a14, v19
    v_accvgpr_read_b32 v18, a15
    v_mul_f32 v19, v18, v17
    v_accvgpr_write_b32 a15, v19
    v_accvgpr_read_b32 v18, a16
    v_mul_f32 v19, v18, v17
    v_accvgpr_write_b32 a16, v19
    v_accvgpr_read_b32 v18, a17
    v_mul_f32 v19, v18, v17
    v_accvgpr_write_b32 a17, v19
    v_accvgpr_read_b32 v18, a18
    v_mul_f32 v19, v18, v17
    v_accvgpr_write_b32 a18, v19
    v_accvgpr_read_b32 v18, a19
    v_mul_f32 v19, v18, v17
    v_accvgpr_write_b32 a19, v19
    v_accvgpr_read_b32 v18, a20
    v_mul_f32 v19, v18, v17
    v_accvgpr_write_b32 a20, v19
    v_accvgpr_read_b32 v18, a21
    v_mul_f32 v19, v18, v17
    v_accvgpr_write_b32 a21, v19
    v_accvgpr_read_b32 v18, a22
    v_mul_f32 v19, v18, v17
    v_accvgpr_write_b32 a22, v19
    v_accvgpr_read_b32 v18, a23
    v_mul_f32 v19, v18, v17
    v_accvgpr_write_b32 a23, v19
    v_accvgpr_read_b32 v18, a24
    v_mul_f32 v19, v18, v17
    v_accvgpr_write_b32 a24, v19
    v_accvgpr_read_b32 v18, a25
    v_mul_f32 v19, v18, v17
    v_accvgpr_write_b32 a25, v19
    v_accvgpr_read_b32 v18, a26
    v_mul_f32 v19, v18, v17
    v_accvgpr_write_b32 a26, v19
    v_accvgpr_read_b32 v18, a27
    v_mul_f32 v19, v18, v17
    v_accvgpr_write_b32 a27, v19
    v_accvgpr_read_b32 v18, a28
    v_mul_f32 v19, v18, v17
    v_accvgpr_write_b32 a28, v19
    v_accvgpr_read_b32 v18, a29
    v_mul_f32 v19, v18, v17
    v_accvgpr_write_b32 a29, v19
    v_accvgpr_read_b32 v18, a30
    v_mul_f32 v19, v18, v17
    v_accvgpr_write_b32 a30, v19
    v_accvgpr_read_b32 v18, a31
    v_mul_f32 v19, v18, v17
    v_accvgpr_write_b32 a31, v19
    v_accvgpr_read_b32 v18, a32
    v_mul_f32 v19, v18, v17
    v_accvgpr_write_b32 a32, v19
    v_accvgpr_read_b32 v18, a33
    v_mul_f32 v19, v18, v17
    v_accvgpr_write_b32 a33, v19
    v_accvgpr_read_b32 v18, a34
    v_mul_f32 v19, v18, v17
    v_accvgpr_write_b32 a34, v19
    v_accvgpr_read_b32 v18, a35
    v_mul_f32 v19, v18, v17
    v_accvgpr_write_b32 a35, v19
    v_accvgpr_read_b32 v18, a36
    v_mul_f32 v19, v18, v17
    v_accvgpr_write_b32 a36, v19
    v_accvgpr_read_b32 v18, a37
    v_mul_f32 v19, v18, v17
    v_accvgpr_write_b32 a37, v19
    v_accvgpr_read_b32 v18, a38
    v_mul_f32 v19, v18, v17
    v_accvgpr_write_b32 a38, v19
    v_accvgpr_read_b32 v18, a39
    v_mul_f32 v19, v18, v17
    v_accvgpr_write_b32 a39, v19
    v_accvgpr_read_b32 v18, a40
    v_mul_f32 v19, v18, v17
    v_accvgpr_write_b32 a40, v19
    v_accvgpr_read_b32 v18, a41
    v_mul_f32 v19, v18, v17
    v_accvgpr_write_b32 a41, v19
    v_accvgpr_read_b32 v18, a42
    v_mul_f32 v19, v18, v17
    v_accvgpr_write_b32 a42, v19
    v_accvgpr_read_b32 v18, a43
    v_mul_f32 v19, v18, v17
    v_accvgpr_write_b32 a43, v19
    v_accvgpr_read_b32 v18, a44
    v_mul_f32 v19, v18, v17
    v_accvgpr_write_b32 a44, v19
    v_accvgpr_read_b32 v18, a45
    v_mul_f32 v19, v18, v17
    v_accvgpr_write_b32 a45, v19
    v_accvgpr_read_b32 v18, a46
    v_mul_f32 v19, v18, v17
    v_accvgpr_write_b32 a46, v19
    v_accvgpr_read_b32 v18, a47
    v_mul_f32 v19, v18, v17
    v_accvgpr_write_b32 a47, v19
    v_accvgpr_read_b32 v18, a48
    v_mul_f32 v19, v18, v17
    v_accvgpr_write_b32 a48, v19
    v_accvgpr_read_b32 v18, a49
    v_mul_f32 v19, v18, v17
    v_accvgpr_write_b32 a49, v19
    v_accvgpr_read_b32 v18, a50
    v_mul_f32 v19, v18, v17
    v_accvgpr_write_b32 a50, v19
    v_accvgpr_read_b32 v18, a51
    v_mul_f32 v19, v18, v17
    v_accvgpr_write_b32 a51, v19
    v_accvgpr_read_b32 v18, a52
    v_mul_f32 v19, v18, v17
    v_accvgpr_write_b32 a52, v19
    v_accvgpr_read_b32 v18, a53
    v_mul_f32 v19, v18, v17
    v_accvgpr_write_b32 a53, v19
    v_accvgpr_read_b32 v18, a54
    v_mul_f32 v19, v18, v17
    v_accvgpr_write_b32 a54, v19
    v_accvgpr_read_b32 v18, a55
    v_mul_f32 v19, v18, v17
    v_accvgpr_write_b32 a55, v19
    v_accvgpr_read_b32 v18, a56
    v_mul_f32 v19, v18, v17
    v_accvgpr_write_b32 a56, v19
    v_accvgpr_read_b32 v18, a57
    v_mul_f32 v19, v18, v17
    v_accvgpr_write_b32 a57, v19
    v_accvgpr_read_b32 v18, a58
    v_mul_f32 v19, v18, v17
    v_accvgpr_write_b32 a58, v19
    v_accvgpr_read_b32 v18, a59
    v_mul_f32 v19, v18, v17
    v_accvgpr_write_b32 a59, v19
    v_accvgpr_read_b32 v18, a60
    v_mul_f32 v19, v18, v17
    v_accvgpr_write_b32 a60, v19
    v_accvgpr_read_b32 v18, a61
    v_mul_f32 v19, v18, v17
    v_accvgpr_write_b32 a61, v19
    v_accvgpr_read_b32 v18, a62
    v_mul_f32 v19, v18, v17
    v_accvgpr_write_b32 a62, v19
    v_accvgpr_read_b32 v18, a63
    v_mul_f32 v19, v18, v17
    v_accvgpr_write_b32 a63, v19
    v_mov_b32 v14, 0
    v_sub_f32 v18, v64, v16
    v_sub_f32 v19, v65, v16
    v_exp_f32 v18, v18
    v_exp_f32 v19, v19
    s_nop 0
    v_add_f32 v14, v14, v18
    v_add_f32 v14, v14, v19
    v_cvt_pk_bf16_f32 v96, v18, v19
    v_sub_f32 v18, v66, v16
    v_sub_f32 v19, v67, v16
    v_exp_f32 v18, v18
    v_exp_f32 v19, v19
    s_nop 0
    v_add_f32 v14, v14, v18
    v_add_f32 v14, v14, v19
    v_cvt_pk_bf16_f32 v97, v18, v19
    v_sub_f32 v18, v68, v16
    v_sub_f32 v19, v69, v16
    v_exp_f32 v18, v18
    v_exp_f32 v19, v19
    s_nop 0
    v_add_f32 v14, v14, v18
    v_add_f32 v14, v14, v19
    v_cvt_pk_bf16_f32 v98, v18, v19
    v_sub_f32 v18, v70, v16
    v_sub_f32 v19, v71, v16
    v_exp_f32 v18, v18
    v_exp_f32 v19, v19
    s_nop 0
    v_add_f32 v14, v14, v18
    v_add_f32 v14, v14, v19
    v_cvt_pk_bf16_f32 v99, v18, v19
    v_sub_f32 v18, v72, v16
    v_sub_f32 v19, v73, v16
    v_exp_f32 v18, v18
    v_exp_f32 v19, v19
    s_nop 0
    v_add_f32 v14, v14, v18
    v_add_f32 v14, v14, v19
    v_cvt_pk_bf16_f32 v100, v18, v19
    v_sub_f32 v18, v74, v16
    v_sub_f32 v19, v75, v16
    v_exp_f32 v18, v18
    v_exp_f32 v19, v19
    s_nop 0
    v_add_f32 v14, v14, v18
    v_add_f32 v14, v14, v19
    v_cvt_pk_bf16_f32 v101, v18, v19
    v_sub_f32 v18, v76, v16
    v_sub_f32 v19, v77, v16
    v_exp_f32 v18, v18
    v_exp_f32 v19, v19
    s_nop 0
    v_add_f32 v14, v14, v18
    v_add_f32 v14, v14, v19
    v_cvt_pk_bf16_f32 v102, v18, v19
    v_sub_f32 v18, v78, v16
    v_sub_f32 v19, v79, v16
    v_exp_f32 v18, v18
    v_exp_f32 v19, v19
    s_nop 0
    v_add_f32 v14, v14, v18
    v_add_f32 v14, v14, v19
    v_cvt_pk_bf16_f32 v103, v18, v19
    s_nop 3
    s_branch L_back8
L_slow9:
    s_nop 15
    s_nop 15
    v_max3_f32 v16, v80, v81, v82
    v_max3_f32 v16, v16, v83, v84
    v_max3_f32 v16, v16, v85, v86
    v_max3_f32 v16, v16, v87, v88
    v_max3_f32 v16, v16, v89, v90
    v_max3_f32 v16, v16, v91, v92
    v_max3_f32 v16, v16, v93, v94
    v_max_f32 v16, v16, v95
    v_mov_b32 v17, v16
    s_nop 1
    v_permlane32_swap_b32 v16, v17
    s_nop 1
    v_max3_f32 v16, v16, v17, 0
    v_exp_f32 v17, -v16
    s_nop 1
    v_sub_f32 v13, v13, v16
    v_mov_b32 v112, v13
    v_mov_b32 v113, v13
    v_mov_b32 v114, v13
    v_mov_b32 v115, v13
    v_mov_b32 v116, v13
    v_mov_b32 v117, v13
    v_mov_b32 v118, v13
    v_mov_b32 v119, v13
    v_mov_b32 v120, v13
    v_mov_b32 v121, v13
    v_mov_b32 v122, v13
    v_mov_b32 v123, v13
    v_mov_b32 v124, v13
    v_mov_b32 v125, v13
    v_mov_b32 v126, v13
    v_mov_b32 v127, v13
    v_sub_f32 v64, v64, v16
    v_sub_f32 v65, v65, v16
    v_sub_f32 v66, v66, v16
    v_sub_f32 v67, v67, v16
    v_sub_f32 v68, v68, v16
    v_sub_f32 v69, v69, v16
    v_sub_f32 v70, v70, v16
    v_sub_f32 v71, v71, v16
    v_sub_f32 v72, v72, v16
    v_sub_f32 v73, v73, v16
    v_sub_f32 v74, v74, v16
    v_sub_f32 v75, v75, v16
    v_sub_f32 v76, v76, v16
    v_sub_f32 v77, v77, v16
    v_sub_f32 v78, v78, v16
    v_sub_f32 v79, v79, v16
    v_mul_f32 v9, v9, v17
    v_accvgpr_read_b32 v18, a0
    v_mul_f32 v19, v18, v17
    v_accvgpr_write_b32 a0, v19
    v_accvgpr_read_b32 v18, a1
    v_mul_f32 v19, v18, v17
    v_accvgpr_write_b32 a1, v19
    v_accvgpr_read_b32 v18, a2
    v_mul_f32 v19, v18, v17
    v_accvgpr_write_b32 a2, v19
    v_accvgpr_read_b32 v18, a3
    v_mul_f32 v19, v18, v17
    v_accvgpr_write_b32 a3, v19
    v_accvgpr_read_b32 v18, a4
    v_mul_f32 v19, v18, v17
    v_accvgpr_write_b32 a4, v19
    v_accvgpr_read_b32 v18, a5
    v_mul_f32 v19, v18, v17
    v_accvgpr_write_b32 a5, v19
    v_accvgpr_read_b32 v18, a6
    v_mul_f32 v19, v18, v17
    v_accvgpr_write_b32 a6, v19
    v_accvgpr_read_b32 v18, a7
    v_mul_f32 v19, v18, v17
    v_accvgpr_write_b32 a7, v19
    v_accvgpr_read_b32 v18, a8
    v_mul_f32 v19, v18, v17
    v_accvgpr_write_b32 a8, v19
    v_accvgpr_read_b32 v18, a9
    v_mul_f32 v19, v18, v17
    v_accvgpr_write_b32 a9, v19
    v_accvgpr_read_b32 v18, a10
    v_mul_f32 v19, v18, v17
    v_accvgpr_write_b32 a10, v19
    v_accvgpr_read_b32 v18, a11
    v_mul_f32 v19, v18, v17
    v_accvgpr_write_b32 a11, v19
    v_accvgpr_read_b32 v18, a12
    v_mul_f32 v19, v18, v17
    v_accvgpr_write_b32 a12, v19
    v_accvgpr_read_b32 v18, a13
    v_mul_f32 v19, v18, v17
    v_accvgpr_write_b32 a13, v19
    v_accvgpr_read_b32 v18, a14
    v_mul_f32 v19, v18, v17
    v_accvgpr_write_b32 a14, v19
    v_accvgpr_read_b32 v18, a15
    v_mul_f32 v19, v18, v17
    v_accvgpr_write_b32 a15, v19
    v_accvgpr_read_b32 v18, a16
    v_mul_f32 v19, v18, v17
    v_accvgpr_write_b32 a16, v19
    v_accvgpr_read_b32 v18, a17
    v_mul_f32 v19, v18, v17
    v_accvgpr_write_b32 a17, v19
    v_accvgpr_read_b32 v18, a18
    v_mul_f32 v19, v18, v17
    v_accvgpr_write_b32 a18, v19
    v_accvgpr_read_b32 v18, a19
    v_mul_f32 v19, v18, v17
    v_accvgpr_write_b32 a19, v19
    v_accvgpr_read_b32 v18, a20
    v_mul_f32 v19, v18, v17
    v_accvgpr_write_b32 a20, v19
    v_accvgpr_read_b32 v18, a21
    v_mul_f32 v19, v18, v17
    v_accvgpr_write_b32 a21, v19
    v_accvgpr_read_b32 v18, a22
    v_mul_f32 v19, v18, v17
    v_accvgpr_write_b32 a22, v19
    v_accvgpr_read_b32 v18, a23
    v_mul_f32 v19, v18, v17
    v_accvgpr_write_b32 a23, v19
    v_accvgpr_read_b32 v18, a24
    v_mul_f32 v19, v18, v17
    v_accvgpr_write_b32 a24, v19
    v_accvgpr_read_b32 v18, a25
    v_mul_f32 v19, v18, v17
    v_accvgpr_write_b32 a25, v19
    v_accvgpr_read_b32 v18, a26
    v_mul_f32 v19, v18, v17
    v_accvgpr_write_b32 a26, v19
    v_accvgpr_read_b32 v18, a27
    v_mul_f32 v19, v18, v17
    v_accvgpr_write_b32 a27, v19
    v_accvgpr_read_b32 v18, a28
    v_mul_f32 v19, v18, v17
    v_accvgpr_write_b32 a28, v19
    v_accvgpr_read_b32 v18, a29
    v_mul_f32 v19, v18, v17
    v_accvgpr_write_b32 a29, v19
    v_accvgpr_read_b32 v18, a30
    v_mul_f32 v19, v18, v17
    v_accvgpr_write_b32 a30, v19
    v_accvgpr_read_b32 v18, a31
    v_mul_f32 v19, v18, v17
    v_accvgpr_write_b32 a31, v19
    v_accvgpr_read_b32 v18, a32
    v_mul_f32 v19, v18, v17
    v_accvgpr_write_b32 a32, v19
    v_accvgpr_read_b32 v18, a33
    v_mul_f32 v19, v18, v17
    v_accvgpr_write_b32 a33, v19
    v_accvgpr_read_b32 v18, a34
    v_mul_f32 v19, v18, v17
    v_accvgpr_write_b32 a34, v19
    v_accvgpr_read_b32 v18, a35
    v_mul_f32 v19, v18, v17
    v_accvgpr_write_b32 a35, v19
    v_accvgpr_read_b32 v18, a36
    v_mul_f32 v19, v18, v17
    v_accvgpr_write_b32 a36, v19
    v_accvgpr_read_b32 v18, a37
    v_mul_f32 v19, v18, v17
    v_accvgpr_write_b32 a37, v19
    v_accvgpr_read_b32 v18, a38
    v_mul_f32 v19, v18, v17
    v_accvgpr_write_b32 a38, v19
    v_accvgpr_read_b32 v18, a39
    v_mul_f32 v19, v18, v17
    v_accvgpr_write_b32 a39, v19
    v_accvgpr_read_b32 v18, a40
    v_mul_f32 v19, v18, v17
    v_accvgpr_write_b32 a40, v19
    v_accvgpr_read_b32 v18, a41
    v_mul_f32 v19, v18, v17
    v_accvgpr_write_b32 a41, v19
    v_accvgpr_read_b32 v18, a42
    v_mul_f32 v19, v18, v17
    v_accvgpr_write_b32 a42, v19
    v_accvgpr_read_b32 v18, a43
    v_mul_f32 v19, v18, v17
    v_accvgpr_write_b32 a43, v19
    v_accvgpr_read_b32 v18, a44
    v_mul_f32 v19, v18, v17
    v_accvgpr_write_b32 a44, v19
    v_accvgpr_read_b32 v18, a45
    v_mul_f32 v19, v18, v17
    v_accvgpr_write_b32 a45, v19
    v_accvgpr_read_b32 v18, a46
    v_mul_f32 v19, v18, v17
    v_accvgpr_write_b32 a46, v19
    v_accvgpr_read_b32 v18, a47
    v_mul_f32 v19, v18, v17
    v_accvgpr_write_b32 a47, v19
    v_accvgpr_read_b32 v18, a48
    v_mul_f32 v19, v18, v17
    v_accvgpr_write_b32 a48, v19
    v_accvgpr_read_b32 v18, a49
    v_mul_f32 v19, v18, v17
    v_accvgpr_write_b32 a49, v19
    v_accvgpr_read_b32 v18, a50
    v_mul_f32 v19, v18, v17
    v_accvgpr_write_b32 a50, v19
    v_accvgpr_read_b32 v18, a51
    v_mul_f32 v19, v18, v17
    v_accvgpr_write_b32 a51, v19
    v_accvgpr_read_b32 v18, a52
    v_mul_f32 v19, v18, v17
    v_accvgpr_write_b32 a52, v19
    v_accvgpr_read_b32 v18, a53
    v_mul_f32 v19, v18, v17
    v_accvgpr_write_b32 a53, v19
    v_accvgpr_read_b32 v18, a54
    v_mul_f32 v19, v18, v17
    v_accvgpr_write_b32 a54, v19
    v_accvgpr_read_b32 v18, a55
    v_mul_f32 v19, v18, v17
    v_accvgpr_write_b32 a55, v19
    v_accvgpr_read_b32 v18, a56
    v_mul_f32 v19, v18, v17
    v_accvgpr_write_b32 a56, v19
    v_accvgpr_read_b32 v18, a57
    v_mul_f32 v19, v18, v17
    v_accvgpr_write_b32 a57, v19
    v_accvgpr_read_b32 v18, a58
    v_mul_f32 v19, v18, v17
    v_accvgpr_write_b32 a58, v19
    v_accvgpr_read_b32 v18, a59
    v_mul_f32 v19, v18, v17
    v_accvgpr_write_b32 a59, v19
    v_accvgpr_read_b32 v18, a60
    v_mul_f32 v19, v18, v17
    v_accvgpr_write_b32 a60, v19
    v_accvgpr_read_b32 v18, a61
    v_mul_f32 v19, v18, v17
    v_accvgpr_write_b32 a61, v19
    v_accvgpr_read_b32 v18, a62
    v_mul_f32 v19, v18, v17
    v_accvgpr_write_b32 a62, v19
    v_accvgpr_read_b32 v18, a63
    v_mul_f32 v19, v18, v17
    v_accvgpr_write_b32 a63, v19
    v_mov_b32 v14, 0
    v_sub_f32 v18, v80, v16
    v_sub_f32 v19, v81, v16
    v_exp_f32 v18, v18
    v_exp_f32 v19, v19
    s_nop 0
    v_add_f32 v14, v14, v18
    v_add_f32 v14, v14, v19
    v_cvt_pk_bf16_f32 v104, v18, v19
    v_sub_f32 v18, v82, v16
    v_sub_f32 v19, v83, v16
    v_exp_f32 v18, v18
    v_exp_f32 v19, v19
    s_nop 0
    v_add_f32 v14, v14, v18
    v_add_f32 v14, v14, v19
    v_cvt_pk_bf16_f32 v105, v18, v19
    v_sub_f32 v18, v84, v16
    v_sub_f32 v19, v85, v16
    v_exp_f32 v18, v18
    v_exp_f32 v19, v19
    s_nop 0
    v_add_f32 v14, v14, v18
    v_add_f32 v14, v14, v19
    v_cvt_pk_bf16_f32 v106, v18, v19
    v_sub_f32 v18, v86, v16
    v_sub_f32 v19, v87, v16
    v_exp_f32 v18, v18
    v_exp_f32 v19, v19
    s_nop 0
    v_add_f32 v14, v14, v18
    v_add_f32 v14, v14, v19
    v_cvt_pk_bf16_f32 v107, v18, v19
    v_sub_f32 v18, v88, v16
    v_sub_f32 v19, v89, v16
    v_exp_f32 v18, v18
    v_exp_f32 v19, v19
    s_nop 0
    v_add_f32 v14, v14, v18
    v_add_f32 v14, v14, v19
    v_cvt_pk_bf16_f32 v108, v18, v19
    v_sub_f32 v18, v90, v16
    v_sub_f32 v19, v91, v16
    v_exp_f32 v18, v18
    v_exp_f32 v19, v19
    s_nop 0
    v_add_f32 v14, v14, v18
    v_add_f32 v14, v14, v19
    v_cvt_pk_bf16_f32 v109, v18, v19
    v_sub_f32 v18, v92, v16
    v_sub_f32 v19, v93, v16
    v_exp_f32 v18, v18
    v_exp_f32 v19, v19
    s_nop 0
    v_add_f32 v14, v14, v18
    v_add_f32 v14, v14, v19
    v_cvt_pk_bf16_f32 v110, v18, v19
    v_sub_f32 v18, v94, v16
    v_sub_f32 v19, v95, v16
    v_exp_f32 v18, v18
    v_exp_f32 v19, v19
    s_nop 0
    v_add_f32 v14, v14, v18
    v_add_f32 v14, v14, v19
    v_cvt_pk_bf16_f32 v111, v18, v19
    s_nop 3
    s_branch L_back9
L_slow10:
    s_nop 15
    s_nop 15
    v_max3_f32 v16, v64, v65, v66
    v_max3_f32 v16, v16, v67, v68
    v_max3_f32 v16, v16, v69, v70
    v_max3_f32 v16, v16, v71, v72
    v_max3_f32 v16, v16, v73, v74
    v_max3_f32 v16, v16, v75, v76
    v_max3_f32 v16, v16, v77, v78
    v_max_f32 v16, v16, v79
    v_mov_b32 v17, v16
    s_nop 1
    v_permlane32_swap_b32 v16, v17
    s_nop 1
    v_max3_f32 v16, v16, v17, 0
    v_exp_f32 v17, -v16
    s_nop 1
    v_sub_f32 v13, v13, v16
    v_mov_b32 v112, v13
    v_mov_b32 v113, v13
    v_mov_b32 v114, v13
    v_mov_b32 v115, v13
    v_mov_b32 v116, v13
    v_mov_b32 v117, v13
    v_mov_b32 v118, v13
    v_mov_b32 v119, v13
    v_mov_b32 v120, v13
    v_mov_b32 v121, v13
    v_mov_b32 v122, v13
    v_mov_b32 v123, v13
    v_mov_b32 v124, v13
    v_mov_b32 v125, v13
    v_mov_b32 v126, v13
    v_mov_b32 v127, v13
    v_sub_f32 v80, v80, v16
    v_sub_f32 v81, v81, v16
    v_sub_f32 v82, v82, v16
    v_sub_f32 v83, v83, v16
    v_sub_f32 v84, v84, v16
    v_sub_f32 v85, v85, v16
    v_sub_f32 v86, v86, v16
    v_sub_f32 v87, v87, v16
    v_sub_f32 v88, v88, v16
    v_sub_f32 v89, v89, v16
    v_sub_f32 v90, v90, v16
    v_sub_f32 v91, v91, v16
    v_sub_f32 v92, v92, v16
    v_sub_f32 v93, v93, v16
    v_sub_f32 v94, v94, v16
    v_sub_f32 v95, v95, v16
    v_mul_f32 v9, v9, v17
    v_accvgpr_read_b32 v18, a0
    v_mul_f32 v19, v18, v17
    v_accvgpr_write_b32 a0, v19
    v_accvgpr_read_b32 v18, a1
    v_mul_f32 v19, v18, v17
    v_accvgpr_write_b32 a1, v19
    v_accvgpr_read_b32 v18, a2
    v_mul_f32 v19, v18, v17
    v_accvgpr_write_b32 a2, v19
    v_accvgpr_read_b32 v18, a3
    v_mul_f32 v19, v18, v17
    v_accvgpr_write_b32 a3, v19
    v_accvgpr_read_b32 v18, a4
    v_mul_f32 v19, v18, v17
    v_accvgpr_write_b32 a4, v19
    v_accvgpr_read_b32 v18, a5
    v_mul_f32 v19, v18, v17
    v_accvgpr_write_b32 a5, v19
    v_accvgpr_read_b32 v18, a6
    v_mul_f32 v19, v18, v17
    v_accvgpr_write_b32 a6, v19
    v_accvgpr_read_b32 v18, a7
    v_mul_f32 v19, v18, v17
    v_accvgpr_write_b32 a7, v19
    v_accvgpr_read_b32 v18, a8
    v_mul_f32 v19, v18, v17
    v_accvgpr_write_b32 a8, v19
    v_accvgpr_read_b32 v18, a9
    v_mul_f32 v19, v18, v17
    v_accvgpr_write_b32 a9, v19
    v_accvgpr_read_b32 v18, a10
    v_mul_f32 v19, v18, v17
    v_accvgpr_write_b32 a10, v19
    v_accvgpr_read_b32 v18, a11
    v_mul_f32 v19, v18, v17
    v_accvgpr_write_b32 a11, v19
    v_accvgpr_read_b32 v18, a12
    v_mul_f32 v19, v18, v17
    v_accvgpr_write_b32 a12, v19
    v_accvgpr_read_b32 v18, a13
    v_mul_f32 v19, v18, v17
    v_accvgpr_write_b32 a13, v19
    v_accvgpr_read_b32 v18, a14
    v_mul_f32 v19, v18, v17
    v_accvgpr_write_b32 a14, v19
    v_accvgpr_read_b32 v18, a15
    v_mul_f32 v19, v18, v17
    v_accvgpr_write_b32 a15, v19
    v_accvgpr_read_b32 v18, a16
    v_mul_f32 v19, v18, v17
    v_accvgpr_write_b32 a16, v19
    v_accvgpr_read_b32 v18, a17
    v_mul_f32 v19, v18, v17
    v_accvgpr_write_b32 a17, v19
    v_accvgpr_read_b32 v18, a18
    v_mul_f32 v19, v18, v17
    v_accvgpr_write_b32 a18, v19
    v_accvgpr_read_b32 v18, a19
    v_mul_f32 v19, v18, v17
    v_accvgpr_write_b32 a19, v19
    v_accvgpr_read_b32 v18, a20
    v_mul_f32 v19, v18, v17
    v_accvgpr_write_b32 a20, v19
    v_accvgpr_read_b32 v18, a21
    v_mul_f32 v19, v18, v17
    v_accvgpr_write_b32 a21, v19
    v_accvgpr_read_b32 v18, a22
    v_mul_f32 v19, v18, v17
    v_accvgpr_write_b32 a22, v19
    v_accvgpr_read_b32 v18, a23
    v_mul_f32 v19, v18, v17
    v_accvgpr_write_b32 a23, v19
    v_accvgpr_read_b32 v18, a24
    v_mul_f32 v19, v18, v17
    v_accvgpr_write_b32 a24, v19
    v_accvgpr_read_b32 v18, a25
    v_mul_f32 v19, v18, v17
    v_accvgpr_write_b32 a25, v19
    v_accvgpr_read_b32 v18, a26
    v_mul_f32 v19, v18, v17
    v_accvgpr_write_b32 a26, v19
    v_accvgpr_read_b32 v18, a27
    v_mul_f32 v19, v18, v17
    v_accvgpr_write_b32 a27, v19
    v_accvgpr_read_b32 v18, a28
    v_mul_f32 v19, v18, v17
    v_accvgpr_write_b32 a28, v19
    v_accvgpr_read_b32 v18, a29
    v_mul_f32 v19, v18, v17
    v_accvgpr_write_b32 a29, v19
    v_accvgpr_read_b32 v18, a30
    v_mul_f32 v19, v18, v17
    v_accvgpr_write_b32 a30, v19
    v_accvgpr_read_b32 v18, a31
    v_mul_f32 v19, v18, v17
    v_accvgpr_write_b32 a31, v19
    v_accvgpr_read_b32 v18, a32
    v_mul_f32 v19, v18, v17
    v_accvgpr_write_b32 a32, v19
    v_accvgpr_read_b32 v18, a33
    v_mul_f32 v19, v18, v17
    v_accvgpr_write_b32 a33, v19
    v_accvgpr_read_b32 v18, a34
    v_mul_f32 v19, v18, v17
    v_accvgpr_write_b32 a34, v19
    v_accvgpr_read_b32 v18, a35
    v_mul_f32 v19, v18, v17
    v_accvgpr_write_b32 a35, v19
    v_accvgpr_read_b32 v18, a36
    v_mul_f32 v19, v18, v17
    v_accvgpr_write_b32 a36, v19
    v_accvgpr_read_b32 v18, a37
    v_mul_f32 v19, v18, v17
    v_accvgpr_write_b32 a37, v19
    v_accvgpr_read_b32 v18, a38
    v_mul_f32 v19, v18, v17
    v_accvgpr_write_b32 a38, v19
    v_accvgpr_read_b32 v18, a39
    v_mul_f32 v19, v18, v17
    v_accvgpr_write_b32 a39, v19
    v_accvgpr_read_b32 v18, a40
    v_mul_f32 v19, v18, v17
    v_accvgpr_write_b32 a40, v19
    v_accvgpr_read_b32 v18, a41
    v_mul_f32 v19, v18, v17
    v_accvgpr_write_b32 a41, v19
    v_accvgpr_read_b32 v18, a42
    v_mul_f32 v19, v18, v17
    v_accvgpr_write_b32 a42, v19
    v_accvgpr_read_b32 v18, a43
    v_mul_f32 v19, v18, v17
    v_accvgpr_write_b32 a43, v19
    v_accvgpr_read_b32 v18, a44
    v_mul_f32 v19, v18, v17
    v_accvgpr_write_b32 a44, v19
    v_accvgpr_read_b32 v18, a45
    v_mul_f32 v19, v18, v17
    v_accvgpr_write_b32 a45, v19
    v_accvgpr_read_b32 v18, a46
    v_mul_f32 v19, v18, v17
    v_accvgpr_write_b32 a46, v19
    v_accvgpr_read_b32 v18, a47
    v_mul_f32 v19, v18, v17
    v_accvgpr_write_b32 a47, v19
    v_accvgpr_read_b32 v18, a48
    v_mul_f32 v19, v18, v17
    v_accvgpr_write_b32 a48, v19
    v_accvgpr_read_b32 v18, a49
    v_mul_f32 v19, v18, v17
    v_accvgpr_write_b32 a49, v19
    v_accvgpr_read_b32 v18, a50
    v_mul_f32 v19, v18, v17
    v_accvgpr_write_b32 a50, v19
    v_accvgpr_read_b32 v18, a51
    v_mul_f32 v19, v18, v17
    v_accvgpr_write_b32 a51, v19
    v_accvgpr_read_b32 v18, a52
    v_mul_f32 v19, v18, v17
    v_accvgpr_write_b32 a52, v19
    v_accvgpr_read_b32 v18, a53
    v_mul_f32 v19, v18, v17
    v_accvgpr_write_b32 a53, v19
    v_accvgpr_read_b32 v18, a54
    v_mul_f32 v19, v18, v17
    v_accvgpr_write_b32 a54, v19
    v_accvgpr_read_b32 v18, a55
    v_mul_f32 v19, v18, v17
    v_accvgpr_write_b32 a55, v19
    v_accvgpr_read_b32 v18, a56
    v_mul_f32 v19, v18, v17
    v_accvgpr_write_b32 a56, v19
    v_accvgpr_read_b32 v18, a57
    v_mul_f32 v19, v18, v17
    v_accvgpr_write_b32 a57, v19
    v_accvgpr_read_b32 v18, a58
    v_mul_f32 v19, v18, v17
    v_accvgpr_write_b32 a58, v19
    v_accvgpr_read_b32 v18, a59
    v_mul_f32 v19, v18, v17
    v_accvgpr_write_b32 a59, v19
    v_accvgpr_read_b32 v18, a60
    v_mul_f32 v19, v18, v17
    v_accvgpr_write_b32 a60, v19
    v_accvgpr_read_b32 v18, a61
    v_mul_f32 v19, v18, v17
    v_accvgpr_write_b32 a61, v19
    v_accvgpr_read_b32 v18, a62
    v_mul_f32 v19, v18, v17
    v_accvgpr_write_b32 a62, v19
    v_accvgpr_read_b32 v18, a63
    v_mul_f32 v19, v18, v17
    v_accvgpr_write_b32 a63, v19
    v_mov_b32 v14, 0
    v_sub_f32 v18, v64, v16
    v_sub_f32 v19, v65, v16
    v_exp_f32 v18, v18
    v_exp_f32 v19, v19
    s_nop 0
    v_add_f32 v14, v14, v18
    v_add_f32 v14, v14, v19
    v_cvt_pk_bf16_f32 v96, v18, v19
    v_sub_f32 v18, v66, v16
    v_sub_f32 v19, v67, v16
    v_exp_f32 v18, v18
    v_exp_f32 v19, v19
    s_nop 0
    v_add_f32 v14, v14, v18
    v_add_f32 v14, v14, v19
    v_cvt_pk_bf16_f32 v97, v18, v19
    v_sub_f32 v18, v68, v16
    v_sub_f32 v19, v69, v16
    v_exp_f32 v18, v18
    v_exp_f32 v19, v19
    s_nop 0
    v_add_f32 v14, v14, v18
    v_add_f32 v14, v14, v19
    v_cvt_pk_bf16_f32 v98, v18, v19
    v_sub_f32 v18, v70, v16
    v_sub_f32 v19, v71, v16
    v_exp_f32 v18, v18
    v_exp_f32 v19, v19
    s_nop 0
    v_add_f32 v14, v14, v18
    v_add_f32 v14, v14, v19
    v_cvt_pk_bf16_f32 v99, v18, v19
    v_sub_f32 v18, v72, v16
    v_sub_f32 v19, v73, v16
    v_exp_f32 v18, v18
    v_exp_f32 v19, v19
    s_nop 0
    v_add_f32 v14, v14, v18
    v_add_f32 v14, v14, v19
    v_cvt_pk_bf16_f32 v100, v18, v19
    v_sub_f32 v18, v74, v16
    v_sub_f32 v19, v75, v16
    v_exp_f32 v18, v18
    v_exp_f32 v19, v19
    s_nop 0
    v_add_f32 v14, v14, v18
    v_add_f32 v14, v14, v19
    v_cvt_pk_bf16_f32 v101, v18, v19
    v_sub_f32 v18, v76, v16
    v_sub_f32 v19, v77, v16
    v_exp_f32 v18, v18
    v_exp_f32 v19, v19
    s_nop 0
    v_add_f32 v14, v14, v18
    v_add_f32 v14, v14, v19
    v_cvt_pk_bf16_f32 v102, v18, v19
    v_sub_f32 v18, v78, v16
    v_sub_f32 v19, v79, v16
    v_exp_f32 v18, v18
    v_exp_f32 v19, v19
    s_nop 0
    v_add_f32 v14, v14, v18
    v_add_f32 v14, v14, v19
    v_cvt_pk_bf16_f32 v103, v18, v19
    s_nop 3
    s_branch L_back10
L_slow11:
    s_nop 15
    s_nop 15
    v_max3_f32 v16, v80, v81, v82
    v_max3_f32 v16, v16, v83, v84
    v_max3_f32 v16, v16, v85, v86
    v_max3_f32 v16, v16, v87, v88
    v_max3_f32 v16, v16, v89, v90
    v_max3_f32 v16, v16, v91, v92
    v_max3_f32 v16, v16, v93, v94
    v_max_f32 v16, v16, v95
    v_mov_b32 v17, v16
    s_nop 1
    v_permlane32_swap_b32 v16, v17
    s_nop 1
    v_max3_f32 v16, v16, v17, 0
    v_exp_f32 v17, -v16
    s_nop 1
    v_sub_f32 v13, v13, v16
    v_mov_b32 v112, v13
    v_mov_b32 v113, v13
    v_mov_b32 v114, v13
    v_mov_b32 v115, v13
    v_mov_b32 v116, v13
    v_mov_b32 v117, v13
    v_mov_b32 v118, v13
    v_mov_b32 v119, v13
    v_mov_b32 v120, v13
    v_mov_b32 v121, v13
    v_mov_b32 v122, v13
    v_mov_b32 v123, v13
    v_mov_b32 v124, v13
    v_mov_b32 v125, v13
    v_mov_b32 v126, v13
    v_mov_b32 v127, v13
    v_sub_f32 v64, v64, v16
    v_sub_f32 v65, v65, v16
    v_sub_f32 v66, v66, v16
    v_sub_f32 v67, v67, v16
    v_sub_f32 v68, v68, v16
    v_sub_f32 v69, v69, v16
    v_sub_f32 v70, v70, v16
    v_sub_f32 v71, v71, v16
    v_sub_f32 v72, v72, v16
    v_sub_f32 v73, v73, v16
    v_sub_f32 v74, v74, v16
    v_sub_f32 v75, v75, v16
    v_sub_f32 v76, v76, v16
    v_sub_f32 v77, v77, v16
    v_sub_f32 v78, v78, v16
    v_sub_f32 v79, v79, v16
    v_mul_f32 v9, v9, v17
    v_accvgpr_read_b32 v18, a0
    v_mul_f32 v19, v18, v17
    v_accvgpr_write_b32 a0, v19
    v_accvgpr_read_b32 v18, a1
    v_mul_f32 v19, v18, v17
    v_accvgpr_write_b32 a1, v19
    v_accvgpr_read_b32 v18, a2
    v_mul_f32 v19, v18, v17
    v_accvgpr_write_b32 a2, v19
    v_accvgpr_read_b32 v18, a3
    v_mul_f32 v19, v18, v17
    v_accvgpr_write_b32 a3, v19
    v_accvgpr_read_b32 v18, a4
    v_mul_f32 v19, v18, v17
    v_accvgpr_write_b32 a4, v19
    v_accvgpr_read_b32 v18, a5
    v_mul_f32 v19, v18, v17
    v_accvgpr_write_b32 a5, v19
    v_accvgpr_read_b32 v18, a6
    v_mul_f32 v19, v18, v17
    v_accvgpr_write_b32 a6, v19
    v_accvgpr_read_b32 v18, a7
    v_mul_f32 v19, v18, v17
    v_accvgpr_write_b32 a7, v19
    v_accvgpr_read_b32 v18, a8
    v_mul_f32 v19, v18, v17
    v_accvgpr_write_b32 a8, v19
    v_accvgpr_read_b32 v18, a9
    v_mul_f32 v19, v18, v17
    v_accvgpr_write_b32 a9, v19
    v_accvgpr_read_b32 v18, a10
    v_mul_f32 v19, v18, v17
    v_accvgpr_write_b32 a10, v19
    v_accvgpr_read_b32 v18, a11
    v_mul_f32 v19, v18, v17
    v_accvgpr_write_b32 a11, v19
    v_accvgpr_read_b32 v18, a12
    v_mul_f32 v19, v18, v17
    v_accvgpr_write_b32 a12, v19
    v_accvgpr_read_b32 v18, a13
    v_mul_f32 v19, v18, v17
    v_accvgpr_write_b32 a13, v19
    v_accvgpr_read_b32 v18, a14
    v_mul_f32 v19, v18, v17
    v_accvgpr_write_b32 a14, v19
    v_accvgpr_read_b32 v18, a15
    v_mul_f32 v19, v18, v17
    v_accvgpr_write_b32 a15, v19
    v_accvgpr_read_b32 v18, a16
    v_mul_f32 v19, v18, v17
    v_accvgpr_write_b32 a16, v19
    v_accvgpr_read_b32 v18, a17
    v_mul_f32 v19, v18, v17
    v_accvgpr_write_b32 a17, v19
    v_accvgpr_read_b32 v18, a18
    v_mul_f32 v19, v18, v17
    v_accvgpr_write_b32 a18, v19
    v_accvgpr_read_b32 v18, a19
    v_mul_f32 v19, v18, v17
    v_accvgpr_write_b32 a19, v19
    v_accvgpr_read_b32 v18, a20
    v_mul_f32 v19, v18, v17
    v_accvgpr_write_b32 a20, v19
    v_accvgpr_read_b32 v18, a21
    v_mul_f32 v19, v18, v17
    v_accvgpr_write_b32 a21, v19
    v_accvgpr_read_b32 v18, a22
    v_mul_f32 v19, v18, v17
    v_accvgpr_write_b32 a22, v19
    v_accvgpr_read_b32 v18, a23
    v_mul_f32 v19, v18, v17
    v_accvgpr_write_b32 a23, v19
    v_accvgpr_read_b32 v18, a24
    v_mul_f32 v19, v18, v17
    v_accvgpr_write_b32 a24, v19
    v_accvgpr_read_b32 v18, a25
    v_mul_f32 v19, v18, v17
    v_accvgpr_write_b32 a25, v19
    v_accvgpr_read_b32 v18, a26
    v_mul_f32 v19, v18, v17
    v_accvgpr_write_b32 a26, v19
    v_accvgpr_read_b32 v18, a27
    v_mul_f32 v19, v18, v17
    v_accvgpr_write_b32 a27, v19
    v_accvgpr_read_b32 v18, a28
    v_mul_f32 v19, v18, v17
    v_accvgpr_write_b32 a28, v19
    v_accvgpr_read_b32 v18, a29
    v_mul_f32 v19, v18, v17
    v_accvgpr_write_b32 a29, v19
    v_accvgpr_read_b32 v18, a30
    v_mul_f32 v19, v18, v17
    v_accvgpr_write_b32 a30, v19
    v_accvgpr_read_b32 v18, a31
    v_mul_f32 v19, v18, v17
    v_accvgpr_write_b32 a31, v19
    v_accvgpr_read_b32 v18, a32
    v_mul_f32 v19, v18, v17
    v_accvgpr_write_b32 a32, v19
    v_accvgpr_read_b32 v18, a33
    v_mul_f32 v19, v18, v17
    v_accvgpr_write_b32 a33, v19
    v_accvgpr_read_b32 v18, a34
    v_mul_f32 v19, v18, v17
    v_accvgpr_write_b32 a34, v19
    v_accvgpr_read_b32 v18, a35
    v_mul_f32 v19, v18, v17
    v_accvgpr_write_b32 a35, v19
    v_accvgpr_read_b32 v18, a36
    v_mul_f32 v19, v18, v17
    v_accvgpr_write_b32 a36, v19
    v_accvgpr_read_b32 v18, a37
    v_mul_f32 v19, v18, v17
    v_accvgpr_write_b32 a37, v19
    v_accvgpr_read_b32 v18, a38
    v_mul_f32 v19, v18, v17
    v_accvgpr_write_b32 a38, v19
    v_accvgpr_read_b32 v18, a39
    v_mul_f32 v19, v18, v17
    v_accvgpr_write_b32 a39, v19
    v_accvgpr_read_b32 v18, a40
    v_mul_f32 v19, v18, v17
    v_accvgpr_write_b32 a40, v19
    v_accvgpr_read_b32 v18, a41
    v_mul_f32 v19, v18, v17
    v_accvgpr_write_b32 a41, v19
    v_accvgpr_read_b32 v18, a42
    v_mul_f32 v19, v18, v17
    v_accvgpr_write_b32 a42, v19
    v_accvgpr_read_b32 v18, a43
    v_mul_f32 v19, v18, v17
    v_accvgpr_write_b32 a43, v19
    v_accvgpr_read_b32 v18, a44
    v_mul_f32 v19, v18, v17
    v_accvgpr_write_b32 a44, v19
    v_accvgpr_read_b32 v18, a45
    v_mul_f32 v19, v18, v17
    v_accvgpr_write_b32 a45, v19
    v_accvgpr_read_b32 v18, a46
    v_mul_f32 v19, v18, v17
    v_accvgpr_write_b32 a46, v19
    v_accvgpr_read_b32 v18, a47
    v_mul_f32 v19, v18, v17
    v_accvgpr_write_b32 a47, v19
    v_accvgpr_read_b32 v18, a48
    v_mul_f32 v19, v18, v17
    v_accvgpr_write_b32 a48, v19
    v_accvgpr_read_b32 v18, a49
    v_mul_f32 v19, v18, v17
    v_accvgpr_write_b32 a49, v19
    v_accvgpr_read_b32 v18, a50
    v_mul_f32 v19, v18, v17
    v_accvgpr_write_b32 a50, v19
    v_accvgpr_read_b32 v18, a51
    v_mul_f32 v19, v18, v17
    v_accvgpr_write_b32 a51, v19
    v_accvgpr_read_b32 v18, a52
    v_mul_f32 v19, v18, v17
    v_accvgpr_write_b32 a52, v19
    v_accvgpr_read_b32 v18, a53
    v_mul_f32 v19, v18, v17
    v_accvgpr_write_b32 a53, v19
    v_accvgpr_read_b32 v18, a54
    v_mul_f32 v19, v18, v17
    v_accvgpr_write_b32 a54, v19
    v_accvgpr_read_b32 v18, a55
    v_mul_f32 v19, v18, v17
    v_accvgpr_write_b32 a55, v19
    v_accvgpr_read_b32 v18, a56
    v_mul_f32 v19, v18, v17
    v_accvgpr_write_b32 a56, v19
    v_accvgpr_read_b32 v18, a57
    v_mul_f32 v19, v18, v17
    v_accvgpr_write_b32 a57, v19
    v_accvgpr_read_b32 v18, a58
    v_mul_f32 v19, v18, v17
    v_accvgpr_write_b32 a58, v19
    v_accvgpr_read_b32 v18, a59
    v_mul_f32 v19, v18, v17
    v_accvgpr_write_b32 a59, v19
    v_accvgpr_read_b32 v18, a60
    v_mul_f32 v19, v18, v17
    v_accvgpr_write_b32 a60, v19
    v_accvgpr_read_b32 v18, a61
    v_mul_f32 v19, v18, v17
    v_accvgpr_write_b32 a61, v19
    v_accvgpr_read_b32 v18, a62
    v_mul_f32 v19, v18, v17
    v_accvgpr_write_b32 a62, v19
    v_accvgpr_read_b32 v18, a63
    v_mul_f32 v19, v18, v17
    v_accvgpr_write_b32 a63, v19
    v_mov_b32 v14, 0
    v_sub_f32 v18, v80, v16
    v_sub_f32 v19, v81, v16
    v_exp_f32 v18, v18
    v_exp_f32 v19, v19
    s_nop 0
    v_add_f32 v14, v14, v18
    v_add_f32 v14, v14, v19
    v_cvt_pk_bf16_f32 v104, v18, v19
    v_sub_f32 v18, v82, v16
    v_sub_f32 v19, v83, v16
    v_exp_f32 v18, v18
    v_exp_f32 v19, v19
    s_nop 0
    v_add_f32 v14, v14, v18
    v_add_f32 v14, v14, v19
    v_cvt_pk_bf16_f32 v105, v18, v19
    v_sub_f32 v18, v84, v16
    v_sub_f32 v19, v85, v16
    v_exp_f32 v18, v18
    v_exp_f32 v19, v19
    s_nop 0
    v_add_f32 v14, v14, v18
    v_add_f32 v14, v14, v19
    v_cvt_pk_bf16_f32 v106, v18, v19
    v_sub_f32 v18, v86, v16
    v_sub_f32 v19, v87, v16
    v_exp_f32 v18, v18
    v_exp_f32 v19, v19
    s_nop 0
    v_add_f32 v14, v14, v18
    v_add_f32 v14, v14, v19
    v_cvt_pk_bf16_f32 v107, v18, v19
    v_sub_f32 v18, v88, v16
    v_sub_f32 v19, v89, v16
    v_exp_f32 v18, v18
    v_exp_f32 v19, v19
    s_nop 0
    v_add_f32 v14, v14, v18
    v_add_f32 v14, v14, v19
    v_cvt_pk_bf16_f32 v108, v18, v19
    v_sub_f32 v18, v90, v16
    v_sub_f32 v19, v91, v16
    v_exp_f32 v18, v18
    v_exp_f32 v19, v19
    s_nop 0
    v_add_f32 v14, v14, v18
    v_add_f32 v14, v14, v19
    v_cvt_pk_bf16_f32 v109, v18, v19
    v_sub_f32 v18, v92, v16
    v_sub_f32 v19, v93, v16
    v_exp_f32 v18, v18
    v_exp_f32 v19, v19
    s_nop 0
    v_add_f32 v14, v14, v18
    v_add_f32 v14, v14, v19
    v_cvt_pk_bf16_f32 v110, v18, v19
    v_sub_f32 v18, v94, v16
    v_sub_f32 v19, v95, v16
    v_exp_f32 v18, v18
    v_exp_f32 v19, v19
    s_nop 0
    v_add_f32 v14, v14, v18
    v_add_f32 v14, v14, v19
    v_cvt_pk_bf16_f32 v111, v18, v19
    s_nop 3
    s_branch L_back11
L_slow12:
    s_nop 15
    s_nop 15
    v_max3_f32 v16, v64, v65, v66
    v_max3_f32 v16, v16, v67, v68
    v_max3_f32 v16, v16, v69, v70
    v_max3_f32 v16, v16, v71, v72
    v_max3_f32 v16, v16, v73, v74
    v_max3_f32 v16, v16, v75, v76
    v_max3_f32 v16, v16, v77, v78
    v_max_f32 v16, v16, v79
    v_mov_b32 v17, v16
    s_nop 1
    v_permlane32_swap_b32 v16, v17
    s_nop 1
    v_max3_f32 v16, v16, v17, 0
    v_exp_f32 v17, -v16
    s_nop 1
    v_sub_f32 v13, v13, v16
    v_mov_b32 v112, v13
    v_mov_b32 v113, v13
    v_mov_b32 v114, v13
    v_mov_b32 v115, v13
    v_mov_b32 v116, v13
    v_mov_b32 v117, v13
    v_mov_b32 v118, v13
    v_mov_b32 v119, v13
    v_mov_b32 v120, v13
    v_mov_b32 v121, v13
    v_mov_b32 v122, v13
    v_mov_b32 v123, v13
    v_mov_b32 v124, v13
    v_mov_b32 v125, v13
    v_mov_b32 v126, v13
    v_mov_b32 v127, v13
    v_sub_f32 v80, v80, v16
    v_sub_f32 v81, v81, v16
    v_sub_f32 v82, v82, v16
    v_sub_f32 v83, v83, v16
    v_sub_f32 v84, v84, v16
    v_sub_f32 v85, v85, v16
    v_sub_f32 v86, v86, v16
    v_sub_f32 v87, v87, v16
    v_sub_f32 v88, v88, v16
    v_sub_f32 v89, v89, v16
    v_sub_f32 v90, v90, v16
    v_sub_f32 v91, v91, v16
    v_sub_f32 v92, v92, v16
    v_sub_f32 v93, v93, v16
    v_sub_f32 v94, v94, v16
    v_sub_f32 v95, v95, v16
    v_mul_f32 v9, v9, v17
    v_accvgpr_read_b32 v18, a0
    v_mul_f32 v19, v18, v17
    v_accvgpr_write_b32 a0, v19
    v_accvgpr_read_b32 v18, a1
    v_mul_f32 v19, v18, v17
    v_accvgpr_write_b32 a1, v19
    v_accvgpr_read_b32 v18, a2
    v_mul_f32 v19, v18, v17
    v_accvgpr_write_b32 a2, v19
    v_accvgpr_read_b32 v18, a3
    v_mul_f32 v19, v18, v17
    v_accvgpr_write_b32 a3, v19
    v_accvgpr_read_b32 v18, a4
    v_mul_f32 v19, v18, v17
    v_accvgpr_write_b32 a4, v19
    v_accvgpr_read_b32 v18, a5
    v_mul_f32 v19, v18, v17
    v_accvgpr_write_b32 a5, v19
    v_accvgpr_read_b32 v18, a6
    v_mul_f32 v19, v18, v17
    v_accvgpr_write_b32 a6, v19
    v_accvgpr_read_b32 v18, a7
    v_mul_f32 v19, v18, v17
    v_accvgpr_write_b32 a7, v19
    v_accvgpr_read_b32 v18, a8
    v_mul_f32 v19, v18, v17
    v_accvgpr_write_b32 a8, v19
    v_accvgpr_read_b32 v18, a9
    v_mul_f32 v19, v18, v17
    v_accvgpr_write_b32 a9, v19
    v_accvgpr_read_b32 v18, a10
    v_mul_f32 v19, v18, v17
    v_accvgpr_write_b32 a10, v19
    v_accvgpr_read_b32 v18, a11
    v_mul_f32 v19, v18, v17
    v_accvgpr_write_b32 a11, v19
    v_accvgpr_read_b32 v18, a12
    v_mul_f32 v19, v18, v17
    v_accvgpr_write_b32 a12, v19
    v_accvgpr_read_b32 v18, a13
    v_mul_f32 v19, v18, v17
    v_accvgpr_write_b32 a13, v19
    v_accvgpr_read_b32 v18, a14
    v_mul_f32 v19, v18, v17
    v_accvgpr_write_b32 a14, v19
    v_accvgpr_read_b32 v18, a15
    v_mul_f32 v19, v18, v17
    v_accvgpr_write_b32 a15, v19
    v_accvgpr_read_b32 v18, a16
    v_mul_f32 v19, v18, v17
    v_accvgpr_write_b32 a16, v19
    v_accvgpr_read_b32 v18, a17
    v_mul_f32 v19, v18, v17
    v_accvgpr_write_b32 a17, v19
    v_accvgpr_read_b32 v18, a18
    v_mul_f32 v19, v18, v17
    v_accvgpr_write_b32 a18, v19
    v_accvgpr_read_b32 v18, a19
    v_mul_f32 v19, v18, v17
    v_accvgpr_write_b32 a19, v19
    v_accvgpr_read_b32 v18, a20
    v_mul_f32 v19, v18, v17
    v_accvgpr_write_b32 a20, v19
    v_accvgpr_read_b32 v18, a21
    v_mul_f32 v19, v18, v17
    v_accvgpr_write_b32 a21, v19
    v_accvgpr_read_b32 v18, a22
    v_mul_f32 v19, v18, v17
    v_accvgpr_write_b32 a22, v19
    v_accvgpr_read_b32 v18, a23
    v_mul_f32 v19, v18, v17
    v_accvgpr_write_b32 a23, v19
    v_accvgpr_read_b32 v18, a24
    v_mul_f32 v19, v18, v17
    v_accvgpr_write_b32 a24, v19
    v_accvgpr_read_b32 v18, a25
    v_mul_f32 v19, v18, v17
    v_accvgpr_write_b32 a25, v19
    v_accvgpr_read_b32 v18, a26
    v_mul_f32 v19, v18, v17
    v_accvgpr_write_b32 a26, v19
    v_accvgpr_read_b32 v18, a27
    v_mul_f32 v19, v18, v17
    v_accvgpr_write_b32 a27, v19
    v_accvgpr_read_b32 v18, a28
    v_mul_f32 v19, v18, v17
    v_accvgpr_write_b32 a28, v19
    v_accvgpr_read_b32 v18, a29
    v_mul_f32 v19, v18, v17
    v_accvgpr_write_b32 a29, v19
    v_accvgpr_read_b32 v18, a30
    v_mul_f32 v19, v18, v17
    v_accvgpr_write_b32 a30, v19
    v_accvgpr_read_b32 v18, a31
    v_mul_f32 v19, v18, v17
    v_accvgpr_write_b32 a31, v19
    v_accvgpr_read_b32 v18, a32
    v_mul_f32 v19, v18, v17
    v_accvgpr_write_b32 a32, v19
    v_accvgpr_read_b32 v18, a33
    v_mul_f32 v19, v18, v17
    v_accvgpr_write_b32 a33, v19
    v_accvgpr_read_b32 v18, a34
    v_mul_f32 v19, v18, v17
    v_accvgpr_write_b32 a34, v19
    v_accvgpr_read_b32 v18, a35
    v_mul_f32 v19, v18, v17
    v_accvgpr_write_b32 a35, v19
    v_accvgpr_read_b32 v18, a36
    v_mul_f32 v19, v18, v17
    v_accvgpr_write_b32 a36, v19
    v_accvgpr_read_b32 v18, a37
    v_mul_f32 v19, v18, v17
    v_accvgpr_write_b32 a37, v19
    v_accvgpr_read_b32 v18, a38
    v_mul_f32 v19, v18, v17
    v_accvgpr_write_b32 a38, v19
    v_accvgpr_read_b32 v18, a39
    v_mul_f32 v19, v18, v17
    v_accvgpr_write_b32 a39, v19
    v_accvgpr_read_b32 v18, a40
    v_mul_f32 v19, v18, v17
    v_accvgpr_write_b32 a40, v19
    v_accvgpr_read_b32 v18, a41
    v_mul_f32 v19, v18, v17
    v_accvgpr_write_b32 a41, v19
    v_accvgpr_read_b32 v18, a42
    v_mul_f32 v19, v18, v17
    v_accvgpr_write_b32 a42, v19
    v_accvgpr_read_b32 v18, a43
    v_mul_f32 v19, v18, v17
    v_accvgpr_write_b32 a43, v19
    v_accvgpr_read_b32 v18, a44
    v_mul_f32 v19, v18, v17
    v_accvgpr_write_b32 a44, v19
    v_accvgpr_read_b32 v18, a45
    v_mul_f32 v19, v18, v17
    v_accvgpr_write_b32 a45, v19
    v_accvgpr_read_b32 v18, a46
    v_mul_f32 v19, v18, v17
    v_accvgpr_write_b32 a46, v19
    v_accvgpr_read_b32 v18, a47
    v_mul_f32 v19, v18, v17
    v_accvgpr_write_b32 a47, v19
    v_accvgpr_read_b32 v18, a48
    v_mul_f32 v19, v18, v17
    v_accvgpr_write_b32 a48, v19
    v_accvgpr_read_b32 v18, a49
    v_mul_f32 v19, v18, v17
    v_accvgpr_write_b32 a49, v19
    v_accvgpr_read_b32 v18, a50
    v_mul_f32 v19, v18, v17
    v_accvgpr_write_b32 a50, v19
    v_accvgpr_read_b32 v18, a51
    v_mul_f32 v19, v18, v17
    v_accvgpr_write_b32 a51, v19
    v_accvgpr_read_b32 v18, a52
    v_mul_f32 v19, v18, v17
    v_accvgpr_write_b32 a52, v19
    v_accvgpr_read_b32 v18, a53
    v_mul_f32 v19, v18, v17
    v_accvgpr_write_b32 a53, v19
    v_accvgpr_read_b32 v18, a54
    v_mul_f32 v19, v18, v17
    v_accvgpr_write_b32 a54, v19
    v_accvgpr_read_b32 v18, a55
    v_mul_f32 v19, v18, v17
    v_accvgpr_write_b32 a55, v19
    v_accvgpr_read_b32 v18, a56
    v_mul_f32 v19, v18, v17
    v_accvgpr_write_b32 a56, v19
    v_accvgpr_read_b32 v18, a57
    v_mul_f32 v19, v18, v17
    v_accvgpr_write_b32 a57, v19
    v_accvgpr_read_b32 v18, a58
    v_mul_f32 v19, v18, v17
    v_accvgpr_write_b32 a58, v19
    v_accvgpr_read_b32 v18, a59
    v_mul_f32 v19, v18, v17
    v_accvgpr_write_b32 a59, v19
    v_accvgpr_read_b32 v18, a60
    v_mul_f32 v19, v18, v17
    v_accvgpr_write_b32 a60, v19
    v_accvgpr_read_b32 v18, a61
    v_mul_f32 v19, v18, v17
    v_accvgpr_write_b32 a61, v19
    v_accvgpr_read_b32 v18, a62
    v_mul_f32 v19, v18, v17
    v_accvgpr_write_b32 a62, v19
    v_accvgpr_read_b32 v18, a63
    v_mul_f32 v19, v18, v17
    v_accvgpr_write_b32 a63, v19
    v_mov_b32 v14, 0
    v_sub_f32 v18, v64, v16
    v_sub_f32 v19, v65, v16
    v_exp_f32 v18, v18
    v_exp_f32 v19, v19
    s_nop 0
    v_add_f32 v14, v14, v18
    v_add_f32 v14, v14, v19
    v_cvt_pk_bf16_f32 v96, v18, v19
    v_sub_f32 v18, v66, v16
    v_sub_f32 v19, v67, v16
    v_exp_f32 v18, v18
    v_exp_f32 v19, v19
    s_nop 0
    v_add_f32 v14, v14, v18
    v_add_f32 v14, v14, v19
    v_cvt_pk_bf16_f32 v97, v18, v19
    v_sub_f32 v18, v68, v16
    v_sub_f32 v19, v69, v16
    v_exp_f32 v18, v18
    v_exp_f32 v19, v19
    s_nop 0
    v_add_f32 v14, v14, v18
    v_add_f32 v14, v14, v19
    v_cvt_pk_bf16_f32 v98, v18, v19
    v_sub_f32 v18, v70, v16
    v_sub_f32 v19, v71, v16
    v_exp_f32 v18, v18
    v_exp_f32 v19, v19
    s_nop 0
    v_add_f32 v14, v14, v18
    v_add_f32 v14, v14, v19
    v_cvt_pk_bf16_f32 v99, v18, v19
    v_sub_f32 v18, v72, v16
    v_sub_f32 v19, v73, v16
    v_exp_f32 v18, v18
    v_exp_f32 v19, v19
    s_nop 0
    v_add_f32 v14, v14, v18
    v_add_f32 v14, v14, v19
    v_cvt_pk_bf16_f32 v100, v18, v19
    v_sub_f32 v18, v74, v16
    v_sub_f32 v19, v75, v16
    v_exp_f32 v18, v18
    v_exp_f32 v19, v19
    s_nop 0
    v_add_f32 v14, v14, v18
    v_add_f32 v14, v14, v19
    v_cvt_pk_bf16_f32 v101, v18, v19
    v_sub_f32 v18, v76, v16
    v_sub_f32 v19, v77, v16
    v_exp_f32 v18, v18
    v_exp_f32 v19, v19
    s_nop 0
    v_add_f32 v14, v14, v18
    v_add_f32 v14, v14, v19
    v_cvt_pk_bf16_f32 v102, v18, v19
    v_sub_f32 v18, v78, v16
    v_sub_f32 v19, v79, v16
    v_exp_f32 v18, v18
    v_exp_f32 v19, v19
    s_nop 0
    v_add_f32 v14, v14, v18
    v_add_f32 v14, v14, v19
    v_cvt_pk_bf16_f32 v103, v18, v19
    s_nop 3
    s_branch L_back12
L_slow13:
    s_nop 15
    s_nop 15
    v_max3_f32 v16, v80, v81, v82
    v_max3_f32 v16, v16, v83, v84
    v_max3_f32 v16, v16, v85, v86
    v_max3_f32 v16, v16, v87, v88
    v_max3_f32 v16, v16, v89, v90
    v_max3_f32 v16, v16, v91, v92
    v_max3_f32 v16, v16, v93, v94
    v_max_f32 v16, v16, v95
    v_mov_b32 v17, v16
    s_nop 1
    v_permlane32_swap_b32 v16, v17
    s_nop 1
    v_max3_f32 v16, v16, v17, 0
    v_exp_f32 v17, -v16
    s_nop 1
    v_sub_f32 v13, v13, v16
    v_mov_b32 v112, v13
    v_mov_b32 v113, v13
    v_mov_b32 v114, v13
    v_mov_b32 v115, v13
    v_mov_b32 v116, v13
    v_mov_b32 v117, v13
    v_mov_b32 v118, v13
    v_mov_b32 v119, v13
    v_mov_b32 v120, v13
    v_mov_b32 v121, v13
    v_mov_b32 v122, v13
    v_mov_b32 v123, v13
    v_mov_b32 v124, v13
    v_mov_b32 v125, v13
    v_mov_b32 v126, v13
    v_mov_b32 v127, v13
    v_sub_f32 v64, v64, v16
    v_sub_f32 v65, v65, v16
    v_sub_f32 v66, v66, v16
    v_sub_f32 v67, v67, v16
    v_sub_f32 v68, v68, v16
    v_sub_f32 v69, v69, v16
    v_sub_f32 v70, v70, v16
    v_sub_f32 v71, v71, v16
    v_sub_f32 v72, v72, v16
    v_sub_f32 v73, v73, v16
    v_sub_f32 v74, v74, v16
    v_sub_f32 v75, v75, v16
    v_sub_f32 v76, v76, v16
    v_sub_f32 v77, v77, v16
    v_sub_f32 v78, v78, v16
    v_sub_f32 v79, v79, v16
    v_mul_f32 v9, v9, v17
    v_accvgpr_read_b32 v18, a0
    v_mul_f32 v19, v18, v17
    v_accvgpr_write_b32 a0, v19
    v_accvgpr_read_b32 v18, a1
    v_mul_f32 v19, v18, v17
    v_accvgpr_write_b32 a1, v19
    v_accvgpr_read_b32 v18, a2
    v_mul_f32 v19, v18, v17
    v_accvgpr_write_b32 a2, v19
    v_accvgpr_read_b32 v18, a3
    v_mul_f32 v19, v18, v17
    v_accvgpr_write_b32 a3, v19
    v_accvgpr_read_b32 v18, a4
    v_mul_f32 v19, v18, v17
    v_accvgpr_write_b32 a4, v19
    v_accvgpr_read_b32 v18, a5
    v_mul_f32 v19, v18, v17
    v_accvgpr_write_b32 a5, v19
    v_accvgpr_read_b32 v18, a6
    v_mul_f32 v19, v18, v17
    v_accvgpr_write_b32 a6, v19
    v_accvgpr_read_b32 v18, a7
    v_mul_f32 v19, v18, v17
    v_accvgpr_write_b32 a7, v19
    v_accvgpr_read_b32 v18, a8
    v_mul_f32 v19, v18, v17
    v_accvgpr_write_b32 a8, v19
    v_accvgpr_read_b32 v18, a9
    v_mul_f32 v19, v18, v17
    v_accvgpr_write_b32 a9, v19
    v_accvgpr_read_b32 v18, a10
    v_mul_f32 v19, v18, v17
    v_accvgpr_write_b32 a10, v19
    v_accvgpr_read_b32 v18, a11
    v_mul_f32 v19, v18, v17
    v_accvgpr_write_b32 a11, v19
    v_accvgpr_read_b32 v18, a12
    v_mul_f32 v19, v18, v17
    v_accvgpr_write_b32 a12, v19
    v_accvgpr_read_b32 v18, a13
    v_mul_f32 v19, v18, v17
    v_accvgpr_write_b32 a13, v19
    v_accvgpr_read_b32 v18, a14
    v_mul_f32 v19, v18, v17
    v_accvgpr_write_b32 a14, v19
    v_accvgpr_read_b32 v18, a15
    v_mul_f32 v19, v18, v17
    v_accvgpr_write_b32 a15, v19
    v_accvgpr_read_b32 v18, a16
    v_mul_f32 v19, v18, v17
    v_accvgpr_write_b32 a16, v19
    v_accvgpr_read_b32 v18, a17
    v_mul_f32 v19, v18, v17
    v_accvgpr_write_b32 a17, v19
    v_accvgpr_read_b32 v18, a18
    v_mul_f32 v19, v18, v17
    v_accvgpr_write_b32 a18, v19
    v_accvgpr_read_b32 v18, a19
    v_mul_f32 v19, v18, v17
    v_accvgpr_write_b32 a19, v19
    v_accvgpr_read_b32 v18, a20
    v_mul_f32 v19, v18, v17
    v_accvgpr_write_b32 a20, v19
    v_accvgpr_read_b32 v18, a21
    v_mul_f32 v19, v18, v17
    v_accvgpr_write_b32 a21, v19
    v_accvgpr_read_b32 v18, a22
    v_mul_f32 v19, v18, v17
    v_accvgpr_write_b32 a22, v19
    v_accvgpr_read_b32 v18, a23
    v_mul_f32 v19, v18, v17
    v_accvgpr_write_b32 a23, v19
    v_accvgpr_read_b32 v18, a24
    v_mul_f32 v19, v18, v17
    v_accvgpr_write_b32 a24, v19
    v_accvgpr_read_b32 v18, a25
    v_mul_f32 v19, v18, v17
    v_accvgpr_write_b32 a25, v19
    v_accvgpr_read_b32 v18, a26
    v_mul_f32 v19, v18, v17
    v_accvgpr_write_b32 a26, v19
    v_accvgpr_read_b32 v18, a27
    v_mul_f32 v19, v18, v17
    v_accvgpr_write_b32 a27, v19
    v_accvgpr_read_b32 v18, a28
    v_mul_f32 v19, v18, v17
    v_accvgpr_write_b32 a28, v19
    v_accvgpr_read_b32 v18, a29
    v_mul_f32 v19, v18, v17
    v_accvgpr_write_b32 a29, v19
    v_accvgpr_read_b32 v18, a30
    v_mul_f32 v19, v18, v17
    v_accvgpr_write_b32 a30, v19
    v_accvgpr_read_b32 v18, a31
    v_mul_f32 v19, v18, v17
    v_accvgpr_write_b32 a31, v19
    v_accvgpr_read_b32 v18, a32
    v_mul_f32 v19, v18, v17
    v_accvgpr_write_b32 a32, v19
    v_accvgpr_read_b32 v18, a33
    v_mul_f32 v19, v18, v17
    v_accvgpr_write_b32 a33, v19
    v_accvgpr_read_b32 v18, a34
    v_mul_f32 v19, v18, v17
    v_accvgpr_write_b32 a34, v19
    v_accvgpr_read_b32 v18, a35
    v_mul_f32 v19, v18, v17
    v_accvgpr_write_b32 a35, v19
    v_accvgpr_read_b32 v18, a36
    v_mul_f32 v19, v18, v17
    v_accvgpr_write_b32 a36, v19
    v_accvgpr_read_b32 v18, a37
    v_mul_f32 v19, v18, v17
    v_accvgpr_write_b32 a37, v19
    v_accvgpr_read_b32 v18, a38
    v_mul_f32 v19, v18, v17
    v_accvgpr_write_b32 a38, v19
    v_accvgpr_read_b32 v18, a39
    v_mul_f32 v19, v18, v17
    v_accvgpr_write_b32 a39, v19
    v_accvgpr_read_b32 v18, a40
    v_mul_f32 v19, v18, v17
    v_accvgpr_write_b32 a40, v19
    v_accvgpr_read_b32 v18, a41
    v_mul_f32 v19, v18, v17
    v_accvgpr_write_b32 a41, v19
    v_accvgpr_read_b32 v18, a42
    v_mul_f32 v19, v18, v17
    v_accvgpr_write_b32 a42, v19
    v_accvgpr_read_b32 v18, a43
    v_mul_f32 v19, v18, v17
    v_accvgpr_write_b32 a43, v19
    v_accvgpr_read_b32 v18, a44
    v_mul_f32 v19, v18, v17
    v_accvgpr_write_b32 a44, v19
    v_accvgpr_read_b32 v18, a45
    v_mul_f32 v19, v18, v17
    v_accvgpr_write_b32 a45, v19
    v_accvgpr_read_b32 v18, a46
    v_mul_f32 v19, v18, v17
    v_accvgpr_write_b32 a46, v19
    v_accvgpr_read_b32 v18, a47
    v_mul_f32 v19, v18, v17
    v_accvgpr_write_b32 a47, v19
    v_accvgpr_read_b32 v18, a48
    v_mul_f32 v19, v18, v17
    v_accvgpr_write_b32 a48, v19
    v_accvgpr_read_b32 v18, a49
    v_mul_f32 v19, v18, v17
    v_accvgpr_write_b32 a49, v19
    v_accvgpr_read_b32 v18, a50
    v_mul_f32 v19, v18, v17
    v_accvgpr_write_b32 a50, v19
    v_accvgpr_read_b32 v18, a51
    v_mul_f32 v19, v18, v17
    v_accvgpr_write_b32 a51, v19
    v_accvgpr_read_b32 v18, a52
    v_mul_f32 v19, v18, v17
    v_accvgpr_write_b32 a52, v19
    v_accvgpr_read_b32 v18, a53
    v_mul_f32 v19, v18, v17
    v_accvgpr_write_b32 a53, v19
    v_accvgpr_read_b32 v18, a54
    v_mul_f32 v19, v18, v17
    v_accvgpr_write_b32 a54, v19
    v_accvgpr_read_b32 v18, a55
    v_mul_f32 v19, v18, v17
    v_accvgpr_write_b32 a55, v19
    v_accvgpr_read_b32 v18, a56
    v_mul_f32 v19, v18, v17
    v_accvgpr_write_b32 a56, v19
    v_accvgpr_read_b32 v18, a57
    v_mul_f32 v19, v18, v17
    v_accvgpr_write_b32 a57, v19
    v_accvgpr_read_b32 v18, a58
    v_mul_f32 v19, v18, v17
    v_accvgpr_write_b32 a58, v19
    v_accvgpr_read_b32 v18, a59
    v_mul_f32 v19, v18, v17
    v_accvgpr_write_b32 a59, v19
    v_accvgpr_read_b32 v18, a60
    v_mul_f32 v19, v18, v17
    v_accvgpr_write_b32 a60, v19
    v_accvgpr_read_b32 v18, a61
    v_mul_f32 v19, v18, v17
    v_accvgpr_write_b32 a61, v19
    v_accvgpr_read_b32 v18, a62
    v_mul_f32 v19, v18, v17
    v_accvgpr_write_b32 a62, v19
    v_accvgpr_read_b32 v18, a63
    v_mul_f32 v19, v18, v17
    v_accvgpr_write_b32 a63, v19
    v_mov_b32 v14, 0
    v_sub_f32 v18, v80, v16
    v_sub_f32 v19, v81, v16
    v_exp_f32 v18, v18
    v_exp_f32 v19, v19
    s_nop 0
    v_add_f32 v14, v14, v18
    v_add_f32 v14, v14, v19
    v_cvt_pk_bf16_f32 v104, v18, v19
    v_sub_f32 v18, v82, v16
    v_sub_f32 v19, v83, v16
    v_exp_f32 v18, v18
    v_exp_f32 v19, v19
    s_nop 0
    v_add_f32 v14, v14, v18
    v_add_f32 v14, v14, v19
    v_cvt_pk_bf16_f32 v105, v18, v19
    v_sub_f32 v18, v84, v16
    v_sub_f32 v19, v85, v16
    v_exp_f32 v18, v18
    v_exp_f32 v19, v19
    s_nop 0
    v_add_f32 v14, v14, v18
    v_add_f32 v14, v14, v19
    v_cvt_pk_bf16_f32 v106, v18, v19
    v_sub_f32 v18, v86, v16
    v_sub_f32 v19, v87, v16
    v_exp_f32 v18, v18
    v_exp_f32 v19, v19
    s_nop 0
    v_add_f32 v14, v14, v18
    v_add_f32 v14, v14, v19
    v_cvt_pk_bf16_f32 v107, v18, v19
    v_sub_f32 v18, v88, v16
    v_sub_f32 v19, v89, v16
    v_exp_f32 v18, v18
    v_exp_f32 v19, v19
    s_nop 0
    v_add_f32 v14, v14, v18
    v_add_f32 v14, v14, v19
    v_cvt_pk_bf16_f32 v108, v18, v19
    v_sub_f32 v18, v90, v16
    v_sub_f32 v19, v91, v16
    v_exp_f32 v18, v18
    v_exp_f32 v19, v19
    s_nop 0
    v_add_f32 v14, v14, v18
    v_add_f32 v14, v14, v19
    v_cvt_pk_bf16_f32 v109, v18, v19
    v_sub_f32 v18, v92, v16
    v_sub_f32 v19, v93, v16
    v_exp_f32 v18, v18
    v_exp_f32 v19, v19
    s_nop 0
    v_add_f32 v14, v14, v18
    v_add_f32 v14, v14, v19
    v_cvt_pk_bf16_f32 v110, v18, v19
    v_sub_f32 v18, v94, v16
    v_sub_f32 v19, v95, v16
    v_exp_f32 v18, v18
    v_exp_f32 v19, v19
    s_nop 0
    v_add_f32 v14, v14, v18
    v_add_f32 v14, v14, v19
    v_cvt_pk_bf16_f32 v111, v18, v19
    s_nop 3
    s_branch L_back13
L_slow14:
    s_nop 15
    s_nop 15
    v_max3_f32 v16, v64, v65, v66
    v_max3_f32 v16, v16, v67, v68
    v_max3_f32 v16, v16, v69, v70
    v_max3_f32 v16, v16, v71, v72
    v_max3_f32 v16, v16, v73, v74
    v_max3_f32 v16, v16, v75, v76
    v_max3_f32 v16, v16, v77, v78
    v_max_f32 v16, v16, v79
    v_mov_b32 v17, v16
    s_nop 1
    v_permlane32_swap_b32 v16, v17
    s_nop 1
    v_max3_f32 v16, v16, v17, 0
    v_exp_f32 v17, -v16
    s_nop 1
    v_sub_f32 v13, v13, v16
    v_mov_b32 v112, v13
    v_mov_b32 v113, v13
    v_mov_b32 v114, v13
    v_mov_b32 v115, v13
    v_mov_b32 v116, v13
    v_mov_b32 v117, v13
    v_mov_b32 v118, v13
    v_mov_b32 v119, v13
    v_mov_b32 v120, v13
    v_mov_b32 v121, v13
    v_mov_b32 v122, v13
    v_mov_b32 v123, v13
    v_mov_b32 v124, v13
    v_mov_b32 v125, v13
    v_mov_b32 v126, v13
    v_mov_b32 v127, v13
    v_sub_f32 v80, v80, v16
    v_sub_f32 v81, v81, v16
    v_sub_f32 v82, v82, v16
    v_sub_f32 v83, v83, v16
    v_sub_f32 v84, v84, v16
    v_sub_f32 v85, v85, v16
    v_sub_f32 v86, v86, v16
    v_sub_f32 v87, v87, v16
    v_sub_f32 v88, v88, v16
    v_sub_f32 v89, v89, v16
    v_sub_f32 v90, v90, v16
    v_sub_f32 v91, v91, v16
    v_sub_f32 v92, v92, v16
    v_sub_f32 v93, v93, v16
    v_sub_f32 v94, v94, v16
    v_sub_f32 v95, v95, v16
    v_mul_f32 v9, v9, v17
    v_accvgpr_read_b32 v18, a0
    v_mul_f32 v19, v18, v17
    v_accvgpr_write_b32 a0, v19
    v_accvgpr_read_b32 v18, a1
    v_mul_f32 v19, v18, v17
    v_accvgpr_write_b32 a1, v19
    v_accvgpr_read_b32 v18, a2
    v_mul_f32 v19, v18, v17
    v_accvgpr_write_b32 a2, v19
    v_accvgpr_read_b32 v18, a3
    v_mul_f32 v19, v18, v17
    v_accvgpr_write_b32 a3, v19
    v_accvgpr_read_b32 v18, a4
    v_mul_f32 v19, v18, v17
    v_accvgpr_write_b32 a4, v19
    v_accvgpr_read_b32 v18, a5
    v_mul_f32 v19, v18, v17
    v_accvgpr_write_b32 a5, v19
    v_accvgpr_read_b32 v18, a6
    v_mul_f32 v19, v18, v17
    v_accvgpr_write_b32 a6, v19
    v_accvgpr_read_b32 v18, a7
    v_mul_f32 v19, v18, v17
    v_accvgpr_write_b32 a7, v19
    v_accvgpr_read_b32 v18, a8
    v_mul_f32 v19, v18, v17
    v_accvgpr_write_b32 a8, v19
    v_accvgpr_read_b32 v18, a9
    v_mul_f32 v19, v18, v17
    v_accvgpr_write_b32 a9, v19
    v_accvgpr_read_b32 v18, a10
    v_mul_f32 v19, v18, v17
    v_accvgpr_write_b32 a10, v19
    v_accvgpr_read_b32 v18, a11
    v_mul_f32 v19, v18, v17
    v_accvgpr_write_b32 a11, v19
    v_accvgpr_read_b32 v18, a12
    v_mul_f32 v19, v18, v17
    v_accvgpr_write_b32 a12, v19
    v_accvgpr_read_b32 v18, a13
    v_mul_f32 v19, v18, v17
    v_accvgpr_write_b32 a13, v19
    v_accvgpr_read_b32 v18, a14
    v_mul_f32 v19, v18, v17
    v_accvgpr_write_b32 a14, v19
    v_accvgpr_read_b32 v18, a15
    v_mul_f32 v19, v18, v17
    v_accvgpr_write_b32 a15, v19
    v_accvgpr_read_b32 v18, a16
    v_mul_f32 v19, v18, v17
    v_accvgpr_write_b32 a16, v19
    v_accvgpr_read_b32 v18, a17
    v_mul_f32 v19, v18, v17
    v_accvgpr_write_b32 a17, v19
    v_accvgpr_read_b32 v18, a18
    v_mul_f32 v19, v18, v17
    v_accvgpr_write_b32 a18, v19
    v_accvgpr_read_b32 v18, a19
    v_mul_f32 v19, v18, v17
    v_accvgpr_write_b32 a19, v19
    v_accvgpr_read_b32 v18, a20
    v_mul_f32 v19, v18, v17
    v_accvgpr_write_b32 a20, v19
    v_accvgpr_read_b32 v18, a21
    v_mul_f32 v19, v18, v17
    v_accvgpr_write_b32 a21, v19
    v_accvgpr_read_b32 v18, a22
    v_mul_f32 v19, v18, v17
    v_accvgpr_write_b32 a22, v19
    v_accvgpr_read_b32 v18, a23
    v_mul_f32 v19, v18, v17
    v_accvgpr_write_b32 a23, v19
    v_accvgpr_read_b32 v18, a24
    v_mul_f32 v19, v18, v17
    v_accvgpr_write_b32 a24, v19
    v_accvgpr_read_b32 v18, a25
    v_mul_f32 v19, v18, v17
    v_accvgpr_write_b32 a25, v19
    v_accvgpr_read_b32 v18, a26
    v_mul_f32 v19, v18, v17
    v_accvgpr_write_b32 a26, v19
    v_accvgpr_read_b32 v18, a27
    v_mul_f32 v19, v18, v17
    v_accvgpr_write_b32 a27, v19
    v_accvgpr_read_b32 v18, a28
    v_mul_f32 v19, v18, v17
    v_accvgpr_write_b32 a28, v19
    v_accvgpr_read_b32 v18, a29
    v_mul_f32 v19, v18, v17
    v_accvgpr_write_b32 a29, v19
    v_accvgpr_read_b32 v18, a30
    v_mul_f32 v19, v18, v17
    v_accvgpr_write_b32 a30, v19
    v_accvgpr_read_b32 v18, a31
    v_mul_f32 v19, v18, v17
    v_accvgpr_write_b32 a31, v19
    v_accvgpr_read_b32 v18, a32
    v_mul_f32 v19, v18, v17
    v_accvgpr_write_b32 a32, v19
    v_accvgpr_read_b32 v18, a33
    v_mul_f32 v19, v18, v17
    v_accvgpr_write_b32 a33, v19
    v_accvgpr_read_b32 v18, a34
    v_mul_f32 v19, v18, v17
    v_accvgpr_write_b32 a34, v19
    v_accvgpr_read_b32 v18, a35
    v_mul_f32 v19, v18, v17
    v_accvgpr_write_b32 a35, v19
    v_accvgpr_read_b32 v18, a36
    v_mul_f32 v19, v18, v17
    v_accvgpr_write_b32 a36, v19
    v_accvgpr_read_b32 v18, a37
    v_mul_f32 v19, v18, v17
    v_accvgpr_write_b32 a37, v19
    v_accvgpr_read_b32 v18, a38
    v_mul_f32 v19, v18, v17
    v_accvgpr_write_b32 a38, v19
    v_accvgpr_read_b32 v18, a39
    v_mul_f32 v19, v18, v17
    v_accvgpr_write_b32 a39, v19
    v_accvgpr_read_b32 v18, a40
    v_mul_f32 v19, v18, v17
    v_accvgpr_write_b32 a40, v19
    v_accvgpr_read_b32 v18, a41
    v_mul_f32 v19, v18, v17
    v_accvgpr_write_b32 a41, v19
    v_accvgpr_read_b32 v18, a42
    v_mul_f32 v19, v18, v17
    v_accvgpr_write_b32 a42, v19
    v_accvgpr_read_b32 v18, a43
    v_mul_f32 v19, v18, v17
    v_accvgpr_write_b32 a43, v19
    v_accvgpr_read_b32 v18, a44
    v_mul_f32 v19, v18, v17
    v_accvgpr_write_b32 a44, v19
    v_accvgpr_read_b32 v18, a45
    v_mul_f32 v19, v18, v17
    v_accvgpr_write_b32 a45, v19
    v_accvgpr_read_b32 v18, a46
    v_mul_f32 v19, v18, v17
    v_accvgpr_write_b32 a46, v19
    v_accvgpr_read_b32 v18, a47
    v_mul_f32 v19, v18, v17
    v_accvgpr_write_b32 a47, v19
    v_accvgpr_read_b32 v18, a48
    v_mul_f32 v19, v18, v17
    v_accvgpr_write_b32 a48, v19
    v_accvgpr_read_b32 v18, a49
    v_mul_f32 v19, v18, v17
    v_accvgpr_write_b32 a49, v19
    v_accvgpr_read_b32 v18, a50
    v_mul_f32 v19, v18, v17
    v_accvgpr_write_b32 a50, v19
    v_accvgpr_read_b32 v18, a51
    v_mul_f32 v19, v18, v17
    v_accvgpr_write_b32 a51, v19
    v_accvgpr_read_b32 v18, a52
    v_mul_f32 v19, v18, v17
    v_accvgpr_write_b32 a52, v19
    v_accvgpr_read_b32 v18, a53
    v_mul_f32 v19, v18, v17
    v_accvgpr_write_b32 a53, v19
    v_accvgpr_read_b32 v18, a54
    v_mul_f32 v19, v18, v17
    v_accvgpr_write_b32 a54, v19
    v_accvgpr_read_b32 v18, a55
    v_mul_f32 v19, v18, v17
    v_accvgpr_write_b32 a55, v19
    v_accvgpr_read_b32 v18, a56
    v_mul_f32 v19, v18, v17
    v_accvgpr_write_b32 a56, v19
    v_accvgpr_read_b32 v18, a57
    v_mul_f32 v19, v18, v17
    v_accvgpr_write_b32 a57, v19
    v_accvgpr_read_b32 v18, a58
    v_mul_f32 v19, v18, v17
    v_accvgpr_write_b32 a58, v19
    v_accvgpr_read_b32 v18, a59
    v_mul_f32 v19, v18, v17
    v_accvgpr_write_b32 a59, v19
    v_accvgpr_read_b32 v18, a60
    v_mul_f32 v19, v18, v17
    v_accvgpr_write_b32 a60, v19
    v_accvgpr_read_b32 v18, a61
    v_mul_f32 v19, v18, v17
    v_accvgpr_write_b32 a61, v19
    v_accvgpr_read_b32 v18, a62
    v_mul_f32 v19, v18, v17
    v_accvgpr_write_b32 a62, v19
    v_accvgpr_read_b32 v18, a63
    v_mul_f32 v19, v18, v17
    v_accvgpr_write_b32 a63, v19
    v_mov_b32 v14, 0
    v_sub_f32 v18, v64, v16
    v_sub_f32 v19, v65, v16
    v_exp_f32 v18, v18
    v_exp_f32 v19, v19
    s_nop 0
    v_add_f32 v14, v14, v18
    v_add_f32 v14, v14, v19
    v_cvt_pk_bf16_f32 v96, v18, v19
    v_sub_f32 v18, v66, v16
    v_sub_f32 v19, v67, v16
    v_exp_f32 v18, v18
    v_exp_f32 v19, v19
    s_nop 0
    v_add_f32 v14, v14, v18
    v_add_f32 v14, v14, v19
    v_cvt_pk_bf16_f32 v97, v18, v19
    v_sub_f32 v18, v68, v16
    v_sub_f32 v19, v69, v16
    v_exp_f32 v18, v18
    v_exp_f32 v19, v19
    s_nop 0
    v_add_f32 v14, v14, v18
    v_add_f32 v14, v14, v19
    v_cvt_pk_bf16_f32 v98, v18, v19
    v_sub_f32 v18, v70, v16
    v_sub_f32 v19, v71, v16
    v_exp_f32 v18, v18
    v_exp_f32 v19, v19
    s_nop 0
    v_add_f32 v14, v14, v18
    v_add_f32 v14, v14, v19
    v_cvt_pk_bf16_f32 v99, v18, v19
    v_sub_f32 v18, v72, v16
    v_sub_f32 v19, v73, v16
    v_exp_f32 v18, v18
    v_exp_f32 v19, v19
    s_nop 0
    v_add_f32 v14, v14, v18
    v_add_f32 v14, v14, v19
    v_cvt_pk_bf16_f32 v100, v18, v19
    v_sub_f32 v18, v74, v16
    v_sub_f32 v19, v75, v16
    v_exp_f32 v18, v18
    v_exp_f32 v19, v19
    s_nop 0
    v_add_f32 v14, v14, v18
    v_add_f32 v14, v14, v19
    v_cvt_pk_bf16_f32 v101, v18, v19
    v_sub_f32 v18, v76, v16
    v_sub_f32 v19, v77, v16
    v_exp_f32 v18, v18
    v_exp_f32 v19, v19
    s_nop 0
    v_add_f32 v14, v14, v18
    v_add_f32 v14, v14, v19
    v_cvt_pk_bf16_f32 v102, v18, v19
    v_sub_f32 v18, v78, v16
    v_sub_f32 v19, v79, v16
    v_exp_f32 v18, v18
    v_exp_f32 v19, v19
    s_nop 0
    v_add_f32 v14, v14, v18
    v_add_f32 v14, v14, v19
    v_cvt_pk_bf16_f32 v103, v18, v19
    s_nop 3
    s_branch L_back14
L_slow15:
    s_nop 15
    s_nop 15
    v_max3_f32 v16, v80, v81, v82
    v_max3_f32 v16, v16, v83, v84
    v_max3_f32 v16, v16, v85, v86
    v_max3_f32 v16, v16, v87, v88
    v_max3_f32 v16, v16, v89, v90
    v_max3_f32 v16, v16, v91, v92
    v_max3_f32 v16, v16, v93, v94
    v_max_f32 v16, v16, v95
    v_mov_b32 v17, v16
    s_nop 1
    v_permlane32_swap_b32 v16, v17
    s_nop 1
    v_max3_f32 v16, v16, v17, 0
    v_exp_f32 v17, -v16
    s_nop 1
    v_mul_f32 v9, v9, v17
    v_accvgpr_read_b32 v18, a0
    v_mul_f32 v19, v18, v17
    v_accvgpr_write_b32 a0, v19
    v_accvgpr_read_b32 v18, a1
    v_mul_f32 v19, v18, v17
    v_accvgpr_write_b32 a1, v19
    v_accvgpr_read_b32 v18, a2
    v_mul_f32 v19, v18, v17
    v_accvgpr_write_b32 a2, v19
    v_accvgpr_read_b32 v18, a3
    v_mul_f32 v19, v18, v17
    v_accvgpr_write_b32 a3, v19
    v_accvgpr_read_b32 v18, a4
    v_mul_f32 v19, v18, v17
    v_accvgpr_write_b32 a4, v19
    v_accvgpr_read_b32 v18, a5
    v_mul_f32 v19, v18, v17
    v_accvgpr_write_b32 a5, v19
    v_accvgpr_read_b32 v18, a6
    v_mul_f32 v19, v18, v17
    v_accvgpr_write_b32 a6, v19
    v_accvgpr_read_b32 v18, a7
    v_mul_f32 v19, v18, v17
    v_accvgpr_write_b32 a7, v19
    v_accvgpr_read_b32 v18, a8
    v_mul_f32 v19, v18, v17
    v_accvgpr_write_b32 a8, v19
    v_accvgpr_read_b32 v18, a9
    v_mul_f32 v19, v18, v17
    v_accvgpr_write_b32 a9, v19
    v_accvgpr_read_b32 v18, a10
    v_mul_f32 v19, v18, v17
    v_accvgpr_write_b32 a10, v19
    v_accvgpr_read_b32 v18, a11
    v_mul_f32 v19, v18, v17
    v_accvgpr_write_b32 a11, v19
    v_accvgpr_read_b32 v18, a12
    v_mul_f32 v19, v18, v17
    v_accvgpr_write_b32 a12, v19
    v_accvgpr_read_b32 v18, a13
    v_mul_f32 v19, v18, v17
    v_accvgpr_write_b32 a13, v19
    v_accvgpr_read_b32 v18, a14
    v_mul_f32 v19, v18, v17
    v_accvgpr_write_b32 a14, v19
    v_accvgpr_read_b32 v18, a15
    v_mul_f32 v19, v18, v17
    v_accvgpr_write_b32 a15, v19
    v_accvgpr_read_b32 v18, a16
    v_mul_f32 v19, v18, v17
    v_accvgpr_write_b32 a16, v19
    v_accvgpr_read_b32 v18, a17
    v_mul_f32 v19, v18, v17
    v_accvgpr_write_b32 a17, v19
    v_accvgpr_read_b32 v18, a18
    v_mul_f32 v19, v18, v17
    v_accvgpr_write_b32 a18, v19
    v_accvgpr_read_b32 v18, a19
    v_mul_f32 v19, v18, v17
    v_accvgpr_write_b32 a19, v19
    v_accvgpr_read_b32 v18, a20
    v_mul_f32 v19, v18, v17
    v_accvgpr_write_b32 a20, v19
    v_accvgpr_read_b32 v18, a21
    v_mul_f32 v19, v18, v17
    v_accvgpr_write_b32 a21, v19
    v_accvgpr_read_b32 v18, a22
    v_mul_f32 v19, v18, v17
    v_accvgpr_write_b32 a22, v19
    v_accvgpr_read_b32 v18, a23
    v_mul_f32 v19, v18, v17
    v_accvgpr_write_b32 a23, v19
    v_accvgpr_read_b32 v18, a24
    v_mul_f32 v19, v18, v17
    v_accvgpr_write_b32 a24, v19
    v_accvgpr_read_b32 v18, a25
    v_mul_f32 v19, v18, v17
    v_accvgpr_write_b32 a25, v19
    v_accvgpr_read_b32 v18, a26
    v_mul_f32 v19, v18, v17
    v_accvgpr_write_b32 a26, v19
    v_accvgpr_read_b32 v18, a27
    v_mul_f32 v19, v18, v17
    v_accvgpr_write_b32 a27, v19
    v_accvgpr_read_b32 v18, a28
    v_mul_f32 v19, v18, v17
    v_accvgpr_write_b32 a28, v19
    v_accvgpr_read_b32 v18, a29
    v_mul_f32 v19, v18, v17
    v_accvgpr_write_b32 a29, v19
    v_accvgpr_read_b32 v18, a30
    v_mul_f32 v19, v18, v17
    v_accvgpr_write_b32 a30, v19
    v_accvgpr_read_b32 v18, a31
    v_mul_f32 v19, v18, v17
    v_accvgpr_write_b32 a31, v19
    v_accvgpr_read_b32 v18, a32
    v_mul_f32 v19, v18, v17
    v_accvgpr_write_b32 a32, v19
    v_accvgpr_read_b32 v18, a33
    v_mul_f32 v19, v18, v17
    v_accvgpr_write_b32 a33, v19
    v_accvgpr_read_b32 v18, a34
    v_mul_f32 v19, v18, v17
    v_accvgpr_write_b32 a34, v19
    v_accvgpr_read_b32 v18, a35
    v_mul_f32 v19, v18, v17
    v_accvgpr_write_b32 a35, v19
    v_accvgpr_read_b32 v18, a36
    v_mul_f32 v19, v18, v17
    v_accvgpr_write_b32 a36, v19
    v_accvgpr_read_b32 v18, a37
    v_mul_f32 v19, v18, v17
    v_accvgpr_write_b32 a37, v19
    v_accvgpr_read_b32 v18, a38
    v_mul_f32 v19, v18, v17
    v_accvgpr_write_b32 a38, v19
    v_accvgpr_read_b32 v18, a39
    v_mul_f32 v19, v18, v17
    v_accvgpr_write_b32 a39, v19
    v_accvgpr_read_b32 v18, a40
    v_mul_f32 v19, v18, v17
    v_accvgpr_write_b32 a40, v19
    v_accvgpr_read_b32 v18, a41
    v_mul_f32 v19, v18, v17
    v_accvgpr_write_b32 a41, v19
    v_accvgpr_read_b32 v18, a42
    v_mul_f32 v19, v18, v17
    v_accvgpr_write_b32 a42, v19
    v_accvgpr_read_b32 v18, a43
    v_mul_f32 v19, v18, v17
    v_accvgpr_write_b32 a43, v19
    v_accvgpr_read_b32 v18, a44
    v_mul_f32 v19, v18, v17
    v_accvgpr_write_b32 a44, v19
    v_accvgpr_read_b32 v18, a45
    v_mul_f32 v19, v18, v17
    v_accvgpr_write_b32 a45, v19
    v_accvgpr_read_b32 v18, a46
    v_mul_f32 v19, v18, v17
    v_accvgpr_write_b32 a46, v19
    v_accvgpr_read_b32 v18, a47
    v_mul_f32 v19, v18, v17
    v_accvgpr_write_b32 a47, v19
    v_accvgpr_read_b32 v18, a48
    v_mul_f32 v19, v18, v17
    v_accvgpr_write_b32 a48, v19
    v_accvgpr_read_b32 v18, a49
    v_mul_f32 v19, v18, v17
    v_accvgpr_write_b32 a49, v19
    v_accvgpr_read_b32 v18, a50
    v_mul_f32 v19, v18, v17
    v_accvgpr_write_b32 a50, v19
    v_accvgpr_read_b32 v18, a51
    v_mul_f32 v19, v18, v17
    v_accvgpr_write_b32 a51, v19
    v_accvgpr_read_b32 v18, a52
    v_mul_f32 v19, v18, v17
    v_accvgpr_write_b32 a52, v19
    v_accvgpr_read_b32 v18, a53
    v_mul_f32 v19, v18, v17
    v_accvgpr_write_b32 a53, v19
    v_accvgpr_read_b32 v18, a54
    v_mul_f32 v19, v18, v17
    v_accvgpr_write_b32 a54, v19
    v_accvgpr_read_b32 v18, a55
    v_mul_f32 v19, v18, v17
    v_accvgpr_write_b32 a55, v19
    v_accvgpr_read_b32 v18, a56
    v_mul_f32 v19, v18, v17
    v_accvgpr_write_b32 a56, v19
    v_accvgpr_read_b32 v18, a57
    v_mul_f32 v19, v18, v17
    v_accvgpr_write_b32 a57, v19
    v_accvgpr_read_b32 v18, a58
    v_mul_f32 v19, v18, v17
    v_accvgpr_write_b32 a58, v19
    v_accvgpr_read_b32 v18, a59
    v_mul_f32 v19, v18, v17
    v_accvgpr_write_b32 a59, v19
    v_accvgpr_read_b32 v18, a60
    v_mul_f32 v19, v18, v17
    v_accvgpr_write_b32 a60, v19
    v_accvgpr_read_b32 v18, a61
    v_mul_f32 v19, v18, v17
    v_accvgpr_write_b32 a61, v19
    v_accvgpr_read_b32 v18, a62
    v_mul_f32 v19, v18, v17
    v_accvgpr_write_b32 a62, v19
    v_accvgpr_read_b32 v18, a63
    v_mul_f32 v19, v18, v17
    v_accvgpr_write_b32 a63, v19
    v_mov_b32 v14, 0
    v_sub_f32 v18, v80, v16
    v_sub_f32 v19, v81, v16
    v_exp_f32 v18, v18
    v_exp_f32 v19, v19
    s_nop 0
    v_add_f32 v14, v14, v18
    v_add_f32 v14, v14, v19
    v_cvt_pk_bf16_f32 v104, v18, v19
    v_sub_f32 v18, v82, v16
    v_sub_f32 v19, v83, v16
    v_exp_f32 v18, v18
    v_exp_f32 v19, v19
    s_nop 0
    v_add_f32 v14, v14, v18
    v_add_f32 v14, v14, v19
    v_cvt_pk_bf16_f32 v105, v18, v19
    v_sub_f32 v18, v84, v16
    v_sub_f32 v19, v85, v16
    v_exp_f32 v18, v18
    v_exp_f32 v19, v19
    s_nop 0
    v_add_f32 v14, v14, v18
    v_add_f32 v14, v14, v19
    v_cvt_pk_bf16_f32 v106, v18, v19
    v_sub_f32 v18, v86, v16
    v_sub_f32 v19, v87, v16
    v_exp_f32 v18, v18
    v_exp_f32 v19, v19
    s_nop 0
    v_add_f32 v14, v14, v18
    v_add_f32 v14, v14, v19
    v_cvt_pk_bf16_f32 v107, v18, v19
    v_sub_f32 v18, v88, v16
    v_sub_f32 v19, v89, v16
    v_exp_f32 v18, v18
    v_exp_f32 v19, v19
    s_nop 0
    v_add_f32 v14, v14, v18
    v_add_f32 v14, v14, v19
    v_cvt_pk_bf16_f32 v108, v18, v19
    v_sub_f32 v18, v90, v16
    v_sub_f32 v19, v91, v16
    v_exp_f32 v18, v18
    v_exp_f32 v19, v19
    s_nop 0
    v_add_f32 v14, v14, v18
    v_add_f32 v14, v14, v19
    v_cvt_pk_bf16_f32 v109, v18, v19
    v_sub_f32 v18, v92, v16
    v_sub_f32 v19, v93, v16
    v_exp_f32 v18, v18
    v_exp_f32 v19, v19
    s_nop 0
    v_add_f32 v14, v14, v18
    v_add_f32 v14, v14, v19
    v_cvt_pk_bf16_f32 v110, v18, v19
    v_sub_f32 v18, v94, v16
    v_sub_f32 v19, v95, v16
    v_exp_f32 v18, v18
    v_exp_f32 v19, v19
    s_nop 0
    v_add_f32 v14, v14, v18
    v_add_f32 v14, v14, v19
    v_cvt_pk_bf16_f32 v111, v18, v19
    s_nop 3
    s_branch L_back15
L_slow17:
    s_nop 15
    s_nop 15
    v_max3_f32 v16, v80, v81, v82
    v_max3_f32 v16, v16, v83, v84
    v_max3_f32 v16, v16, v85, v86
    v_max3_f32 v16, v16, v87, v88
    v_max3_f32 v16, v16, v89, v90
    v_max3_f32 v16, v16, v91, v92
    v_max3_f32 v16, v16, v93, v94
    v_max_f32 v16, v16, v95
    v_mov_b32 v17, v16
    s_nop 1
    v_permlane32_swap_b32 v16, v17
    s_nop 1
    v_max3_f32 v16, v16, v17, 0
    v_exp_f32 v17, -v16
    s_nop 1
    v_sub_f32 v13, v13, v16
    v_mov_b32 v112, v13
    v_mov_b32 v113, v13
    v_mov_b32 v114, v13
    v_mov_b32 v115, v13
    v_mov_b32 v116, v13
    v_mov_b32 v117, v13
    v_mov_b32 v118, v13
    v_mov_b32 v119, v13
    v_mov_b32 v120, v13
    v_mov_b32 v121, v13
    v_mov_b32 v122, v13
    v_mov_b32 v123, v13
    v_mov_b32 v124, v13
    v_mov_b32 v125, v13
    v_mov_b32 v126, v13
    v_mov_b32 v127, v13
    v_sub_f32 v64, v64, v16
    v_sub_f32 v65, v65, v16
    v_sub_f32 v66, v66, v16
    v_sub_f32 v67, v67, v16
    v_sub_f32 v68, v68, v16
    v_sub_f32 v69, v69, v16
    v_sub_f32 v70, v70, v16
    v_sub_f32 v71, v71, v16
    v_sub_f32 v72, v72, v16
    v_sub_f32 v73, v73, v16
    v_sub_f32 v74, v74, v16
    v_sub_f32 v75, v75, v16
    v_sub_f32 v76, v76, v16
    v_sub_f32 v77, v77, v16
    v_sub_f32 v78, v78, v16
    v_sub_f32 v79, v79, v16
    v_mul_f32 v12, v12, v17
    v_accvgpr_read_b32 v18, a0
    v_mul_f32 v19, v18, v17
    v_accvgpr_write_b32 a0, v19
    v_accvgpr_read_b32 v18, a1
    v_mul_f32 v19, v18, v17
    v_accvgpr_write_b32 a1, v19
    v_accvgpr_read_b32 v18, a2
    v_mul_f32 v19, v18, v17
    v_accvgpr_write_b32 a2, v19
    v_accvgpr_read_b32 v18, a3
    v_mul_f32 v19, v18, v17
    v_accvgpr_write_b32 a3, v19
    v_accvgpr_read_b32 v18, a4
    v_mul_f32 v19, v18, v17
    v_accvgpr_write_b32 a4, v19
    v_accvgpr_read_b32 v18, a5
    v_mul_f32 v19, v18, v17
    v_accvgpr_write_b32 a5, v19
    v_accvgpr_read_b32 v18, a6
    v_mul_f32 v19, v18, v17
    v_accvgpr_write_b32 a6, v19
    v_accvgpr_read_b32 v18, a7
    v_mul_f32 v19, v18, v17
    v_accvgpr_write_b32 a7, v19
    v_accvgpr_read_b32 v18, a8
    v_mul_f32 v19, v18, v17
    v_accvgpr_write_b32 a8, v19
    v_accvgpr_read_b32 v18, a9
    v_mul_f32 v19, v18, v17
    v_accvgpr_write_b32 a9, v19
    v_accvgpr_read_b32 v18, a10
    v_mul_f32 v19, v18, v17
    v_accvgpr_write_b32 a10, v19
    v_accvgpr_read_b32 v18, a11
    v_mul_f32 v19, v18, v17
    v_accvgpr_write_b32 a11, v19
    v_accvgpr_read_b32 v18, a12
    v_mul_f32 v19, v18, v17
    v_accvgpr_write_b32 a12, v19
    v_accvgpr_read_b32 v18, a13
    v_mul_f32 v19, v18, v17
    v_accvgpr_write_b32 a13, v19
    v_accvgpr_read_b32 v18, a14
    v_mul_f32 v19, v18, v17
    v_accvgpr_write_b32 a14, v19
    v_accvgpr_read_b32 v18, a15
    v_mul_f32 v19, v18, v17
    v_accvgpr_write_b32 a15, v19
    v_accvgpr_read_b32 v18, a16
    v_mul_f32 v19, v18, v17
    v_accvgpr_write_b32 a16, v19
    v_accvgpr_read_b32 v18, a17
    v_mul_f32 v19, v18, v17
    v_accvgpr_write_b32 a17, v19
    v_accvgpr_read_b32 v18, a18
    v_mul_f32 v19, v18, v17
    v_accvgpr_write_b32 a18, v19
    v_accvgpr_read_b32 v18, a19
    v_mul_f32 v19, v18, v17
    v_accvgpr_write_b32 a19, v19
    v_accvgpr_read_b32 v18, a20
    v_mul_f32 v19, v18, v17
    v_accvgpr_write_b32 a20, v19
    v_accvgpr_read_b32 v18, a21
    v_mul_f32 v19, v18, v17
    v_accvgpr_write_b32 a21, v19
    v_accvgpr_read_b32 v18, a22
    v_mul_f32 v19, v18, v17
    v_accvgpr_write_b32 a22, v19
    v_accvgpr_read_b32 v18, a23
    v_mul_f32 v19, v18, v17
    v_accvgpr_write_b32 a23, v19
    v_accvgpr_read_b32 v18, a24
    v_mul_f32 v19, v18, v17
    v_accvgpr_write_b32 a24, v19
    v_accvgpr_read_b32 v18, a25
    v_mul_f32 v19, v18, v17
    v_accvgpr_write_b32 a25, v19
    v_accvgpr_read_b32 v18, a26
    v_mul_f32 v19, v18, v17
    v_accvgpr_write_b32 a26, v19
    v_accvgpr_read_b32 v18, a27
    v_mul_f32 v19, v18, v17
    v_accvgpr_write_b32 a27, v19
    v_accvgpr_read_b32 v18, a28
    v_mul_f32 v19, v18, v17
    v_accvgpr_write_b32 a28, v19
    v_accvgpr_read_b32 v18, a29
    v_mul_f32 v19, v18, v17
    v_accvgpr_write_b32 a29, v19
    v_accvgpr_read_b32 v18, a30
    v_mul_f32 v19, v18, v17
    v_accvgpr_write_b32 a30, v19
    v_accvgpr_read_b32 v18, a31
    v_mul_f32 v19, v18, v17
    v_accvgpr_write_b32 a31, v19
    v_accvgpr_read_b32 v18, a32
    v_mul_f32 v19, v18, v17
    v_accvgpr_write_b32 a32, v19
    v_accvgpr_read_b32 v18, a33
    v_mul_f32 v19, v18, v17
    v_accvgpr_write_b32 a33, v19
    v_accvgpr_read_b32 v18, a34
    v_mul_f32 v19, v18, v17
    v_accvgpr_write_b32 a34, v19
    v_accvgpr_read_b32 v18, a35
    v_mul_f32 v19, v18, v17
    v_accvgpr_write_b32 a35, v19
    v_accvgpr_read_b32 v18, a36
    v_mul_f32 v19, v18, v17
    v_accvgpr_write_b32 a36, v19
    v_accvgpr_read_b32 v18, a37
    v_mul_f32 v19, v18, v17
    v_accvgpr_write_b32 a37, v19
    v_accvgpr_read_b32 v18, a38
    v_mul_f32 v19, v18, v17
    v_accvgpr_write_b32 a38, v19
    v_accvgpr_read_b32 v18, a39
    v_mul_f32 v19, v18, v17
    v_accvgpr_write_b32 a39, v19
    v_accvgpr_read_b32 v18, a40
    v_mul_f32 v19, v18, v17
    v_accvgpr_write_b32 a40, v19
    v_accvgpr_read_b32 v18, a41
    v_mul_f32 v19, v18, v17
    v_accvgpr_write_b32 a41, v19
    v_accvgpr_read_b32 v18, a42
    v_mul_f32 v19, v18, v17
    v_accvgpr_write_b32 a42, v19
    v_accvgpr_read_b32 v18, a43
    v_mul_f32 v19, v18, v17
    v_accvgpr_write_b32 a43, v19
    v_accvgpr_read_b32 v18, a44
    v_mul_f32 v19, v18, v17
    v_accvgpr_write_b32 a44, v19
    v_accvgpr_read_b32 v18, a45
    v_mul_f32 v19, v18, v17
    v_accvgpr_write_b32 a45, v19
    v_accvgpr_read_b32 v18, a46
    v_mul_f32 v19, v18, v17
    v_accvgpr_write_b32 a46, v19
    v_accvgpr_read_b32 v18, a47
    v_mul_f32 v19, v18, v17
    v_accvgpr_write_b32 a47, v19
    v_accvgpr_read_b32 v18, a48
    v_mul_f32 v19, v18, v17
    v_accvgpr_write_b32 a48, v19
    v_accvgpr_read_b32 v18, a49
    v_mul_f32 v19, v18, v17
    v_accvgpr_write_b32 a49, v19
    v_accvgpr_read_b32 v18, a50
    v_mul_f32 v19, v18, v17
    v_accvgpr_write_b32 a50, v19
    v_accvgpr_read_b32 v18, a51
    v_mul_f32 v19, v18, v17
    v_accvgpr_write_b32 a51, v19
    v_accvgpr_read_b32 v18, a52
    v_mul_f32 v19, v18, v17
    v_accvgpr_write_b32 a52, v19
    v_accvgpr_read_b32 v18, a53
    v_mul_f32 v19, v18, v17
    v_accvgpr_write_b32 a53, v19
    v_accvgpr_read_b32 v18, a54
    v_mul_f32 v19, v18, v17
    v_accvgpr_write_b32 a54, v19
    v_accvgpr_read_b32 v18, a55
    v_mul_f32 v19, v18, v17
    v_accvgpr_write_b32 a55, v19
    v_accvgpr_read_b32 v18, a56
    v_mul_f32 v19, v18, v17
    v_accvgpr_write_b32 a56, v19
    v_accvgpr_read_b32 v18, a57
    v_mul_f32 v19, v18, v17
    v_accvgpr_write_b32 a57, v19
    v_accvgpr_read_b32 v18, a58
    v_mul_f32 v19, v18, v17
    v_accvgpr_write_b32 a58, v19
    v_accvgpr_read_b32 v18, a59
    v_mul_f32 v19, v18, v17
    v_accvgpr_write_b32 a59, v19
    v_accvgpr_read_b32 v18, a60
    v_mul_f32 v19, v18, v17
    v_accvgpr_write_b32 a60, v19
    v_accvgpr_read_b32 v18, a61
    v_mul_f32 v19, v18, v17
    v_accvgpr_write_b32 a61, v19
    v_accvgpr_read_b32 v18, a62
    v_mul_f32 v19, v18, v17
    v_accvgpr_write_b32 a62, v19
    v_accvgpr_read_b32 v18, a63
    v_mul_f32 v19, v18, v17
    v_accvgpr_write_b32 a63, v19
    v_mov_b32 v14, 0
    v_sub_f32 v18, v80, v16
    v_sub_f32 v19, v81, v16
    v_exp_f32 v18, v18
    v_exp_f32 v19, v19
    s_nop 0
    v_add_f32 v14, v14, v18
    v_add_f32 v14, v14, v19
    v_cvt_pk_bf16_f32 v104, v18, v19
    v_sub_f32 v18, v82, v16
    v_sub_f32 v19, v83, v16
    v_exp_f32 v18, v18
    v_exp_f32 v19, v19
    s_nop 0
    v_add_f32 v14, v14, v18
    v_add_f32 v14, v14, v19
    v_cvt_pk_bf16_f32 v105, v18, v19
    v_sub_f32 v18, v84, v16
    v_sub_f32 v19, v85, v16
    v_exp_f32 v18, v18
    v_exp_f32 v19, v19
    s_nop 0
    v_add_f32 v14, v14, v18
    v_add_f32 v14, v14, v19
    v_cvt_pk_bf16_f32 v106, v18, v19
    v_sub_f32 v18, v86, v16
    v_sub_f32 v19, v87, v16
    v_exp_f32 v18, v18
    v_exp_f32 v19, v19
    s_nop 0
    v_add_f32 v14, v14, v18
    v_add_f32 v14, v14, v19
    v_cvt_pk_bf16_f32 v107, v18, v19
    v_sub_f32 v18, v88, v16
    v_sub_f32 v19, v89, v16
    v_exp_f32 v18, v18
    v_exp_f32 v19, v19
    s_nop 0
    v_add_f32 v14, v14, v18
    v_add_f32 v14, v14, v19
    v_cvt_pk_bf16_f32 v108, v18, v19
    v_sub_f32 v18, v90, v16
    v_sub_f32 v19, v91, v16
    v_exp_f32 v18, v18
    v_exp_f32 v19, v19
    s_nop 0
    v_add_f32 v14, v14, v18
    v_add_f32 v14, v14, v19
    v_cvt_pk_bf16_f32 v109, v18, v19
    v_sub_f32 v18, v92, v16
    v_sub_f32 v19, v93, v16
    v_exp_f32 v18, v18
    v_exp_f32 v19, v19
    s_nop 0
    v_add_f32 v14, v14, v18
    v_add_f32 v14, v14, v19
    v_cvt_pk_bf16_f32 v110, v18, v19
    v_sub_f32 v18, v94, v16
    v_sub_f32 v19, v95, v16
    v_exp_f32 v18, v18
    v_exp_f32 v19, v19
    s_nop 0
    v_add_f32 v14, v14, v18
    v_add_f32 v14, v14, v19
    v_cvt_pk_bf16_f32 v111, v18, v19
    s_nop 3
    s_branch L_back17
L_slow18:
    s_nop 15
    s_nop 15
    v_max3_f32 v16, v64, v65, v66
    v_max3_f32 v16, v16, v67, v68
    v_max3_f32 v16, v16, v69, v70
    v_max3_f32 v16, v16, v71, v72
    v_max3_f32 v16, v16, v73, v74
    v_max3_f32 v16, v16, v75, v76
    v_max3_f32 v16, v16, v77, v78
    v_max_f32 v16, v16, v79
    v_mov_b32 v17, v16
    s_nop 1
    v_permlane32_swap_b32 v16, v17
    s_nop 1
    v_max3_f32 v16, v16, v17, 0
    v_exp_f32 v17, -v16
    s_nop 1
    v_sub_f32 v13, v13, v16
    v_mov_b32 v112, v13
    v_mov_b32 v113, v13
    v_mov_b32 v114, v13
    v_mov_b32 v115, v13
    v_mov_b32 v116, v13
    v_mov_b32 v117, v13
    v_mov_b32 v118, v13
    v_mov_b32 v119, v13
    v_mov_b32 v120, v13
    v_mov_b32 v121, v13
    v_mov_b32 v122, v13
    v_mov_b32 v123, v13
    v_mov_b32 v124, v13
    v_mov_b32 v125, v13
    v_mov_b32 v126, v13
    v_mov_b32 v127, v13
    v_sub_f32 v80, v80, v16
    v_sub_f32 v81, v81, v16
    v_sub_f32 v82, v82, v16
    v_sub_f32 v83, v83, v16
    v_sub_f32 v84, v84, v16
    v_sub_f32 v85, v85, v16
    v_sub_f32 v86, v86, v16
    v_sub_f32 v87, v87, v16
    v_sub_f32 v88, v88, v16
    v_sub_f32 v89, v89, v16
    v_sub_f32 v90, v90, v16
    v_sub_f32 v91, v91, v16
    v_sub_f32 v92, v92, v16
    v_sub_f32 v93, v93, v16
    v_sub_f32 v94, v94, v16
    v_sub_f32 v95, v95, v16
    v_mul_f32 v12, v12, v17
    v_accvgpr_read_b32 v18, a0
    v_mul_f32 v19, v18, v17
    v_accvgpr_write_b32 a0, v19
    v_accvgpr_read_b32 v18, a1
    v_mul_f32 v19, v18, v17
    v_accvgpr_write_b32 a1, v19
    v_accvgpr_read_b32 v18, a2
    v_mul_f32 v19, v18, v17
    v_accvgpr_write_b32 a2, v19
    v_accvgpr_read_b32 v18, a3
    v_mul_f32 v19, v18, v17
    v_accvgpr_write_b32 a3, v19
    v_accvgpr_read_b32 v18, a4
    v_mul_f32 v19, v18, v17
    v_accvgpr_write_b32 a4, v19
    v_accvgpr_read_b32 v18, a5
    v_mul_f32 v19, v18, v17
    v_accvgpr_write_b32 a5, v19
    v_accvgpr_read_b32 v18, a6
    v_mul_f32 v19, v18, v17
    v_accvgpr_write_b32 a6, v19
    v_accvgpr_read_b32 v18, a7
    v_mul_f32 v19, v18, v17
    v_accvgpr_write_b32 a7, v19
    v_accvgpr_read_b32 v18, a8
    v_mul_f32 v19, v18, v17
    v_accvgpr_write_b32 a8, v19
    v_accvgpr_read_b32 v18, a9
    v_mul_f32 v19, v18, v17
    v_accvgpr_write_b32 a9, v19
    v_accvgpr_read_b32 v18, a10
    v_mul_f32 v19, v18, v17
    v_accvgpr_write_b32 a10, v19
    v_accvgpr_read_b32 v18, a11
    v_mul_f32 v19, v18, v17
    v_accvgpr_write_b32 a11, v19
    v_accvgpr_read_b32 v18, a12
    v_mul_f32 v19, v18, v17
    v_accvgpr_write_b32 a12, v19
    v_accvgpr_read_b32 v18, a13
    v_mul_f32 v19, v18, v17
    v_accvgpr_write_b32 a13, v19
    v_accvgpr_read_b32 v18, a14
    v_mul_f32 v19, v18, v17
    v_accvgpr_write_b32 a14, v19
    v_accvgpr_read_b32 v18, a15
    v_mul_f32 v19, v18, v17
    v_accvgpr_write_b32 a15, v19
    v_accvgpr_read_b32 v18, a16
    v_mul_f32 v19, v18, v17
    v_accvgpr_write_b32 a16, v19
    v_accvgpr_read_b32 v18, a17
    v_mul_f32 v19, v18, v17
    v_accvgpr_write_b32 a17, v19
    v_accvgpr_read_b32 v18, a18
    v_mul_f32 v19, v18, v17
    v_accvgpr_write_b32 a18, v19
    v_accvgpr_read_b32 v18, a19
    v_mul_f32 v19, v18, v17
    v_accvgpr_write_b32 a19, v19
    v_accvgpr_read_b32 v18, a20
    v_mul_f32 v19, v18, v17
    v_accvgpr_write_b32 a20, v19
    v_accvgpr_read_b32 v18, a21
    v_mul_f32 v19, v18, v17
    v_accvgpr_write_b32 a21, v19
    v_accvgpr_read_b32 v18, a22
    v_mul_f32 v19, v18, v17
    v_accvgpr_write_b32 a22, v19
    v_accvgpr_read_b32 v18, a23
    v_mul_f32 v19, v18, v17
    v_accvgpr_write_b32 a23, v19
    v_accvgpr_read_b32 v18, a24
    v_mul_f32 v19, v18, v17
    v_accvgpr_write_b32 a24, v19
    v_accvgpr_read_b32 v18, a25
    v_mul_f32 v19, v18, v17
    v_accvgpr_write_b32 a25, v19
    v_accvgpr_read_b32 v18, a26
    v_mul_f32 v19, v18, v17
    v_accvgpr_write_b32 a26, v19
    v_accvgpr_read_b32 v18, a27
    v_mul_f32 v19, v18, v17
    v_accvgpr_write_b32 a27, v19
    v_accvgpr_read_b32 v18, a28
    v_mul_f32 v19, v18, v17
    v_accvgpr_write_b32 a28, v19
    v_accvgpr_read_b32 v18, a29
    v_mul_f32 v19, v18, v17
    v_accvgpr_write_b32 a29, v19
    v_accvgpr_read_b32 v18, a30
    v_mul_f32 v19, v18, v17
    v_accvgpr_write_b32 a30, v19
    v_accvgpr_read_b32 v18, a31
    v_mul_f32 v19, v18, v17
    v_accvgpr_write_b32 a31, v19
    v_accvgpr_read_b32 v18, a32
    v_mul_f32 v19, v18, v17
    v_accvgpr_write_b32 a32, v19
    v_accvgpr_read_b32 v18, a33
    v_mul_f32 v19, v18, v17
    v_accvgpr_write_b32 a33, v19
    v_accvgpr_read_b32 v18, a34
    v_mul_f32 v19, v18, v17
    v_accvgpr_write_b32 a34, v19
    v_accvgpr_read_b32 v18, a35
    v_mul_f32 v19, v18, v17
    v_accvgpr_write_b32 a35, v19
    v_accvgpr_read_b32 v18, a36
    v_mul_f32 v19, v18, v17
    v_accvgpr_write_b32 a36, v19
    v_accvgpr_read_b32 v18, a37
    v_mul_f32 v19, v18, v17
    v_accvgpr_write_b32 a37, v19
    v_accvgpr_read_b32 v18, a38
    v_mul_f32 v19, v18, v17
    v_accvgpr_write_b32 a38, v19
    v_accvgpr_read_b32 v18, a39
    v_mul_f32 v19, v18, v17
    v_accvgpr_write_b32 a39, v19
    v_accvgpr_read_b32 v18, a40
    v_mul_f32 v19, v18, v17
    v_accvgpr_write_b32 a40, v19
    v_accvgpr_read_b32 v18, a41
    v_mul_f32 v19, v18, v17
    v_accvgpr_write_b32 a41, v19
    v_accvgpr_read_b32 v18, a42
    v_mul_f32 v19, v18, v17
    v_accvgpr_write_b32 a42, v19
    v_accvgpr_read_b32 v18, a43
    v_mul_f32 v19, v18, v17
    v_accvgpr_write_b32 a43, v19
    v_accvgpr_read_b32 v18, a44
    v_mul_f32 v19, v18, v17
    v_accvgpr_write_b32 a44, v19
    v_accvgpr_read_b32 v18, a45
    v_mul_f32 v19, v18, v17
    v_accvgpr_write_b32 a45, v19
    v_accvgpr_read_b32 v18, a46
    v_mul_f32 v19, v18, v17
    v_accvgpr_write_b32 a46, v19
    v_accvgpr_read_b32 v18, a47
    v_mul_f32 v19, v18, v17
    v_accvgpr_write_b32 a47, v19
    v_accvgpr_read_b32 v18, a48
    v_mul_f32 v19, v18, v17
    v_accvgpr_write_b32 a48, v19
    v_accvgpr_read_b32 v18, a49
    v_mul_f32 v19, v18, v17
    v_accvgpr_write_b32 a49, v19
    v_accvgpr_read_b32 v18, a50
    v_mul_f32 v19, v18, v17
    v_accvgpr_write_b32 a50, v19
    v_accvgpr_read_b32 v18, a51
    v_mul_f32 v19, v18, v17
    v_accvgpr_write_b32 a51, v19
    v_accvgpr_read_b32 v18, a52
    v_mul_f32 v19, v18, v17
    v_accvgpr_write_b32 a52, v19
    v_accvgpr_read_b32 v18, a53
    v_mul_f32 v19, v18, v17
    v_accvgpr_write_b32 a53, v19
    v_accvgpr_read_b32 v18, a54
    v_mul_f32 v19, v18, v17
    v_accvgpr_write_b32 a54, v19
    v_accvgpr_read_b32 v18, a55
    v_mul_f32 v19, v18, v17
    v_accvgpr_write_b32 a55, v19
    v_accvgpr_read_b32 v18, a56
    v_mul_f32 v19, v18, v17
    v_accvgpr_write_b32 a56, v19
    v_accvgpr_read_b32 v18, a57
    v_mul_f32 v19, v18, v17
    v_accvgpr_write_b32 a57, v19
    v_accvgpr_read_b32 v18, a58
    v_mul_f32 v19, v18, v17
    v_accvgpr_write_b32 a58, v19
    v_accvgpr_read_b32 v18, a59
    v_mul_f32 v19, v18, v17
    v_accvgpr_write_b32 a59, v19
    v_accvgpr_read_b32 v18, a60
    v_mul_f32 v19, v18, v17
    v_accvgpr_write_b32 a60, v19
    v_accvgpr_read_b32 v18, a61
    v_mul_f32 v19, v18, v17
    v_accvgpr_write_b32 a61, v19
    v_accvgpr_read_b32 v18, a62
    v_mul_f32 v19, v18, v17
    v_accvgpr_write_b32 a62, v19
    v_accvgpr_read_b32 v18, a63
    v_mul_f32 v19, v18, v17
    v_accvgpr_write_b32 a63, v19
    v_mov_b32 v14, 0
    v_sub_f32 v18, v64, v16
    v_sub_f32 v19, v65, v16
    v_exp_f32 v18, v18
    v_exp_f32 v19, v19
    s_nop 0
    v_add_f32 v14, v14, v18
    v_add_f32 v14, v14, v19
    v_cvt_pk_bf16_f32 v96, v18, v19
    v_sub_f32 v18, v66, v16
    v_sub_f32 v19, v67, v16
    v_exp_f32 v18, v18
    v_exp_f32 v19, v19
    s_nop 0
    v_add_f32 v14, v14, v18
    v_add_f32 v14, v14, v19
    v_cvt_pk_bf16_f32 v97, v18, v19
    v_sub_f32 v18, v68, v16
    v_sub_f32 v19, v69, v16
    v_exp_f32 v18, v18
    v_exp_f32 v19, v19
    s_nop 0
    v_add_f32 v14, v14, v18
    v_add_f32 v14, v14, v19
    v_cvt_pk_bf16_f32 v98, v18, v19
    v_sub_f32 v18, v70, v16
    v_sub_f32 v19, v71, v16
    v_exp_f32 v18, v18
    v_exp_f32 v19, v19
    s_nop 0
    v_add_f32 v14, v14, v18
    v_add_f32 v14, v14, v19
    v_cvt_pk_bf16_f32 v99, v18, v19
    v_sub_f32 v18, v72, v16
    v_sub_f32 v19, v73, v16
    v_exp_f32 v18, v18
    v_exp_f32 v19, v19
    s_nop 0
    v_add_f32 v14, v14, v18
    v_add_f32 v14, v14, v19
    v_cvt_pk_bf16_f32 v100, v18, v19
    v_sub_f32 v18, v74, v16
    v_sub_f32 v19, v75, v16
    v_exp_f32 v18, v18
    v_exp_f32 v19, v19
    s_nop 0
    v_add_f32 v14, v14, v18
    v_add_f32 v14, v14, v19
    v_cvt_pk_bf16_f32 v101, v18, v19
    v_sub_f32 v18, v76, v16
    v_sub_f32 v19, v77, v16
    v_exp_f32 v18, v18
    v_exp_f32 v19, v19
    s_nop 0
    v_add_f32 v14, v14, v18
    v_add_f32 v14, v14, v19
    v_cvt_pk_bf16_f32 v102, v18, v19
    v_sub_f32 v18, v78, v16
    v_sub_f32 v19, v79, v16
    v_exp_f32 v18, v18
    v_exp_f32 v19, v19
    s_nop 0
    v_add_f32 v14, v14, v18
    v_add_f32 v14, v14, v19
    v_cvt_pk_bf16_f32 v103, v18, v19
    s_nop 3
    s_branch L_back18
L_slow19:
    s_nop 15
    s_nop 15
    v_max3_f32 v16, v80, v81, v82
    v_max3_f32 v16, v16, v83, v84
    v_max3_f32 v16, v16, v85, v86
    v_max3_f32 v16, v16, v87, v88
    v_max3_f32 v16, v16, v89, v90
    v_max3_f32 v16, v16, v91, v92
    v_max3_f32 v16, v16, v93, v94
    v_max_f32 v16, v16, v95
    v_mov_b32 v17, v16
    s_nop 1
    v_permlane32_swap_b32 v16, v17
    s_nop 1
    v_max3_f32 v16, v16, v17, 0
    v_exp_f32 v17, -v16
    s_nop 1
    v_sub_f32 v13, v13, v16
    v_mov_b32 v112, v13
    v_mov_b32 v113, v13
    v_mov_b32 v114, v13
    v_mov_b32 v115, v13
    v_mov_b32 v116, v13
    v_mov_b32 v117, v13
    v_mov_b32 v118, v13
    v_mov_b32 v119, v13
    v_mov_b32 v120, v13
    v_mov_b32 v121, v13
    v_mov_b32 v122, v13
    v_mov_b32 v123, v13
    v_mov_b32 v124, v13
    v_mov_b32 v125, v13
    v_mov_b32 v126, v13
    v_mov_b32 v127, v13
    v_sub_f32 v64, v64, v16
    v_sub_f32 v65, v65, v16
    v_sub_f32 v66, v66, v16
    v_sub_f32 v67, v67, v16
    v_sub_f32 v68, v68, v16
    v_sub_f32 v69, v69, v16
    v_sub_f32 v70, v70, v16
    v_sub_f32 v71, v71, v16
    v_sub_f32 v72, v72, v16
    v_sub_f32 v73, v73, v16
    v_sub_f32 v74, v74, v16
    v_sub_f32 v75, v75, v16
    v_sub_f32 v76, v76, v16
    v_sub_f32 v77, v77, v16
    v_sub_f32 v78, v78, v16
    v_sub_f32 v79, v79, v16
    v_mul_f32 v12, v12, v17
    v_accvgpr_read_b32 v18, a0
    v_mul_f32 v19, v18, v17
    v_accvgpr_write_b32 a0, v19
    v_accvgpr_read_b32 v18, a1
    v_mul_f32 v19, v18, v17
    v_accvgpr_write_b32 a1, v19
    v_accvgpr_read_b32 v18, a2
    v_mul_f32 v19, v18, v17
    v_accvgpr_write_b32 a2, v19
    v_accvgpr_read_b32 v18, a3
    v_mul_f32 v19, v18, v17
    v_accvgpr_write_b32 a3, v19
    v_accvgpr_read_b32 v18, a4
    v_mul_f32 v19, v18, v17
    v_accvgpr_write_b32 a4, v19
    v_accvgpr_read_b32 v18, a5
    v_mul_f32 v19, v18, v17
    v_accvgpr_write_b32 a5, v19
    v_accvgpr_read_b32 v18, a6
    v_mul_f32 v19, v18, v17
    v_accvgpr_write_b32 a6, v19
    v_accvgpr_read_b32 v18, a7
    v_mul_f32 v19, v18, v17
    v_accvgpr_write_b32 a7, v19
    v_accvgpr_read_b32 v18, a8
    v_mul_f32 v19, v18, v17
    v_accvgpr_write_b32 a8, v19
    v_accvgpr_read_b32 v18, a9
    v_mul_f32 v19, v18, v17
    v_accvgpr_write_b32 a9, v19
    v_accvgpr_read_b32 v18, a10
    v_mul_f32 v19, v18, v17
    v_accvgpr_write_b32 a10, v19
    v_accvgpr_read_b32 v18, a11
    v_mul_f32 v19, v18, v17
    v_accvgpr_write_b32 a11, v19
    v_accvgpr_read_b32 v18, a12
    v_mul_f32 v19, v18, v17
    v_accvgpr_write_b32 a12, v19
    v_accvgpr_read_b32 v18, a13
    v_mul_f32 v19, v18, v17
    v_accvgpr_write_b32 a13, v19
    v_accvgpr_read_b32 v18, a14
    v_mul_f32 v19, v18, v17
    v_accvgpr_write_b32 a14, v19
    v_accvgpr_read_b32 v18, a15
    v_mul_f32 v19, v18, v17
    v_accvgpr_write_b32 a15, v19
    v_accvgpr_read_b32 v18, a16
    v_mul_f32 v19, v18, v17
    v_accvgpr_write_b32 a16, v19
    v_accvgpr_read_b32 v18, a17
    v_mul_f32 v19, v18, v17
    v_accvgpr_write_b32 a17, v19
    v_accvgpr_read_b32 v18, a18
    v_mul_f32 v19, v18, v17
    v_accvgpr_write_b32 a18, v19
    v_accvgpr_read_b32 v18, a19
    v_mul_f32 v19, v18, v17
    v_accvgpr_write_b32 a19, v19
    v_accvgpr_read_b32 v18, a20
    v_mul_f32 v19, v18, v17
    v_accvgpr_write_b32 a20, v19
    v_accvgpr_read_b32 v18, a21
    v_mul_f32 v19, v18, v17
    v_accvgpr_write_b32 a21, v19
    v_accvgpr_read_b32 v18, a22
    v_mul_f32 v19, v18, v17
    v_accvgpr_write_b32 a22, v19
    v_accvgpr_read_b32 v18, a23
    v_mul_f32 v19, v18, v17
    v_accvgpr_write_b32 a23, v19
    v_accvgpr_read_b32 v18, a24
    v_mul_f32 v19, v18, v17
    v_accvgpr_write_b32 a24, v19
    v_accvgpr_read_b32 v18, a25
    v_mul_f32 v19, v18, v17
    v_accvgpr_write_b32 a25, v19
    v_accvgpr_read_b32 v18, a26
    v_mul_f32 v19, v18, v17
    v_accvgpr_write_b32 a26, v19
    v_accvgpr_read_b32 v18, a27
    v_mul_f32 v19, v18, v17
    v_accvgpr_write_b32 a27, v19
    v_accvgpr_read_b32 v18, a28
    v_mul_f32 v19, v18, v17
    v_accvgpr_write_b32 a28, v19
    v_accvgpr_read_b32 v18, a29
    v_mul_f32 v19, v18, v17
    v_accvgpr_write_b32 a29, v19
    v_accvgpr_read_b32 v18, a30
    v_mul_f32 v19, v18, v17
    v_accvgpr_write_b32 a30, v19
    v_accvgpr_read_b32 v18, a31
    v_mul_f32 v19, v18, v17
    v_accvgpr_write_b32 a31, v19
    v_accvgpr_read_b32 v18, a32
    v_mul_f32 v19, v18, v17
    v_accvgpr_write_b32 a32, v19
    v_accvgpr_read_b32 v18, a33
    v_mul_f32 v19, v18, v17
    v_accvgpr_write_b32 a33, v19
    v_accvgpr_read_b32 v18, a34
    v_mul_f32 v19, v18, v17
    v_accvgpr_write_b32 a34, v19
    v_accvgpr_read_b32 v18, a35
    v_mul_f32 v19, v18, v17
    v_accvgpr_write_b32 a35, v19
    v_accvgpr_read_b32 v18, a36
    v_mul_f32 v19, v18, v17
    v_accvgpr_write_b32 a36, v19
    v_accvgpr_read_b32 v18, a37
    v_mul_f32 v19, v18, v17
    v_accvgpr_write_b32 a37, v19
    v_accvgpr_read_b32 v18, a38
    v_mul_f32 v19, v18, v17
    v_accvgpr_write_b32 a38, v19
    v_accvgpr_read_b32 v18, a39
    v_mul_f32 v19, v18, v17
    v_accvgpr_write_b32 a39, v19
    v_accvgpr_read_b32 v18, a40
    v_mul_f32 v19, v18, v17
    v_accvgpr_write_b32 a40, v19
    v_accvgpr_read_b32 v18, a41
    v_mul_f32 v19, v18, v17
    v_accvgpr_write_b32 a41, v19
    v_accvgpr_read_b32 v18, a42
    v_mul_f32 v19, v18, v17
    v_accvgpr_write_b32 a42, v19
    v_accvgpr_read_b32 v18, a43
    v_mul_f32 v19, v18, v17
    v_accvgpr_write_b32 a43, v19
    v_accvgpr_read_b32 v18, a44
    v_mul_f32 v19, v18, v17
    v_accvgpr_write_b32 a44, v19
    v_accvgpr_read_b32 v18, a45
    v_mul_f32 v19, v18, v17
    v_accvgpr_write_b32 a45, v19
    v_accvgpr_read_b32 v18, a46
    v_mul_f32 v19, v18, v17
    v_accvgpr_write_b32 a46, v19
    v_accvgpr_read_b32 v18, a47
    v_mul_f32 v19, v18, v17
    v_accvgpr_write_b32 a47, v19
    v_accvgpr_read_b32 v18, a48
    v_mul_f32 v19, v18, v17
    v_accvgpr_write_b32 a48, v19
    v_accvgpr_read_b32 v18, a49
    v_mul_f32 v19, v18, v17
    v_accvgpr_write_b32 a49, v19
    v_accvgpr_read_b32 v18, a50
    v_mul_f32 v19, v18, v17
    v_accvgpr_write_b32 a50, v19
    v_accvgpr_read_b32 v18, a51
    v_mul_f32 v19, v18, v17
    v_accvgpr_write_b32 a51, v19
    v_accvgpr_read_b32 v18, a52
    v_mul_f32 v19, v18, v17
    v_accvgpr_write_b32 a52, v19
    v_accvgpr_read_b32 v18, a53
    v_mul_f32 v19, v18, v17
    v_accvgpr_write_b32 a53, v19
    v_accvgpr_read_b32 v18, a54
    v_mul_f32 v19, v18, v17
    v_accvgpr_write_b32 a54, v19
    v_accvgpr_read_b32 v18, a55
    v_mul_f32 v19, v18, v17
    v_accvgpr_write_b32 a55, v19
    v_accvgpr_read_b32 v18, a56
    v_mul_f32 v19, v18, v17
    v_accvgpr_write_b32 a56, v19
    v_accvgpr_read_b32 v18, a57
    v_mul_f32 v19, v18, v17
    v_accvgpr_write_b32 a57, v19
    v_accvgpr_read_b32 v18, a58
    v_mul_f32 v19, v18, v17
    v_accvgpr_write_b32 a58, v19
    v_accvgpr_read_b32 v18, a59
    v_mul_f32 v19, v18, v17
    v_accvgpr_write_b32 a59, v19
    v_accvgpr_read_b32 v18, a60
    v_mul_f32 v19, v18, v17
    v_accvgpr_write_b32 a60, v19
    v_accvgpr_read_b32 v18, a61
    v_mul_f32 v19, v18, v17
    v_accvgpr_write_b32 a61, v19
    v_accvgpr_read_b32 v18, a62
    v_mul_f32 v19, v18, v17
    v_accvgpr_write_b32 a62, v19
    v_accvgpr_read_b32 v18, a63
    v_mul_f32 v19, v18, v17
    v_accvgpr_write_b32 a63, v19
    v_mov_b32 v14, 0
    v_sub_f32 v18, v80, v16
    v_sub_f32 v19, v81, v16
    v_exp_f32 v18, v18
    v_exp_f32 v19, v19
    s_nop 0
    v_add_f32 v14, v14, v18
    v_add_f32 v14, v14, v19
    v_cvt_pk_bf16_f32 v104, v18, v19
    v_sub_f32 v18, v82, v16
    v_sub_f32 v19, v83, v16
    v_exp_f32 v18, v18
    v_exp_f32 v19, v19
    s_nop 0
    v_add_f32 v14, v14, v18
    v_add_f32 v14, v14, v19
    v_cvt_pk_bf16_f32 v105, v18, v19
    v_sub_f32 v18, v84, v16
    v_sub_f32 v19, v85, v16
    v_exp_f32 v18, v18
    v_exp_f32 v19, v19
    s_nop 0
    v_add_f32 v14, v14, v18
    v_add_f32 v14, v14, v19
    v_cvt_pk_bf16_f32 v106, v18, v19
    v_sub_f32 v18, v86, v16
    v_sub_f32 v19, v87, v16
    v_exp_f32 v18, v18
    v_exp_f32 v19, v19
    s_nop 0
    v_add_f32 v14, v14, v18
    v_add_f32 v14, v14, v19
    v_cvt_pk_bf16_f32 v107, v18, v19
    v_sub_f32 v18, v88, v16
    v_sub_f32 v19, v89, v16
    v_exp_f32 v18, v18
    v_exp_f32 v19, v19
    s_nop 0
    v_add_f32 v14, v14, v18
    v_add_f32 v14, v14, v19
    v_cvt_pk_bf16_f32 v108, v18, v19
    v_sub_f32 v18, v90, v16
    v_sub_f32 v19, v91, v16
    v_exp_f32 v18, v18
    v_exp_f32 v19, v19
    s_nop 0
    v_add_f32 v14, v14, v18
    v_add_f32 v14, v14, v19
    v_cvt_pk_bf16_f32 v109, v18, v19
    v_sub_f32 v18, v92, v16
    v_sub_f32 v19, v93, v16
    v_exp_f32 v18, v18
    v_exp_f32 v19, v19
    s_nop 0
    v_add_f32 v14, v14, v18
    v_add_f32 v14, v14, v19
    v_cvt_pk_bf16_f32 v110, v18, v19
    v_sub_f32 v18, v94, v16
    v_sub_f32 v19, v95, v16
    v_exp_f32 v18, v18
    v_exp_f32 v19, v19
    s_nop 0
    v_add_f32 v14, v14, v18
    v_add_f32 v14, v14, v19
    v_cvt_pk_bf16_f32 v111, v18, v19
    s_nop 3
    s_branch L_back19
L_slow20:
    s_nop 15
    s_nop 15
    v_max3_f32 v16, v64, v65, v66
    v_max3_f32 v16, v16, v67, v68
    v_max3_f32 v16, v16, v69, v70
    v_max3_f32 v16, v16, v71, v72
    v_max3_f32 v16, v16, v73, v74
    v_max3_f32 v16, v16, v75, v76
    v_max3_f32 v16, v16, v77, v78
    v_max_f32 v16, v16, v79
    v_mov_b32 v17, v16
    s_nop 1
    v_permlane32_swap_b32 v16, v17
    s_nop 1
    v_max3_f32 v16, v16, v17, 0
    v_exp_f32 v17, -v16
    s_nop 1
    v_sub_f32 v13, v13, v16
    v_mov_b32 v112, v13
    v_mov_b32 v113, v13
    v_mov_b32 v114, v13
    v_mov_b32 v115, v13
    v_mov_b32 v116, v13
    v_mov_b32 v117, v13
    v_mov_b32 v118, v13
    v_mov_b32 v119, v13
    v_mov_b32 v120, v13
    v_mov_b32 v121, v13
    v_mov_b32 v122, v13
    v_mov_b32 v123, v13
    v_mov_b32 v124, v13
    v_mov_b32 v125, v13
    v_mov_b32 v126, v13
    v_mov_b32 v127, v13
    v_sub_f32 v80, v80, v16
    v_sub_f32 v81, v81, v16
    v_sub_f32 v82, v82, v16
    v_sub_f32 v83, v83, v16
    v_sub_f32 v84, v84, v16
    v_sub_f32 v85, v85, v16
    v_sub_f32 v86, v86, v16
    v_sub_f32 v87, v87, v16
    v_sub_f32 v88, v88, v16
    v_sub_f32 v89, v89, v16
    v_sub_f32 v90, v90, v16
    v_sub_f32 v91, v91, v16
    v_sub_f32 v92, v92, v16
    v_sub_f32 v93, v93, v16
    v_sub_f32 v94, v94, v16
    v_sub_f32 v95, v95, v16
    v_mul_f32 v12, v12, v17
    v_accvgpr_read_b32 v18, a0
    v_mul_f32 v19, v18, v17
    v_accvgpr_write_b32 a0, v19
    v_accvgpr_read_b32 v18, a1
    v_mul_f32 v19, v18, v17
    v_accvgpr_write_b32 a1, v19
    v_accvgpr_read_b32 v18, a2
    v_mul_f32 v19, v18, v17
    v_accvgpr_write_b32 a2, v19
    v_accvgpr_read_b32 v18, a3
    v_mul_f32 v19, v18, v17
    v_accvgpr_write_b32 a3, v19
    v_accvgpr_read_b32 v18, a4
    v_mul_f32 v19, v18, v17
    v_accvgpr_write_b32 a4, v19
    v_accvgpr_read_b32 v18, a5
    v_mul_f32 v19, v18, v17
    v_accvgpr_write_b32 a5, v19
    v_accvgpr_read_b32 v18, a6
    v_mul_f32 v19, v18, v17
    v_accvgpr_write_b32 a6, v19
    v_accvgpr_read_b32 v18, a7
    v_mul_f32 v19, v18, v17
    v_accvgpr_write_b32 a7, v19
    v_accvgpr_read_b32 v18, a8
    v_mul_f32 v19, v18, v17
    v_accvgpr_write_b32 a8, v19
    v_accvgpr_read_b32 v18, a9
    v_mul_f32 v19, v18, v17
    v_accvgpr_write_b32 a9, v19
    v_accvgpr_read_b32 v18, a10
    v_mul_f32 v19, v18, v17
    v_accvgpr_write_b32 a10, v19
    v_accvgpr_read_b32 v18, a11
    v_mul_f32 v19, v18, v17
    v_accvgpr_write_b32 a11, v19
    v_accvgpr_read_b32 v18, a12
    v_mul_f32 v19, v18, v17
    v_accvgpr_write_b32 a12, v19
    v_accvgpr_read_b32 v18, a13
    v_mul_f32 v19, v18, v17
    v_accvgpr_write_b32 a13, v19
    v_accvgpr_read_b32 v18, a14
    v_mul_f32 v19, v18, v17
    v_accvgpr_write_b32 a14, v19
    v_accvgpr_read_b32 v18, a15
    v_mul_f32 v19, v18, v17
    v_accvgpr_write_b32 a15, v19
    v_accvgpr_read_b32 v18, a16
    v_mul_f32 v19, v18, v17
    v_accvgpr_write_b32 a16, v19
    v_accvgpr_read_b32 v18, a17
    v_mul_f32 v19, v18, v17
    v_accvgpr_write_b32 a17, v19
    v_accvgpr_read_b32 v18, a18
    v_mul_f32 v19, v18, v17
    v_accvgpr_write_b32 a18, v19
    v_accvgpr_read_b32 v18, a19
    v_mul_f32 v19, v18, v17
    v_accvgpr_write_b32 a19, v19
    v_accvgpr_read_b32 v18, a20
    v_mul_f32 v19, v18, v17
    v_accvgpr_write_b32 a20, v19
    v_accvgpr_read_b32 v18, a21
    v_mul_f32 v19, v18, v17
    v_accvgpr_write_b32 a21, v19
    v_accvgpr_read_b32 v18, a22
    v_mul_f32 v19, v18, v17
    v_accvgpr_write_b32 a22, v19
    v_accvgpr_read_b32 v18, a23
    v_mul_f32 v19, v18, v17
    v_accvgpr_write_b32 a23, v19
    v_accvgpr_read_b32 v18, a24
    v_mul_f32 v19, v18, v17
    v_accvgpr_write_b32 a24, v19
    v_accvgpr_read_b32 v18, a25
    v_mul_f32 v19, v18, v17
    v_accvgpr_write_b32 a25, v19
    v_accvgpr_read_b32 v18, a26
    v_mul_f32 v19, v18, v17
    v_accvgpr_write_b32 a26, v19
    v_accvgpr_read_b32 v18, a27
    v_mul_f32 v19, v18, v17
    v_accvgpr_write_b32 a27, v19
    v_accvgpr_read_b32 v18, a28
    v_mul_f32 v19, v18, v17
    v_accvgpr_write_b32 a28, v19
    v_accvgpr_read_b32 v18, a29
    v_mul_f32 v19, v18, v17
    v_accvgpr_write_b32 a29, v19
    v_accvgpr_read_b32 v18, a30
    v_mul_f32 v19, v18, v17
    v_accvgpr_write_b32 a30, v19
    v_accvgpr_read_b32 v18, a31
    v_mul_f32 v19, v18, v17
    v_accvgpr_write_b32 a31, v19
    v_accvgpr_read_b32 v18, a32
    v_mul_f32 v19, v18, v17
    v_accvgpr_write_b32 a32, v19
    v_accvgpr_read_b32 v18, a33
    v_mul_f32 v19, v18, v17
    v_accvgpr_write_b32 a33, v19
    v_accvgpr_read_b32 v18, a34
    v_mul_f32 v19, v18, v17
    v_accvgpr_write_b32 a34, v19
    v_accvgpr_read_b32 v18, a35
    v_mul_f32 v19, v18, v17
    v_accvgpr_write_b32 a35, v19
    v_accvgpr_read_b32 v18, a36
    v_mul_f32 v19, v18, v17
    v_accvgpr_write_b32 a36, v19
    v_accvgpr_read_b32 v18, a37
    v_mul_f32 v19, v18, v17
    v_accvgpr_write_b32 a37, v19
    v_accvgpr_read_b32 v18, a38
    v_mul_f32 v19, v18, v17
    v_accvgpr_write_b32 a38, v19
    v_accvgpr_read_b32 v18, a39
    v_mul_f32 v19, v18, v17
    v_accvgpr_write_b32 a39, v19
    v_accvgpr_read_b32 v18, a40
    v_mul_f32 v19, v18, v17
    v_accvgpr_write_b32 a40, v19
    v_accvgpr_read_b32 v18, a41
    v_mul_f32 v19, v18, v17
    v_accvgpr_write_b32 a41, v19
    v_accvgpr_read_b32 v18, a42
    v_mul_f32 v19, v18, v17
    v_accvgpr_write_b32 a42, v19
    v_accvgpr_read_b32 v18, a43
    v_mul_f32 v19, v18, v17
    v_accvgpr_write_b32 a43, v19
    v_accvgpr_read_b32 v18, a44
    v_mul_f32 v19, v18, v17
    v_accvgpr_write_b32 a44, v19
    v_accvgpr_read_b32 v18, a45
    v_mul_f32 v19, v18, v17
    v_accvgpr_write_b32 a45, v19
    v_accvgpr_read_b32 v18, a46
    v_mul_f32 v19, v18, v17
    v_accvgpr_write_b32 a46, v19
    v_accvgpr_read_b32 v18, a47
    v_mul_f32 v19, v18, v17
    v_accvgpr_write_b32 a47, v19
    v_accvgpr_read_b32 v18, a48
    v_mul_f32 v19, v18, v17
    v_accvgpr_write_b32 a48, v19
    v_accvgpr_read_b32 v18, a49
    v_mul_f32 v19, v18, v17
    v_accvgpr_write_b32 a49, v19
    v_accvgpr_read_b32 v18, a50
    v_mul_f32 v19, v18, v17
    v_accvgpr_write_b32 a50, v19
    v_accvgpr_read_b32 v18, a51
    v_mul_f32 v19, v18, v17
    v_accvgpr_write_b32 a51, v19
    v_accvgpr_read_b32 v18, a52
    v_mul_f32 v19, v18, v17
    v_accvgpr_write_b32 a52, v19
    v_accvgpr_read_b32 v18, a53
    v_mul_f32 v19, v18, v17
    v_accvgpr_write_b32 a53, v19
    v_accvgpr_read_b32 v18, a54
    v_mul_f32 v19, v18, v17
    v_accvgpr_write_b32 a54, v19
    v_accvgpr_read_b32 v18, a55
    v_mul_f32 v19, v18, v17
    v_accvgpr_write_b32 a55, v19
    v_accvgpr_read_b32 v18, a56
    v_mul_f32 v19, v18, v17
    v_accvgpr_write_b32 a56, v19
    v_accvgpr_read_b32 v18, a57
    v_mul_f32 v19, v18, v17
    v_accvgpr_write_b32 a57, v19
    v_accvgpr_read_b32 v18, a58
    v_mul_f32 v19, v18, v17
    v_accvgpr_write_b32 a58, v19
    v_accvgpr_read_b32 v18, a59
    v_mul_f32 v19, v18, v17
    v_accvgpr_write_b32 a59, v19
    v_accvgpr_read_b32 v18, a60
    v_mul_f32 v19, v18, v17
    v_accvgpr_write_b32 a60, v19
    v_accvgpr_read_b32 v18, a61
    v_mul_f32 v19, v18, v17
    v_accvgpr_write_b32 a61, v19
    v_accvgpr_read_b32 v18, a62
    v_mul_f32 v19, v18, v17
    v_accvgpr_write_b32 a62, v19
    v_accvgpr_read_b32 v18, a63
    v_mul_f32 v19, v18, v17
    v_accvgpr_write_b32 a63, v19
    v_mov_b32 v14, 0
    v_sub_f32 v18, v64, v16
    v_sub_f32 v19, v65, v16
    v_exp_f32 v18, v18
    v_exp_f32 v19, v19
    s_nop 0
    v_add_f32 v14, v14, v18
    v_add_f32 v14, v14, v19
    v_cvt_pk_bf16_f32 v96, v18, v19
    v_sub_f32 v18, v66, v16
    v_sub_f32 v19, v67, v16
    v_exp_f32 v18, v18
    v_exp_f32 v19, v19
    s_nop 0
    v_add_f32 v14, v14, v18
    v_add_f32 v14, v14, v19
    v_cvt_pk_bf16_f32 v97, v18, v19
    v_sub_f32 v18, v68, v16
    v_sub_f32 v19, v69, v16
    v_exp_f32 v18, v18
    v_exp_f32 v19, v19
    s_nop 0
    v_add_f32 v14, v14, v18
    v_add_f32 v14, v14, v19
    v_cvt_pk_bf16_f32 v98, v18, v19
    v_sub_f32 v18, v70, v16
    v_sub_f32 v19, v71, v16
    v_exp_f32 v18, v18
    v_exp_f32 v19, v19
    s_nop 0
    v_add_f32 v14, v14, v18
    v_add_f32 v14, v14, v19
    v_cvt_pk_bf16_f32 v99, v18, v19
    v_sub_f32 v18, v72, v16
    v_sub_f32 v19, v73, v16
    v_exp_f32 v18, v18
    v_exp_f32 v19, v19
    s_nop 0
    v_add_f32 v14, v14, v18
    v_add_f32 v14, v14, v19
    v_cvt_pk_bf16_f32 v100, v18, v19
    v_sub_f32 v18, v74, v16
    v_sub_f32 v19, v75, v16
    v_exp_f32 v18, v18
    v_exp_f32 v19, v19
    s_nop 0
    v_add_f32 v14, v14, v18
    v_add_f32 v14, v14, v19
    v_cvt_pk_bf16_f32 v101, v18, v19
    v_sub_f32 v18, v76, v16
    v_sub_f32 v19, v77, v16
    v_exp_f32 v18, v18
    v_exp_f32 v19, v19
    s_nop 0
    v_add_f32 v14, v14, v18
    v_add_f32 v14, v14, v19
    v_cvt_pk_bf16_f32 v102, v18, v19
    v_sub_f32 v18, v78, v16
    v_sub_f32 v19, v79, v16
    v_exp_f32 v18, v18
    v_exp_f32 v19, v19
    s_nop 0
    v_add_f32 v14, v14, v18
    v_add_f32 v14, v14, v19
    v_cvt_pk_bf16_f32 v103, v18, v19
    s_nop 3
    s_branch L_back20
L_slow21:
    s_nop 15
    s_nop 15
    v_max3_f32 v16, v80, v81, v82
    v_max3_f32 v16, v16, v83, v84
    v_max3_f32 v16, v16, v85, v86
    v_max3_f32 v16, v16, v87, v88
    v_max3_f32 v16, v16, v89, v90
    v_max3_f32 v16, v16, v91, v92
    v_max3_f32 v16, v16, v93, v94
    v_max_f32 v16, v16, v95
    v_mov_b32 v17, v16
    s_nop 1
    v_permlane32_swap_b32 v16, v17
    s_nop 1
    v_max3_f32 v16, v16, v17, 0
    v_exp_f32 v17, -v16
    s_nop 1
    v_sub_f32 v13, v13, v16
    v_mov_b32 v112, v13
    v_mov_b32 v113, v13
    v_mov_b32 v114, v13
    v_mov_b32 v115, v13
    v_mov_b32 v116, v13
    v_mov_b32 v117, v13
    v_mov_b32 v118, v13
    v_mov_b32 v119, v13
    v_mov_b32 v120, v13
    v_mov_b32 v121, v13
    v_mov_b32 v122, v13
    v_mov_b32 v123, v13
    v_mov_b32 v124, v13
    v_mov_b32 v125, v13
    v_mov_b32 v126, v13
    v_mov_b32 v127, v13
    v_sub_f32 v64, v64, v16
    v_sub_f32 v65, v65, v16
    v_sub_f32 v66, v66, v16
    v_sub_f32 v67, v67, v16
    v_sub_f32 v68, v68, v16
    v_sub_f32 v69, v69, v16
    v_sub_f32 v70, v70, v16
    v_sub_f32 v71, v71, v16
    v_sub_f32 v72, v72, v16
    v_sub_f32 v73, v73, v16
    v_sub_f32 v74, v74, v16
    v_sub_f32 v75, v75, v16
    v_sub_f32 v76, v76, v16
    v_sub_f32 v77, v77, v16
    v_sub_f32 v78, v78, v16
    v_sub_f32 v79, v79, v16
    v_mul_f32 v12, v12, v17
    v_accvgpr_read_b32 v18, a0
    v_mul_f32 v19, v18, v17
    v_accvgpr_write_b32 a0, v19
    v_accvgpr_read_b32 v18, a1
    v_mul_f32 v19, v18, v17
    v_accvgpr_write_b32 a1, v19
    v_accvgpr_read_b32 v18, a2
    v_mul_f32 v19, v18, v17
    v_accvgpr_write_b32 a2, v19
    v_accvgpr_read_b32 v18, a3
    v_mul_f32 v19, v18, v17
    v_accvgpr_write_b32 a3, v19
    v_accvgpr_read_b32 v18, a4
    v_mul_f32 v19, v18, v17
    v_accvgpr_write_b32 a4, v19
    v_accvgpr_read_b32 v18, a5
    v_mul_f32 v19, v18, v17
    v_accvgpr_write_b32 a5, v19
    v_accvgpr_read_b32 v18, a6
    v_mul_f32 v19, v18, v17
    v_accvgpr_write_b32 a6, v19
    v_accvgpr_read_b32 v18, a7
    v_mul_f32 v19, v18, v17
    v_accvgpr_write_b32 a7, v19
    v_accvgpr_read_b32 v18, a8
    v_mul_f32 v19, v18, v17
    v_accvgpr_write_b32 a8, v19
    v_accvgpr_read_b32 v18, a9
    v_mul_f32 v19, v18, v17
    v_accvgpr_write_b32 a9, v19
    v_accvgpr_read_b32 v18, a10
    v_mul_f32 v19, v18, v17
    v_accvgpr_write_b32 a10, v19
    v_accvgpr_read_b32 v18, a11
    v_mul_f32 v19, v18, v17
    v_accvgpr_write_b32 a11, v19
    v_accvgpr_read_b32 v18, a12
    v_mul_f32 v19, v18, v17
    v_accvgpr_write_b32 a12, v19
    v_accvgpr_read_b32 v18, a13
    v_mul_f32 v19, v18, v17
    v_accvgpr_write_b32 a13, v19
    v_accvgpr_read_b32 v18, a14
    v_mul_f32 v19, v18, v17
    v_accvgpr_write_b32 a14, v19
    v_accvgpr_read_b32 v18, a15
    v_mul_f32 v19, v18, v17
    v_accvgpr_write_b32 a15, v19
    v_accvgpr_read_b32 v18, a16
    v_mul_f32 v19, v18, v17
    v_accvgpr_write_b32 a16, v19
    v_accvgpr_read_b32 v18, a17
    v_mul_f32 v19, v18, v17
    v_accvgpr_write_b32 a17, v19
    v_accvgpr_read_b32 v18, a18
    v_mul_f32 v19, v18, v17
    v_accvgpr_write_b32 a18, v19
    v_accvgpr_read_b32 v18, a19
    v_mul_f32 v19, v18, v17
    v_accvgpr_write_b32 a19, v19
    v_accvgpr_read_b32 v18, a20
    v_mul_f32 v19, v18, v17
    v_accvgpr_write_b32 a20, v19
    v_accvgpr_read_b32 v18, a21
    v_mul_f32 v19, v18, v17
    v_accvgpr_write_b32 a21, v19
    v_accvgpr_read_b32 v18, a22
    v_mul_f32 v19, v18, v17
    v_accvgpr_write_b32 a22, v19
    v_accvgpr_read_b32 v18, a23
    v_mul_f32 v19, v18, v17
    v_accvgpr_write_b32 a23, v19
    v_accvgpr_read_b32 v18, a24
    v_mul_f32 v19, v18, v17
    v_accvgpr_write_b32 a24, v19
    v_accvgpr_read_b32 v18, a25
    v_mul_f32 v19, v18, v17
    v_accvgpr_write_b32 a25, v19
    v_accvgpr_read_b32 v18, a26
    v_mul_f32 v19, v18, v17
    v_accvgpr_write_b32 a26, v19
    v_accvgpr_read_b32 v18, a27
    v_mul_f32 v19, v18, v17
    v_accvgpr_write_b32 a27, v19
    v_accvgpr_read_b32 v18, a28
    v_mul_f32 v19, v18, v17
    v_accvgpr_write_b32 a28, v19
    v_accvgpr_read_b32 v18, a29
    v_mul_f32 v19, v18, v17
    v_accvgpr_write_b32 a29, v19
    v_accvgpr_read_b32 v18, a30
    v_mul_f32 v19, v18, v17
    v_accvgpr_write_b32 a30, v19
    v_accvgpr_read_b32 v18, a31
    v_mul_f32 v19, v18, v17
    v_accvgpr_write_b32 a31, v19
    v_accvgpr_read_b32 v18, a32
    v_mul_f32 v19, v18, v17
    v_accvgpr_write_b32 a32, v19
    v_accvgpr_read_b32 v18, a33
    v_mul_f32 v19, v18, v17
    v_accvgpr_write_b32 a33, v19
    v_accvgpr_read_b32 v18, a34
    v_mul_f32 v19, v18, v17
    v_accvgpr_write_b32 a34, v19
    v_accvgpr_read_b32 v18, a35
    v_mul_f32 v19, v18, v17
    v_accvgpr_write_b32 a35, v19
    v_accvgpr_read_b32 v18, a36
    v_mul_f32 v19, v18, v17
    v_accvgpr_write_b32 a36, v19
    v_accvgpr_read_b32 v18, a37
    v_mul_f32 v19, v18, v17
    v_accvgpr_write_b32 a37, v19
    v_accvgpr_read_b32 v18, a38
    v_mul_f32 v19, v18, v17
    v_accvgpr_write_b32 a38, v19
    v_accvgpr_read_b32 v18, a39
    v_mul_f32 v19, v18, v17
    v_accvgpr_write_b32 a39, v19
    v_accvgpr_read_b32 v18, a40
    v_mul_f32 v19, v18, v17
    v_accvgpr_write_b32 a40, v19
    v_accvgpr_read_b32 v18, a41
    v_mul_f32 v19, v18, v17
    v_accvgpr_write_b32 a41, v19
    v_accvgpr_read_b32 v18, a42
    v_mul_f32 v19, v18, v17
    v_accvgpr_write_b32 a42, v19
    v_accvgpr_read_b32 v18, a43
    v_mul_f32 v19, v18, v17
    v_accvgpr_write_b32 a43, v19
    v_accvgpr_read_b32 v18, a44
    v_mul_f32 v19, v18, v17
    v_accvgpr_write_b32 a44, v19
    v_accvgpr_read_b32 v18, a45
    v_mul_f32 v19, v18, v17
    v_accvgpr_write_b32 a45, v19
    v_accvgpr_read_b32 v18, a46
    v_mul_f32 v19, v18, v17
    v_accvgpr_write_b32 a46, v19
    v_accvgpr_read_b32 v18, a47
    v_mul_f32 v19, v18, v17
    v_accvgpr_write_b32 a47, v19
    v_accvgpr_read_b32 v18, a48
    v_mul_f32 v19, v18, v17
    v_accvgpr_write_b32 a48, v19
    v_accvgpr_read_b32 v18, a49
    v_mul_f32 v19, v18, v17
    v_accvgpr_write_b32 a49, v19
    v_accvgpr_read_b32 v18, a50
    v_mul_f32 v19, v18, v17
    v_accvgpr_write_b32 a50, v19
    v_accvgpr_read_b32 v18, a51
    v_mul_f32 v19, v18, v17
    v_accvgpr_write_b32 a51, v19
    v_accvgpr_read_b32 v18, a52
    v_mul_f32 v19, v18, v17
    v_accvgpr_write_b32 a52, v19
    v_accvgpr_read_b32 v18, a53
    v_mul_f32 v19, v18, v17
    v_accvgpr_write_b32 a53, v19
    v_accvgpr_read_b32 v18, a54
    v_mul_f32 v19, v18, v17
    v_accvgpr_write_b32 a54, v19
    v_accvgpr_read_b32 v18, a55
    v_mul_f32 v19, v18, v17
    v_accvgpr_write_b32 a55, v19
    v_accvgpr_read_b32 v18, a56
    v_mul_f32 v19, v18, v17
    v_accvgpr_write_b32 a56, v19
    v_accvgpr_read_b32 v18, a57
    v_mul_f32 v19, v18, v17
    v_accvgpr_write_b32 a57, v19
    v_accvgpr_read_b32 v18, a58
    v_mul_f32 v19, v18, v17
    v_accvgpr_write_b32 a58, v19
    v_accvgpr_read_b32 v18, a59
    v_mul_f32 v19, v18, v17
    v_accvgpr_write_b32 a59, v19
    v_accvgpr_read_b32 v18, a60
    v_mul_f32 v19, v18, v17
    v_accvgpr_write_b32 a60, v19
    v_accvgpr_read_b32 v18, a61
    v_mul_f32 v19, v18, v17
    v_accvgpr_write_b32 a61, v19
    v_accvgpr_read_b32 v18, a62
    v_mul_f32 v19, v18, v17
    v_accvgpr_write_b32 a62, v19
    v_accvgpr_read_b32 v18, a63
    v_mul_f32 v19, v18, v17
    v_accvgpr_write_b32 a63, v19
    v_mov_b32 v14, 0
    v_sub_f32 v18, v80, v16
    v_sub_f32 v19, v81, v16
    v_exp_f32 v18, v18
    v_exp_f32 v19, v19
    s_nop 0
    v_add_f32 v14, v14, v18
    v_add_f32 v14, v14, v19
    v_cvt_pk_bf16_f32 v104, v18, v19
    v_sub_f32 v18, v82, v16
    v_sub_f32 v19, v83, v16
    v_exp_f32 v18, v18
    v_exp_f32 v19, v19
    s_nop 0
    v_add_f32 v14, v14, v18
    v_add_f32 v14, v14, v19
    v_cvt_pk_bf16_f32 v105, v18, v19
    v_sub_f32 v18, v84, v16
    v_sub_f32 v19, v85, v16
    v_exp_f32 v18, v18
    v_exp_f32 v19, v19
    s_nop 0
    v_add_f32 v14, v14, v18
    v_add_f32 v14, v14, v19
    v_cvt_pk_bf16_f32 v106, v18, v19
    v_sub_f32 v18, v86, v16
    v_sub_f32 v19, v87, v16
    v_exp_f32 v18, v18
    v_exp_f32 v19, v19
    s_nop 0
    v_add_f32 v14, v14, v18
    v_add_f32 v14, v14, v19
    v_cvt_pk_bf16_f32 v107, v18, v19
    v_sub_f32 v18, v88, v16
    v_sub_f32 v19, v89, v16
    v_exp_f32 v18, v18
    v_exp_f32 v19, v19
    s_nop 0
    v_add_f32 v14, v14, v18
    v_add_f32 v14, v14, v19
    v_cvt_pk_bf16_f32 v108, v18, v19
    v_sub_f32 v18, v90, v16
    v_sub_f32 v19, v91, v16
    v_exp_f32 v18, v18
    v_exp_f32 v19, v19
    s_nop 0
    v_add_f32 v14, v14, v18
    v_add_f32 v14, v14, v19
    v_cvt_pk_bf16_f32 v109, v18, v19
    v_sub_f32 v18, v92, v16
    v_sub_f32 v19, v93, v16
    v_exp_f32 v18, v18
    v_exp_f32 v19, v19
    s_nop 0
    v_add_f32 v14, v14, v18
    v_add_f32 v14, v14, v19
    v_cvt_pk_bf16_f32 v110, v18, v19
    v_sub_f32 v18, v94, v16
    v_sub_f32 v19, v95, v16
    v_exp_f32 v18, v18
    v_exp_f32 v19, v19
    s_nop 0
    v_add_f32 v14, v14, v18
    v_add_f32 v14, v14, v19
    v_cvt_pk_bf16_f32 v111, v18, v19
    s_nop 3
    s_branch L_back21
L_slow22:
    s_nop 15
    s_nop 15
    v_max3_f32 v16, v64, v65, v66
    v_max3_f32 v16, v16, v67, v68
    v_max3_f32 v16, v16, v69, v70
    v_max3_f32 v16, v16, v71, v72
    v_max3_f32 v16, v16, v73, v74
    v_max3_f32 v16, v16, v75, v76
    v_max3_f32 v16, v16, v77, v78
    v_max_f32 v16, v16, v79
    v_mov_b32 v17, v16
    s_nop 1
    v_permlane32_swap_b32 v16, v17
    s_nop 1
    v_max3_f32 v16, v16, v17, 0
    v_exp_f32 v17, -v16
    s_nop 1
    v_sub_f32 v13, v13, v16
    v_mov_b32 v112, v13
    v_mov_b32 v113, v13
    v_mov_b32 v114, v13
    v_mov_b32 v115, v13
    v_mov_b32 v116, v13
    v_mov_b32 v117, v13
    v_mov_b32 v118, v13
    v_mov_b32 v119, v13
    v_mov_b32 v120, v13
    v_mov_b32 v121, v13
    v_mov_b32 v122, v13
    v_mov_b32 v123, v13
    v_mov_b32 v124, v13
    v_mov_b32 v125, v13
    v_mov_b32 v126, v13
    v_mov_b32 v127, v13
    v_sub_f32 v80, v80, v16
    v_sub_f32 v81, v81, v16
    v_sub_f32 v82, v82, v16
    v_sub_f32 v83, v83, v16
    v_sub_f32 v84, v84, v16
    v_sub_f32 v85, v85, v16
    v_sub_f32 v86, v86, v16
    v_sub_f32 v87, v87, v16
    v_sub_f32 v88, v88, v16
    v_sub_f32 v89, v89, v16
    v_sub_f32 v90, v90, v16
    v_sub_f32 v91, v91, v16
    v_sub_f32 v92, v92, v16
    v_sub_f32 v93, v93, v16
    v_sub_f32 v94, v94, v16
    v_sub_f32 v95, v95, v16
    v_mul_f32 v12, v12, v17
    v_accvgpr_read_b32 v18, a0
    v_mul_f32 v19, v18, v17
    v_accvgpr_write_b32 a0, v19
    v_accvgpr_read_b32 v18, a1
    v_mul_f32 v19, v18, v17
    v_accvgpr_write_b32 a1, v19
    v_accvgpr_read_b32 v18, a2
    v_mul_f32 v19, v18, v17
    v_accvgpr_write_b32 a2, v19
    v_accvgpr_read_b32 v18, a3
    v_mul_f32 v19, v18, v17
    v_accvgpr_write_b32 a3, v19
    v_accvgpr_read_b32 v18, a4
    v_mul_f32 v19, v18, v17
    v_accvgpr_write_b32 a4, v19
    v_accvgpr_read_b32 v18, a5
    v_mul_f32 v19, v18, v17
    v_accvgpr_write_b32 a5, v19
    v_accvgpr_read_b32 v18, a6
    v_mul_f32 v19, v18, v17
    v_accvgpr_write_b32 a6, v19
    v_accvgpr_read_b32 v18, a7
    v_mul_f32 v19, v18, v17
    v_accvgpr_write_b32 a7, v19
    v_accvgpr_read_b32 v18, a8
    v_mul_f32 v19, v18, v17
    v_accvgpr_write_b32 a8, v19
    v_accvgpr_read_b32 v18, a9
    v_mul_f32 v19, v18, v17
    v_accvgpr_write_b32 a9, v19
    v_accvgpr_read_b32 v18, a10
    v_mul_f32 v19, v18, v17
    v_accvgpr_write_b32 a10, v19
    v_accvgpr_read_b32 v18, a11
    v_mul_f32 v19, v18, v17
    v_accvgpr_write_b32 a11, v19
    v_accvgpr_read_b32 v18, a12
    v_mul_f32 v19, v18, v17
    v_accvgpr_write_b32 a12, v19
    v_accvgpr_read_b32 v18, a13
    v_mul_f32 v19, v18, v17
    v_accvgpr_write_b32 a13, v19
    v_accvgpr_read_b32 v18, a14
    v_mul_f32 v19, v18, v17
    v_accvgpr_write_b32 a14, v19
    v_accvgpr_read_b32 v18, a15
    v_mul_f32 v19, v18, v17
    v_accvgpr_write_b32 a15, v19
    v_accvgpr_read_b32 v18, a16
    v_mul_f32 v19, v18, v17
    v_accvgpr_write_b32 a16, v19
    v_accvgpr_read_b32 v18, a17
    v_mul_f32 v19, v18, v17
    v_accvgpr_write_b32 a17, v19
    v_accvgpr_read_b32 v18, a18
    v_mul_f32 v19, v18, v17
    v_accvgpr_write_b32 a18, v19
    v_accvgpr_read_b32 v18, a19
    v_mul_f32 v19, v18, v17
    v_accvgpr_write_b32 a19, v19
    v_accvgpr_read_b32 v18, a20
    v_mul_f32 v19, v18, v17
    v_accvgpr_write_b32 a20, v19
    v_accvgpr_read_b32 v18, a21
    v_mul_f32 v19, v18, v17
    v_accvgpr_write_b32 a21, v19
    v_accvgpr_read_b32 v18, a22
    v_mul_f32 v19, v18, v17
    v_accvgpr_write_b32 a22, v19
    v_accvgpr_read_b32 v18, a23
    v_mul_f32 v19, v18, v17
    v_accvgpr_write_b32 a23, v19
    v_accvgpr_read_b32 v18, a24
    v_mul_f32 v19, v18, v17
    v_accvgpr_write_b32 a24, v19
    v_accvgpr_read_b32 v18, a25
    v_mul_f32 v19, v18, v17
    v_accvgpr_write_b32 a25, v19
    v_accvgpr_read_b32 v18, a26
    v_mul_f32 v19, v18, v17
    v_accvgpr_write_b32 a26, v19
    v_accvgpr_read_b32 v18, a27
    v_mul_f32 v19, v18, v17
    v_accvgpr_write_b32 a27, v19
    v_accvgpr_read_b32 v18, a28
    v_mul_f32 v19, v18, v17
    v_accvgpr_write_b32 a28, v19
    v_accvgpr_read_b32 v18, a29
    v_mul_f32 v19, v18, v17
    v_accvgpr_write_b32 a29, v19
    v_accvgpr_read_b32 v18, a30
    v_mul_f32 v19, v18, v17
    v_accvgpr_write_b32 a30, v19
    v_accvgpr_read_b32 v18, a31
    v_mul_f32 v19, v18, v17
    v_accvgpr_write_b32 a31, v19
    v_accvgpr_read_b32 v18, a32
    v_mul_f32 v19, v18, v17
    v_accvgpr_write_b32 a32, v19
    v_accvgpr_read_b32 v18, a33
    v_mul_f32 v19, v18, v17
    v_accvgpr_write_b32 a33, v19
    v_accvgpr_read_b32 v18, a34
    v_mul_f32 v19, v18, v17
    v_accvgpr_write_b32 a34, v19
    v_accvgpr_read_b32 v18, a35
    v_mul_f32 v19, v18, v17
    v_accvgpr_write_b32 a35, v19
    v_accvgpr_read_b32 v18, a36
    v_mul_f32 v19, v18, v17
    v_accvgpr_write_b32 a36, v19
    v_accvgpr_read_b32 v18, a37
    v_mul_f32 v19, v18, v17
    v_accvgpr_write_b32 a37, v19
    v_accvgpr_read_b32 v18, a38
    v_mul_f32 v19, v18, v17
    v_accvgpr_write_b32 a38, v19
    v_accvgpr_read_b32 v18, a39
    v_mul_f32 v19, v18, v17
    v_accvgpr_write_b32 a39, v19
    v_accvgpr_read_b32 v18, a40
    v_mul_f32 v19, v18, v17
    v_accvgpr_write_b32 a40, v19
    v_accvgpr_read_b32 v18, a41
    v_mul_f32 v19, v18, v17
    v_accvgpr_write_b32 a41, v19
    v_accvgpr_read_b32 v18, a42
    v_mul_f32 v19, v18, v17
    v_accvgpr_write_b32 a42, v19
    v_accvgpr_read_b32 v18, a43
    v_mul_f32 v19, v18, v17
    v_accvgpr_write_b32 a43, v19
    v_accvgpr_read_b32 v18, a44
    v_mul_f32 v19, v18, v17
    v_accvgpr_write_b32 a44, v19
    v_accvgpr_read_b32 v18, a45
    v_mul_f32 v19, v18, v17
    v_accvgpr_write_b32 a45, v19
    v_accvgpr_read_b32 v18, a46
    v_mul_f32 v19, v18, v17
    v_accvgpr_write_b32 a46, v19
    v_accvgpr_read_b32 v18, a47
    v_mul_f32 v19, v18, v17
    v_accvgpr_write_b32 a47, v19
    v_accvgpr_read_b32 v18, a48
    v_mul_f32 v19, v18, v17
    v_accvgpr_write_b32 a48, v19
    v_accvgpr_read_b32 v18, a49
    v_mul_f32 v19, v18, v17
    v_accvgpr_write_b32 a49, v19
    v_accvgpr_read_b32 v18, a50
    v_mul_f32 v19, v18, v17
    v_accvgpr_write_b32 a50, v19
    v_accvgpr_read_b32 v18, a51
    v_mul_f32 v19, v18, v17
    v_accvgpr_write_b32 a51, v19
    v_accvgpr_read_b32 v18, a52
    v_mul_f32 v19, v18, v17
    v_accvgpr_write_b32 a52, v19
    v_accvgpr_read_b32 v18, a53
    v_mul_f32 v19, v18, v17
    v_accvgpr_write_b32 a53, v19
    v_accvgpr_read_b32 v18, a54
    v_mul_f32 v19, v18, v17
    v_accvgpr_write_b32 a54, v19
    v_accvgpr_read_b32 v18, a55
    v_mul_f32 v19, v18, v17
    v_accvgpr_write_b32 a55, v19
    v_accvgpr_read_b32 v18, a56
    v_mul_f32 v19, v18, v17
    v_accvgpr_write_b32 a56, v19
    v_accvgpr_read_b32 v18, a57
    v_mul_f32 v19, v18, v17
    v_accvgpr_write_b32 a57, v19
    v_accvgpr_read_b32 v18, a58
    v_mul_f32 v19, v18, v17
    v_accvgpr_write_b32 a58, v19
    v_accvgpr_read_b32 v18, a59
    v_mul_f32 v19, v18, v17
    v_accvgpr_write_b32 a59, v19
    v_accvgpr_read_b32 v18, a60
    v_mul_f32 v19, v18, v17
    v_accvgpr_write_b32 a60, v19
    v_accvgpr_read_b32 v18, a61
    v_mul_f32 v19, v18, v17
    v_accvgpr_write_b32 a61, v19
    v_accvgpr_read_b32 v18, a62
    v_mul_f32 v19, v18, v17
    v_accvgpr_write_b32 a62, v19
    v_accvgpr_read_b32 v18, a63
    v_mul_f32 v19, v18, v17
    v_accvgpr_write_b32 a63, v19
    v_mov_b32 v14, 0
    v_sub_f32 v18, v64, v16
    v_sub_f32 v19, v65, v16
    v_exp_f32 v18, v18
    v_exp_f32 v19, v19
    s_nop 0
    v_add_f32 v14, v14, v18
    v_add_f32 v14, v14, v19
    v_cvt_pk_bf16_f32 v96, v18, v19
    v_sub_f32 v18, v66, v16
    v_sub_f32 v19, v67, v16
    v_exp_f32 v18, v18
    v_exp_f32 v19, v19
    s_nop 0
    v_add_f32 v14, v14, v18
    v_add_f32 v14, v14, v19
    v_cvt_pk_bf16_f32 v97, v18, v19
    v_sub_f32 v18, v68, v16
    v_sub_f32 v19, v69, v16
    v_exp_f32 v18, v18
    v_exp_f32 v19, v19
    s_nop 0
    v_add_f32 v14, v14, v18
    v_add_f32 v14, v14, v19
    v_cvt_pk_bf16_f32 v98, v18, v19
    v_sub_f32 v18, v70, v16
    v_sub_f32 v19, v71, v16
    v_exp_f32 v18, v18
    v_exp_f32 v19, v19
    s_nop 0
    v_add_f32 v14, v14, v18
    v_add_f32 v14, v14, v19
    v_cvt_pk_bf16_f32 v99, v18, v19
    v_sub_f32 v18, v72, v16
    v_sub_f32 v19, v73, v16
    v_exp_f32 v18, v18
    v_exp_f32 v19, v19
    s_nop 0
    v_add_f32 v14, v14, v18
    v_add_f32 v14, v14, v19
    v_cvt_pk_bf16_f32 v100, v18, v19
    v_sub_f32 v18, v74, v16
    v_sub_f32 v19, v75, v16
    v_exp_f32 v18, v18
    v_exp_f32 v19, v19
    s_nop 0
    v_add_f32 v14, v14, v18
    v_add_f32 v14, v14, v19
    v_cvt_pk_bf16_f32 v101, v18, v19
    v_sub_f32 v18, v76, v16
    v_sub_f32 v19, v77, v16
    v_exp_f32 v18, v18
    v_exp_f32 v19, v19
    s_nop 0
    v_add_f32 v14, v14, v18
    v_add_f32 v14, v14, v19
    v_cvt_pk_bf16_f32 v102, v18, v19
    v_sub_f32 v18, v78, v16
    v_sub_f32 v19, v79, v16
    v_exp_f32 v18, v18
    v_exp_f32 v19, v19
    s_nop 0
    v_add_f32 v14, v14, v18
    v_add_f32 v14, v14, v19
    v_cvt_pk_bf16_f32 v103, v18, v19
    s_nop 3
    s_branch L_back22
L_slow23:
    s_nop 15
    s_nop 15
    v_max3_f32 v16, v80, v81, v82
    v_max3_f32 v16, v16, v83, v84
    v_max3_f32 v16, v16, v85, v86
    v_max3_f32 v16, v16, v87, v88
    v_max3_f32 v16, v16, v89, v90
    v_max3_f32 v16, v16, v91, v92
    v_max3_f32 v16, v16, v93, v94
    v_max_f32 v16, v16, v95
    v_mov_b32 v17, v16
    s_nop 1
    v_permlane32_swap_b32 v16, v17
    s_nop 1
    v_max3_f32 v16, v16, v17, 0
    v_exp_f32 v17, -v16
    s_nop 1
    v_sub_f32 v13, v13, v16
    v_mov_b32 v112, v13
    v_mov_b32 v113, v13
    v_mov_b32 v114, v13
    v_mov_b32 v115, v13
    v_mov_b32 v116, v13
    v_mov_b32 v117, v13
    v_mov_b32 v118, v13
    v_mov_b32 v119, v13
    v_mov_b32 v120, v13
    v_mov_b32 v121, v13
    v_mov_b32 v122, v13
    v_mov_b32 v123, v13
    v_mov_b32 v124, v13
    v_mov_b32 v125, v13
    v_mov_b32 v126, v13
    v_mov_b32 v127, v13
    v_sub_f32 v64, v64, v16
    v_sub_f32 v65, v65, v16
    v_sub_f32 v66, v66, v16
    v_sub_f32 v67, v67, v16
    v_sub_f32 v68, v68, v16
    v_sub_f32 v69, v69, v16
    v_sub_f32 v70, v70, v16
    v_sub_f32 v71, v71, v16
    v_sub_f32 v72, v72, v16
    v_sub_f32 v73, v73, v16
    v_sub_f32 v74, v74, v16
    v_sub_f32 v75, v75, v16
    v_sub_f32 v76, v76, v16
    v_sub_f32 v77, v77, v16
    v_sub_f32 v78, v78, v16
    v_sub_f32 v79, v79, v16
    v_mul_f32 v12, v12, v17
    v_accvgpr_read_b32 v18, a0
    v_mul_f32 v19, v18, v17
    v_accvgpr_write_b32 a0, v19
    v_accvgpr_read_b32 v18, a1
    v_mul_f32 v19, v18, v17
    v_accvgpr_write_b32 a1, v19
    v_accvgpr_read_b32 v18, a2
    v_mul_f32 v19, v18, v17
    v_accvgpr_write_b32 a2, v19
    v_accvgpr_read_b32 v18, a3
    v_mul_f32 v19, v18, v17
    v_accvgpr_write_b32 a3, v19
    v_accvgpr_read_b32 v18, a4
    v_mul_f32 v19, v18, v17
    v_accvgpr_write_b32 a4, v19
    v_accvgpr_read_b32 v18, a5
    v_mul_f32 v19, v18, v17
    v_accvgpr_write_b32 a5, v19
    v_accvgpr_read_b32 v18, a6
    v_mul_f32 v19, v18, v17
    v_accvgpr_write_b32 a6, v19
    v_accvgpr_read_b32 v18, a7
    v_mul_f32 v19, v18, v17
    v_accvgpr_write_b32 a7, v19
    v_accvgpr_read_b32 v18, a8
    v_mul_f32 v19, v18, v17
    v_accvgpr_write_b32 a8, v19
    v_accvgpr_read_b32 v18, a9
    v_mul_f32 v19, v18, v17
    v_accvgpr_write_b32 a9, v19
    v_accvgpr_read_b32 v18, a10
    v_mul_f32 v19, v18, v17
    v_accvgpr_write_b32 a10, v19
    v_accvgpr_read_b32 v18, a11
    v_mul_f32 v19, v18, v17
    v_accvgpr_write_b32 a11, v19
    v_accvgpr_read_b32 v18, a12
    v_mul_f32 v19, v18, v17
    v_accvgpr_write_b32 a12, v19
    v_accvgpr_read_b32 v18, a13
    v_mul_f32 v19, v18, v17
    v_accvgpr_write_b32 a13, v19
    v_accvgpr_read_b32 v18, a14
    v_mul_f32 v19, v18, v17
    v_accvgpr_write_b32 a14, v19
    v_accvgpr_read_b32 v18, a15
    v_mul_f32 v19, v18, v17
    v_accvgpr_write_b32 a15, v19
    v_accvgpr_read_b32 v18, a16
    v_mul_f32 v19, v18, v17
    v_accvgpr_write_b32 a16, v19
    v_accvgpr_read_b32 v18, a17
    v_mul_f32 v19, v18, v17
    v_accvgpr_write_b32 a17, v19
    v_accvgpr_read_b32 v18, a18
    v_mul_f32 v19, v18, v17
    v_accvgpr_write_b32 a18, v19
    v_accvgpr_read_b32 v18, a19
    v_mul_f32 v19, v18, v17
    v_accvgpr_write_b32 a19, v19
    v_accvgpr_read_b32 v18, a20
    v_mul_f32 v19, v18, v17
    v_accvgpr_write_b32 a20, v19
    v_accvgpr_read_b32 v18, a21
    v_mul_f32 v19, v18, v17
    v_accvgpr_write_b32 a21, v19
    v_accvgpr_read_b32 v18, a22
    v_mul_f32 v19, v18, v17
    v_accvgpr_write_b32 a22, v19
    v_accvgpr_read_b32 v18, a23
    v_mul_f32 v19, v18, v17
    v_accvgpr_write_b32 a23, v19
    v_accvgpr_read_b32 v18, a24
    v_mul_f32 v19, v18, v17
    v_accvgpr_write_b32 a24, v19
    v_accvgpr_read_b32 v18, a25
    v_mul_f32 v19, v18, v17
    v_accvgpr_write_b32 a25, v19
    v_accvgpr_read_b32 v18, a26
    v_mul_f32 v19, v18, v17
    v_accvgpr_write_b32 a26, v19
    v_accvgpr_read_b32 v18, a27
    v_mul_f32 v19, v18, v17
    v_accvgpr_write_b32 a27, v19
    v_accvgpr_read_b32 v18, a28
    v_mul_f32 v19, v18, v17
    v_accvgpr_write_b32 a28, v19
    v_accvgpr_read_b32 v18, a29
    v_mul_f32 v19, v18, v17
    v_accvgpr_write_b32 a29, v19
    v_accvgpr_read_b32 v18, a30
    v_mul_f32 v19, v18, v17
    v_accvgpr_write_b32 a30, v19
    v_accvgpr_read_b32 v18, a31
    v_mul_f32 v19, v18, v17
    v_accvgpr_write_b32 a31, v19
    v_accvgpr_read_b32 v18, a32
    v_mul_f32 v19, v18, v17
    v_accvgpr_write_b32 a32, v19
    v_accvgpr_read_b32 v18, a33
    v_mul_f32 v19, v18, v17
    v_accvgpr_write_b32 a33, v19
    v_accvgpr_read_b32 v18, a34
    v_mul_f32 v19, v18, v17
    v_accvgpr_write_b32 a34, v19
    v_accvgpr_read_b32 v18, a35
    v_mul_f32 v19, v18, v17
    v_accvgpr_write_b32 a35, v19
    v_accvgpr_read_b32 v18, a36
    v_mul_f32 v19, v18, v17
    v_accvgpr_write_b32 a36, v19
    v_accvgpr_read_b32 v18, a37
    v_mul_f32 v19, v18, v17
    v_accvgpr_write_b32 a37, v19
    v_accvgpr_read_b32 v18, a38
    v_mul_f32 v19, v18, v17
    v_accvgpr_write_b32 a38, v19
    v_accvgpr_read_b32 v18, a39
    v_mul_f32 v19, v18, v17
    v_accvgpr_write_b32 a39, v19
    v_accvgpr_read_b32 v18, a40
    v_mul_f32 v19, v18, v17
    v_accvgpr_write_b32 a40, v19
    v_accvgpr_read_b32 v18, a41
    v_mul_f32 v19, v18, v17
    v_accvgpr_write_b32 a41, v19
    v_accvgpr_read_b32 v18, a42
    v_mul_f32 v19, v18, v17
    v_accvgpr_write_b32 a42, v19
    v_accvgpr_read_b32 v18, a43
    v_mul_f32 v19, v18, v17
    v_accvgpr_write_b32 a43, v19
    v_accvgpr_read_b32 v18, a44
    v_mul_f32 v19, v18, v17
    v_accvgpr_write_b32 a44, v19
    v_accvgpr_read_b32 v18, a45
    v_mul_f32 v19, v18, v17
    v_accvgpr_write_b32 a45, v19
    v_accvgpr_read_b32 v18, a46
    v_mul_f32 v19, v18, v17
    v_accvgpr_write_b32 a46, v19
    v_accvgpr_read_b32 v18, a47
    v_mul_f32 v19, v18, v17
    v_accvgpr_write_b32 a47, v19
    v_accvgpr_read_b32 v18, a48
    v_mul_f32 v19, v18, v17
    v_accvgpr_write_b32 a48, v19
    v_accvgpr_read_b32 v18, a49
    v_mul_f32 v19, v18, v17
    v_accvgpr_write_b32 a49, v19
    v_accvgpr_read_b32 v18, a50
    v_mul_f32 v19, v18, v17
    v_accvgpr_write_b32 a50, v19
    v_accvgpr_read_b32 v18, a51
    v_mul_f32 v19, v18, v17
    v_accvgpr_write_b32 a51, v19
    v_accvgpr_read_b32 v18, a52
    v_mul_f32 v19, v18, v17
    v_accvgpr_write_b32 a52, v19
    v_accvgpr_read_b32 v18, a53
    v_mul_f32 v19, v18, v17
    v_accvgpr_write_b32 a53, v19
    v_accvgpr_read_b32 v18, a54
    v_mul_f32 v19, v18, v17
    v_accvgpr_write_b32 a54, v19
    v_accvgpr_read_b32 v18, a55
    v_mul_f32 v19, v18, v17
    v_accvgpr_write_b32 a55, v19
    v_accvgpr_read_b32 v18, a56
    v_mul_f32 v19, v18, v17
    v_accvgpr_write_b32 a56, v19
    v_accvgpr_read_b32 v18, a57
    v_mul_f32 v19, v18, v17
    v_accvgpr_write_b32 a57, v19
    v_accvgpr_read_b32 v18, a58
    v_mul_f32 v19, v18, v17
    v_accvgpr_write_b32 a58, v19
    v_accvgpr_read_b32 v18, a59
    v_mul_f32 v19, v18, v17
    v_accvgpr_write_b32 a59, v19
    v_accvgpr_read_b32 v18, a60
    v_mul_f32 v19, v18, v17
    v_accvgpr_write_b32 a60, v19
    v_accvgpr_read_b32 v18, a61
    v_mul_f32 v19, v18, v17
    v_accvgpr_write_b32 a61, v19
    v_accvgpr_read_b32 v18, a62
    v_mul_f32 v19, v18, v17
    v_accvgpr_write_b32 a62, v19
    v_accvgpr_read_b32 v18, a63
    v_mul_f32 v19, v18, v17
    v_accvgpr_write_b32 a63, v19
    v_mov_b32 v14, 0
    v_sub_f32 v18, v80, v16
    v_sub_f32 v19, v81, v16
    v_exp_f32 v18, v18
    v_exp_f32 v19, v19
    s_nop 0
    v_add_f32 v14, v14, v18
    v_add_f32 v14, v14, v19
    v_cvt_pk_bf16_f32 v104, v18, v19
    v_sub_f32 v18, v82, v16
    v_sub_f32 v19, v83, v16
    v_exp_f32 v18, v18
    v_exp_f32 v19, v19
    s_nop 0
    v_add_f32 v14, v14, v18
    v_add_f32 v14, v14, v19
    v_cvt_pk_bf16_f32 v105, v18, v19
    v_sub_f32 v18, v84, v16
    v_sub_f32 v19, v85, v16
    v_exp_f32 v18, v18
    v_exp_f32 v19, v19
    s_nop 0
    v_add_f32 v14, v14, v18
    v_add_f32 v14, v14, v19
    v_cvt_pk_bf16_f32 v106, v18, v19
    v_sub_f32 v18, v86, v16
    v_sub_f32 v19, v87, v16
    v_exp_f32 v18, v18
    v_exp_f32 v19, v19
    s_nop 0
    v_add_f32 v14, v14, v18
    v_add_f32 v14, v14, v19
    v_cvt_pk_bf16_f32 v107, v18, v19
    v_sub_f32 v18, v88, v16
    v_sub_f32 v19, v89, v16
    v_exp_f32 v18, v18
    v_exp_f32 v19, v19
    s_nop 0
    v_add_f32 v14, v14, v18
    v_add_f32 v14, v14, v19
    v_cvt_pk_bf16_f32 v108, v18, v19
    v_sub_f32 v18, v90, v16
    v_sub_f32 v19, v91, v16
    v_exp_f32 v18, v18
    v_exp_f32 v19, v19
    s_nop 0
    v_add_f32 v14, v14, v18
    v_add_f32 v14, v14, v19
    v_cvt_pk_bf16_f32 v109, v18, v19
    v_sub_f32 v18, v92, v16
    v_sub_f32 v19, v93, v16
    v_exp_f32 v18, v18
    v_exp_f32 v19, v19
    s_nop 0
    v_add_f32 v14, v14, v18
    v_add_f32 v14, v14, v19
    v_cvt_pk_bf16_f32 v110, v18, v19
    v_sub_f32 v18, v94, v16
    v_sub_f32 v19, v95, v16
    v_exp_f32 v18, v18
    v_exp_f32 v19, v19
    s_nop 0
    v_add_f32 v14, v14, v18
    v_add_f32 v14, v14, v19
    v_cvt_pk_bf16_f32 v111, v18, v19
    s_nop 3
    s_branch L_back23
L_slow24:
    s_nop 15
    s_nop 15
    v_max3_f32 v16, v64, v65, v66
    v_max3_f32 v16, v16, v67, v68
    v_max3_f32 v16, v16, v69, v70
    v_max3_f32 v16, v16, v71, v72
    v_max3_f32 v16, v16, v73, v74
    v_max3_f32 v16, v16, v75, v76
    v_max3_f32 v16, v16, v77, v78
    v_max_f32 v16, v16, v79
    v_mov_b32 v17, v16
    s_nop 1
    v_permlane32_swap_b32 v16, v17
    s_nop 1
    v_max3_f32 v16, v16, v17, 0
    v_exp_f32 v17, -v16
    s_nop 1
    v_sub_f32 v13, v13, v16
    v_mov_b32 v112, v13
    v_mov_b32 v113, v13
    v_mov_b32 v114, v13
    v_mov_b32 v115, v13
    v_mov_b32 v116, v13
    v_mov_b32 v117, v13
    v_mov_b32 v118, v13
    v_mov_b32 v119, v13
    v_mov_b32 v120, v13
    v_mov_b32 v121, v13
    v_mov_b32 v122, v13
    v_mov_b32 v123, v13
    v_mov_b32 v124, v13
    v_mov_b32 v125, v13
    v_mov_b32 v126, v13
    v_mov_b32 v127, v13
    v_sub_f32 v80, v80, v16
    v_sub_f32 v81, v81, v16
    v_sub_f32 v82, v82, v16
    v_sub_f32 v83, v83, v16
    v_sub_f32 v84, v84, v16
    v_sub_f32 v85, v85, v16
    v_sub_f32 v86, v86, v16
    v_sub_f32 v87, v87, v16
    v_sub_f32 v88, v88, v16
    v_sub_f32 v89, v89, v16
    v_sub_f32 v90, v90, v16
    v_sub_f32 v91, v91, v16
    v_sub_f32 v92, v92, v16
    v_sub_f32 v93, v93, v16
    v_sub_f32 v94, v94, v16
    v_sub_f32 v95, v95, v16
    v_mul_f32 v12, v12, v17
    v_accvgpr_read_b32 v18, a0
    v_mul_f32 v19, v18, v17
    v_accvgpr_write_b32 a0, v19
    v_accvgpr_read_b32 v18, a1
    v_mul_f32 v19, v18, v17
    v_accvgpr_write_b32 a1, v19
    v_accvgpr_read_b32 v18, a2
    v_mul_f32 v19, v18, v17
    v_accvgpr_write_b32 a2, v19
    v_accvgpr_read_b32 v18, a3
    v_mul_f32 v19, v18, v17
    v_accvgpr_write_b32 a3, v19
    v_accvgpr_read_b32 v18, a4
    v_mul_f32 v19, v18, v17
    v_accvgpr_write_b32 a4, v19
    v_accvgpr_read_b32 v18, a5
    v_mul_f32 v19, v18, v17
    v_accvgpr_write_b32 a5, v19
    v_accvgpr_read_b32 v18, a6
    v_mul_f32 v19, v18, v17
    v_accvgpr_write_b32 a6, v19
    v_accvgpr_read_b32 v18, a7
    v_mul_f32 v19, v18, v17
    v_accvgpr_write_b32 a7, v19
    v_accvgpr_read_b32 v18, a8
    v_mul_f32 v19, v18, v17
    v_accvgpr_write_b32 a8, v19
    v_accvgpr_read_b32 v18, a9
    v_mul_f32 v19, v18, v17
    v_accvgpr_write_b32 a9, v19
    v_accvgpr_read_b32 v18, a10
    v_mul_f32 v19, v18, v17
    v_accvgpr_write_b32 a10, v19
    v_accvgpr_read_b32 v18, a11
    v_mul_f32 v19, v18, v17
    v_accvgpr_write_b32 a11, v19
    v_accvgpr_read_b32 v18, a12
    v_mul_f32 v19, v18, v17
    v_accvgpr_write_b32 a12, v19
    v_accvgpr_read_b32 v18, a13
    v_mul_f32 v19, v18, v17
    v_accvgpr_write_b32 a13, v19
    v_accvgpr_read_b32 v18, a14
    v_mul_f32 v19, v18, v17
    v_accvgpr_write_b32 a14, v19
    v_accvgpr_read_b32 v18, a15
    v_mul_f32 v19, v18, v17
    v_accvgpr_write_b32 a15, v19
    v_accvgpr_read_b32 v18, a16
    v_mul_f32 v19, v18, v17
    v_accvgpr_write_b32 a16, v19
    v_accvgpr_read_b32 v18, a17
    v_mul_f32 v19, v18, v17
    v_accvgpr_write_b32 a17, v19
    v_accvgpr_read_b32 v18, a18
    v_mul_f32 v19, v18, v17
    v_accvgpr_write_b32 a18, v19
    v_accvgpr_read_b32 v18, a19
    v_mul_f32 v19, v18, v17
    v_accvgpr_write_b32 a19, v19
    v_accvgpr_read_b32 v18, a20
    v_mul_f32 v19, v18, v17
    v_accvgpr_write_b32 a20, v19
    v_accvgpr_read_b32 v18, a21
    v_mul_f32 v19, v18, v17
    v_accvgpr_write_b32 a21, v19
    v_accvgpr_read_b32 v18, a22
    v_mul_f32 v19, v18, v17
    v_accvgpr_write_b32 a22, v19
    v_accvgpr_read_b32 v18, a23
    v_mul_f32 v19, v18, v17
    v_accvgpr_write_b32 a23, v19
    v_accvgpr_read_b32 v18, a24
    v_mul_f32 v19, v18, v17
    v_accvgpr_write_b32 a24, v19
    v_accvgpr_read_b32 v18, a25
    v_mul_f32 v19, v18, v17
    v_accvgpr_write_b32 a25, v19
    v_accvgpr_read_b32 v18, a26
    v_mul_f32 v19, v18, v17
    v_accvgpr_write_b32 a26, v19
    v_accvgpr_read_b32 v18, a27
    v_mul_f32 v19, v18, v17
    v_accvgpr_write_b32 a27, v19
    v_accvgpr_read_b32 v18, a28
    v_mul_f32 v19, v18, v17
    v_accvgpr_write_b32 a28, v19
    v_accvgpr_read_b32 v18, a29
    v_mul_f32 v19, v18, v17
    v_accvgpr_write_b32 a29, v19
    v_accvgpr_read_b32 v18, a30
    v_mul_f32 v19, v18, v17
    v_accvgpr_write_b32 a30, v19
    v_accvgpr_read_b32 v18, a31
    v_mul_f32 v19, v18, v17
    v_accvgpr_write_b32 a31, v19
    v_accvgpr_read_b32 v18, a32
    v_mul_f32 v19, v18, v17
    v_accvgpr_write_b32 a32, v19
    v_accvgpr_read_b32 v18, a33
    v_mul_f32 v19, v18, v17
    v_accvgpr_write_b32 a33, v19
    v_accvgpr_read_b32 v18, a34
    v_mul_f32 v19, v18, v17
    v_accvgpr_write_b32 a34, v19
    v_accvgpr_read_b32 v18, a35
    v_mul_f32 v19, v18, v17
    v_accvgpr_write_b32 a35, v19
    v_accvgpr_read_b32 v18, a36
    v_mul_f32 v19, v18, v17
    v_accvgpr_write_b32 a36, v19
    v_accvgpr_read_b32 v18, a37
    v_mul_f32 v19, v18, v17
    v_accvgpr_write_b32 a37, v19
    v_accvgpr_read_b32 v18, a38
    v_mul_f32 v19, v18, v17
    v_accvgpr_write_b32 a38, v19
    v_accvgpr_read_b32 v18, a39
    v_mul_f32 v19, v18, v17
    v_accvgpr_write_b32 a39, v19
    v_accvgpr_read_b32 v18, a40
    v_mul_f32 v19, v18, v17
    v_accvgpr_write_b32 a40, v19
    v_accvgpr_read_b32 v18, a41
    v_mul_f32 v19, v18, v17
    v_accvgpr_write_b32 a41, v19
    v_accvgpr_read_b32 v18, a42
    v_mul_f32 v19, v18, v17
    v_accvgpr_write_b32 a42, v19
    v_accvgpr_read_b32 v18, a43
    v_mul_f32 v19, v18, v17
    v_accvgpr_write_b32 a43, v19
    v_accvgpr_read_b32 v18, a44
    v_mul_f32 v19, v18, v17
    v_accvgpr_write_b32 a44, v19
    v_accvgpr_read_b32 v18, a45
    v_mul_f32 v19, v18, v17
    v_accvgpr_write_b32 a45, v19
    v_accvgpr_read_b32 v18, a46
    v_mul_f32 v19, v18, v17
    v_accvgpr_write_b32 a46, v19
    v_accvgpr_read_b32 v18, a47
    v_mul_f32 v19, v18, v17
    v_accvgpr_write_b32 a47, v19
    v_accvgpr_read_b32 v18, a48
    v_mul_f32 v19, v18, v17
    v_accvgpr_write_b32 a48, v19
    v_accvgpr_read_b32 v18, a49
    v_mul_f32 v19, v18, v17
    v_accvgpr_write_b32 a49, v19
    v_accvgpr_read_b32 v18, a50
    v_mul_f32 v19, v18, v17
    v_accvgpr_write_b32 a50, v19
    v_accvgpr_read_b32 v18, a51
    v_mul_f32 v19, v18, v17
    v_accvgpr_write_b32 a51, v19
    v_accvgpr_read_b32 v18, a52
    v_mul_f32 v19, v18, v17
    v_accvgpr_write_b32 a52, v19
    v_accvgpr_read_b32 v18, a53
    v_mul_f32 v19, v18, v17
    v_accvgpr_write_b32 a53, v19
    v_accvgpr_read_b32 v18, a54
    v_mul_f32 v19, v18, v17
    v_accvgpr_write_b32 a54, v19
    v_accvgpr_read_b32 v18, a55
    v_mul_f32 v19, v18, v17
    v_accvgpr_write_b32 a55, v19
    v_accvgpr_read_b32 v18, a56
    v_mul_f32 v19, v18, v17
    v_accvgpr_write_b32 a56, v19
    v_accvgpr_read_b32 v18, a57
    v_mul_f32 v19, v18, v17
    v_accvgpr_write_b32 a57, v19
    v_accvgpr_read_b32 v18, a58
    v_mul_f32 v19, v18, v17
    v_accvgpr_write_b32 a58, v19
    v_accvgpr_read_b32 v18, a59
    v_mul_f32 v19, v18, v17
    v_accvgpr_write_b32 a59, v19
    v_accvgpr_read_b32 v18, a60
    v_mul_f32 v19, v18, v17
    v_accvgpr_write_b32 a60, v19
    v_accvgpr_read_b32 v18, a61
    v_mul_f32 v19, v18, v17
    v_accvgpr_write_b32 a61, v19
    v_accvgpr_read_b32 v18, a62
    v_mul_f32 v19, v18, v17
    v_accvgpr_write_b32 a62, v19
    v_accvgpr_read_b32 v18, a63
    v_mul_f32 v19, v18, v17
    v_accvgpr_write_b32 a63, v19
    v_mov_b32 v14, 0
    v_sub_f32 v18, v64, v16
    v_sub_f32 v19, v65, v16
    v_exp_f32 v18, v18
    v_exp_f32 v19, v19
    s_nop 0
    v_add_f32 v14, v14, v18
    v_add_f32 v14, v14, v19
    v_cvt_pk_bf16_f32 v96, v18, v19
    v_sub_f32 v18, v66, v16
    v_sub_f32 v19, v67, v16
    v_exp_f32 v18, v18
    v_exp_f32 v19, v19
    s_nop 0
    v_add_f32 v14, v14, v18
    v_add_f32 v14, v14, v19
    v_cvt_pk_bf16_f32 v97, v18, v19
    v_sub_f32 v18, v68, v16
    v_sub_f32 v19, v69, v16
    v_exp_f32 v18, v18
    v_exp_f32 v19, v19
    s_nop 0
    v_add_f32 v14, v14, v18
    v_add_f32 v14, v14, v19
    v_cvt_pk_bf16_f32 v98, v18, v19
    v_sub_f32 v18, v70, v16
    v_sub_f32 v19, v71, v16
    v_exp_f32 v18, v18
    v_exp_f32 v19, v19
    s_nop 0
    v_add_f32 v14, v14, v18
    v_add_f32 v14, v14, v19
    v_cvt_pk_bf16_f32 v99, v18, v19
    v_sub_f32 v18, v72, v16
    v_sub_f32 v19, v73, v16
    v_exp_f32 v18, v18
    v_exp_f32 v19, v19
    s_nop 0
    v_add_f32 v14, v14, v18
    v_add_f32 v14, v14, v19
    v_cvt_pk_bf16_f32 v100, v18, v19
    v_sub_f32 v18, v74, v16
    v_sub_f32 v19, v75, v16
    v_exp_f32 v18, v18
    v_exp_f32 v19, v19
    s_nop 0
    v_add_f32 v14, v14, v18
    v_add_f32 v14, v14, v19
    v_cvt_pk_bf16_f32 v101, v18, v19
    v_sub_f32 v18, v76, v16
    v_sub_f32 v19, v77, v16
    v_exp_f32 v18, v18
    v_exp_f32 v19, v19
    s_nop 0
    v_add_f32 v14, v14, v18
    v_add_f32 v14, v14, v19
    v_cvt_pk_bf16_f32 v102, v18, v19
    v_sub_f32 v18, v78, v16
    v_sub_f32 v19, v79, v16
    v_exp_f32 v18, v18
    v_exp_f32 v19, v19
    s_nop 0
    v_add_f32 v14, v14, v18
    v_add_f32 v14, v14, v19
    v_cvt_pk_bf16_f32 v103, v18, v19
    s_nop 3
    s_branch L_back24
L_slow25:
    s_nop 15
    s_nop 15
    v_max3_f32 v16, v80, v81, v82
    v_max3_f32 v16, v16, v83, v84
    v_max3_f32 v16, v16, v85, v86
    v_max3_f32 v16, v16, v87, v88
    v_max3_f32 v16, v16, v89, v90
    v_max3_f32 v16, v16, v91, v92
    v_max3_f32 v16, v16, v93, v94
    v_max_f32 v16, v16, v95
    v_mov_b32 v17, v16
    s_nop 1
    v_permlane32_swap_b32 v16, v17
    s_nop 1
    v_max3_f32 v16, v16, v17, 0
    v_exp_f32 v17, -v16
    s_nop 1
    v_sub_f32 v13, v13, v16
    v_mov_b32 v112, v13
    v_mov_b32 v113, v13
    v_mov_b32 v114, v13
    v_mov_b32 v115, v13
    v_mov_b32 v116, v13
    v_mov_b32 v117, v13
    v_mov_b32 v118, v13
    v_mov_b32 v119, v13
    v_mov_b32 v120, v13
    v_mov_b32 v121, v13
    v_mov_b32 v122, v13
    v_mov_b32 v123, v13
    v_mov_b32 v124, v13
    v_mov_b32 v125, v13
    v_mov_b32 v126, v13
    v_mov_b32 v127, v13
    v_sub_f32 v64, v64, v16
    v_sub_f32 v65, v65, v16
    v_sub_f32 v66, v66, v16
    v_sub_f32 v67, v67, v16
    v_sub_f32 v68, v68, v16
    v_sub_f32 v69, v69, v16
    v_sub_f32 v70, v70, v16
    v_sub_f32 v71, v71, v16
    v_sub_f32 v72, v72, v16
    v_sub_f32 v73, v73, v16
    v_sub_f32 v74, v74, v16
    v_sub_f32 v75, v75, v16
    v_sub_f32 v76, v76, v16
    v_sub_f32 v77, v77, v16
    v_sub_f32 v78, v78, v16
    v_sub_f32 v79, v79, v16
    v_mul_f32 v12, v12, v17
    v_accvgpr_read_b32 v18, a0
    v_mul_f32 v19, v18, v17
    v_accvgpr_write_b32 a0, v19
    v_accvgpr_read_b32 v18, a1
    v_mul_f32 v19, v18, v17
    v_accvgpr_write_b32 a1, v19
    v_accvgpr_read_b32 v18, a2
    v_mul_f32 v19, v18, v17
    v_accvgpr_write_b32 a2, v19
    v_accvgpr_read_b32 v18, a3
    v_mul_f32 v19, v18, v17
    v_accvgpr_write_b32 a3, v19
    v_accvgpr_read_b32 v18, a4
    v_mul_f32 v19, v18, v17
    v_accvgpr_write_b32 a4, v19
    v_accvgpr_read_b32 v18, a5
    v_mul_f32 v19, v18, v17
    v_accvgpr_write_b32 a5, v19
    v_accvgpr_read_b32 v18, a6
    v_mul_f32 v19, v18, v17
    v_accvgpr_write_b32 a6, v19
    v_accvgpr_read_b32 v18, a7
    v_mul_f32 v19, v18, v17
    v_accvgpr_write_b32 a7, v19
    v_accvgpr_read_b32 v18, a8
    v_mul_f32 v19, v18, v17
    v_accvgpr_write_b32 a8, v19
    v_accvgpr_read_b32 v18, a9
    v_mul_f32 v19, v18, v17
    v_accvgpr_write_b32 a9, v19
    v_accvgpr_read_b32 v18, a10
    v_mul_f32 v19, v18, v17
    v_accvgpr_write_b32 a10, v19
    v_accvgpr_read_b32 v18, a11
    v_mul_f32 v19, v18, v17
    v_accvgpr_write_b32 a11, v19
    v_accvgpr_read_b32 v18, a12
    v_mul_f32 v19, v18, v17
    v_accvgpr_write_b32 a12, v19
    v_accvgpr_read_b32 v18, a13
    v_mul_f32 v19, v18, v17
    v_accvgpr_write_b32 a13, v19
    v_accvgpr_read_b32 v18, a14
    v_mul_f32 v19, v18, v17
    v_accvgpr_write_b32 a14, v19
    v_accvgpr_read_b32 v18, a15
    v_mul_f32 v19, v18, v17
    v_accvgpr_write_b32 a15, v19
    v_accvgpr_read_b32 v18, a16
    v_mul_f32 v19, v18, v17
    v_accvgpr_write_b32 a16, v19
    v_accvgpr_read_b32 v18, a17
    v_mul_f32 v19, v18, v17
    v_accvgpr_write_b32 a17, v19
    v_accvgpr_read_b32 v18, a18
    v_mul_f32 v19, v18, v17
    v_accvgpr_write_b32 a18, v19
    v_accvgpr_read_b32 v18, a19
    v_mul_f32 v19, v18, v17
    v_accvgpr_write_b32 a19, v19
    v_accvgpr_read_b32 v18, a20
    v_mul_f32 v19, v18, v17
    v_accvgpr_write_b32 a20, v19
    v_accvgpr_read_b32 v18, a21
    v_mul_f32 v19, v18, v17
    v_accvgpr_write_b32 a21, v19
    v_accvgpr_read_b32 v18, a22
    v_mul_f32 v19, v18, v17
    v_accvgpr_write_b32 a22, v19
    v_accvgpr_read_b32 v18, a23
    v_mul_f32 v19, v18, v17
    v_accvgpr_write_b32 a23, v19
    v_accvgpr_read_b32 v18, a24
    v_mul_f32 v19, v18, v17
    v_accvgpr_write_b32 a24, v19
    v_accvgpr_read_b32 v18, a25
    v_mul_f32 v19, v18, v17
    v_accvgpr_write_b32 a25, v19
    v_accvgpr_read_b32 v18, a26
    v_mul_f32 v19, v18, v17
    v_accvgpr_write_b32 a26, v19
    v_accvgpr_read_b32 v18, a27
    v_mul_f32 v19, v18, v17
    v_accvgpr_write_b32 a27, v19
    v_accvgpr_read_b32 v18, a28
    v_mul_f32 v19, v18, v17
    v_accvgpr_write_b32 a28, v19
    v_accvgpr_read_b32 v18, a29
    v_mul_f32 v19, v18, v17
    v_accvgpr_write_b32 a29, v19
    v_accvgpr_read_b32 v18, a30
    v_mul_f32 v19, v18, v17
    v_accvgpr_write_b32 a30, v19
    v_accvgpr_read_b32 v18, a31
    v_mul_f32 v19, v18, v17
    v_accvgpr_write_b32 a31, v19
    v_accvgpr_read_b32 v18, a32
    v_mul_f32 v19, v18, v17
    v_accvgpr_write_b32 a32, v19
    v_accvgpr_read_b32 v18, a33
    v_mul_f32 v19, v18, v17
    v_accvgpr_write_b32 a33, v19
    v_accvgpr_read_b32 v18, a34
    v_mul_f32 v19, v18, v17
    v_accvgpr_write_b32 a34, v19
    v_accvgpr_read_b32 v18, a35
    v_mul_f32 v19, v18, v17
    v_accvgpr_write_b32 a35, v19
    v_accvgpr_read_b32 v18, a36
    v_mul_f32 v19, v18, v17
    v_accvgpr_write_b32 a36, v19
    v_accvgpr_read_b32 v18, a37
    v_mul_f32 v19, v18, v17
    v_accvgpr_write_b32 a37, v19
    v_accvgpr_read_b32 v18, a38
    v_mul_f32 v19, v18, v17
    v_accvgpr_write_b32 a38, v19
    v_accvgpr_read_b32 v18, a39
    v_mul_f32 v19, v18, v17
    v_accvgpr_write_b32 a39, v19
    v_accvgpr_read_b32 v18, a40
    v_mul_f32 v19, v18, v17
    v_accvgpr_write_b32 a40, v19
    v_accvgpr_read_b32 v18, a41
    v_mul_f32 v19, v18, v17
    v_accvgpr_write_b32 a41, v19
    v_accvgpr_read_b32 v18, a42
    v_mul_f32 v19, v18, v17
    v_accvgpr_write_b32 a42, v19
    v_accvgpr_read_b32 v18, a43
    v_mul_f32 v19, v18, v17
    v_accvgpr_write_b32 a43, v19
    v_accvgpr_read_b32 v18, a44
    v_mul_f32 v19, v18, v17
    v_accvgpr_write_b32 a44, v19
    v_accvgpr_read_b32 v18, a45
    v_mul_f32 v19, v18, v17
    v_accvgpr_write_b32 a45, v19
    v_accvgpr_read_b32 v18, a46
    v_mul_f32 v19, v18, v17
    v_accvgpr_write_b32 a46, v19
    v_accvgpr_read_b32 v18, a47
    v_mul_f32 v19, v18, v17
    v_accvgpr_write_b32 a47, v19
    v_accvgpr_read_b32 v18, a48
    v_mul_f32 v19, v18, v17
    v_accvgpr_write_b32 a48, v19
    v_accvgpr_read_b32 v18, a49
    v_mul_f32 v19, v18, v17
    v_accvgpr_write_b32 a49, v19
    v_accvgpr_read_b32 v18, a50
    v_mul_f32 v19, v18, v17
    v_accvgpr_write_b32 a50, v19
    v_accvgpr_read_b32 v18, a51
    v_mul_f32 v19, v18, v17
    v_accvgpr_write_b32 a51, v19
    v_accvgpr_read_b32 v18, a52
    v_mul_f32 v19, v18, v17
    v_accvgpr_write_b32 a52, v19
    v_accvgpr_read_b32 v18, a53
    v_mul_f32 v19, v18, v17
    v_accvgpr_write_b32 a53, v19
    v_accvgpr_read_b32 v18, a54
    v_mul_f32 v19, v18, v17
    v_accvgpr_write_b32 a54, v19
    v_accvgpr_read_b32 v18, a55
    v_mul_f32 v19, v18, v17
    v_accvgpr_write_b32 a55, v19
    v_accvgpr_read_b32 v18, a56
    v_mul_f32 v19, v18, v17
    v_accvgpr_write_b32 a56, v19
    v_accvgpr_read_b32 v18, a57
    v_mul_f32 v19, v18, v17
    v_accvgpr_write_b32 a57, v19
    v_accvgpr_read_b32 v18, a58
    v_mul_f32 v19, v18, v17
    v_accvgpr_write_b32 a58, v19
    v_accvgpr_read_b32 v18, a59
    v_mul_f32 v19, v18, v17
    v_accvgpr_write_b32 a59, v19
    v_accvgpr_read_b32 v18, a60
    v_mul_f32 v19, v18, v17
    v_accvgpr_write_b32 a60, v19
    v_accvgpr_read_b32 v18, a61
    v_mul_f32 v19, v18, v17
    v_accvgpr_write_b32 a61, v19
    v_accvgpr_read_b32 v18, a62
    v_mul_f32 v19, v18, v17
    v_accvgpr_write_b32 a62, v19
    v_accvgpr_read_b32 v18, a63
    v_mul_f32 v19, v18, v17
    v_accvgpr_write_b32 a63, v19
    v_mov_b32 v14, 0
    v_sub_f32 v18, v80, v16
    v_sub_f32 v19, v81, v16
    v_exp_f32 v18, v18
    v_exp_f32 v19, v19
    s_nop 0
    v_add_f32 v14, v14, v18
    v_add_f32 v14, v14, v19
    v_cvt_pk_bf16_f32 v104, v18, v19
    v_sub_f32 v18, v82, v16
    v_sub_f32 v19, v83, v16
    v_exp_f32 v18, v18
    v_exp_f32 v19, v19
    s_nop 0
    v_add_f32 v14, v14, v18
    v_add_f32 v14, v14, v19
    v_cvt_pk_bf16_f32 v105, v18, v19
    v_sub_f32 v18, v84, v16
    v_sub_f32 v19, v85, v16
    v_exp_f32 v18, v18
    v_exp_f32 v19, v19
    s_nop 0
    v_add_f32 v14, v14, v18
    v_add_f32 v14, v14, v19
    v_cvt_pk_bf16_f32 v106, v18, v19
    v_sub_f32 v18, v86, v16
    v_sub_f32 v19, v87, v16
    v_exp_f32 v18, v18
    v_exp_f32 v19, v19
    s_nop 0
    v_add_f32 v14, v14, v18
    v_add_f32 v14, v14, v19
    v_cvt_pk_bf16_f32 v107, v18, v19
    v_sub_f32 v18, v88, v16
    v_sub_f32 v19, v89, v16
    v_exp_f32 v18, v18
    v_exp_f32 v19, v19
    s_nop 0
    v_add_f32 v14, v14, v18
    v_add_f32 v14, v14, v19
    v_cvt_pk_bf16_f32 v108, v18, v19
    v_sub_f32 v18, v90, v16
    v_sub_f32 v19, v91, v16
    v_exp_f32 v18, v18
    v_exp_f32 v19, v19
    s_nop 0
    v_add_f32 v14, v14, v18
    v_add_f32 v14, v14, v19
    v_cvt_pk_bf16_f32 v109, v18, v19
    v_sub_f32 v18, v92, v16
    v_sub_f32 v19, v93, v16
    v_exp_f32 v18, v18
    v_exp_f32 v19, v19
    s_nop 0
    v_add_f32 v14, v14, v18
    v_add_f32 v14, v14, v19
    v_cvt_pk_bf16_f32 v110, v18, v19
    v_sub_f32 v18, v94, v16
    v_sub_f32 v19, v95, v16
    v_exp_f32 v18, v18
    v_exp_f32 v19, v19
    s_nop 0
    v_add_f32 v14, v14, v18
    v_add_f32 v14, v14, v19
    v_cvt_pk_bf16_f32 v111, v18, v19
    s_nop 3
    s_branch L_back25
L_slow26:
    s_nop 15
    s_nop 15
    v_max3_f32 v16, v64, v65, v66
    v_max3_f32 v16, v16, v67, v68
    v_max3_f32 v16, v16, v69, v70
    v_max3_f32 v16, v16, v71, v72
    v_max3_f32 v16, v16, v73, v74
    v_max3_f32 v16, v16, v75, v76
    v_max3_f32 v16, v16, v77, v78
    v_max_f32 v16, v16, v79
    v_mov_b32 v17, v16
    s_nop 1
    v_permlane32_swap_b32 v16, v17
    s_nop 1
    v_max3_f32 v16, v16, v17, 0
    v_exp_f32 v17, -v16
    s_nop 1
    v_sub_f32 v13, v13, v16
    v_mov_b32 v112, v13
    v_mov_b32 v113, v13
    v_mov_b32 v114, v13
    v_mov_b32 v115, v13
    v_mov_b32 v116, v13
    v_mov_b32 v117, v13
    v_mov_b32 v118, v13
    v_mov_b32 v119, v13
    v_mov_b32 v120, v13
    v_mov_b32 v121, v13
    v_mov_b32 v122, v13
    v_mov_b32 v123, v13
    v_mov_b32 v124, v13
    v_mov_b32 v125, v13
    v_mov_b32 v126, v13
    v_mov_b32 v127, v13
    v_sub_f32 v80, v80, v16
    v_sub_f32 v81, v81, v16
    v_sub_f32 v82, v82, v16
    v_sub_f32 v83, v83, v16
    v_sub_f32 v84, v84, v16
    v_sub_f32 v85, v85, v16
    v_sub_f32 v86, v86, v16
    v_sub_f32 v87, v87, v16
    v_sub_f32 v88, v88, v16
    v_sub_f32 v89, v89, v16
    v_sub_f32 v90, v90, v16
    v_sub_f32 v91, v91, v16
    v_sub_f32 v92, v92, v16
    v_sub_f32 v93, v93, v16
    v_sub_f32 v94, v94, v16
    v_sub_f32 v95, v95, v16
    v_mul_f32 v12, v12, v17
    v_accvgpr_read_b32 v18, a0
    v_mul_f32 v19, v18, v17
    v_accvgpr_write_b32 a0, v19
    v_accvgpr_read_b32 v18, a1
    v_mul_f32 v19, v18, v17
    v_accvgpr_write_b32 a1, v19
    v_accvgpr_read_b32 v18, a2
    v_mul_f32 v19, v18, v17
    v_accvgpr_write_b32 a2, v19
    v_accvgpr_read_b32 v18, a3
    v_mul_f32 v19, v18, v17
    v_accvgpr_write_b32 a3, v19
    v_accvgpr_read_b32 v18, a4
    v_mul_f32 v19, v18, v17
    v_accvgpr_write_b32 a4, v19
    v_accvgpr_read_b32 v18, a5
    v_mul_f32 v19, v18, v17
    v_accvgpr_write_b32 a5, v19
    v_accvgpr_read_b32 v18, a6
    v_mul_f32 v19, v18, v17
    v_accvgpr_write_b32 a6, v19
    v_accvgpr_read_b32 v18, a7
    v_mul_f32 v19, v18, v17
    v_accvgpr_write_b32 a7, v19
    v_accvgpr_read_b32 v18, a8
    v_mul_f32 v19, v18, v17
    v_accvgpr_write_b32 a8, v19
    v_accvgpr_read_b32 v18, a9
    v_mul_f32 v19, v18, v17
    v_accvgpr_write_b32 a9, v19
    v_accvgpr_read_b32 v18, a10
    v_mul_f32 v19, v18, v17
    v_accvgpr_write_b32 a10, v19
    v_accvgpr_read_b32 v18, a11
    v_mul_f32 v19, v18, v17
    v_accvgpr_write_b32 a11, v19
    v_accvgpr_read_b32 v18, a12
    v_mul_f32 v19, v18, v17
    v_accvgpr_write_b32 a12, v19
    v_accvgpr_read_b32 v18, a13
    v_mul_f32 v19, v18, v17
    v_accvgpr_write_b32 a13, v19
    v_accvgpr_read_b32 v18, a14
    v_mul_f32 v19, v18, v17
    v_accvgpr_write_b32 a14, v19
    v_accvgpr_read_b32 v18, a15
    v_mul_f32 v19, v18, v17
    v_accvgpr_write_b32 a15, v19
    v_accvgpr_read_b32 v18, a16
    v_mul_f32 v19, v18, v17
    v_accvgpr_write_b32 a16, v19
    v_accvgpr_read_b32 v18, a17
    v_mul_f32 v19, v18, v17
    v_accvgpr_write_b32 a17, v19
    v_accvgpr_read_b32 v18, a18
    v_mul_f32 v19, v18, v17
    v_accvgpr_write_b32 a18, v19
    v_accvgpr_read_b32 v18, a19
    v_mul_f32 v19, v18, v17
    v_accvgpr_write_b32 a19, v19
    v_accvgpr_read_b32 v18, a20
    v_mul_f32 v19, v18, v17
    v_accvgpr_write_b32 a20, v19
    v_accvgpr_read_b32 v18, a21
    v_mul_f32 v19, v18, v17
    v_accvgpr_write_b32 a21, v19
    v_accvgpr_read_b32 v18, a22
    v_mul_f32 v19, v18, v17
    v_accvgpr_write_b32 a22, v19
    v_accvgpr_read_b32 v18, a23
    v_mul_f32 v19, v18, v17
    v_accvgpr_write_b32 a23, v19
    v_accvgpr_read_b32 v18, a24
    v_mul_f32 v19, v18, v17
    v_accvgpr_write_b32 a24, v19
    v_accvgpr_read_b32 v18, a25
    v_mul_f32 v19, v18, v17
    v_accvgpr_write_b32 a25, v19
    v_accvgpr_read_b32 v18, a26
    v_mul_f32 v19, v18, v17
    v_accvgpr_write_b32 a26, v19
    v_accvgpr_read_b32 v18, a27
    v_mul_f32 v19, v18, v17
    v_accvgpr_write_b32 a27, v19
    v_accvgpr_read_b32 v18, a28
    v_mul_f32 v19, v18, v17
    v_accvgpr_write_b32 a28, v19
    v_accvgpr_read_b32 v18, a29
    v_mul_f32 v19, v18, v17
    v_accvgpr_write_b32 a29, v19
    v_accvgpr_read_b32 v18, a30
    v_mul_f32 v19, v18, v17
    v_accvgpr_write_b32 a30, v19
    v_accvgpr_read_b32 v18, a31
    v_mul_f32 v19, v18, v17
    v_accvgpr_write_b32 a31, v19
    v_accvgpr_read_b32 v18, a32
    v_mul_f32 v19, v18, v17
    v_accvgpr_write_b32 a32, v19
    v_accvgpr_read_b32 v18, a33
    v_mul_f32 v19, v18, v17
    v_accvgpr_write_b32 a33, v19
    v_accvgpr_read_b32 v18, a34
    v_mul_f32 v19, v18, v17
    v_accvgpr_write_b32 a34, v19
    v_accvgpr_read_b32 v18, a35
    v_mul_f32 v19, v18, v17
    v_accvgpr_write_b32 a35, v19
    v_accvgpr_read_b32 v18, a36
    v_mul_f32 v19, v18, v17
    v_accvgpr_write_b32 a36, v19
    v_accvgpr_read_b32 v18, a37
    v_mul_f32 v19, v18, v17
    v_accvgpr_write_b32 a37, v19
    v_accvgpr_read_b32 v18, a38
    v_mul_f32 v19, v18, v17
    v_accvgpr_write_b32 a38, v19
    v_accvgpr_read_b32 v18, a39
    v_mul_f32 v19, v18, v17
    v_accvgpr_write_b32 a39, v19
    v_accvgpr_read_b32 v18, a40
    v_mul_f32 v19, v18, v17
    v_accvgpr_write_b32 a40, v19
    v_accvgpr_read_b32 v18, a41
    v_mul_f32 v19, v18, v17
    v_accvgpr_write_b32 a41, v19
    v_accvgpr_read_b32 v18, a42
    v_mul_f32 v19, v18, v17
    v_accvgpr_write_b32 a42, v19
    v_accvgpr_read_b32 v18, a43
    v_mul_f32 v19, v18, v17
    v_accvgpr_write_b32 a43, v19
    v_accvgpr_read_b32 v18, a44
    v_mul_f32 v19, v18, v17
    v_accvgpr_write_b32 a44, v19
    v_accvgpr_read_b32 v18, a45
    v_mul_f32 v19, v18, v17
    v_accvgpr_write_b32 a45, v19
    v_accvgpr_read_b32 v18, a46
    v_mul_f32 v19, v18, v17
    v_accvgpr_write_b32 a46, v19
    v_accvgpr_read_b32 v18, a47
    v_mul_f32 v19, v18, v17
    v_accvgpr_write_b32 a47, v19
    v_accvgpr_read_b32 v18, a48
    v_mul_f32 v19, v18, v17
    v_accvgpr_write_b32 a48, v19
    v_accvgpr_read_b32 v18, a49
    v_mul_f32 v19, v18, v17
    v_accvgpr_write_b32 a49, v19
    v_accvgpr_read_b32 v18, a50
    v_mul_f32 v19, v18, v17
    v_accvgpr_write_b32 a50, v19
    v_accvgpr_read_b32 v18, a51
    v_mul_f32 v19, v18, v17
    v_accvgpr_write_b32 a51, v19
    v_accvgpr_read_b32 v18, a52
    v_mul_f32 v19, v18, v17
    v_accvgpr_write_b32 a52, v19
    v_accvgpr_read_b32 v18, a53
    v_mul_f32 v19, v18, v17
    v_accvgpr_write_b32 a53, v19
    v_accvgpr_read_b32 v18, a54
    v_mul_f32 v19, v18, v17
    v_accvgpr_write_b32 a54, v19
    v_accvgpr_read_b32 v18, a55
    v_mul_f32 v19, v18, v17
    v_accvgpr_write_b32 a55, v19
    v_accvgpr_read_b32 v18, a56
    v_mul_f32 v19, v18, v17
    v_accvgpr_write_b32 a56, v19
    v_accvgpr_read_b32 v18, a57
    v_mul_f32 v19, v18, v17
    v_accvgpr_write_b32 a57, v19
    v_accvgpr_read_b32 v18, a58
    v_mul_f32 v19, v18, v17
    v_accvgpr_write_b32 a58, v19
    v_accvgpr_read_b32 v18, a59
    v_mul_f32 v19, v18, v17
    v_accvgpr_write_b32 a59, v19
    v_accvgpr_read_b32 v18, a60
    v_mul_f32 v19, v18, v17
    v_accvgpr_write_b32 a60, v19
    v_accvgpr_read_b32 v18, a61
    v_mul_f32 v19, v18, v17
    v_accvgpr_write_b32 a61, v19
    v_accvgpr_read_b32 v18, a62
    v_mul_f32 v19, v18, v17
    v_accvgpr_write_b32 a62, v19
    v_accvgpr_read_b32 v18, a63
    v_mul_f32 v19, v18, v17
    v_accvgpr_write_b32 a63, v19
    v_mov_b32 v14, 0
    v_sub_f32 v18, v64, v16
    v_sub_f32 v19, v65, v16
    v_exp_f32 v18, v18
    v_exp_f32 v19, v19
    s_nop 0
    v_add_f32 v14, v14, v18
    v_add_f32 v14, v14, v19
    v_cvt_pk_bf16_f32 v96, v18, v19
    v_sub_f32 v18, v66, v16
    v_sub_f32 v19, v67, v16
    v_exp_f32 v18, v18
    v_exp_f32 v19, v19
    s_nop 0
    v_add_f32 v14, v14, v18
    v_add_f32 v14, v14, v19
    v_cvt_pk_bf16_f32 v97, v18, v19
    v_sub_f32 v18, v68, v16
    v_sub_f32 v19, v69, v16
    v_exp_f32 v18, v18
    v_exp_f32 v19, v19
    s_nop 0
    v_add_f32 v14, v14, v18
    v_add_f32 v14, v14, v19
    v_cvt_pk_bf16_f32 v98, v18, v19
    v_sub_f32 v18, v70, v16
    v_sub_f32 v19, v71, v16
    v_exp_f32 v18, v18
    v_exp_f32 v19, v19
    s_nop 0
    v_add_f32 v14, v14, v18
    v_add_f32 v14, v14, v19
    v_cvt_pk_bf16_f32 v99, v18, v19
    v_sub_f32 v18, v72, v16
    v_sub_f32 v19, v73, v16
    v_exp_f32 v18, v18
    v_exp_f32 v19, v19
    s_nop 0
    v_add_f32 v14, v14, v18
    v_add_f32 v14, v14, v19
    v_cvt_pk_bf16_f32 v100, v18, v19
    v_sub_f32 v18, v74, v16
    v_sub_f32 v19, v75, v16
    v_exp_f32 v18, v18
    v_exp_f32 v19, v19
    s_nop 0
    v_add_f32 v14, v14, v18
    v_add_f32 v14, v14, v19
    v_cvt_pk_bf16_f32 v101, v18, v19
    v_sub_f32 v18, v76, v16
    v_sub_f32 v19, v77, v16
    v_exp_f32 v18, v18
    v_exp_f32 v19, v19
    s_nop 0
    v_add_f32 v14, v14, v18
    v_add_f32 v14, v14, v19
    v_cvt_pk_bf16_f32 v102, v18, v19
    v_sub_f32 v18, v78, v16
    v_sub_f32 v19, v79, v16
    v_exp_f32 v18, v18
    v_exp_f32 v19, v19
    s_nop 0
    v_add_f32 v14, v14, v18
    v_add_f32 v14, v14, v19
    v_cvt_pk_bf16_f32 v103, v18, v19
    s_nop 3
    s_branch L_back26
L_slow27:
    s_nop 15
    s_nop 15
    v_max3_f32 v16, v80, v81, v82
    v_max3_f32 v16, v16, v83, v84
    v_max3_f32 v16, v16, v85, v86
    v_max3_f32 v16, v16, v87, v88
    v_max3_f32 v16, v16, v89, v90
    v_max3_f32 v16, v16, v91, v92
    v_max3_f32 v16, v16, v93, v94
    v_max_f32 v16, v16, v95
    v_mov_b32 v17, v16
    s_nop 1
    v_permlane32_swap_b32 v16, v17
    s_nop 1
    v_max3_f32 v16, v16, v17, 0
    v_exp_f32 v17, -v16
    s_nop 1
    v_sub_f32 v13, v13, v16
    v_mov_b32 v112, v13
    v_mov_b32 v113, v13
    v_mov_b32 v114, v13
    v_mov_b32 v115, v13
    v_mov_b32 v116, v13
    v_mov_b32 v117, v13
    v_mov_b32 v118, v13
    v_mov_b32 v119, v13
    v_mov_b32 v120, v13
    v_mov_b32 v121, v13
    v_mov_b32 v122, v13
    v_mov_b32 v123, v13
    v_mov_b32 v124, v13
    v_mov_b32 v125, v13
    v_mov_b32 v126, v13
    v_mov_b32 v127, v13
    v_sub_f32 v64, v64, v16
    v_sub_f32 v65, v65, v16
    v_sub_f32 v66, v66, v16
    v_sub_f32 v67, v67, v16
    v_sub_f32 v68, v68, v16
    v_sub_f32 v69, v69, v16
    v_sub_f32 v70, v70, v16
    v_sub_f32 v71, v71, v16
    v_sub_f32 v72, v72, v16
    v_sub_f32 v73, v73, v16
    v_sub_f32 v74, v74, v16
    v_sub_f32 v75, v75, v16
    v_sub_f32 v76, v76, v16
    v_sub_f32 v77, v77, v16
    v_sub_f32 v78, v78, v16
    v_sub_f32 v79, v79, v16
    v_mul_f32 v12, v12, v17
    v_accvgpr_read_b32 v18, a0
    v_mul_f32 v19, v18, v17
    v_accvgpr_write_b32 a0, v19
    v_accvgpr_read_b32 v18, a1
    v_mul_f32 v19, v18, v17
    v_accvgpr_write_b32 a1, v19
    v_accvgpr_read_b32 v18, a2
    v_mul_f32 v19, v18, v17
    v_accvgpr_write_b32 a2, v19
    v_accvgpr_read_b32 v18, a3
    v_mul_f32 v19, v18, v17
    v_accvgpr_write_b32 a3, v19
    v_accvgpr_read_b32 v18, a4
    v_mul_f32 v19, v18, v17
    v_accvgpr_write_b32 a4, v19
    v_accvgpr_read_b32 v18, a5
    v_mul_f32 v19, v18, v17
    v_accvgpr_write_b32 a5, v19
    v_accvgpr_read_b32 v18, a6
    v_mul_f32 v19, v18, v17
    v_accvgpr_write_b32 a6, v19
    v_accvgpr_read_b32 v18, a7
    v_mul_f32 v19, v18, v17
    v_accvgpr_write_b32 a7, v19
    v_accvgpr_read_b32 v18, a8
    v_mul_f32 v19, v18, v17
    v_accvgpr_write_b32 a8, v19
    v_accvgpr_read_b32 v18, a9
    v_mul_f32 v19, v18, v17
    v_accvgpr_write_b32 a9, v19
    v_accvgpr_read_b32 v18, a10
    v_mul_f32 v19, v18, v17
    v_accvgpr_write_b32 a10, v19
    v_accvgpr_read_b32 v18, a11
    v_mul_f32 v19, v18, v17
    v_accvgpr_write_b32 a11, v19
    v_accvgpr_read_b32 v18, a12
    v_mul_f32 v19, v18, v17
    v_accvgpr_write_b32 a12, v19
    v_accvgpr_read_b32 v18, a13
    v_mul_f32 v19, v18, v17
    v_accvgpr_write_b32 a13, v19
    v_accvgpr_read_b32 v18, a14
    v_mul_f32 v19, v18, v17
    v_accvgpr_write_b32 a14, v19
    v_accvgpr_read_b32 v18, a15
    v_mul_f32 v19, v18, v17
    v_accvgpr_write_b32 a15, v19
    v_accvgpr_read_b32 v18, a16
    v_mul_f32 v19, v18, v17
    v_accvgpr_write_b32 a16, v19
    v_accvgpr_read_b32 v18, a17
    v_mul_f32 v19, v18, v17
    v_accvgpr_write_b32 a17, v19
    v_accvgpr_read_b32 v18, a18
    v_mul_f32 v19, v18, v17
    v_accvgpr_write_b32 a18, v19
    v_accvgpr_read_b32 v18, a19
    v_mul_f32 v19, v18, v17
    v_accvgpr_write_b32 a19, v19
    v_accvgpr_read_b32 v18, a20
    v_mul_f32 v19, v18, v17
    v_accvgpr_write_b32 a20, v19
    v_accvgpr_read_b32 v18, a21
    v_mul_f32 v19, v18, v17
    v_accvgpr_write_b32 a21, v19
    v_accvgpr_read_b32 v18, a22
    v_mul_f32 v19, v18, v17
    v_accvgpr_write_b32 a22, v19
    v_accvgpr_read_b32 v18, a23
    v_mul_f32 v19, v18, v17
    v_accvgpr_write_b32 a23, v19
    v_accvgpr_read_b32 v18, a24
    v_mul_f32 v19, v18, v17
    v_accvgpr_write_b32 a24, v19
    v_accvgpr_read_b32 v18, a25
    v_mul_f32 v19, v18, v17
    v_accvgpr_write_b32 a25, v19
    v_accvgpr_read_b32 v18, a26
    v_mul_f32 v19, v18, v17
    v_accvgpr_write_b32 a26, v19
    v_accvgpr_read_b32 v18, a27
    v_mul_f32 v19, v18, v17
    v_accvgpr_write_b32 a27, v19
    v_accvgpr_read_b32 v18, a28
    v_mul_f32 v19, v18, v17
    v_accvgpr_write_b32 a28, v19
    v_accvgpr_read_b32 v18, a29
    v_mul_f32 v19, v18, v17
    v_accvgpr_write_b32 a29, v19
    v_accvgpr_read_b32 v18, a30
    v_mul_f32 v19, v18, v17
    v_accvgpr_write_b32 a30, v19
    v_accvgpr_read_b32 v18, a31
    v_mul_f32 v19, v18, v17
    v_accvgpr_write_b32 a31, v19
    v_accvgpr_read_b32 v18, a32
    v_mul_f32 v19, v18, v17
    v_accvgpr_write_b32 a32, v19
    v_accvgpr_read_b32 v18, a33
    v_mul_f32 v19, v18, v17
    v_accvgpr_write_b32 a33, v19
    v_accvgpr_read_b32 v18, a34
    v_mul_f32 v19, v18, v17
    v_accvgpr_write_b32 a34, v19
    v_accvgpr_read_b32 v18, a35
    v_mul_f32 v19, v18, v17
    v_accvgpr_write_b32 a35, v19
    v_accvgpr_read_b32 v18, a36
    v_mul_f32 v19, v18, v17
    v_accvgpr_write_b32 a36, v19
    v_accvgpr_read_b32 v18, a37
    v_mul_f32 v19, v18, v17
    v_accvgpr_write_b32 a37, v19
    v_accvgpr_read_b32 v18, a38
    v_mul_f32 v19, v18, v17
    v_accvgpr_write_b32 a38, v19
    v_accvgpr_read_b32 v18, a39
    v_mul_f32 v19, v18, v17
    v_accvgpr_write_b32 a39, v19
    v_accvgpr_read_b32 v18, a40
    v_mul_f32 v19, v18, v17
    v_accvgpr_write_b32 a40, v19
    v_accvgpr_read_b32 v18, a41
    v_mul_f32 v19, v18, v17
    v_accvgpr_write_b32 a41, v19
    v_accvgpr_read_b32 v18, a42
    v_mul_f32 v19, v18, v17
    v_accvgpr_write_b32 a42, v19
    v_accvgpr_read_b32 v18, a43
    v_mul_f32 v19, v18, v17
    v_accvgpr_write_b32 a43, v19
    v_accvgpr_read_b32 v18, a44
    v_mul_f32 v19, v18, v17
    v_accvgpr_write_b32 a44, v19
    v_accvgpr_read_b32 v18, a45
    v_mul_f32 v19, v18, v17
    v_accvgpr_write_b32 a45, v19
    v_accvgpr_read_b32 v18, a46
    v_mul_f32 v19, v18, v17
    v_accvgpr_write_b32 a46, v19
    v_accvgpr_read_b32 v18, a47
    v_mul_f32 v19, v18, v17
    v_accvgpr_write_b32 a47, v19
    v_accvgpr_read_b32 v18, a48
    v_mul_f32 v19, v18, v17
    v_accvgpr_write_b32 a48, v19
    v_accvgpr_read_b32 v18, a49
    v_mul_f32 v19, v18, v17
    v_accvgpr_write_b32 a49, v19
    v_accvgpr_read_b32 v18, a50
    v_mul_f32 v19, v18, v17
    v_accvgpr_write_b32 a50, v19
    v_accvgpr_read_b32 v18, a51
    v_mul_f32 v19, v18, v17
    v_accvgpr_write_b32 a51, v19
    v_accvgpr_read_b32 v18, a52
    v_mul_f32 v19, v18, v17
    v_accvgpr_write_b32 a52, v19
    v_accvgpr_read_b32 v18, a53
    v_mul_f32 v19, v18, v17
    v_accvgpr_write_b32 a53, v19
    v_accvgpr_read_b32 v18, a54
    v_mul_f32 v19, v18, v17
    v_accvgpr_write_b32 a54, v19
    v_accvgpr_read_b32 v18, a55
    v_mul_f32 v19, v18, v17
    v_accvgpr_write_b32 a55, v19
    v_accvgpr_read_b32 v18, a56
    v_mul_f32 v19, v18, v17
    v_accvgpr_write_b32 a56, v19
    v_accvgpr_read_b32 v18, a57
    v_mul_f32 v19, v18, v17
    v_accvgpr_write_b32 a57, v19
    v_accvgpr_read_b32 v18, a58
    v_mul_f32 v19, v18, v17
    v_accvgpr_write_b32 a58, v19
    v_accvgpr_read_b32 v18, a59
    v_mul_f32 v19, v18, v17
    v_accvgpr_write_b32 a59, v19
    v_accvgpr_read_b32 v18, a60
    v_mul_f32 v19, v18, v17
    v_accvgpr_write_b32 a60, v19
    v_accvgpr_read_b32 v18, a61
    v_mul_f32 v19, v18, v17
    v_accvgpr_write_b32 a61, v19
    v_accvgpr_read_b32 v18, a62
    v_mul_f32 v19, v18, v17
    v_accvgpr_write_b32 a62, v19
    v_accvgpr_read_b32 v18, a63
    v_mul_f32 v19, v18, v17
    v_accvgpr_write_b32 a63, v19
    v_mov_b32 v14, 0
    v_sub_f32 v18, v80, v16
    v_sub_f32 v19, v81, v16
    v_exp_f32 v18, v18
    v_exp_f32 v19, v19
    s_nop 0
    v_add_f32 v14, v14, v18
    v_add_f32 v14, v14, v19
    v_cvt_pk_bf16_f32 v104, v18, v19
    v_sub_f32 v18, v82, v16
    v_sub_f32 v19, v83, v16
    v_exp_f32 v18, v18
    v_exp_f32 v19, v19
    s_nop 0
    v_add_f32 v14, v14, v18
    v_add_f32 v14, v14, v19
    v_cvt_pk_bf16_f32 v105, v18, v19
    v_sub_f32 v18, v84, v16
    v_sub_f32 v19, v85, v16
    v_exp_f32 v18, v18
    v_exp_f32 v19, v19
    s_nop 0
    v_add_f32 v14, v14, v18
    v_add_f32 v14, v14, v19
    v_cvt_pk_bf16_f32 v106, v18, v19
    v_sub_f32 v18, v86, v16
    v_sub_f32 v19, v87, v16
    v_exp_f32 v18, v18
    v_exp_f32 v19, v19
    s_nop 0
    v_add_f32 v14, v14, v18
    v_add_f32 v14, v14, v19
    v_cvt_pk_bf16_f32 v107, v18, v19
    v_sub_f32 v18, v88, v16
    v_sub_f32 v19, v89, v16
    v_exp_f32 v18, v18
    v_exp_f32 v19, v19
    s_nop 0
    v_add_f32 v14, v14, v18
    v_add_f32 v14, v14, v19
    v_cvt_pk_bf16_f32 v108, v18, v19
    v_sub_f32 v18, v90, v16
    v_sub_f32 v19, v91, v16
    v_exp_f32 v18, v18
    v_exp_f32 v19, v19
    s_nop 0
    v_add_f32 v14, v14, v18
    v_add_f32 v14, v14, v19
    v_cvt_pk_bf16_f32 v109, v18, v19
    v_sub_f32 v18, v92, v16
    v_sub_f32 v19, v93, v16
    v_exp_f32 v18, v18
    v_exp_f32 v19, v19
    s_nop 0
    v_add_f32 v14, v14, v18
    v_add_f32 v14, v14, v19
    v_cvt_pk_bf16_f32 v110, v18, v19
    v_sub_f32 v18, v94, v16
    v_sub_f32 v19, v95, v16
    v_exp_f32 v18, v18
    v_exp_f32 v19, v19
    s_nop 0
    v_add_f32 v14, v14, v18
    v_add_f32 v14, v14, v19
    v_cvt_pk_bf16_f32 v111, v18, v19
    s_nop 3
    s_branch L_back27
L_slow28:
    s_nop 15
    s_nop 15
    v_max3_f32 v16, v64, v65, v66
    v_max3_f32 v16, v16, v67, v68
    v_max3_f32 v16, v16, v69, v70
    v_max3_f32 v16, v16, v71, v72
    v_max3_f32 v16, v16, v73, v74
    v_max3_f32 v16, v16, v75, v76
    v_max3_f32 v16, v16, v77, v78
    v_max_f32 v16, v16, v79
    v_mov_b32 v17, v16
    s_nop 1
    v_permlane32_swap_b32 v16, v17
    s_nop 1
    v_max3_f32 v16, v16, v17, 0
    v_exp_f32 v17, -v16
    s_nop 1
    v_sub_f32 v13, v13, v16
    v_mov_b32 v112, v13
    v_mov_b32 v113, v13
    v_mov_b32 v114, v13
    v_mov_b32 v115, v13
    v_mov_b32 v116, v13
    v_mov_b32 v117, v13
    v_mov_b32 v118, v13
    v_mov_b32 v119, v13
    v_mov_b32 v120, v13
    v_mov_b32 v121, v13
    v_mov_b32 v122, v13
    v_mov_b32 v123, v13
    v_mov_b32 v124, v13
    v_mov_b32 v125, v13
    v_mov_b32 v126, v13
    v_mov_b32 v127, v13
    v_sub_f32 v80, v80, v16
    v_sub_f32 v81, v81, v16
    v_sub_f32 v82, v82, v16
    v_sub_f32 v83, v83, v16
    v_sub_f32 v84, v84, v16
    v_sub_f32 v85, v85, v16
    v_sub_f32 v86, v86, v16
    v_sub_f32 v87, v87, v16
    v_sub_f32 v88, v88, v16
    v_sub_f32 v89, v89, v16
    v_sub_f32 v90, v90, v16
    v_sub_f32 v91, v91, v16
    v_sub_f32 v92, v92, v16
    v_sub_f32 v93, v93, v16
    v_sub_f32 v94, v94, v16
    v_sub_f32 v95, v95, v16
    v_mul_f32 v12, v12, v17
    v_accvgpr_read_b32 v18, a0
    v_mul_f32 v19, v18, v17
    v_accvgpr_write_b32 a0, v19
    v_accvgpr_read_b32 v18, a1
    v_mul_f32 v19, v18, v17
    v_accvgpr_write_b32 a1, v19
    v_accvgpr_read_b32 v18, a2
    v_mul_f32 v19, v18, v17
    v_accvgpr_write_b32 a2, v19
    v_accvgpr_read_b32 v18, a3
    v_mul_f32 v19, v18, v17
    v_accvgpr_write_b32 a3, v19
    v_accvgpr_read_b32 v18, a4
    v_mul_f32 v19, v18, v17
    v_accvgpr_write_b32 a4, v19
    v_accvgpr_read_b32 v18, a5
    v_mul_f32 v19, v18, v17
    v_accvgpr_write_b32 a5, v19
    v_accvgpr_read_b32 v18, a6
    v_mul_f32 v19, v18, v17
    v_accvgpr_write_b32 a6, v19
    v_accvgpr_read_b32 v18, a7
    v_mul_f32 v19, v18, v17
    v_accvgpr_write_b32 a7, v19
    v_accvgpr_read_b32 v18, a8
    v_mul_f32 v19, v18, v17
    v_accvgpr_write_b32 a8, v19
    v_accvgpr_read_b32 v18, a9
    v_mul_f32 v19, v18, v17
    v_accvgpr_write_b32 a9, v19
    v_accvgpr_read_b32 v18, a10
    v_mul_f32 v19, v18, v17
    v_accvgpr_write_b32 a10, v19
    v_accvgpr_read_b32 v18, a11
    v_mul_f32 v19, v18, v17
    v_accvgpr_write_b32 a11, v19
    v_accvgpr_read_b32 v18, a12
    v_mul_f32 v19, v18, v17
    v_accvgpr_write_b32 a12, v19
    v_accvgpr_read_b32 v18, a13
    v_mul_f32 v19, v18, v17
    v_accvgpr_write_b32 a13, v19
    v_accvgpr_read_b32 v18, a14
    v_mul_f32 v19, v18, v17
    v_accvgpr_write_b32 a14, v19
    v_accvgpr_read_b32 v18, a15
    v_mul_f32 v19, v18, v17
    v_accvgpr_write_b32 a15, v19
    v_accvgpr_read_b32 v18, a16
    v_mul_f32 v19, v18, v17
    v_accvgpr_write_b32 a16, v19
    v_accvgpr_read_b32 v18, a17
    v_mul_f32 v19, v18, v17
    v_accvgpr_write_b32 a17, v19
    v_accvgpr_read_b32 v18, a18
    v_mul_f32 v19, v18, v17
    v_accvgpr_write_b32 a18, v19
    v_accvgpr_read_b32 v18, a19
    v_mul_f32 v19, v18, v17
    v_accvgpr_write_b32 a19, v19
    v_accvgpr_read_b32 v18, a20
    v_mul_f32 v19, v18, v17
    v_accvgpr_write_b32 a20, v19
    v_accvgpr_read_b32 v18, a21
    v_mul_f32 v19, v18, v17
    v_accvgpr_write_b32 a21, v19
    v_accvgpr_read_b32 v18, a22
    v_mul_f32 v19, v18, v17
    v_accvgpr_write_b32 a22, v19
    v_accvgpr_read_b32 v18, a23
    v_mul_f32 v19, v18, v17
    v_accvgpr_write_b32 a23, v19
    v_accvgpr_read_b32 v18, a24
    v_mul_f32 v19, v18, v17
    v_accvgpr_write_b32 a24, v19
    v_accvgpr_read_b32 v18, a25
    v_mul_f32 v19, v18, v17
    v_accvgpr_write_b32 a25, v19
    v_accvgpr_read_b32 v18, a26
    v_mul_f32 v19, v18, v17
    v_accvgpr_write_b32 a26, v19
    v_accvgpr_read_b32 v18, a27
    v_mul_f32 v19, v18, v17
    v_accvgpr_write_b32 a27, v19
    v_accvgpr_read_b32 v18, a28
    v_mul_f32 v19, v18, v17
    v_accvgpr_write_b32 a28, v19
    v_accvgpr_read_b32 v18, a29
    v_mul_f32 v19, v18, v17
    v_accvgpr_write_b32 a29, v19
    v_accvgpr_read_b32 v18, a30
    v_mul_f32 v19, v18, v17
    v_accvgpr_write_b32 a30, v19
    v_accvgpr_read_b32 v18, a31
    v_mul_f32 v19, v18, v17
    v_accvgpr_write_b32 a31, v19
    v_accvgpr_read_b32 v18, a32
    v_mul_f32 v19, v18, v17
    v_accvgpr_write_b32 a32, v19
    v_accvgpr_read_b32 v18, a33
    v_mul_f32 v19, v18, v17
    v_accvgpr_write_b32 a33, v19
    v_accvgpr_read_b32 v18, a34
    v_mul_f32 v19, v18, v17
    v_accvgpr_write_b32 a34, v19
    v_accvgpr_read_b32 v18, a35
    v_mul_f32 v19, v18, v17
    v_accvgpr_write_b32 a35, v19
    v_accvgpr_read_b32 v18, a36
    v_mul_f32 v19, v18, v17
    v_accvgpr_write_b32 a36, v19
    v_accvgpr_read_b32 v18, a37
    v_mul_f32 v19, v18, v17
    v_accvgpr_write_b32 a37, v19
    v_accvgpr_read_b32 v18, a38
    v_mul_f32 v19, v18, v17
    v_accvgpr_write_b32 a38, v19
    v_accvgpr_read_b32 v18, a39
    v_mul_f32 v19, v18, v17
    v_accvgpr_write_b32 a39, v19
    v_accvgpr_read_b32 v18, a40
    v_mul_f32 v19, v18, v17
    v_accvgpr_write_b32 a40, v19
    v_accvgpr_read_b32 v18, a41
    v_mul_f32 v19, v18, v17
    v_accvgpr_write_b32 a41, v19
    v_accvgpr_read_b32 v18, a42
    v_mul_f32 v19, v18, v17
    v_accvgpr_write_b32 a42, v19
    v_accvgpr_read_b32 v18, a43
    v_mul_f32 v19, v18, v17
    v_accvgpr_write_b32 a43, v19
    v_accvgpr_read_b32 v18, a44
    v_mul_f32 v19, v18, v17
    v_accvgpr_write_b32 a44, v19
    v_accvgpr_read_b32 v18, a45
    v_mul_f32 v19, v18, v17
    v_accvgpr_write_b32 a45, v19
    v_accvgpr_read_b32 v18, a46
    v_mul_f32 v19, v18, v17
    v_accvgpr_write_b32 a46, v19
    v_accvgpr_read_b32 v18, a47
    v_mul_f32 v19, v18, v17
    v_accvgpr_write_b32 a47, v19
    v_accvgpr_read_b32 v18, a48
    v_mul_f32 v19, v18, v17
    v_accvgpr_write_b32 a48, v19
    v_accvgpr_read_b32 v18, a49
    v_mul_f32 v19, v18, v17
    v_accvgpr_write_b32 a49, v19
    v_accvgpr_read_b32 v18, a50
    v_mul_f32 v19, v18, v17
    v_accvgpr_write_b32 a50, v19
    v_accvgpr_read_b32 v18, a51
    v_mul_f32 v19, v18, v17
    v_accvgpr_write_b32 a51, v19
    v_accvgpr_read_b32 v18, a52
    v_mul_f32 v19, v18, v17
    v_accvgpr_write_b32 a52, v19
    v_accvgpr_read_b32 v18, a53
    v_mul_f32 v19, v18, v17
    v_accvgpr_write_b32 a53, v19
    v_accvgpr_read_b32 v18, a54
    v_mul_f32 v19, v18, v17
    v_accvgpr_write_b32 a54, v19
    v_accvgpr_read_b32 v18, a55
    v_mul_f32 v19, v18, v17
    v_accvgpr_write_b32 a55, v19
    v_accvgpr_read_b32 v18, a56
    v_mul_f32 v19, v18, v17
    v_accvgpr_write_b32 a56, v19
    v_accvgpr_read_b32 v18, a57
    v_mul_f32 v19, v18, v17
    v_accvgpr_write_b32 a57, v19
    v_accvgpr_read_b32 v18, a58
    v_mul_f32 v19, v18, v17
    v_accvgpr_write_b32 a58, v19
    v_accvgpr_read_b32 v18, a59
    v_mul_f32 v19, v18, v17
    v_accvgpr_write_b32 a59, v19
    v_accvgpr_read_b32 v18, a60
    v_mul_f32 v19, v18, v17
    v_accvgpr_write_b32 a60, v19
    v_accvgpr_read_b32 v18, a61
    v_mul_f32 v19, v18, v17
    v_accvgpr_write_b32 a61, v19
    v_accvgpr_read_b32 v18, a62
    v_mul_f32 v19, v18, v17
    v_accvgpr_write_b32 a62, v19
    v_accvgpr_read_b32 v18, a63
    v_mul_f32 v19, v18, v17
    v_accvgpr_write_b32 a63, v19
    v_mov_b32 v14, 0
    v_sub_f32 v18, v64, v16
    v_sub_f32 v19, v65, v16
    v_exp_f32 v18, v18
    v_exp_f32 v19, v19
    s_nop 0
    v_add_f32 v14, v14, v18
    v_add_f32 v14, v14, v19
    v_cvt_pk_bf16_f32 v96, v18, v19
    v_sub_f32 v18, v66, v16
    v_sub_f32 v19, v67, v16
    v_exp_f32 v18, v18
    v_exp_f32 v19, v19
    s_nop 0
    v_add_f32 v14, v14, v18
    v_add_f32 v14, v14, v19
    v_cvt_pk_bf16_f32 v97, v18, v19
    v_sub_f32 v18, v68, v16
    v_sub_f32 v19, v69, v16
    v_exp_f32 v18, v18
    v_exp_f32 v19, v19
    s_nop 0
    v_add_f32 v14, v14, v18
    v_add_f32 v14, v14, v19
    v_cvt_pk_bf16_f32 v98, v18, v19
    v_sub_f32 v18, v70, v16
    v_sub_f32 v19, v71, v16
    v_exp_f32 v18, v18
    v_exp_f32 v19, v19
    s_nop 0
    v_add_f32 v14, v14, v18
    v_add_f32 v14, v14, v19
    v_cvt_pk_bf16_f32 v99, v18, v19
    v_sub_f32 v18, v72, v16
    v_sub_f32 v19, v73, v16
    v_exp_f32 v18, v18
    v_exp_f32 v19, v19
    s_nop 0
    v_add_f32 v14, v14, v18
    v_add_f32 v14, v14, v19
    v_cvt_pk_bf16_f32 v100, v18, v19
    v_sub_f32 v18, v74, v16
    v_sub_f32 v19, v75, v16
    v_exp_f32 v18, v18
    v_exp_f32 v19, v19
    s_nop 0
    v_add_f32 v14, v14, v18
    v_add_f32 v14, v14, v19
    v_cvt_pk_bf16_f32 v101, v18, v19
    v_sub_f32 v18, v76, v16
    v_sub_f32 v19, v77, v16
    v_exp_f32 v18, v18
    v_exp_f32 v19, v19
    s_nop 0
    v_add_f32 v14, v14, v18
    v_add_f32 v14, v14, v19
    v_cvt_pk_bf16_f32 v102, v18, v19
    v_sub_f32 v18, v78, v16
    v_sub_f32 v19, v79, v16
    v_exp_f32 v18, v18
    v_exp_f32 v19, v19
    s_nop 0
    v_add_f32 v14, v14, v18
    v_add_f32 v14, v14, v19
    v_cvt_pk_bf16_f32 v103, v18, v19
    s_nop 3
    s_branch L_back28
L_slow29:
    s_nop 15
    s_nop 15
    v_max3_f32 v16, v80, v81, v82
    v_max3_f32 v16, v16, v83, v84
    v_max3_f32 v16, v16, v85, v86
    v_max3_f32 v16, v16, v87, v88
    v_max3_f32 v16, v16, v89, v90
    v_max3_f32 v16, v16, v91, v92
    v_max3_f32 v16, v16, v93, v94
    v_max_f32 v16, v16, v95
    v_mov_b32 v17, v16
    s_nop 1
    v_permlane32_swap_b32 v16, v17
    s_nop 1
    v_max3_f32 v16, v16, v17, 0
    v_exp_f32 v17, -v16
    s_nop 1
    v_sub_f32 v13, v13, v16
    v_mov_b32 v112, v13
    v_mov_b32 v113, v13
    v_mov_b32 v114, v13
    v_mov_b32 v115, v13
    v_mov_b32 v116, v13
    v_mov_b32 v117, v13
    v_mov_b32 v118, v13
    v_mov_b32 v119, v13
    v_mov_b32 v120, v13
    v_mov_b32 v121, v13
    v_mov_b32 v122, v13
    v_mov_b32 v123, v13
    v_mov_b32 v124, v13
    v_mov_b32 v125, v13
    v_mov_b32 v126, v13
    v_mov_b32 v127, v13
    v_sub_f32 v64, v64, v16
    v_sub_f32 v65, v65, v16
    v_sub_f32 v66, v66, v16
    v_sub_f32 v67, v67, v16
    v_sub_f32 v68, v68, v16
    v_sub_f32 v69, v69, v16
    v_sub_f32 v70, v70, v16
    v_sub_f32 v71, v71, v16
    v_sub_f32 v72, v72, v16
    v_sub_f32 v73, v73, v16
    v_sub_f32 v74, v74, v16
    v_sub_f32 v75, v75, v16
    v_sub_f32 v76, v76, v16
    v_sub_f32 v77, v77, v16
    v_sub_f32 v78, v78, v16
    v_sub_f32 v79, v79, v16
    v_mul_f32 v12, v12, v17
    v_accvgpr_read_b32 v18, a0
    v_mul_f32 v19, v18, v17
    v_accvgpr_write_b32 a0, v19
    v_accvgpr_read_b32 v18, a1
    v_mul_f32 v19, v18, v17
    v_accvgpr_write_b32 a1, v19
    v_accvgpr_read_b32 v18, a2
    v_mul_f32 v19, v18, v17
    v_accvgpr_write_b32 a2, v19
    v_accvgpr_read_b32 v18, a3
    v_mul_f32 v19, v18, v17
    v_accvgpr_write_b32 a3, v19
    v_accvgpr_read_b32 v18, a4
    v_mul_f32 v19, v18, v17
    v_accvgpr_write_b32 a4, v19
    v_accvgpr_read_b32 v18, a5
    v_mul_f32 v19, v18, v17
    v_accvgpr_write_b32 a5, v19
    v_accvgpr_read_b32 v18, a6
    v_mul_f32 v19, v18, v17
    v_accvgpr_write_b32 a6, v19
    v_accvgpr_read_b32 v18, a7
    v_mul_f32 v19, v18, v17
    v_accvgpr_write_b32 a7, v19
    v_accvgpr_read_b32 v18, a8
    v_mul_f32 v19, v18, v17
    v_accvgpr_write_b32 a8, v19
    v_accvgpr_read_b32 v18, a9
    v_mul_f32 v19, v18, v17
    v_accvgpr_write_b32 a9, v19
    v_accvgpr_read_b32 v18, a10
    v_mul_f32 v19, v18, v17
    v_accvgpr_write_b32 a10, v19
    v_accvgpr_read_b32 v18, a11
    v_mul_f32 v19, v18, v17
    v_accvgpr_write_b32 a11, v19
    v_accvgpr_read_b32 v18, a12
    v_mul_f32 v19, v18, v17
    v_accvgpr_write_b32 a12, v19
    v_accvgpr_read_b32 v18, a13
    v_mul_f32 v19, v18, v17
    v_accvgpr_write_b32 a13, v19
    v_accvgpr_read_b32 v18, a14
    v_mul_f32 v19, v18, v17
    v_accvgpr_write_b32 a14, v19
    v_accvgpr_read_b32 v18, a15
    v_mul_f32 v19, v18, v17
    v_accvgpr_write_b32 a15, v19
    v_accvgpr_read_b32 v18, a16
    v_mul_f32 v19, v18, v17
    v_accvgpr_write_b32 a16, v19
    v_accvgpr_read_b32 v18, a17
    v_mul_f32 v19, v18, v17
    v_accvgpr_write_b32 a17, v19
    v_accvgpr_read_b32 v18, a18
    v_mul_f32 v19, v18, v17
    v_accvgpr_write_b32 a18, v19
    v_accvgpr_read_b32 v18, a19
    v_mul_f32 v19, v18, v17
    v_accvgpr_write_b32 a19, v19
    v_accvgpr_read_b32 v18, a20
    v_mul_f32 v19, v18, v17
    v_accvgpr_write_b32 a20, v19
    v_accvgpr_read_b32 v18, a21
    v_mul_f32 v19, v18, v17
    v_accvgpr_write_b32 a21, v19
    v_accvgpr_read_b32 v18, a22
    v_mul_f32 v19, v18, v17
    v_accvgpr_write_b32 a22, v19
    v_accvgpr_read_b32 v18, a23
    v_mul_f32 v19, v18, v17
    v_accvgpr_write_b32 a23, v19
    v_accvgpr_read_b32 v18, a24
    v_mul_f32 v19, v18, v17
    v_accvgpr_write_b32 a24, v19
    v_accvgpr_read_b32 v18, a25
    v_mul_f32 v19, v18, v17
    v_accvgpr_write_b32 a25, v19
    v_accvgpr_read_b32 v18, a26
    v_mul_f32 v19, v18, v17
    v_accvgpr_write_b32 a26, v19
    v_accvgpr_read_b32 v18, a27
    v_mul_f32 v19, v18, v17
    v_accvgpr_write_b32 a27, v19
    v_accvgpr_read_b32 v18, a28
    v_mul_f32 v19, v18, v17
    v_accvgpr_write_b32 a28, v19
    v_accvgpr_read_b32 v18, a29
    v_mul_f32 v19, v18, v17
    v_accvgpr_write_b32 a29, v19
    v_accvgpr_read_b32 v18, a30
    v_mul_f32 v19, v18, v17
    v_accvgpr_write_b32 a30, v19
    v_accvgpr_read_b32 v18, a31
    v_mul_f32 v19, v18, v17
    v_accvgpr_write_b32 a31, v19
    v_accvgpr_read_b32 v18, a32
    v_mul_f32 v19, v18, v17
    v_accvgpr_write_b32 a32, v19
    v_accvgpr_read_b32 v18, a33
    v_mul_f32 v19, v18, v17
    v_accvgpr_write_b32 a33, v19
    v_accvgpr_read_b32 v18, a34
    v_mul_f32 v19, v18, v17
    v_accvgpr_write_b32 a34, v19
    v_accvgpr_read_b32 v18, a35
    v_mul_f32 v19, v18, v17
    v_accvgpr_write_b32 a35, v19
    v_accvgpr_read_b32 v18, a36
    v_mul_f32 v19, v18, v17
    v_accvgpr_write_b32 a36, v19
    v_accvgpr_read_b32 v18, a37
    v_mul_f32 v19, v18, v17
    v_accvgpr_write_b32 a37, v19
    v_accvgpr_read_b32 v18, a38
    v_mul_f32 v19, v18, v17
    v_accvgpr_write_b32 a38, v19
    v_accvgpr_read_b32 v18, a39
    v_mul_f32 v19, v18, v17
    v_accvgpr_write_b32 a39, v19
    v_accvgpr_read_b32 v18, a40
    v_mul_f32 v19, v18, v17
    v_accvgpr_write_b32 a40, v19
    v_accvgpr_read_b32 v18, a41
    v_mul_f32 v19, v18, v17
    v_accvgpr_write_b32 a41, v19
    v_accvgpr_read_b32 v18, a42
    v_mul_f32 v19, v18, v17
    v_accvgpr_write_b32 a42, v19
    v_accvgpr_read_b32 v18, a43
    v_mul_f32 v19, v18, v17
    v_accvgpr_write_b32 a43, v19
    v_accvgpr_read_b32 v18, a44
    v_mul_f32 v19, v18, v17
    v_accvgpr_write_b32 a44, v19
    v_accvgpr_read_b32 v18, a45
    v_mul_f32 v19, v18, v17
    v_accvgpr_write_b32 a45, v19
    v_accvgpr_read_b32 v18, a46
    v_mul_f32 v19, v18, v17
    v_accvgpr_write_b32 a46, v19
    v_accvgpr_read_b32 v18, a47
    v_mul_f32 v19, v18, v17
    v_accvgpr_write_b32 a47, v19
    v_accvgpr_read_b32 v18, a48
    v_mul_f32 v19, v18, v17
    v_accvgpr_write_b32 a48, v19
    v_accvgpr_read_b32 v18, a49
    v_mul_f32 v19, v18, v17
    v_accvgpr_write_b32 a49, v19
    v_accvgpr_read_b32 v18, a50
    v_mul_f32 v19, v18, v17
    v_accvgpr_write_b32 a50, v19
    v_accvgpr_read_b32 v18, a51
    v_mul_f32 v19, v18, v17
    v_accvgpr_write_b32 a51, v19
    v_accvgpr_read_b32 v18, a52
    v_mul_f32 v19, v18, v17
    v_accvgpr_write_b32 a52, v19
    v_accvgpr_read_b32 v18, a53
    v_mul_f32 v19, v18, v17
    v_accvgpr_write_b32 a53, v19
    v_accvgpr_read_b32 v18, a54
    v_mul_f32 v19, v18, v17
    v_accvgpr_write_b32 a54, v19
    v_accvgpr_read_b32 v18, a55
    v_mul_f32 v19, v18, v17
    v_accvgpr_write_b32 a55, v19
    v_accvgpr_read_b32 v18, a56
    v_mul_f32 v19, v18, v17
    v_accvgpr_write_b32 a56, v19
    v_accvgpr_read_b32 v18, a57
    v_mul_f32 v19, v18, v17
    v_accvgpr_write_b32 a57, v19
    v_accvgpr_read_b32 v18, a58
    v_mul_f32 v19, v18, v17
    v_accvgpr_write_b32 a58, v19
    v_accvgpr_read_b32 v18, a59
    v_mul_f32 v19, v18, v17
    v_accvgpr_write_b32 a59, v19
    v_accvgpr_read_b32 v18, a60
    v_mul_f32 v19, v18, v17
    v_accvgpr_write_b32 a60, v19
    v_accvgpr_read_b32 v18, a61
    v_mul_f32 v19, v18, v17
    v_accvgpr_write_b32 a61, v19
    v_accvgpr_read_b32 v18, a62
    v_mul_f32 v19, v18, v17
    v_accvgpr_write_b32 a62, v19
    v_accvgpr_read_b32 v18, a63
    v_mul_f32 v19, v18, v17
    v_accvgpr_write_b32 a63, v19
    v_mov_b32 v14, 0
    v_sub_f32 v18, v80, v16
    v_sub_f32 v19, v81, v16
    v_exp_f32 v18, v18
    v_exp_f32 v19, v19
    s_nop 0
    v_add_f32 v14, v14, v18
    v_add_f32 v14, v14, v19
    v_cvt_pk_bf16_f32 v104, v18, v19
    v_sub_f32 v18, v82, v16
    v_sub_f32 v19, v83, v16
    v_exp_f32 v18, v18
    v_exp_f32 v19, v19
    s_nop 0
    v_add_f32 v14, v14, v18
    v_add_f32 v14, v14, v19
    v_cvt_pk_bf16_f32 v105, v18, v19
    v_sub_f32 v18, v84, v16
    v_sub_f32 v19, v85, v16
    v_exp_f32 v18, v18
    v_exp_f32 v19, v19
    s_nop 0
    v_add_f32 v14, v14, v18
    v_add_f32 v14, v14, v19
    v_cvt_pk_bf16_f32 v106, v18, v19
    v_sub_f32 v18, v86, v16
    v_sub_f32 v19, v87, v16
    v_exp_f32 v18, v18
    v_exp_f32 v19, v19
    s_nop 0
    v_add_f32 v14, v14, v18
    v_add_f32 v14, v14, v19
    v_cvt_pk_bf16_f32 v107, v18, v19
    v_sub_f32 v18, v88, v16
    v_sub_f32 v19, v89, v16
    v_exp_f32 v18, v18
    v_exp_f32 v19, v19
    s_nop 0
    v_add_f32 v14, v14, v18
    v_add_f32 v14, v14, v19
    v_cvt_pk_bf16_f32 v108, v18, v19
    v_sub_f32 v18, v90, v16
    v_sub_f32 v19, v91, v16
    v_exp_f32 v18, v18
    v_exp_f32 v19, v19
    s_nop 0
    v_add_f32 v14, v14, v18
    v_add_f32 v14, v14, v19
    v_cvt_pk_bf16_f32 v109, v18, v19
    v_sub_f32 v18, v92, v16
    v_sub_f32 v19, v93, v16
    v_exp_f32 v18, v18
    v_exp_f32 v19, v19
    s_nop 0
    v_add_f32 v14, v14, v18
    v_add_f32 v14, v14, v19
    v_cvt_pk_bf16_f32 v110, v18, v19
    v_sub_f32 v18, v94, v16
    v_sub_f32 v19, v95, v16
    v_exp_f32 v18, v18
    v_exp_f32 v19, v19
    s_nop 0
    v_add_f32 v14, v14, v18
    v_add_f32 v14, v14, v19
    v_cvt_pk_bf16_f32 v111, v18, v19
    s_nop 3
    s_branch L_back29
L_slow30:
    s_nop 15
    s_nop 15
    v_max3_f32 v16, v64, v65, v66
    v_max3_f32 v16, v16, v67, v68
    v_max3_f32 v16, v16, v69, v70
    v_max3_f32 v16, v16, v71, v72
    v_max3_f32 v16, v16, v73, v74
    v_max3_f32 v16, v16, v75, v76
    v_max3_f32 v16, v16, v77, v78
    v_max_f32 v16, v16, v79
    v_mov_b32 v17, v16
    s_nop 1
    v_permlane32_swap_b32 v16, v17
    s_nop 1
    v_max3_f32 v16, v16, v17, 0
    v_exp_f32 v17, -v16
    s_nop 1
    v_sub_f32 v13, v13, v16
    v_mov_b32 v112, v13
    v_mov_b32 v113, v13
    v_mov_b32 v114, v13
    v_mov_b32 v115, v13
    v_mov_b32 v116, v13
    v_mov_b32 v117, v13
    v_mov_b32 v118, v13
    v_mov_b32 v119, v13
    v_mov_b32 v120, v13
    v_mov_b32 v121, v13
    v_mov_b32 v122, v13
    v_mov_b32 v123, v13
    v_mov_b32 v124, v13
    v_mov_b32 v125, v13
    v_mov_b32 v126, v13
    v_mov_b32 v127, v13
    v_sub_f32 v80, v80, v16
    v_sub_f32 v81, v81, v16
    v_sub_f32 v82, v82, v16
    v_sub_f32 v83, v83, v16
    v_sub_f32 v84, v84, v16
    v_sub_f32 v85, v85, v16
    v_sub_f32 v86, v86, v16
    v_sub_f32 v87, v87, v16
    v_sub_f32 v88, v88, v16
    v_sub_f32 v89, v89, v16
    v_sub_f32 v90, v90, v16
    v_sub_f32 v91, v91, v16
    v_sub_f32 v92, v92, v16
    v_sub_f32 v93, v93, v16
    v_sub_f32 v94, v94, v16
    v_sub_f32 v95, v95, v16
    v_mul_f32 v12, v12, v17
    v_accvgpr_read_b32 v18, a0
    v_mul_f32 v19, v18, v17
    v_accvgpr_write_b32 a0, v19
    v_accvgpr_read_b32 v18, a1
    v_mul_f32 v19, v18, v17
    v_accvgpr_write_b32 a1, v19
    v_accvgpr_read_b32 v18, a2
    v_mul_f32 v19, v18, v17
    v_accvgpr_write_b32 a2, v19
    v_accvgpr_read_b32 v18, a3
    v_mul_f32 v19, v18, v17
    v_accvgpr_write_b32 a3, v19
    v_accvgpr_read_b32 v18, a4
    v_mul_f32 v19, v18, v17
    v_accvgpr_write_b32 a4, v19
    v_accvgpr_read_b32 v18, a5
    v_mul_f32 v19, v18, v17
    v_accvgpr_write_b32 a5, v19
    v_accvgpr_read_b32 v18, a6
    v_mul_f32 v19, v18, v17
    v_accvgpr_write_b32 a6, v19
    v_accvgpr_read_b32 v18, a7
    v_mul_f32 v19, v18, v17
    v_accvgpr_write_b32 a7, v19
    v_accvgpr_read_b32 v18, a8
    v_mul_f32 v19, v18, v17
    v_accvgpr_write_b32 a8, v19
    v_accvgpr_read_b32 v18, a9
    v_mul_f32 v19, v18, v17
    v_accvgpr_write_b32 a9, v19
    v_accvgpr_read_b32 v18, a10
    v_mul_f32 v19, v18, v17
    v_accvgpr_write_b32 a10, v19
    v_accvgpr_read_b32 v18, a11
    v_mul_f32 v19, v18, v17
    v_accvgpr_write_b32 a11, v19
    v_accvgpr_read_b32 v18, a12
    v_mul_f32 v19, v18, v17
    v_accvgpr_write_b32 a12, v19
    v_accvgpr_read_b32 v18, a13
    v_mul_f32 v19, v18, v17
    v_accvgpr_write_b32 a13, v19
    v_accvgpr_read_b32 v18, a14
    v_mul_f32 v19, v18, v17
    v_accvgpr_write_b32 a14, v19
    v_accvgpr_read_b32 v18, a15
    v_mul_f32 v19, v18, v17
    v_accvgpr_write_b32 a15, v19
    v_accvgpr_read_b32 v18, a16
    v_mul_f32 v19, v18, v17
    v_accvgpr_write_b32 a16, v19
    v_accvgpr_read_b32 v18, a17
    v_mul_f32 v19, v18, v17
    v_accvgpr_write_b32 a17, v19
    v_accvgpr_read_b32 v18, a18
    v_mul_f32 v19, v18, v17
    v_accvgpr_write_b32 a18, v19
    v_accvgpr_read_b32 v18, a19
    v_mul_f32 v19, v18, v17
    v_accvgpr_write_b32 a19, v19
    v_accvgpr_read_b32 v18, a20
    v_mul_f32 v19, v18, v17
    v_accvgpr_write_b32 a20, v19
    v_accvgpr_read_b32 v18, a21
    v_mul_f32 v19, v18, v17
    v_accvgpr_write_b32 a21, v19
    v_accvgpr_read_b32 v18, a22
    v_mul_f32 v19, v18, v17
    v_accvgpr_write_b32 a22, v19
    v_accvgpr_read_b32 v18, a23
    v_mul_f32 v19, v18, v17
    v_accvgpr_write_b32 a23, v19
    v_accvgpr_read_b32 v18, a24
    v_mul_f32 v19, v18, v17
    v_accvgpr_write_b32 a24, v19
    v_accvgpr_read_b32 v18, a25
    v_mul_f32 v19, v18, v17
    v_accvgpr_write_b32 a25, v19
    v_accvgpr_read_b32 v18, a26
    v_mul_f32 v19, v18, v17
    v_accvgpr_write_b32 a26, v19
    v_accvgpr_read_b32 v18, a27
    v_mul_f32 v19, v18, v17
    v_accvgpr_write_b32 a27, v19
    v_accvgpr_read_b32 v18, a28
    v_mul_f32 v19, v18, v17
    v_accvgpr_write_b32 a28, v19
    v_accvgpr_read_b32 v18, a29
    v_mul_f32 v19, v18, v17
    v_accvgpr_write_b32 a29, v19
    v_accvgpr_read_b32 v18, a30
    v_mul_f32 v19, v18, v17
    v_accvgpr_write_b32 a30, v19
    v_accvgpr_read_b32 v18, a31
    v_mul_f32 v19, v18, v17
    v_accvgpr_write_b32 a31, v19
    v_accvgpr_read_b32 v18, a32
    v_mul_f32 v19, v18, v17
    v_accvgpr_write_b32 a32, v19
    v_accvgpr_read_b32 v18, a33
    v_mul_f32 v19, v18, v17
    v_accvgpr_write_b32 a33, v19
    v_accvgpr_read_b32 v18, a34
    v_mul_f32 v19, v18, v17
    v_accvgpr_write_b32 a34, v19
    v_accvgpr_read_b32 v18, a35
    v_mul_f32 v19, v18, v17
    v_accvgpr_write_b32 a35, v19
    v_accvgpr_read_b32 v18, a36
    v_mul_f32 v19, v18, v17
    v_accvgpr_write_b32 a36, v19
    v_accvgpr_read_b32 v18, a37
    v_mul_f32 v19, v18, v17
    v_accvgpr_write_b32 a37, v19
    v_accvgpr_read_b32 v18, a38
    v_mul_f32 v19, v18, v17
    v_accvgpr_write_b32 a38, v19
    v_accvgpr_read_b32 v18, a39
    v_mul_f32 v19, v18, v17
    v_accvgpr_write_b32 a39, v19
    v_accvgpr_read_b32 v18, a40
    v_mul_f32 v19, v18, v17
    v_accvgpr_write_b32 a40, v19
    v_accvgpr_read_b32 v18, a41
    v_mul_f32 v19, v18, v17
    v_accvgpr_write_b32 a41, v19
    v_accvgpr_read_b32 v18, a42
    v_mul_f32 v19, v18, v17
    v_accvgpr_write_b32 a42, v19
    v_accvgpr_read_b32 v18, a43
    v_mul_f32 v19, v18, v17
    v_accvgpr_write_b32 a43, v19
    v_accvgpr_read_b32 v18, a44
    v_mul_f32 v19, v18, v17
    v_accvgpr_write_b32 a44, v19
    v_accvgpr_read_b32 v18, a45
    v_mul_f32 v19, v18, v17
    v_accvgpr_write_b32 a45, v19
    v_accvgpr_read_b32 v18, a46
    v_mul_f32 v19, v18, v17
    v_accvgpr_write_b32 a46, v19
    v_accvgpr_read_b32 v18, a47
    v_mul_f32 v19, v18, v17
    v_accvgpr_write_b32 a47, v19
    v_accvgpr_read_b32 v18, a48
    v_mul_f32 v19, v18, v17
    v_accvgpr_write_b32 a48, v19
    v_accvgpr_read_b32 v18, a49
    v_mul_f32 v19, v18, v17
    v_accvgpr_write_b32 a49, v19
    v_accvgpr_read_b32 v18, a50
    v_mul_f32 v19, v18, v17
    v_accvgpr_write_b32 a50, v19
    v_accvgpr_read_b32 v18, a51
    v_mul_f32 v19, v18, v17
    v_accvgpr_write_b32 a51, v19
    v_accvgpr_read_b32 v18, a52
    v_mul_f32 v19, v18, v17
    v_accvgpr_write_b32 a52, v19
    v_accvgpr_read_b32 v18, a53
    v_mul_f32 v19, v18, v17
    v_accvgpr_write_b32 a53, v19
    v_accvgpr_read_b32 v18, a54
    v_mul_f32 v19, v18, v17
    v_accvgpr_write_b32 a54, v19
    v_accvgpr_read_b32 v18, a55
    v_mul_f32 v19, v18, v17
    v_accvgpr_write_b32 a55, v19
    v_accvgpr_read_b32 v18, a56
    v_mul_f32 v19, v18, v17
    v_accvgpr_write_b32 a56, v19
    v_accvgpr_read_b32 v18, a57
    v_mul_f32 v19, v18, v17
    v_accvgpr_write_b32 a57, v19
    v_accvgpr_read_b32 v18, a58
    v_mul_f32 v19, v18, v17
    v_accvgpr_write_b32 a58, v19
    v_accvgpr_read_b32 v18, a59
    v_mul_f32 v19, v18, v17
    v_accvgpr_write_b32 a59, v19
    v_accvgpr_read_b32 v18, a60
    v_mul_f32 v19, v18, v17
    v_accvgpr_write_b32 a60, v19
    v_accvgpr_read_b32 v18, a61
    v_mul_f32 v19, v18, v17
    v_accvgpr_write_b32 a61, v19
    v_accvgpr_read_b32 v18, a62
    v_mul_f32 v19, v18, v17
    v_accvgpr_write_b32 a62, v19
    v_accvgpr_read_b32 v18, a63
    v_mul_f32 v19, v18, v17
    v_accvgpr_write_b32 a63, v19
    v_mov_b32 v14, 0
    v_sub_f32 v18, v64, v16
    v_sub_f32 v19, v65, v16
    v_exp_f32 v18, v18
    v_exp_f32 v19, v19
    s_nop 0
    v_add_f32 v14, v14, v18
    v_add_f32 v14, v14, v19
    v_cvt_pk_bf16_f32 v96, v18, v19
    v_sub_f32 v18, v66, v16
    v_sub_f32 v19, v67, v16
    v_exp_f32 v18, v18
    v_exp_f32 v19, v19
    s_nop 0
    v_add_f32 v14, v14, v18
    v_add_f32 v14, v14, v19
    v_cvt_pk_bf16_f32 v97, v18, v19
    v_sub_f32 v18, v68, v16
    v_sub_f32 v19, v69, v16
    v_exp_f32 v18, v18
    v_exp_f32 v19, v19
    s_nop 0
    v_add_f32 v14, v14, v18
    v_add_f32 v14, v14, v19
    v_cvt_pk_bf16_f32 v98, v18, v19
    v_sub_f32 v18, v70, v16
    v_sub_f32 v19, v71, v16
    v_exp_f32 v18, v18
    v_exp_f32 v19, v19
    s_nop 0
    v_add_f32 v14, v14, v18
    v_add_f32 v14, v14, v19
    v_cvt_pk_bf16_f32 v99, v18, v19
    v_sub_f32 v18, v72, v16
    v_sub_f32 v19, v73, v16
    v_exp_f32 v18, v18
    v_exp_f32 v19, v19
    s_nop 0
    v_add_f32 v14, v14, v18
    v_add_f32 v14, v14, v19
    v_cvt_pk_bf16_f32 v100, v18, v19
    v_sub_f32 v18, v74, v16
    v_sub_f32 v19, v75, v16
    v_exp_f32 v18, v18
    v_exp_f32 v19, v19
    s_nop 0
    v_add_f32 v14, v14, v18
    v_add_f32 v14, v14, v19
    v_cvt_pk_bf16_f32 v101, v18, v19
    v_sub_f32 v18, v76, v16
    v_sub_f32 v19, v77, v16
    v_exp_f32 v18, v18
    v_exp_f32 v19, v19
    s_nop 0
    v_add_f32 v14, v14, v18
    v_add_f32 v14, v14, v19
    v_cvt_pk_bf16_f32 v102, v18, v19
    v_sub_f32 v18, v78, v16
    v_sub_f32 v19, v79, v16
    v_exp_f32 v18, v18
    v_exp_f32 v19, v19
    s_nop 0
    v_add_f32 v14, v14, v18
    v_add_f32 v14, v14, v19
    v_cvt_pk_bf16_f32 v103, v18, v19
    s_nop 3
    s_branch L_back30
L_slow31:
    s_nop 15
    s_nop 15
    v_max3_f32 v16, v80, v81, v82
    v_max3_f32 v16, v16, v83, v84
    v_max3_f32 v16, v16, v85, v86
    v_max3_f32 v16, v16, v87, v88
    v_max3_f32 v16, v16, v89, v90
    v_max3_f32 v16, v16, v91, v92
    v_max3_f32 v16, v16, v93, v94
    v_max_f32 v16, v16, v95
    v_mov_b32 v17, v16
    s_nop 1
    v_permlane32_swap_b32 v16, v17
    s_nop 1
    v_max3_f32 v16, v16, v17, 0
    v_exp_f32 v17, -v16
    s_nop 1
    v_mul_f32 v12, v12, v17
    v_accvgpr_read_b32 v18, a0
    v_mul_f32 v19, v18, v17
    v_accvgpr_write_b32 a0, v19
    v_accvgpr_read_b32 v18, a1
    v_mul_f32 v19, v18, v17
    v_accvgpr_write_b32 a1, v19
    v_accvgpr_read_b32 v18, a2
    v_mul_f32 v19, v18, v17
    v_accvgpr_write_b32 a2, v19
    v_accvgpr_read_b32 v18, a3
    v_mul_f32 v19, v18, v17
    v_accvgpr_write_b32 a3, v19
    v_accvgpr_read_b32 v18, a4
    v_mul_f32 v19, v18, v17
    v_accvgpr_write_b32 a4, v19
    v_accvgpr_read_b32 v18, a5
    v_mul_f32 v19, v18, v17
    v_accvgpr_write_b32 a5, v19
    v_accvgpr_read_b32 v18, a6
    v_mul_f32 v19, v18, v17
    v_accvgpr_write_b32 a6, v19
    v_accvgpr_read_b32 v18, a7
    v_mul_f32 v19, v18, v17
    v_accvgpr_write_b32 a7, v19
    v_accvgpr_read_b32 v18, a8
    v_mul_f32 v19, v18, v17
    v_accvgpr_write_b32 a8, v19
    v_accvgpr_read_b32 v18, a9
    v_mul_f32 v19, v18, v17
    v_accvgpr_write_b32 a9, v19
    v_accvgpr_read_b32 v18, a10
    v_mul_f32 v19, v18, v17
    v_accvgpr_write_b32 a10, v19
    v_accvgpr_read_b32 v18, a11
    v_mul_f32 v19, v18, v17
    v_accvgpr_write_b32 a11, v19
    v_accvgpr_read_b32 v18, a12
    v_mul_f32 v19, v18, v17
    v_accvgpr_write_b32 a12, v19
    v_accvgpr_read_b32 v18, a13
    v_mul_f32 v19, v18, v17
    v_accvgpr_write_b32 a13, v19
    v_accvgpr_read_b32 v18, a14
    v_mul_f32 v19, v18, v17
    v_accvgpr_write_b32 a14, v19
    v_accvgpr_read_b32 v18, a15
    v_mul_f32 v19, v18, v17
    v_accvgpr_write_b32 a15, v19
    v_accvgpr_read_b32 v18, a16
    v_mul_f32 v19, v18, v17
    v_accvgpr_write_b32 a16, v19
    v_accvgpr_read_b32 v18, a17
    v_mul_f32 v19, v18, v17
    v_accvgpr_write_b32 a17, v19
    v_accvgpr_read_b32 v18, a18
    v_mul_f32 v19, v18, v17
    v_accvgpr_write_b32 a18, v19
    v_accvgpr_read_b32 v18, a19
    v_mul_f32 v19, v18, v17
    v_accvgpr_write_b32 a19, v19
    v_accvgpr_read_b32 v18, a20
    v_mul_f32 v19, v18, v17
    v_accvgpr_write_b32 a20, v19
    v_accvgpr_read_b32 v18, a21
    v_mul_f32 v19, v18, v17
    v_accvgpr_write_b32 a21, v19
    v_accvgpr_read_b32 v18, a22
    v_mul_f32 v19, v18, v17
    v_accvgpr_write_b32 a22, v19
    v_accvgpr_read_b32 v18, a23
    v_mul_f32 v19, v18, v17
    v_accvgpr_write_b32 a23, v19
    v_accvgpr_read_b32 v18, a24
    v_mul_f32 v19, v18, v17
    v_accvgpr_write_b32 a24, v19
    v_accvgpr_read_b32 v18, a25
    v_mul_f32 v19, v18, v17
    v_accvgpr_write_b32 a25, v19
    v_accvgpr_read_b32 v18, a26
    v_mul_f32 v19, v18, v17
    v_accvgpr_write_b32 a26, v19
    v_accvgpr_read_b32 v18, a27
    v_mul_f32 v19, v18, v17
    v_accvgpr_write_b32 a27, v19
    v_accvgpr_read_b32 v18, a28
    v_mul_f32 v19, v18, v17
    v_accvgpr_write_b32 a28, v19
    v_accvgpr_read_b32 v18, a29
    v_mul_f32 v19, v18, v17
    v_accvgpr_write_b32 a29, v19
    v_accvgpr_read_b32 v18, a30
    v_mul_f32 v19, v18, v17
    v_accvgpr_write_b32 a30, v19
    v_accvgpr_read_b32 v18, a31
    v_mul_f32 v19, v18, v17
    v_accvgpr_write_b32 a31, v19
    v_accvgpr_read_b32 v18, a32
    v_mul_f32 v19, v18, v17
    v_accvgpr_write_b32 a32, v19
    v_accvgpr_read_b32 v18, a33
    v_mul_f32 v19, v18, v17
    v_accvgpr_write_b32 a33, v19
    v_accvgpr_read_b32 v18, a34
    v_mul_f32 v19, v18, v17
    v_accvgpr_write_b32 a34, v19
    v_accvgpr_read_b32 v18, a35
    v_mul_f32 v19, v18, v17
    v_accvgpr_write_b32 a35, v19
    v_accvgpr_read_b32 v18, a36
    v_mul_f32 v19, v18, v17
    v_accvgpr_write_b32 a36, v19
    v_accvgpr_read_b32 v18, a37
    v_mul_f32 v19, v18, v17
    v_accvgpr_write_b32 a37, v19
    v_accvgpr_read_b32 v18, a38
    v_mul_f32 v19, v18, v17
    v_accvgpr_write_b32 a38, v19
    v_accvgpr_read_b32 v18, a39
    v_mul_f32 v19, v18, v17
    v_accvgpr_write_b32 a39, v19
    v_accvgpr_read_b32 v18, a40
    v_mul_f32 v19, v18, v17
    v_accvgpr_write_b32 a40, v19
    v_accvgpr_read_b32 v18, a41
    v_mul_f32 v19, v18, v17
    v_accvgpr_write_b32 a41, v19
    v_accvgpr_read_b32 v18, a42
    v_mul_f32 v19, v18, v17
    v_accvgpr_write_b32 a42, v19
    v_accvgpr_read_b32 v18, a43
    v_mul_f32 v19, v18, v17
    v_accvgpr_write_b32 a43, v19
    v_accvgpr_read_b32 v18, a44
    v_mul_f32 v19, v18, v17
    v_accvgpr_write_b32 a44, v19
    v_accvgpr_read_b32 v18, a45
    v_mul_f32 v19, v18, v17
    v_accvgpr_write_b32 a45, v19
    v_accvgpr_read_b32 v18, a46
    v_mul_f32 v19, v18, v17
    v_accvgpr_write_b32 a46, v19
    v_accvgpr_read_b32 v18, a47
    v_mul_f32 v19, v18, v17
    v_accvgpr_write_b32 a47, v19
    v_accvgpr_read_b32 v18, a48
    v_mul_f32 v19, v18, v17
    v_accvgpr_write_b32 a48, v19
    v_accvgpr_read_b32 v18, a49
    v_mul_f32 v19, v18, v17
    v_accvgpr_write_b32 a49, v19
    v_accvgpr_read_b32 v18, a50
    v_mul_f32 v19, v18, v17
    v_accvgpr_write_b32 a50, v19
    v_accvgpr_read_b32 v18, a51
    v_mul_f32 v19, v18, v17
    v_accvgpr_write_b32 a51, v19
    v_accvgpr_read_b32 v18, a52
    v_mul_f32 v19, v18, v17
    v_accvgpr_write_b32 a52, v19
    v_accvgpr_read_b32 v18, a53
    v_mul_f32 v19, v18, v17
    v_accvgpr_write_b32 a53, v19
    v_accvgpr_read_b32 v18, a54
    v_mul_f32 v19, v18, v17
    v_accvgpr_write_b32 a54, v19
    v_accvgpr_read_b32 v18, a55
    v_mul_f32 v19, v18, v17
    v_accvgpr_write_b32 a55, v19
    v_accvgpr_read_b32 v18, a56
    v_mul_f32 v19, v18, v17
    v_accvgpr_write_b32 a56, v19
    v_accvgpr_read_b32 v18, a57
    v_mul_f32 v19, v18, v17
    v_accvgpr_write_b32 a57, v19
    v_accvgpr_read_b32 v18, a58
    v_mul_f32 v19, v18, v17
    v_accvgpr_write_b32 a58, v19
    v_accvgpr_read_b32 v18, a59
    v_mul_f32 v19, v18, v17
    v_accvgpr_write_b32 a59, v19
    v_accvgpr_read_b32 v18, a60
    v_mul_f32 v19, v18, v17
    v_accvgpr_write_b32 a60, v19
    v_accvgpr_read_b32 v18, a61
    v_mul_f32 v19, v18, v17
    v_accvgpr_write_b32 a61, v19
    v_accvgpr_read_b32 v18, a62
    v_mul_f32 v19, v18, v17
    v_accvgpr_write_b32 a62, v19
    v_accvgpr_read_b32 v18, a63
    v_mul_f32 v19, v18, v17
    v_accvgpr_write_b32 a63, v19
    v_mov_b32 v14, 0
    v_sub_f32 v18, v80, v16
    v_sub_f32 v19, v81, v16
    v_exp_f32 v18, v18
    v_exp_f32 v19, v19
    s_nop 0
    v_add_f32 v14, v14, v18
    v_add_f32 v14, v14, v19
    v_cvt_pk_bf16_f32 v104, v18, v19
    v_sub_f32 v18, v82, v16
    v_sub_f32 v19, v83, v16
    v_exp_f32 v18, v18
    v_exp_f32 v19, v19
    s_nop 0
    v_add_f32 v14, v14, v18
    v_add_f32 v14, v14, v19
    v_cvt_pk_bf16_f32 v105, v18, v19
    v_sub_f32 v18, v84, v16
    v_sub_f32 v19, v85, v16
    v_exp_f32 v18, v18
    v_exp_f32 v19, v19
    s_nop 0
    v_add_f32 v14, v14, v18
    v_add_f32 v14, v14, v19
    v_cvt_pk_bf16_f32 v106, v18, v19
    v_sub_f32 v18, v86, v16
    v_sub_f32 v19, v87, v16
    v_exp_f32 v18, v18
    v_exp_f32 v19, v19
    s_nop 0
    v_add_f32 v14, v14, v18
    v_add_f32 v14, v14, v19
    v_cvt_pk_bf16_f32 v107, v18, v19
    v_sub_f32 v18, v88, v16
    v_sub_f32 v19, v89, v16
    v_exp_f32 v18, v18
    v_exp_f32 v19, v19
    s_nop 0
    v_add_f32 v14, v14, v18
    v_add_f32 v14, v14, v19
    v_cvt_pk_bf16_f32 v108, v18, v19
    v_sub_f32 v18, v90, v16
    v_sub_f32 v19, v91, v16
    v_exp_f32 v18, v18
    v_exp_f32 v19, v19
    s_nop 0
    v_add_f32 v14, v14, v18
    v_add_f32 v14, v14, v19
    v_cvt_pk_bf16_f32 v109, v18, v19
    v_sub_f32 v18, v92, v16
    v_sub_f32 v19, v93, v16
    v_exp_f32 v18, v18
    v_exp_f32 v19, v19
    s_nop 0
    v_add_f32 v14, v14, v18
    v_add_f32 v14, v14, v19
    v_cvt_pk_bf16_f32 v110, v18, v19
    v_sub_f32 v18, v94, v16
    v_sub_f32 v19, v95, v16
    v_exp_f32 v18, v18
    v_exp_f32 v19, v19
    s_nop 0
    v_add_f32 v14, v14, v18
    v_add_f32 v14, v14, v19
    v_cvt_pk_bf16_f32 v111, v18, v19
    s_nop 3
    s_branch L_back31
.globl oproj_kernel
.p2align 8
.type oproj_kernel,@function
oproj_kernel:
    s_cmp_ge_u32 s2, 256
    s_cbranch_scc1 L2_end
    s_load_dwordx2 s[64:65], s[0:1], 32
    s_load_dwordx2 s[66:67], s[0:1], 72
    s_load_dwordx4 s[68:71], s[0:1], 80
    s_load_dwordx2 s[72:73], s[0:1], 96
    s_and_b32 s16, s2, 7
    s_lshr_b32 s17, s2, 3
    s_lshr_b32 s18, s16, 2
    s_and_b32 s19, s16, 1
    s_lshl_b32 s19, s19, 3
    s_lshr_b32 s20, s17, 2
    s_add_u32 s19, s19, s20
    s_and_b32 s20, s17, 3
    s_bfe_u32 s41, s16, 0x10001
    s_cmp_ge_u32 s19, 15
    s_cbranch_scc1 L2_end
    s_waitcnt lgkmcnt(0)
    s_cmp_eq_u32 s18, 0
    s_cselect_b32 s4, s64, s66
    s_cselect_b32 s5, s65, s67
    s_mov_b32 s6, 4194304
    s_mov_b32 s7, 0x00020000
    s_mov_b32 s8, s72
    s_mov_b32 s9, s73
    s_mov_b32 s10, 116391936
    s_mov_b32 s11, 0x00020000
    s_mov_b32 s32, s72
    s_mov_b32 s33, s73
    s_mov_b32 s34, 31457280
    s_mov_b32 s35, 0x00020000
    s_mov_b32 s12, s68
    s_mov_b32 s13, s69
    s_mov_b32 s14, 3932160
    s_mov_b32 s15, 0x00020000
    s_mov_b32 s36, s70
    s_mov_b32 s37, s71
    s_mov_b32 s38, 256
    s_mov_b32 s39, 0x00020000
    s_mul_i32 s40, s18, 15
    s_add_u32 s40, s40, s19
    s_lshl_b32 s40, s40, 2
    s_add_u32 s40, s40, s20
    v_lshrrev_b32 v1, 6, v0
    s_nop 0
    v_readfirstlane_b32 s21, v1
    s_lshr_b32 s31, s21, 2
    s_and_b32 s21, s21, 3
    s_mul_i32 s30, s31, 81920
    s_lshl_b32 s24, s21, 10
    s_add_u32 s24, s24, s30
    s_mov_b32 s23, s24
    s_mov_b32 s22, 0
    s_mov_b32 s28, 0
    v_and_b32 v10, 63, v0
    v_lshrrev_b32 v11, 5, v10
    s_lshl_b32 s27, s41, 1
    s_add_u32 s27, s27, s31
    s_lshl_b32 s25, s27, 20
    s_lshl_b32 s16, s20, 8
    s_add_u32 s25, s25, s16
    s_lshl_b32 s26, s27, 16
    s_mul_i32 s27, s18, 60
    s_lshl_b32 s16, s19, 2
    s_add_u32 s16, s16, s21
    s_add_u32 s27, s27, s16
    s_lshl_b32 s27, s27, 18
    s_add_u32 s26, s26, s27
    v_lshlrev_b32 v2, 4, v10
    s_lshl_b32 s16, s16, 5
    v_and_b32 v1, 31, v10
    v_add_u32 v1, s16, v1
    v_lshlrev_b32 v8, 11, v1
    v_lshl_add_u32 v8, v11, 4, v8
    s_lshl_b32 s16, s18, 10
    s_lshl_b32 s17, s20, 8
    s_add_u32 s16, s16, s17
    v_add_u32 v8, s16, v8
    v_lshrrev_b32 v240, 4, v10
    v_lshlrev_b32 v241, 2, v240
    v_and_b32 v242, 15, v10
    v_xor_b32 v241, v241, v242
    v_lshlrev_b32 v241, 4, v241
    s_lshl_b32 s16, s21, 2
    v_add_u32 v240, s16, v240
    v_lshl_add_u32 v3, v240, 10, v241
    s_lshl_b32 s42, s40, 17
    s_add_u32 s42, s42, 100663296
    s_lshl_b32 s16, s21, 14
    v_lshlrev_b32 v9, 4, v10
    v_add_u32 v9, s16, v9
    s_add_u32 m0, s23, 0
    s_add_u32 s16, s25, 0
    buffer_load_dwordx4 v3, s[4:7], s16 offen lds
    s_add_u32 m0, s23, 4096
    s_add_u32 s16, s25, 16384
    buffer_load_dwordx4 v3, s[4:7], s16 offen lds
    s_add_u32 m0, s23, 8192
    s_add_u32 s16, s25, 32768
    buffer_load_dwordx4 v3, s[4:7], s16 offen lds
    s_add_u32 m0, s23, 12288
    s_add_u32 s16, s25, 49152
    buffer_load_dwordx4 v3, s[4:7], s16 offen lds
    s_add_u32 s25, s25, 65536
    s_add_u32 s22, s22, 16384
    s_cmp_eq_u32 s22, 81920
    s_cselect_b32 s22, 0, s22
    s_add_u32 s23, s22, s24
    s_add_u32 s17, s26, 0
    buffer_load_dwordx4 v[108:111], v2, s[32:35], s17 offen offset:0
    s_add_u32 s17, s26, 0
    buffer_load_dwordx4 v[112:115], v2, s[32:35], s17 offen offset:1024
    s_add_u32 s17, s26, 0
    buffer_load_dwordx4 v[116:119], v2, s[32:35], s17 offen offset:2048
    s_add_u32 s17, s26, 0
    buffer_load_dwordx4 v[120:123], v2, s[32:35], s17 offen offset:3072
    s_add_u32 m0, s23, 0
    s_add_u32 s16, s25, 0
    buffer_load_dwordx4 v3, s[4:7], s16 offen lds
    s_add_u32 m0, s23, 4096
    s_add_u32 s16, s25, 16384
    buffer_load_dwordx4 v3, s[4:7], s16 offen lds
    s_add_u32 m0, s23, 8192
    s_add_u32 s16, s25, 32768
    buffer_load_dwordx4 v3, s[4:7], s16 offen lds
    s_add_u32 m0, s23, 12288
    s_add_u32 s16, s25, 49152
    buffer_load_dwordx4 v3, s[4:7], s16 offen lds
    s_add_u32 s25, s25, 65536
    s_add_u32 s22, s22, 16384
    s_cmp_eq_u32 s22, 81920
    s_cselect_b32 s22, 0, s22
    s_add_u32 s23, s22, s24
    v_bfe_u32 v240, v10, 2, 2
    v_lshl_add_u32 v241, v11, 3, v240
    v_lshlrev_b32 v241, 8, v241
    v_bfe_u32 v242, v10, 4, 1
    v_lshl_add_u32 v241, v242, 5, v241
    v_and_b32 v242, 1, v10
    v_lshl_add_u32 v241, v242, 4, v241
    v_bfe_u32 v242, v10, 1, 1
    v_lshl_add_u32 v241, v242, 3, v241
    v_add_u32 v241, s30, v241
    v_xor_b32 v242, 0, v240
    v_lshl_add_u32 v4, v242, 6, v241
    v_xor_b32 v242, 1, v240
    v_lshl_add_u32 v5, v242, 6, v241
    v_xor_b32 v242, 2, v240
    v_lshl_add_u32 v6, v242, 6, v241
    v_xor_b32 v242, 3, v240
    v_lshl_add_u32 v7, v242, 6, v241
    v_mov_b32 v44, 0
    v_mov_b32 v45, 0
    v_mov_b32 v46, 0
    v_mov_b32 v47, 0
    v_mov_b32 v48, 0
    v_mov_b32 v49, 0
    v_mov_b32 v50, 0
    v_mov_b32 v51, 0
    v_mov_b32 v52, 0
    v_mov_b32 v53, 0
    v_mov_b32 v54, 0
    v_mov_b32 v55, 0
    v_mov_b32 v56, 0
    v_mov_b32 v57, 0
    v_mov_b32 v58, 0
    v_mov_b32 v59, 0
    v_mov_b32 v60, 0
    v_mov_b32 v61, 0
    v_mov_b32 v62, 0
    v_mov_b32 v63, 0
    v_mov_b32 v64, 0
    v_mov_b32 v65, 0
    v_mov_b32 v66, 0
    v_mov_b32 v67, 0
    v_mov_b32 v68, 0
    v_mov_b32 v69, 0
    v_mov_b32 v70, 0
    v_mov_b32 v71, 0
    v_mov_b32 v72, 0
    v_mov_b32 v73, 0
    v_mov_b32 v74, 0
    v_mov_b32 v75, 0
    v_mov_b32 v76, 0
    v_mov_b32 v77, 0
    v_mov_b32 v78, 0
    v_mov_b32 v79, 0
    v_mov_b32 v80, 0
    v_mov_b32 v81, 0
    v_mov_b32 v82, 0
    v_mov_b32 v83, 0
    v_mov_b32 v84, 0
    v_mov_b32 v85, 0
    v_mov_b32 v86, 0
    v_mov_b32 v87, 0
    v_mov_b32 v88, 0
    v_mov_b32 v89, 0
    v_mov_b32 v90, 0
    v_mov_b32 v91, 0
    v_mov_b32 v92, 0
    v_mov_b32 v93, 0
    v_mov_b32 v94, 0
    v_mov_b32 v95, 0
    v_mov_b32 v96, 0
    v_mov_b32 v97, 0
    v_mov_b32 v98, 0
    v_mov_b32 v99, 0
    v_mov_b32 v100, 0
    v_mov_b32 v101, 0
    v_mov_b32 v102, 0
    v_mov_b32 v103, 0
    v_mov_b32 v104, 0
    v_mov_b32 v105, 0
    v_mov_b32 v106, 0
    v_mov_b32 v107, 0
    s_add_u32 s17, s26, 4096
    buffer_load_dwordx4 v[124:127], v2, s[32:35], s17 offen offset:0
    s_add_u32 s17, s26, 4096
    buffer_load_dwordx4 v[128:131], v2, s[32:35], s17 offen offset:1024
    s_add_u32 s17, s26, 4096
    buffer_load_dwordx4 v[132:135], v2, s[32:35], s17 offen offset:2048
    s_add_u32 s17, s26, 4096
    buffer_load_dwordx4 v[136:139], v2, s[32:35], s17 offen offset:3072
    s_waitcnt vmcnt(12)
    s_barrier
    ds_read_b64_tr_b16 v[12:13], v4 offset:0
    ds_read_b64_tr_b16 v[14:15], v4 offset:1024
    ds_read_b64_tr_b16 v[16:17], v5 offset:0
    ds_read_b64_tr_b16 v[18:19], v5 offset:1024
    ds_read_b64_tr_b16 v[20:21], v6 offset:0
    ds_read_b64_tr_b16 v[22:23], v6 offset:1024
    ds_read_b64_tr_b16 v[24:25], v7 offset:0
    ds_read_b64_tr_b16 v[26:27], v7 offset:1024
    ds_read_b64_tr_b16 v[28:29], v4 offset:4096
    ds_read_b64_tr_b16 v[30:31], v4 offset:5120
    s_mov_b32 s27, 0
    s_waitcnt vmcnt(4)
    s_barrier
    s_waitcnt vmcnt(11) lgkmcnt(8)
    v_mfma_f32_32x32x16_bf16 v[44:59], v[12:15], v[108:111], v[44:59]
    ds_read_b64_tr_b16 v[32:33], v5 offset:4096
    ds_read_b64_tr_b16 v[34:35], v5 offset:5120
    s_add_u32 s17, s26, 8192
    buffer_load_dwordx4 v[140:143], v2, s[32:35], s17 offen offset:0
    s_waitcnt lgkmcnt(8)
    v_mfma_f32_32x32x16_bf16 v[60:75], v[16:19], v[108:111], v[60:75]
    ds_read_b64_tr_b16 v[36:37], v6 offset:4096
    ds_read_b64_tr_b16 v[38:39], v6 offset:5120
    s_add_u32 s17, s26, 8192
    buffer_load_dwordx4 v[144:147], v2, s[32:35], s17 offen offset:1024
    s_waitcnt lgkmcnt(8)
    v_mfma_f32_32x32x16_bf16 v[76:91], v[20:23], v[108:111], v[76:91]
    ds_read_b64_tr_b16 v[40:41], v7 offset:4096
    ds_read_b64_tr_b16 v[42:43], v7 offset:5120
    s_add_u32 s17, s26, 8192
    buffer_load_dwordx4 v[148:151], v2, s[32:35], s17 offen offset:2048
    s_waitcnt lgkmcnt(8)
    v_mfma_f32_32x32x16_bf16 v[92:107], v[24:27], v[108:111], v[92:107]
    ds_read_b64_tr_b16 v[12:13], v4 offset:8192
    ds_read_b64_tr_b16 v[14:15], v4 offset:9216
    s_add_u32 s17, s26, 8192
    buffer_load_dwordx4 v[152:155], v2, s[32:35], s17 offen offset:3072
    s_add_u32 s17, s26, 16384
    buffer_load_dwordx4 v[108:111], v2, s[32:35], s17 offen offset:0
    s_waitcnt vmcnt(15) lgkmcnt(8)
    v_mfma_f32_32x32x16_bf16 v[44:59], v[28:31], v[112:115], v[44:59]
    ds_read_b64_tr_b16 v[16:17], v5 offset:8192
    ds_read_b64_tr_b16 v[18:19], v5 offset:9216
    s_add_u32 m0, s23, 0
    s_add_u32 s16, s25, 0
    buffer_load_dwordx4 v3, s[4:7], s16 offen lds
    s_waitcnt lgkmcnt(8)
    v_mfma_f32_32x32x16_bf16 v[60:75], v[32:35], v[112:115], v[60:75]
    ds_read_b64_tr_b16 v[20:21], v6 offset:8192
    ds_read_b64_tr_b16 v[22:23], v6 offset:9216
    s_add_u32 m0, s23, 4096
    s_add_u32 s16, s25, 16384
    buffer_load_dwordx4 v3, s[4:7], s16 offen lds
    s_waitcnt lgkmcnt(8)
    v_mfma_f32_32x32x16_bf16 v[76:91], v[36:39], v[112:115], v[76:91]
    ds_read_b64_tr_b16 v[24:25], v7 offset:8192
    ds_read_b64_tr_b16 v[26:27], v7 offset:9216
    s_add_u32 m0, s23, 8192
    s_add_u32 s16, s25, 32768
    buffer_load_dwordx4 v3, s[4:7], s16 offen lds
    s_waitcnt lgkmcnt(8)
    v_mfma_f32_32x32x16_bf16 v[92:107], v[40:43], v[112:115], v[92:107]
    ds_read_b64_tr_b16 v[28:29], v4 offset:12288
    ds_read_b64_tr_b16 v[30:31], v4 offset:13312
    s_add_u32 m0, s23, 12288
    s_add_u32 s16, s25, 49152
    buffer_load_dwordx4 v3, s[4:7], s16 offen lds
    s_add_u32 s25, s25, 65536
    s_add_u32 s22, s22, 16384
    s_cmp_eq_u32 s22, 81920
    s_cselect_b32 s22, 0, s22
    s_add_u32 s23, s22, s24
    s_add_u32 s17, s26, 16384
    buffer_load_dwordx4 v[112:115], v2, s[32:35], s17 offen offset:1024
    s_waitcnt vmcnt(19) lgkmcnt(8)
    v_mfma_f32_32x32x16_bf16 v[44:59], v[12:15], v[116:119], v[44:59]
    ds_read_b64_tr_b16 v[32:33], v5 offset:12288
    ds_read_b64_tr_b16 v[34:35], v5 offset:13312
    s_add_u32 s17, s26, 12288
    buffer_load_dwordx4 v[156:159], v2, s[32:35], s17 offen offset:0
    s_waitcnt lgkmcnt(8)
    v_mfma_f32_32x32x16_bf16 v[60:75], v[16:19], v[116:119], v[60:75]
    ds_read_b64_tr_b16 v[36:37], v6 offset:12288
    ds_read_b64_tr_b16 v[38:39], v6 offset:13312
    s_add_u32 s17, s26, 12288
    buffer_load_dwordx4 v[160:163], v2, s[32:35], s17 offen offset:1024
    s_waitcnt lgkmcnt(8)
    v_mfma_f32_32x32x16_bf16 v[76:91], v[20:23], v[116:119], v[76:91]
    ds_read_b64_tr_b16 v[40:41], v7 offset:12288
    ds_read_b64_tr_b16 v[42:43], v7 offset:13312
    s_add_u32 s17, s26, 12288
    buffer_load_dwordx4 v[164:167], v2, s[32:35], s17 offen offset:2048
    s_waitcnt lgkmcnt(8)
    v_mfma_f32_32x32x16_bf16 v[92:107], v[24:27], v[116:119], v[92:107]
    s_mov_b32 s29, s28
    s_add_u32 s28, s28, 16384
    s_cmp_eq_u32 s28, 81920
    s_cselect_b32 s28, 0, s28
    s_sub_u32 s29, s28, s29
    v_add_u32 v4, s29, v4
    v_add_u32 v5, s29, v5
    v_add_u32 v6, s29, v6
    v_add_u32 v7, s29, v7
    ds_read_b64_tr_b16 v[12:13], v4 offset:0
    ds_read_b64_tr_b16 v[14:15], v4 offset:1024
    s_add_u32 s17, s26, 12288
    buffer_load_dwordx4 v[168:171], v2, s[32:35], s17 offen offset:3072
    s_add_u32 s17, s26, 16384
    buffer_load_dwordx4 v[116:119], v2, s[32:35], s17 offen offset:2048
    s_waitcnt vmcnt(23) lgkmcnt(8)
    v_mfma_f32_32x32x16_bf16 v[44:59], v[28:31], v[120:123], v[44:59]
    ds_read_b64_tr_b16 v[16:17], v5 offset:0
    ds_read_b64_tr_b16 v[18:19], v5 offset:1024
    s_add_u32 m0, s23, 0
    s_add_u32 s16, s25, 0
    buffer_load_dwordx4 v3, s[4:7], s16 offen lds
    s_waitcnt lgkmcnt(8)
    v_mfma_f32_32x32x16_bf16 v[60:75], v[32:35], v[120:123], v[60:75]
    ds_read_b64_tr_b16 v[20:21], v6 offset:0
    ds_read_b64_tr_b16 v[22:23], v6 offset:1024
    s_add_u32 m0, s23, 4096
    s_add_u32 s16, s25, 16384
    buffer_load_dwordx4 v3, s[4:7], s16 offen lds
    s_waitcnt lgkmcnt(8)
    v_mfma_f32_32x32x16_bf16 v[76:91], v[36:39], v[120:123], v[76:91]
    ds_read_b64_tr_b16 v[24:25], v7 offset:0
    ds_read_b64_tr_b16 v[26:27], v7 offset:1024
    s_add_u32 m0, s23, 8192
    s_add_u32 s16, s25, 32768
    buffer_load_dwordx4 v3, s[4:7], s16 offen lds
    s_waitcnt lgkmcnt(8)
    v_mfma_f32_32x32x16_bf16 v[92:107], v[40:43], v[120:123], v[92:107]
    ds_read_b64_tr_b16 v[28:29], v4 offset:4096
    ds_read_b64_tr_b16 v[30:31], v4 offset:5120
    s_add_u32 m0, s23, 12288
    s_add_u32 s16, s25, 49152
    buffer_load_dwordx4 v3, s[4:7], s16 offen lds
    s_add_u32 s25, s25, 65536
    s_add_u32 s22, s22, 16384
    s_cmp_eq_u32 s22, 81920
    s_cselect_b32 s22, 0, s22
    s_add_u32 s23, s22, s24
    s_add_u32 s17, s26, 16384
    buffer_load_dwordx4 v[120:123], v2, s[32:35], s17 offen offset:3072
    s_waitcnt vmcnt(11)
    s_barrier
    s_waitcnt vmcnt(23) lgkmcnt(8)
    v_mfma_f32_32x32x16_bf16 v[44:59], v[12:15], v[124:127], v[44:59]
    ds_read_b64_tr_b16 v[32:33], v5 offset:4096
    ds_read_b64_tr_b16 v[34:35], v5 offset:5120
    s_waitcnt lgkmcnt(8)
    v_mfma_f32_32x32x16_bf16 v[60:75], v[16:19], v[124:127], v[60:75]
    ds_read_b64_tr_b16 v[36:37], v6 offset:4096
    ds_read_b64_tr_b16 v[38:39], v6 offset:5120
    s_add_u32 m0, s23, 0
    s_add_u32 s16, s25, 0
    buffer_load_dwordx4 v3, s[4:7], s16 offen lds
    s_waitcnt lgkmcnt(8)
    v_mfma_f32_32x32x16_bf16 v[76:91], v[20:23], v[124:127], v[76:91]
    ds_read_b64_tr_b16 v[40:41], v7 offset:4096
    ds_read_b64_tr_b16 v[42:43], v7 offset:5120
    s_waitcnt lgkmcnt(8)
    v_mfma_f32_32x32x16_bf16 v[92:107], v[24:27], v[124:127], v[92:107]
    ds_read_b64_tr_b16 v[12:13], v4 offset:8192
    ds_read_b64_tr_b16 v[14:15], v4 offset:9216
    s_add_u32 m0, s23, 4096
    s_add_u32 s16, s25, 16384
    buffer_load_dwordx4 v3, s[4:7], s16 offen lds
    s_add_u32 s17, s26, 20480
    buffer_load_dwordx4 v[124:127], v2, s[32:35], s17 offen offset:0
    s_waitcnt vmcnt(25) lgkmcnt(8)
    v_mfma_f32_32x32x16_bf16 v[44:59], v[28:31], v[128:131], v[44:59]
    ds_read_b64_tr_b16 v[16:17], v5 offset:8192
    ds_read_b64_tr_b16 v[18:19], v5 offset:9216
    s_waitcnt lgkmcnt(8)
    v_mfma_f32_32x32x16_bf16 v[60:75], v[32:35], v[128:131], v[60:75]
    ds_read_b64_tr_b16 v[20:21], v6 offset:8192
    ds_read_b64_tr_b16 v[22:23], v6 offset:9216
    s_add_u32 m0, s23, 8192
    s_add_u32 s16, s25, 32768
    buffer_load_dwordx4 v3, s[4:7], s16 offen lds
    s_waitcnt lgkmcnt(8)
    v_mfma_f32_32x32x16_bf16 v[76:91], v[36:39], v[128:131], v[76:91]
    ds_read_b64_tr_b16 v[24:25], v7 offset:8192
    ds_read_b64_tr_b16 v[26:27], v7 offset:9216
    s_waitcnt lgkmcnt(8)
    v_mfma_f32_32x32x16_bf16 v[92:107], v[40:43], v[128:131], v[92:107]
    ds_read_b64_tr_b16 v[28:29], v4 offset:12288
    ds_read_b64_tr_b16 v[30:31], v4 offset:13312
    s_add_u32 m0, s23, 12288
    s_add_u32 s16, s25, 49152
    buffer_load_dwordx4 v3, s[4:7], s16 offen lds
    s_add_u32 s25, s25, 65536
    s_add_u32 s22, s22, 16384
    s_cmp_eq_u32 s22, 81920
    s_cselect_b32 s22, 0, s22
    s_add_u32 s23, s22, s24
    s_add_u32 s17, s26, 20480
    buffer_load_dwordx4 v[128:131], v2, s[32:35], s17 offen offset:1024
    s_waitcnt vmcnt(27) lgkmcnt(8)
    v_mfma_f32_32x32x16_bf16 v[44:59], v[12:15], v[132:135], v[44:59]
    ds_read_b64_tr_b16 v[32:33], v5 offset:12288
    ds_read_b64_tr_b16 v[34:35], v5 offset:13312
    s_waitcnt lgkmcnt(8)
    v_mfma_f32_32x32x16_bf16 v[60:75], v[16:19], v[132:135], v[60:75]
    ds_read_b64_tr_b16 v[36:37], v6 offset:12288
    ds_read_b64_tr_b16 v[38:39], v6 offset:13312
    s_add_u32 m0, s23, 0
    s_add_u32 s16, s25, 0
    buffer_load_dwordx4 v3, s[4:7], s16 offen lds
    s_waitcnt lgkmcnt(8)
    v_mfma_f32_32x32x16_bf16 v[76:91], v[20:23], v[132:135], v[76:91]
    ds_read_b64_tr_b16 v[40:41], v7 offset:12288
    ds_read_b64_tr_b16 v[42:43], v7 offset:13312
    s_waitcnt lgkmcnt(8)
    v_mfma_f32_32x32x16_bf16 v[92:107], v[24:27], v[132:135], v[92:107]
    s_mov_b32 s29, s28
    s_add_u32 s28, s28, 16384
    s_cmp_eq_u32 s28, 81920
    s_cselect_b32 s28, 0, s28
    s_sub_u32 s29, s28, s29
    v_add_u32 v4, s29, v4
    v_add_u32 v5, s29, v5
    v_add_u32 v6, s29, v6
    v_add_u32 v7, s29, v7
    ds_read_b64_tr_b16 v[12:13], v4 offset:0
    ds_read_b64_tr_b16 v[14:15], v4 offset:1024
    s_add_u32 m0, s23, 4096
    s_add_u32 s16, s25, 16384
    buffer_load_dwordx4 v3, s[4:7], s16 offen lds
    s_add_u32 s17, s26, 20480
    buffer_load_dwordx4 v[132:135], v2, s[32:35], s17 offen offset:2048
    s_waitcnt vmcnt(29) lgkmcnt(8)
    v_mfma_f32_32x32x16_bf16 v[44:59], v[28:31], v[136:139], v[44:59]
    ds_read_b64_tr_b16 v[16:17], v5 offset:0
    ds_read_b64_tr_b16 v[18:19], v5 offset:1024
    s_waitcnt lgkmcnt(8)
    v_mfma_f32_32x32x16_bf16 v[60:75], v[32:35], v[136:139], v[60:75]
    ds_read_b64_tr_b16 v[20:21], v6 offset:0
    ds_read_b64_tr_b16 v[22:23], v6 offset:1024
    s_add_u32 m0, s23, 8192
    s_add_u32 s16, s25, 32768
    buffer_load_dwordx4 v3, s[4:7], s16 offen lds
    s_waitcnt lgkmcnt(8)
    v_mfma_f32_32x32x16_bf16 v[76:91], v[36:39], v[136:139], v[76:91]
    ds_read_b64_tr_b16 v[24:25], v7 offset:0
    ds_read_b64_tr_b16 v[26:27], v7 offset:1024
    s_waitcnt lgkmcnt(8)
    v_mfma_f32_32x32x16_bf16 v[92:107], v[40:43], v[136:139], v[92:107]
    ds_read_b64_tr_b16 v[28:29], v4 offset:4096
    ds_read_b64_tr_b16 v[30:31], v4 offset:5120
    s_add_u32 m0, s23, 12288
    s_add_u32 s16, s25, 49152
    buffer_load_dwordx4 v3, s[4:7], s16 offen lds
    s_add_u32 s25, s25, 65536
    s_add_u32 s22, s22, 16384
    s_cmp_eq_u32 s22, 81920
    s_cselect_b32 s22, 0, s22
    s_add_u32 s23, s22, s24
    s_add_u32 s17, s26, 20480
    buffer_load_dwordx4 v[136:139], v2, s[32:35], s17 offen offset:3072
    s_waitcnt vmcnt(13)
    s_barrier
    s_waitcnt vmcnt(31) lgkmcnt(8)
    v_mfma_f32_32x32x16_bf16 v[44:59], v[12:15], v[140:143], v[44:59]
    ds_read_b64_tr_b16 v[32:33], v5 offset:4096
    ds_read_b64_tr_b16 v[34:35], v5 offset:5120
    s_waitcnt lgkmcnt(8)
    v_mfma_f32_32x32x16_bf16 v[60:75], v[16:19], v[140:143], v[60:75]
    ds_read_b64_tr_b16 v[36:37], v6 offset:4096
    ds_read_b64_tr_b16 v[38:39], v6 offset:5120
    s_add_u32 m0, s23, 0
    s_add_u32 s16, s25, 0
    buffer_load_dwordx4 v3, s[4:7], s16 offen lds
    s_waitcnt lgkmcnt(8)
    v_mfma_f32_32x32x16_bf16 v[76:91], v[20:23], v[140:143], v[76:91]
    ds_read_b64_tr_b16 v[40:41], v7 offset:4096
    ds_read_b64_tr_b16 v[42:43], v7 offset:5120
    s_waitcnt lgkmcnt(8)
    v_mfma_f32_32x32x16_bf16 v[92:107], v[24:27], v[140:143], v[92:107]
    ds_read_b64_tr_b16 v[12:13], v4 offset:8192
    ds_read_b64_tr_b16 v[14:15], v4 offset:9216
    s_add_u32 m0, s23, 4096
    s_add_u32 s16, s25, 16384
    buffer_load_dwordx4 v3, s[4:7], s16 offen lds
    s_add_u32 s17, s26, 24576
    buffer_load_dwordx4 v[140:143], v2, s[32:35], s17 offen offset:0
    s_waitcnt vmcnt(33) lgkmcnt(8)
    v_mfma_f32_32x32x16_bf16 v[44:59], v[28:31], v[144:147], v[44:59]
    ds_read_b64_tr_b16 v[16:17], v5 offset:8192
    ds_read_b64_tr_b16 v[18:19], v5 offset:9216
    s_waitcnt lgkmcnt(8)
    v_mfma_f32_32x32x16_bf16 v[60:75], v[32:35], v[144:147], v[60:75]
    ds_read_b64_tr_b16 v[20:21], v6 offset:8192
    ds_read_b64_tr_b16 v[22:23], v6 offset:9216
    s_add_u32 m0, s23, 8192
    s_add_u32 s16, s25, 32768
    buffer_load_dwordx4 v3, s[4:7], s16 offen lds
    s_waitcnt lgkmcnt(8)
    v_mfma_f32_32x32x16_bf16 v[76:91], v[36:39], v[144:147], v[76:91]
    ds_read_b64_tr_b16 v[24:25], v7 offset:8192
    ds_read_b64_tr_b16 v[26:27], v7 offset:9216
    s_waitcnt lgkmcnt(8)
    v_mfma_f32_32x32x16_bf16 v[92:107], v[40:43], v[144:147], v[92:107]
    ds_read_b64_tr_b16 v[28:29], v4 offset:12288
    ds_read_b64_tr_b16 v[30:31], v4 offset:13312
    s_add_u32 m0, s23, 12288
    s_add_u32 s16, s25, 49152
    buffer_load_dwordx4 v3, s[4:7], s16 offen lds
    s_add_u32 s25, s25, 65536
    s_add_u32 s22, s22, 16384
    s_cmp_eq_u32 s22, 81920
    s_cselect_b32 s22, 0, s22
    s_add_u32 s23, s22, s24
    s_add_u32 s17, s26, 24576
    buffer_load_dwordx4 v[144:147], v2, s[32:35], s17 offen offset:1024
    s_waitcnt vmcnt(35) lgkmcnt(8)
    v_mfma_f32_32x32x16_bf16 v[44:59], v[12:15], v[148:151], v[44:59]
    ds_read_b64_tr_b16 v[32:33], v5 offset:12288
    ds_read_b64_tr_b16 v[34:35], v5 offset:13312
    s_waitcnt lgkmcnt(8)
    v_mfma_f32_32x32x16_bf16 v[60:75], v[16:19], v[148:151], v[60:75]
    ds_read_b64_tr_b16 v[36:37], v6 offset:12288
    ds_read_b64_tr_b16 v[38:39], v6 offset:13312
    s_waitcnt lgkmcnt(8)
    v_mfma_f32_32x32x16_bf16 v[76:91], v[20:23], v[148:151], v[76:91]
    ds_read_b64_tr_b16 v[40:41], v7 offset:12288
    ds_read_b64_tr_b16 v[42:43], v7 offset:13312
    s_waitcnt lgkmcnt(8)
    v_mfma_f32_32x32x16_bf16 v[92:107], v[24:27], v[148:151], v[92:107]
    s_mov_b32 s29, s28
    s_add_u32 s28, s28, 16384
    s_cmp_eq_u32 s28, 81920
    s_cselect_b32 s28, 0, s28
    s_sub_u32 s29, s28, s29
    v_add_u32 v4, s29, v4
    v_add_u32 v5, s29, v5
    v_add_u32 v6, s29, v6
    v_add_u32 v7, s29, v7
    ds_read_b64_tr_b16 v[12:13], v4 offset:0
    ds_read_b64_tr_b16 v[14:15], v4 offset:1024
    s_add_u32 s17, s26, 24576
    buffer_load_dwordx4 v[148:151], v2, s[32:35], s17 offen offset:2048
    s_waitcnt vmcnt(35) lgkmcnt(8)
    v_mfma_f32_32x32x16_bf16 v[44:59], v[28:31], v[152:155], v[44:59]
    ds_read_b64_tr_b16 v[16:17], v5 offset:0
    ds_read_b64_tr_b16 v[18:19], v5 offset:1024
    s_waitcnt lgkmcnt(8)
    v_mfma_f32_32x32x16_bf16 v[60:75], v[32:35], v[152:155], v[60:75]
    ds_read_b64_tr_b16 v[20:21], v6 offset:0
    ds_read_b64_tr_b16 v[22:23], v6 offset:1024
    s_waitcnt lgkmcnt(8)
    v_mfma_f32_32x32x16_bf16 v[76:91], v[36:39], v[152:155], v[76:91]
    ds_read_b64_tr_b16 v[24:25], v7 offset:0
    ds_read_b64_tr_b16 v[26:27], v7 offset:1024
    s_waitcnt lgkmcnt(8)
    v_mfma_f32_32x32x16_bf16 v[92:107], v[40:43], v[152:155], v[92:107]
    ds_read_b64_tr_b16 v[28:29], v4 offset:4096
    ds_read_b64_tr_b16 v[30:31], v4 offset:5120
    s_add_u32 s17, s26, 24576
    buffer_load_dwordx4 v[152:155], v2, s[32:35], s17 offen offset:3072
    s_waitcnt vmcnt(15)
    s_barrier
    s_waitcnt vmcnt(29) lgkmcnt(8)
    v_mfma_f32_32x32x16_bf16 v[44:59], v[12:15], v[156:159], v[44:59]
    ds_read_b64_tr_b16 v[32:33], v5 offset:4096
    ds_read_b64_tr_b16 v[34:35], v5 offset:5120
    s_waitcnt lgkmcnt(8)
    v_mfma_f32_32x32x16_bf16 v[60:75], v[16:19], v[156:159], v[60:75]
    ds_read_b64_tr_b16 v[36:37], v6 offset:4096
    ds_read_b64_tr_b16 v[38:39], v6 offset:5120
    s_add_u32 m0, s23, 0
    s_add_u32 s16, s25, 0
    buffer_load_dwordx4 v3, s[4:7], s16 offen lds
    s_waitcnt lgkmcnt(8)
    v_mfma_f32_32x32x16_bf16 v[76:91], v[20:23], v[156:159], v[76:91]
    ds_read_b64_tr_b16 v[40:41], v7 offset:4096
    ds_read_b64_tr_b16 v[42:43], v7 offset:5120
    s_waitcnt lgkmcnt(8)
    v_mfma_f32_32x32x16_bf16 v[92:107], v[24:27], v[156:159], v[92:107]
    ds_read_b64_tr_b16 v[12:13], v4 offset:8192
    ds_read_b64_tr_b16 v[14:15], v4 offset:9216
    s_add_u32 m0, s23, 4096
    s_add_u32 s16, s25, 16384
    buffer_load_dwordx4 v3, s[4:7], s16 offen lds
    s_add_u32 s17, s26, 28672
    buffer_load_dwordx4 v[156:159], v2, s[32:35], s17 offen offset:0
    s_waitcnt vmcnt(31) lgkmcnt(8)
    v_mfma_f32_32x32x16_bf16 v[44:59], v[28:31], v[160:163], v[44:59]
    ds_read_b64_tr_b16 v[16:17], v5 offset:8192
    ds_read_b64_tr_b16 v[18:19], v5 offset:9216
    s_waitcnt lgkmcnt(8)
    v_mfma_f32_32x32x16_bf16 v[60:75], v[32:35], v[160:163], v[60:75]
    ds_read_b64_tr_b16 v[20:21], v6 offset:8192
    ds_read_b64_tr_b16 v[22:23], v6 offset:9216
    s_add_u32 m0, s23, 8192
    s_add_u32 s16, s25, 32768
    buffer_load_dwordx4 v3, s[4:7], s16 offen lds
    s_waitcnt lgkmcnt(8)
    v_mfma_f32_32x32x16_bf16 v[76:91], v[36:39], v[160:163], v[76:91]
    ds_read_b64_tr_b16 v[24:25], v7 offset:8192
    ds_read_b64_tr_b16 v[26:27], v7 offset:9216
    s_waitcnt lgkmcnt(8)
    v_mfma_f32_32x32x16_bf16 v[92:107], v[40:43], v[160:163], v[92:107]
    ds_read_b64_tr_b16 v[28:29], v4 offset:12288
    ds_read_b64_tr_b16 v[30:31], v4 offset:13312
    s_add_u32 m0, s23, 12288
    s_add_u32 s16, s25, 49152
    buffer_load_dwordx4 v3, s[4:7], s16 offen lds
    s_add_u32 s25, s25, 65536
    s_add_u32 s22, s22, 16384
    s_cmp_eq_u32 s22, 81920
    s_cselect_b32 s22, 0, s22
    s_add_u32 s23, s22, s24
    s_add_u32 s17, s26, 28672
    buffer_load_dwordx4 v[160:163], v2, s[32:35], s17 offen offset:1024
    s_waitcnt vmcnt(33) lgkmcnt(8)
    v_mfma_f32_32x32x16_bf16 v[44:59], v[12:15], v[164:167], v[44:59]
    ds_read_b64_tr_b16 v[32:33], v5 offset:12288
    ds_read_b64_tr_b16 v[34:35], v5 offset:13312
    s_waitcnt lgkmcnt(8)
    v_mfma_f32_32x32x16_bf16 v[60:75], v[16:19], v[164:167], v[60:75]
    ds_read_b64_tr_b16 v[36:37], v6 offset:12288
    ds_read_b64_tr_b16 v[38:39], v6 offset:13312
    s_waitcnt lgkmcnt(8)
    v_mfma_f32_32x32x16_bf16 v[76:91], v[20:23], v[164:167], v[76:91]
    ds_read_b64_tr_b16 v[40:41], v7 offset:12288
    ds_read_b64_tr_b16 v[42:43], v7 offset:13312
    s_waitcnt lgkmcnt(8)
    v_mfma_f32_32x32x16_bf16 v[92:107], v[24:27], v[164:167], v[92:107]
    s_mov_b32 s29, s28
    s_add_u32 s28, s28, 16384
    s_cmp_eq_u32 s28, 81920
    s_cselect_b32 s28, 0, s28
    s_sub_u32 s29, s28, s29
    v_add_u32 v4, s29, v4
    v_add_u32 v5, s29, v5
    v_add_u32 v6, s29, v6
    v_add_u32 v7, s29, v7
    ds_read_b64_tr_b16 v[12:13], v4 offset:0
    ds_read_b64_tr_b16 v[14:15], v4 offset:1024
    s_add_u32 s17, s26, 28672
    buffer_load_dwordx4 v[164:167], v2, s[32:35], s17 offen offset:2048
    s_waitcnt vmcnt(33) lgkmcnt(8)
    v_mfma_f32_32x32x16_bf16 v[44:59], v[28:31], v[168:171], v[44:59]
    ds_read_b64_tr_b16 v[16:17], v5 offset:0
    ds_read_b64_tr_b16 v[18:19], v5 offset:1024
    s_waitcnt lgkmcnt(8)
    v_mfma_f32_32x32x16_bf16 v[60:75], v[32:35], v[168:171], v[60:75]
    ds_read_b64_tr_b16 v[20:21], v6 offset:0
    ds_read_b64_tr_b16 v[22:23], v6 offset:1024
    s_waitcnt lgkmcnt(8)
    v_mfma_f32_32x32x16_bf16 v[76:91], v[36:39], v[168:171], v[76:91]
    ds_read_b64_tr_b16 v[24:25], v7 offset:0
    ds_read_b64_tr_b16 v[26:27], v7 offset:1024
    s_waitcnt lgkmcnt(8)
    v_mfma_f32_32x32x16_bf16 v[92:107], v[40:43], v[168:171], v[92:107]
    ds_read_b64_tr_b16 v[28:29], v4 offset:4096
    ds_read_b64_tr_b16 v[30:31], v4 offset:5120
    s_add_u32 s17, s26, 28672
    buffer_load_dwordx4 v[168:171], v2, s[32:35], s17 offen offset:3072
    s_waitcnt vmcnt(17)
    s_barrier
    s_waitcnt vmcnt(43) lgkmcnt(8)
    v_mfma_f32_32x32x16_bf16 v[44:59], v[12:15], v[108:111], v[44:59]
    ds_read_b64_tr_b16 v[32:33], v5 offset:4096
    ds_read_b64_tr_b16 v[34:35], v5 offset:5120
    s_waitcnt lgkmcnt(8)
    v_mfma_f32_32x32x16_bf16 v[60:75], v[16:19], v[108:111], v[60:75]
    ds_read_b64_tr_b16 v[36:37], v6 offset:4096
    ds_read_b64_tr_b16 v[38:39], v6 offset:5120
    s_add_u32 m0, s23, 0
    s_add_u32 s16, s25, 0
    buffer_load_dwordx4 v3, s[4:7], s16 offen lds
    s_waitcnt lgkmcnt(8)
    v_mfma_f32_32x32x16_bf16 v[76:91], v[20:23], v[108:111], v[76:91]
    ds_read_b64_tr_b16 v[40:41], v7 offset:4096
    ds_read_b64_tr_b16 v[42:43], v7 offset:5120
    s_waitcnt lgkmcnt(8)
    v_mfma_f32_32x32x16_bf16 v[92:107], v[24:27], v[108:111], v[92:107]
    ds_read_b64_tr_b16 v[12:13], v4 offset:8192
    ds_read_b64_tr_b16 v[14:15], v4 offset:9216
    s_add_u32 m0, s23, 4096
    s_add_u32 s16, s25, 16384
    buffer_load_dwordx4 v3, s[4:7], s16 offen lds
    s_add_u32 s17, s26, 32768
    buffer_load_dwordx4 v[108:111], v2, s[32:35], s17 offen offset:0
    s_waitcnt vmcnt(41) lgkmcnt(8)
    v_mfma_f32_32x32x16_bf16 v[44:59], v[28:31], v[112:115], v[44:59]
    ds_read_b64_tr_b16 v[16:17], v5 offset:8192
    ds_read_b64_tr_b16 v[18:19], v5 offset:9216
    s_waitcnt lgkmcnt(8)
    v_mfma_f32_32x32x16_bf16 v[60:75], v[32:35], v[112:115], v[60:75]
    ds_read_b64_tr_b16 v[20:21], v6 offset:8192
    ds_read_b64_tr_b16 v[22:23], v6 offset:9216
    s_add_u32 m0, s23, 8192
    s_add_u32 s16, s25, 32768
    buffer_load_dwordx4 v3, s[4:7], s16 offen lds
    s_waitcnt lgkmcnt(8)
    v_mfma_f32_32x32x16_bf16 v[76:91], v[36:39], v[112:115], v[76:91]
    ds_read_b64_tr_b16 v[24:25], v7 offset:8192
    ds_read_b64_tr_b16 v[26:27], v7 offset:9216
    s_waitcnt lgkmcnt(8)
    v_mfma_f32_32x32x16_bf16 v[92:107], v[40:43], v[112:115], v[92:107]
    ds_read_b64_tr_b16 v[28:29], v4 offset:12288
    ds_read_b64_tr_b16 v[30:31], v4 offset:13312
    s_add_u32 m0, s23, 12288
    s_add_u32 s16, s25, 49152
    buffer_load_dwordx4 v3, s[4:7], s16 offen lds
    s_add_u32 s25, s25, 65536
    s_add_u32 s22, s22, 16384
    s_cmp_eq_u32 s22, 81920
    s_cselect_b32 s22, 0, s22
    s_add_u32 s23, s22, s24
    s_add_u32 s17, s26, 32768
    buffer_load_dwordx4 v[112:115], v2, s[32:35], s17 offen offset:1024
    s_waitcnt vmcnt(39) lgkmcnt(8)
    v_mfma_f32_32x32x16_bf16 v[44:59], v[12:15], v[116:119], v[44:59]
    ds_read_b64_tr_b16 v[32:33], v5 offset:12288
    ds_read_b64_tr_b16 v[34:35], v5 offset:13312
    s_waitcnt lgkmcnt(8)
    v_mfma_f32_32x32x16_bf16 v[60:75], v[16:19], v[116:119], v[60:75]
    ds_read_b64_tr_b16 v[36:37], v6 offset:12288
    ds_read_b64_tr_b16 v[38:39], v6 offset:13312
    s_waitcnt lgkmcnt(8)
    v_mfma_f32_32x32x16_bf16 v[76:91], v[20:23], v[116:119], v[76:91]
    ds_read_b64_tr_b16 v[40:41], v7 offset:12288
    ds_read_b64_tr_b16 v[42:43], v7 offset:13312
    s_waitcnt lgkmcnt(8)
    v_mfma_f32_32x32x16_bf16 v[92:107], v[24:27], v[116:119], v[92:107]
    s_mov_b32 s29, s28
    s_add_u32 s28, s28, 16384
    s_cmp_eq_u32 s28, 81920
    s_cselect_b32 s28, 0, s28
    s_sub_u32 s29, s28, s29
    v_add_u32 v4, s29, v4
    v_add_u32 v5, s29, v5
    v_add_u32 v6, s29, v6
    v_add_u32 v7, s29, v7
    ds_read_b64_tr_b16 v[12:13], v4 offset:0
    ds_read_b64_tr_b16 v[14:15], v4 offset:1024
    s_add_u32 s17, s26, 32768
    buffer_load_dwordx4 v[116:119], v2, s[32:35], s17 offen offset:2048
    s_waitcnt vmcnt(35) lgkmcnt(8)
    v_mfma_f32_32x32x16_bf16 v[44:59], v[28:31], v[120:123], v[44:59]
    ds_read_b64_tr_b16 v[16:17], v5 offset:0
    ds_read_b64_tr_b16 v[18:19], v5 offset:1024
    s_waitcnt lgkmcnt(8)
    v_mfma_f32_32x32x16_bf16 v[60:75], v[32:35], v[120:123], v[60:75]
    ds_read_b64_tr_b16 v[20:21], v6 offset:0
    ds_read_b64_tr_b16 v[22:23], v6 offset:1024
    s_waitcnt lgkmcnt(8)
    v_mfma_f32_32x32x16_bf16 v[76:91], v[36:39], v[120:123], v[76:91]
    ds_read_b64_tr_b16 v[24:25], v7 offset:0
    ds_read_b64_tr_b16 v[26:27], v7 offset:1024
    s_waitcnt lgkmcnt(8)
    v_mfma_f32_32x32x16_bf16 v[92:107], v[40:43], v[120:123], v[92:107]
    ds_read_b64_tr_b16 v[28:29], v4 offset:4096
    ds_read_b64_tr_b16 v[30:31], v4 offset:5120
    s_add_u32 s17, s26, 32768
    buffer_load_dwordx4 v[120:123], v2, s[32:35], s17 offen offset:3072
    s_waitcnt vmcnt(19)
    s_barrier
    s_waitcnt vmcnt(33) lgkmcnt(8)
    v_mfma_f32_32x32x16_bf16 v[44:59], v[12:15], v[124:127], v[44:59]
    ds_read_b64_tr_b16 v[32:33], v5 offset:4096
    ds_read_b64_tr_b16 v[34:35], v5 offset:5120
    s_waitcnt lgkmcnt(8)
    v_mfma_f32_32x32x16_bf16 v[60:75], v[16:19], v[124:127], v[60:75]
    ds_read_b64_tr_b16 v[36:37], v6 offset:4096
    ds_read_b64_tr_b16 v[38:39], v6 offset:5120
    s_add_u32 m0, s23, 0
    s_add_u32 s16, s25, 0
    buffer_load_dwordx4 v3, s[4:7], s16 offen lds
    s_waitcnt lgkmcnt(8)
    v_mfma_f32_32x32x16_bf16 v[76:91], v[20:23], v[124:127], v[76:91]
    ds_read_b64_tr_b16 v[40:41], v7 offset:4096
    ds_read_b64_tr_b16 v[42:43], v7 offset:5120
    s_waitcnt lgkmcnt(8)
    v_mfma_f32_32x32x16_bf16 v[92:107], v[24:27], v[124:127], v[92:107]
    ds_read_b64_tr_b16 v[12:13], v4 offset:8192
    ds_read_b64_tr_b16 v[14:15], v4 offset:9216
    s_add_u32 m0, s23, 4096
    s_add_u32 s16, s25, 16384
    buffer_load_dwordx4 v3, s[4:7], s16 offen lds
    s_add_u32 s17, s26, 36864
    buffer_load_dwordx4 v[124:127], v2, s[32:35], s17 offen offset:0
    s_waitcnt vmcnt(33) lgkmcnt(8)
    v_mfma_f32_32x32x16_bf16 v[44:59], v[28:31], v[128:131], v[44:59]
    ds_read_b64_tr_b16 v[16:17], v5 offset:8192
    ds_read_b64_tr_b16 v[18:19], v5 offset:9216
    s_waitcnt lgkmcnt(8)
    v_mfma_f32_32x32x16_bf16 v[60:75], v[32:35], v[128:131], v[60:75]
    ds_read_b64_tr_b16 v[20:21], v6 offset:8192
    ds_read_b64_tr_b16 v[22:23], v6 offset:9216
    s_add_u32 m0, s23, 8192
    s_add_u32 s16, s25, 32768
    buffer_load_dwordx4 v3, s[4:7], s16 offen lds
    s_waitcnt lgkmcnt(8)
    v_mfma_f32_32x32x16_bf16 v[76:91], v[36:39], v[128:131], v[76:91]
    ds_read_b64_tr_b16 v[24:25], v7 offset:8192
    ds_read_b64_tr_b16 v[26:27], v7 offset:9216
    s_waitcnt lgkmcnt(8)
    v_mfma_f32_32x32x16_bf16 v[92:107], v[40:43], v[128:131], v[92:107]
    ds_read_b64_tr_b16 v[28:29], v4 offset:12288
    ds_read_b64_tr_b16 v[30:31], v4 offset:13312
    s_add_u32 m0, s23, 12288
    s_add_u32 s16, s25, 49152
    buffer_load_dwordx4 v3, s[4:7], s16 offen lds
    s_add_u32 s25, s25, 65536
    s_add_u32 s22, s22, 16384
    s_cmp_eq_u32 s22, 81920
    s_cselect_b32 s22, 0, s22
    s_add_u32 s23, s22, s24
    s_add_u32 s17, s26, 36864
    buffer_load_dwordx4 v[128:131], v2, s[32:35], s17 offen offset:1024
    s_waitcnt vmcnt(33) lgkmcnt(8)
    v_mfma_f32_32x32x16_bf16 v[44:59], v[12:15], v[132:135], v[44:59]
    ds_read_b64_tr_b16 v[32:33], v5 offset:12288
    ds_read_b64_tr_b16 v[34:35], v5 offset:13312
    s_waitcnt lgkmcnt(8)
    v_mfma_f32_32x32x16_bf16 v[60:75], v[16:19], v[132:135], v[60:75]
    ds_read_b64_tr_b16 v[36:37], v6 offset:12288
    ds_read_b64_tr_b16 v[38:39], v6 offset:13312
    s_waitcnt lgkmcnt(8)
    v_mfma_f32_32x32x16_bf16 v[76:91], v[20:23], v[132:135], v[76:91]
    ds_read_b64_tr_b16 v[40:41], v7 offset:12288
    ds_read_b64_tr_b16 v[42:43], v7 offset:13312
    s_waitcnt lgkmcnt(8)
    v_mfma_f32_32x32x16_bf16 v[92:107], v[24:27], v[132:135], v[92:107]
    s_mov_b32 s29, s28
    s_add_u32 s28, s28, 16384
    s_cmp_eq_u32 s28, 81920
    s_cselect_b32 s28, 0, s28
    s_sub_u32 s29, s28, s29
    v_add_u32 v4, s29, v4
    v_add_u32 v5, s29, v5
    v_add_u32 v6, s29, v6
    v_add_u32 v7, s29, v7
    ds_read_b64_tr_b16 v[12:13], v4 offset:0
    ds_read_b64_tr_b16 v[14:15], v4 offset:1024
    s_add_u32 s17, s26, 36864
    buffer_load_dwordx4 v[132:135], v2, s[32:35], s17 offen offset:2048
    s_waitcnt vmcnt(31) lgkmcnt(8)
    v_mfma_f32_32x32x16_bf16 v[44:59], v[28:31], v[136:139], v[44:59]
    ds_read_b64_tr_b16 v[16:17], v5 offset:0
    ds_read_b64_tr_b16 v[18:19], v5 offset:1024
    s_waitcnt lgkmcnt(8)
    v_mfma_f32_32x32x16_bf16 v[60:75], v[32:35], v[136:139], v[60:75]
    ds_read_b64_tr_b16 v[20:21], v6 offset:0
    ds_read_b64_tr_b16 v[22:23], v6 offset:1024
    s_waitcnt lgkmcnt(8)
    v_mfma_f32_32x32x16_bf16 v[76:91], v[36:39], v[136:139], v[76:91]
    ds_read_b64_tr_b16 v[24:25], v7 offset:0
    ds_read_b64_tr_b16 v[26:27], v7 offset:1024
    s_waitcnt lgkmcnt(8)
    v_mfma_f32_32x32x16_bf16 v[92:107], v[40:43], v[136:139], v[92:107]
    ds_read_b64_tr_b16 v[28:29], v4 offset:4096
    ds_read_b64_tr_b16 v[30:31], v4 offset:5120
    s_add_u32 s17, s26, 36864
    buffer_load_dwordx4 v[136:139], v2, s[32:35], s17 offen offset:3072
    s_waitcnt vmcnt(19)
    s_barrier
    s_waitcnt vmcnt(29) lgkmcnt(8)
    v_mfma_f32_32x32x16_bf16 v[44:59], v[12:15], v[140:143], v[44:59]
    ds_read_b64_tr_b16 v[32:33], v5 offset:4096
    ds_read_b64_tr_b16 v[34:35], v5 offset:5120
    s_waitcnt lgkmcnt(8)
    v_mfma_f32_32x32x16_bf16 v[60:75], v[16:19], v[140:143], v[60:75]
    ds_read_b64_tr_b16 v[36:37], v6 offset:4096
    ds_read_b64_tr_b16 v[38:39], v6 offset:5120
    s_add_u32 m0, s23, 0
    s_add_u32 s16, s25, 0
    buffer_load_dwordx4 v3, s[4:7], s16 offen lds
    s_waitcnt lgkmcnt(8)
    v_mfma_f32_32x32x16_bf16 v[76:91], v[20:23], v[140:143], v[76:91]
    ds_read_b64_tr_b16 v[40:41], v7 offset:4096
    ds_read_b64_tr_b16 v[42:43], v7 offset:5120
    s_waitcnt lgkmcnt(8)
    v_mfma_f32_32x32x16_bf16 v[92:107], v[24:27], v[140:143], v[92:107]
    ds_read_b64_tr_b16 v[12:13], v4 offset:8192
    ds_read_b64_tr_b16 v[14:15], v4 offset:9216
    s_add_u32 m0, s23, 4096
    s_add_u32 s16, s25, 16384
    buffer_load_dwordx4 v3, s[4:7], s16 offen lds
    s_add_u32 s17, s26, 40960
    buffer_load_dwordx4 v[140:143], v2, s[32:35], s17 offen offset:0
    s_waitcnt vmcnt(29) lgkmcnt(8)
    v_mfma_f32_32x32x16_bf16 v[44:59], v[28:31], v[144:147], v[44:59]
    ds_read_b64_tr_b16 v[16:17], v5 offset:8192
    ds_read_b64_tr_b16 v[18:19], v5 offset:9216
    s_waitcnt lgkmcnt(8)
    v_mfma_f32_32x32x16_bf16 v[60:75], v[32:35], v[144:147], v[60:75]
    ds_read_b64_tr_b16 v[20:21], v6 offset:8192
    ds_read_b64_tr_b16 v[22:23], v6 offset:9216
    s_add_u32 m0, s23, 8192
    s_add_u32 s16, s25, 32768
    buffer_load_dwordx4 v3, s[4:7], s16 offen lds
    s_waitcnt lgkmcnt(8)
    v_mfma_f32_32x32x16_bf16 v[76:91], v[36:39], v[144:147], v[76:91]
    ds_read_b64_tr_b16 v[24:25], v7 offset:8192
    ds_read_b64_tr_b16 v[26:27], v7 offset:9216
    s_waitcnt lgkmcnt(8)
    v_mfma_f32_32x32x16_bf16 v[92:107], v[40:43], v[144:147], v[92:107]
    ds_read_b64_tr_b16 v[28:29], v4 offset:12288
    ds_read_b64_tr_b16 v[30:31], v4 offset:13312
    s_add_u32 m0, s23, 12288
    s_add_u32 s16, s25, 49152
    buffer_load_dwordx4 v3, s[4:7], s16 offen lds
    s_add_u32 s25, s25, 65536
    s_add_u32 s22, s22, 16384
    s_cmp_eq_u32 s22, 81920
    s_cselect_b32 s22, 0, s22
    s_add_u32 s23, s22, s24
    s_add_u32 s17, s26, 40960
    buffer_load_dwordx4 v[144:147], v2, s[32:35], s17 offen offset:1024
    s_waitcnt vmcnt(31) lgkmcnt(8)
    v_mfma_f32_32x32x16_bf16 v[44:59], v[12:15], v[148:151], v[44:59]
    ds_read_b64_tr_b16 v[32:33], v5 offset:12288
    ds_read_b64_tr_b16 v[34:35], v5 offset:13312
    s_waitcnt lgkmcnt(8)
    v_mfma_f32_32x32x16_bf16 v[60:75], v[16:19], v[148:151], v[60:75]
    ds_read_b64_tr_b16 v[36:37], v6 offset:12288
    ds_read_b64_tr_b16 v[38:39], v6 offset:13312
    s_waitcnt lgkmcnt(8)
    v_mfma_f32_32x32x16_bf16 v[76:91], v[20:23], v[148:151], v[76:91]
    ds_read_b64_tr_b16 v[40:41], v7 offset:12288
    ds_read_b64_tr_b16 v[42:43], v7 offset:13312
    s_waitcnt lgkmcnt(8)
    v_mfma_f32_32x32x16_bf16 v[92:107], v[24:27], v[148:151], v[92:107]
    s_mov_b32 s29, s28
    s_add_u32 s28, s28, 16384
    s_cmp_eq_u32 s28, 81920
    s_cselect_b32 s28, 0, s28
    s_sub_u32 s29, s28, s29
    v_add_u32 v4, s29, v4
    v_add_u32 v5, s29, v5
    v_add_u32 v6, s29, v6
    v_add_u32 v7, s29, v7
    ds_read_b64_tr_b16 v[12:13], v4 offset:0
    ds_read_b64_tr_b16 v[14:15], v4 offset:1024
    s_add_u32 s17, s26, 40960
    buffer_load_dwordx4 v[148:151], v2, s[32:35], s17 offen offset:2048
    s_waitcnt vmcnt(31) lgkmcnt(8)
    v_mfma_f32_32x32x16_bf16 v[44:59], v[28:31], v[152:155], v[44:59]
    ds_read_b64_tr_b16 v[16:17], v5 offset:0
    ds_read_b64_tr_b16 v[18:19], v5 offset:1024
    s_waitcnt lgkmcnt(8)
    v_mfma_f32_32x32x16_bf16 v[60:75], v[32:35], v[152:155], v[60:75]
    ds_read_b64_tr_b16 v[20:21], v6 offset:0
    ds_read_b64_tr_b16 v[22:23], v6 offset:1024
    s_waitcnt lgkmcnt(8)
    v_mfma_f32_32x32x16_bf16 v[76:91], v[36:39], v[152:155], v[76:91]
    ds_read_b64_tr_b16 v[24:25], v7 offset:0
    ds_read_b64_tr_b16 v[26:27], v7 offset:1024
    s_waitcnt lgkmcnt(8)
    v_mfma_f32_32x32x16_bf16 v[92:107], v[40:43], v[152:155], v[92:107]
    ds_read_b64_tr_b16 v[28:29], v4 offset:4096
    ds_read_b64_tr_b16 v[30:31], v4 offset:5120
    s_add_u32 s17, s26, 40960
    buffer_load_dwordx4 v[152:155], v2, s[32:35], s17 offen offset:3072
    s_waitcnt vmcnt(19)
    s_barrier
    s_waitcnt vmcnt(29) lgkmcnt(8)
    v_mfma_f32_32x32x16_bf16 v[44:59], v[12:15], v[156:159], v[44:59]
    ds_read_b64_tr_b16 v[32:33], v5 offset:4096
    ds_read_b64_tr_b16 v[34:35], v5 offset:5120
    s_waitcnt lgkmcnt(8)
    v_mfma_f32_32x32x16_bf16 v[60:75], v[16:19], v[156:159], v[60:75]
    ds_read_b64_tr_b16 v[36:37], v6 offset:4096
    ds_read_b64_tr_b16 v[38:39], v6 offset:5120
    s_add_u32 m0, s23, 0
    s_add_u32 s16, s25, 0
    buffer_load_dwordx4 v3, s[4:7], s16 offen lds
    s_waitcnt lgkmcnt(8)
    v_mfma_f32_32x32x16_bf16 v[76:91], v[20:23], v[156:159], v[76:91]
    ds_read_b64_tr_b16 v[40:41], v7 offset:4096
    ds_read_b64_tr_b16 v[42:43], v7 offset:5120
    s_waitcnt lgkmcnt(8)
    v_mfma_f32_32x32x16_bf16 v[92:107], v[24:27], v[156:159], v[92:107]
    ds_read_b64_tr_b16 v[12:13], v4 offset:8192
    ds_read_b64_tr_b16 v[14:15], v4 offset:9216
    s_add_u32 m0, s23, 4096
    s_add_u32 s16, s25, 16384
    buffer_load_dwordx4 v3, s[4:7], s16 offen lds
    s_add_u32 s17, s26, 45056
    buffer_load_dwordx4 v[156:159], v2, s[32:35], s17 offen offset:0
    s_waitcnt vmcnt(29) lgkmcnt(8)
    v_mfma_f32_32x32x16_bf16 v[44:59], v[28:31], v[160:163], v[44:59]
    ds_read_b64_tr_b16 v[16:17], v5 offset:8192
    ds_read_b64_tr_b16 v[18:19], v5 offset:9216
    s_waitcnt lgkmcnt(8)
    v_mfma_f32_32x32x16_bf16 v[60:75], v[32:35], v[160:163], v[60:75]
    ds_read_b64_tr_b16 v[20:21], v6 offset:8192
    ds_read_b64_tr_b16 v[22:23], v6 offset:9216
    s_add_u32 m0, s23, 8192
    s_add_u32 s16, s25, 32768
    buffer_load_dwordx4 v3, s[4:7], s16 offen lds
    s_waitcnt lgkmcnt(8)
    v_mfma_f32_32x32x16_bf16 v[76:91], v[36:39], v[160:163], v[76:91]
    ds_read_b64_tr_b16 v[24:25], v7 offset:8192
    ds_read_b64_tr_b16 v[26:27], v7 offset:9216
    s_waitcnt lgkmcnt(8)
    v_mfma_f32_32x32x16_bf16 v[92:107], v[40:43], v[160:163], v[92:107]
    ds_read_b64_tr_b16 v[28:29], v4 offset:12288
    ds_read_b64_tr_b16 v[30:31], v4 offset:13312
    s_add_u32 m0, s23, 12288
    s_add_u32 s16, s25, 49152
    buffer_load_dwordx4 v3, s[4:7], s16 offen lds
    s_add_u32 s25, s25, 65536
    s_add_u32 s22, s22, 16384
    s_cmp_eq_u32 s22, 81920
    s_cselect_b32 s22, 0, s22
    s_add_u32 s23, s22, s24
    s_add_u32 s17, s26, 45056
    buffer_load_dwordx4 v[160:163], v2, s[32:35], s17 offen offset:1024
    s_waitcnt vmcnt(31) lgkmcnt(8)
    v_mfma_f32_32x32x16_bf16 v[44:59], v[12:15], v[164:167], v[44:59]
    ds_read_b64_tr_b16 v[32:33], v5 offset:12288
    ds_read_b64_tr_b16 v[34:35], v5 offset:13312
    s_waitcnt lgkmcnt(8)
    v_mfma_f32_32x32x16_bf16 v[60:75], v[16:19], v[164:167], v[60:75]
    ds_read_b64_tr_b16 v[36:37], v6 offset:12288
    ds_read_b64_tr_b16 v[38:39], v6 offset:13312
    s_waitcnt lgkmcnt(8)
    v_mfma_f32_32x32x16_bf16 v[76:91], v[20:23], v[164:167], v[76:91]
    ds_read_b64_tr_b16 v[40:41], v7 offset:12288
    ds_read_b64_tr_b16 v[42:43], v7 offset:13312
    s_waitcnt lgkmcnt(8)
    v_mfma_f32_32x32x16_bf16 v[92:107], v[24:27], v[164:167], v[92:107]
    s_mov_b32 s29, s28
    s_add_u32 s28, s28, 16384
    s_cmp_eq_u32 s28, 81920
    s_cselect_b32 s28, 0, s28
    s_sub_u32 s29, s28, s29
    v_add_u32 v4, s29, v4
    v_add_u32 v5, s29, v5
    v_add_u32 v6, s29, v6
    v_add_u32 v7, s29, v7
    ds_read_b64_tr_b16 v[12:13], v4 offset:0
    ds_read_b64_tr_b16 v[14:15], v4 offset:1024
    s_add_u32 s17, s26, 45056
    buffer_load_dwordx4 v[164:167], v2, s[32:35], s17 offen offset:2048
    s_waitcnt vmcnt(31) lgkmcnt(8)
    v_mfma_f32_32x32x16_bf16 v[44:59], v[28:31], v[168:171], v[44:59]
    ds_read_b64_tr_b16 v[16:17], v5 offset:0
    ds_read_b64_tr_b16 v[18:19], v5 offset:1024
    s_waitcnt lgkmcnt(8)
    v_mfma_f32_32x32x16_bf16 v[60:75], v[32:35], v[168:171], v[60:75]
    ds_read_b64_tr_b16 v[20:21], v6 offset:0
    ds_read_b64_tr_b16 v[22:23], v6 offset:1024
    s_waitcnt lgkmcnt(8)
    v_mfma_f32_32x32x16_bf16 v[76:91], v[36:39], v[168:171], v[76:91]
    ds_read_b64_tr_b16 v[24:25], v7 offset:0
    ds_read_b64_tr_b16 v[26:27], v7 offset:1024
    s_waitcnt lgkmcnt(8)
    v_mfma_f32_32x32x16_bf16 v[92:107], v[40:43], v[168:171], v[92:107]
    ds_read_b64_tr_b16 v[28:29], v4 offset:4096
    ds_read_b64_tr_b16 v[30:31], v4 offset:5120
    s_add_u32 s17, s26, 45056
    buffer_load_dwordx4 v[168:171], v2, s[32:35], s17 offen offset:3072
    s_waitcnt vmcnt(19)
    s_barrier
    s_waitcnt vmcnt(29) lgkmcnt(8)
    v_mfma_f32_32x32x16_bf16 v[44:59], v[12:15], v[108:111], v[44:59]
    ds_read_b64_tr_b16 v[32:33], v5 offset:4096
    ds_read_b64_tr_b16 v[34:35], v5 offset:5120
    s_waitcnt lgkmcnt(8)
    v_mfma_f32_32x32x16_bf16 v[60:75], v[16:19], v[108:111], v[60:75]
    ds_read_b64_tr_b16 v[36:37], v6 offset:4096
    ds_read_b64_tr_b16 v[38:39], v6 offset:5120
    s_add_u32 m0, s23, 0
    s_add_u32 s16, s25, 0
    buffer_load_dwordx4 v3, s[4:7], s16 offen lds
    s_waitcnt lgkmcnt(8)
    v_mfma_f32_32x32x16_bf16 v[76:91], v[20:23], v[108:111], v[76:91]
    ds_read_b64_tr_b16 v[40:41], v7 offset:4096
    ds_read_b64_tr_b16 v[42:43], v7 offset:5120
    s_waitcnt lgkmcnt(8)
    v_mfma_f32_32x32x16_bf16 v[92:107], v[24:27], v[108:111], v[92:107]
    ds_read_b64_tr_b16 v[12:13], v4 offset:8192
    ds_read_b64_tr_b16 v[14:15], v4 offset:9216
    s_add_u32 m0, s23, 4096
    s_add_u32 s16, s25, 16384
    buffer_load_dwordx4 v3, s[4:7], s16 offen lds
    s_add_u32 s17, s26, 49152
    buffer_load_dwordx4 v[108:111], v2, s[32:35], s17 offen offset:0
    s_waitcnt vmcnt(29) lgkmcnt(8)
    v_mfma_f32_32x32x16_bf16 v[44:59], v[28:31], v[112:115], v[44:59]
    ds_read_b64_tr_b16 v[16:17], v5 offset:8192
    ds_read_b64_tr_b16 v[18:19], v5 offset:9216
    s_waitcnt lgkmcnt(8)
    v_mfma_f32_32x32x16_bf16 v[60:75], v[32:35], v[112:115], v[60:75]
    ds_read_b64_tr_b16 v[20:21], v6 offset:8192
    ds_read_b64_tr_b16 v[22:23], v6 offset:9216
    s_add_u32 m0, s23, 8192
    s_add_u32 s16, s25, 32768
    buffer_load_dwordx4 v3, s[4:7], s16 offen lds
    s_waitcnt lgkmcnt(8)
    v_mfma_f32_32x32x16_bf16 v[76:91], v[36:39], v[112:115], v[76:91]
    ds_read_b64_tr_b16 v[24:25], v7 offset:8192
    ds_read_b64_tr_b16 v[26:27], v7 offset:9216
    s_waitcnt lgkmcnt(8)
    v_mfma_f32_32x32x16_bf16 v[92:107], v[40:43], v[112:115], v[92:107]
    ds_read_b64_tr_b16 v[28:29], v4 offset:12288
    ds_read_b64_tr_b16 v[30:31], v4 offset:13312
    s_add_u32 m0, s23, 12288
    s_add_u32 s16, s25, 49152
    buffer_load_dwordx4 v3, s[4:7], s16 offen lds
    s_add_u32 s25, s25, 65536
    s_add_u32 s22, s22, 16384
    s_cmp_eq_u32 s22, 81920
    s_cselect_b32 s22, 0, s22
    s_add_u32 s23, s22, s24
    s_add_u32 s17, s26, 49152
    buffer_load_dwordx4 v[112:115], v2, s[32:35], s17 offen offset:1024
    s_waitcnt vmcnt(31) lgkmcnt(8)
    v_mfma_f32_32x32x16_bf16 v[44:59], v[12:15], v[116:119], v[44:59]
    ds_read_b64_tr_b16 v[32:33], v5 offset:12288
    ds_read_b64_tr_b16 v[34:35], v5 offset:13312
    s_waitcnt lgkmcnt(8)
    v_mfma_f32_32x32x16_bf16 v[60:75], v[16:19], v[116:119], v[60:75]
    ds_read_b64_tr_b16 v[36:37], v6 offset:12288
    ds_read_b64_tr_b16 v[38:39], v6 offset:13312
    s_waitcnt lgkmcnt(8)
    v_mfma_f32_32x32x16_bf16 v[76:91], v[20:23], v[116:119], v[76:91]
    ds_read_b64_tr_b16 v[40:41], v7 offset:12288
    ds_read_b64_tr_b16 v[42:43], v7 offset:13312
    s_waitcnt lgkmcnt(8)
    v_mfma_f32_32x32x16_bf16 v[92:107], v[24:27], v[116:119], v[92:107]
    s_mov_b32 s29, s28
    s_add_u32 s28, s28, 16384
    s_cmp_eq_u32 s28, 81920
    s_cselect_b32 s28, 0, s28
    s_sub_u32 s29, s28, s29
    v_add_u32 v4, s29, v4
    v_add_u32 v5, s29, v5
    v_add_u32 v6, s29, v6
    v_add_u32 v7, s29, v7
    ds_read_b64_tr_b16 v[12:13], v4 offset:0
    ds_read_b64_tr_b16 v[14:15], v4 offset:1024
    s_add_u32 s17, s26, 49152
    buffer_load_dwordx4 v[116:119], v2, s[32:35], s17 offen offset:2048
    s_waitcnt vmcnt(31) lgkmcnt(8)
    v_mfma_f32_32x32x16_bf16 v[44:59], v[28:31], v[120:123], v[44:59]
    ds_read_b64_tr_b16 v[16:17], v5 offset:0
    ds_read_b64_tr_b16 v[18:19], v5 offset:1024
    s_waitcnt lgkmcnt(8)
    v_mfma_f32_32x32x16_bf16 v[60:75], v[32:35], v[120:123], v[60:75]
    ds_read_b64_tr_b16 v[20:21], v6 offset:0
    ds_read_b64_tr_b16 v[22:23], v6 offset:1024
    s_waitcnt lgkmcnt(8)
    v_mfma_f32_32x32x16_bf16 v[76:91], v[36:39], v[120:123], v[76:91]
    ds_read_b64_tr_b16 v[24:25], v7 offset:0
    ds_read_b64_tr_b16 v[26:27], v7 offset:1024
    s_waitcnt lgkmcnt(8)
    v_mfma_f32_32x32x16_bf16 v[92:107], v[40:43], v[120:123], v[92:107]
    ds_read_b64_tr_b16 v[28:29], v4 offset:4096
    ds_read_b64_tr_b16 v[30:31], v4 offset:5120
    s_add_u32 s17, s26, 49152
    buffer_load_dwordx4 v[120:123], v2, s[32:35], s17 offen offset:3072
    s_waitcnt vmcnt(19)
    s_barrier
    s_waitcnt vmcnt(29) lgkmcnt(8)
    v_mfma_f32_32x32x16_bf16 v[44:59], v[12:15], v[124:127], v[44:59]
    ds_read_b64_tr_b16 v[32:33], v5 offset:4096
    ds_read_b64_tr_b16 v[34:35], v5 offset:5120
    s_waitcnt lgkmcnt(8)
    v_mfma_f32_32x32x16_bf16 v[60:75], v[16:19], v[124:127], v[60:75]
    ds_read_b64_tr_b16 v[36:37], v6 offset:4096
    ds_read_b64_tr_b16 v[38:39], v6 offset:5120
    s_add_u32 m0, s23, 0
    s_add_u32 s16, s25, 0
    buffer_load_dwordx4 v3, s[4:7], s16 offen lds
    s_waitcnt lgkmcnt(8)
    v_mfma_f32_32x32x16_bf16 v[76:91], v[20:23], v[124:127], v[76:91]
    ds_read_b64_tr_b16 v[40:41], v7 offset:4096
    ds_read_b64_tr_b16 v[42:43], v7 offset:5120
    s_waitcnt lgkmcnt(8)
    v_mfma_f32_32x32x16_bf16 v[92:107], v[24:27], v[124:127], v[92:107]
    ds_read_b64_tr_b16 v[12:13], v4 offset:8192
    ds_read_b64_tr_b16 v[14:15], v4 offset:9216
    s_add_u32 m0, s23, 4096
    s_add_u32 s16, s25, 16384
    buffer_load_dwordx4 v3, s[4:7], s16 offen lds
    s_add_u32 s17, s26, 53248
    buffer_load_dwordx4 v[124:127], v2, s[32:35], s17 offen offset:0
    s_waitcnt vmcnt(29) lgkmcnt(8)
    v_mfma_f32_32x32x16_bf16 v[44:59], v[28:31], v[128:131], v[44:59]
    ds_read_b64_tr_b16 v[16:17], v5 offset:8192
    ds_read_b64_tr_b16 v[18:19], v5 offset:9216
    s_waitcnt lgkmcnt(8)
    v_mfma_f32_32x32x16_bf16 v[60:75], v[32:35], v[128:131], v[60:75]
    ds_read_b64_tr_b16 v[20:21], v6 offset:8192
    ds_read_b64_tr_b16 v[22:23], v6 offset:9216
    s_add_u32 m0, s23, 8192
    s_add_u32 s16, s25, 32768
    buffer_load_dwordx4 v3, s[4:7], s16 offen lds
    s_waitcnt lgkmcnt(8)
    v_mfma_f32_32x32x16_bf16 v[76:91], v[36:39], v[128:131], v[76:91]
    ds_read_b64_tr_b16 v[24:25], v7 offset:8192
    ds_read_b64_tr_b16 v[26:27], v7 offset:9216
    s_waitcnt lgkmcnt(8)
    v_mfma_f32_32x32x16_bf16 v[92:107], v[40:43], v[128:131], v[92:107]
    ds_read_b64_tr_b16 v[28:29], v4 offset:12288
    ds_read_b64_tr_b16 v[30:31], v4 offset:13312
    s_add_u32 m0, s23, 12288
    s_add_u32 s16, s25, 49152
    buffer_load_dwordx4 v3, s[4:7], s16 offen lds
    s_add_u32 s25, s25, 65536
    s_add_u32 s22, s22, 16384
    s_cmp_eq_u32 s22, 81920
    s_cselect_b32 s22, 0, s22
    s_add_u32 s23, s22, s24
    s_add_u32 s17, s26, 53248
    buffer_load_dwordx4 v[128:131], v2, s[32:35], s17 offen offset:1024
    s_waitcnt vmcnt(31) lgkmcnt(8)
    v_mfma_f32_32x32x16_bf16 v[44:59], v[12:15], v[132:135], v[44:59]
    ds_read_b64_tr_b16 v[32:33], v5 offset:12288
    ds_read_b64_tr_b16 v[34:35], v5 offset:13312
    s_waitcnt lgkmcnt(8)
    v_mfma_f32_32x32x16_bf16 v[60:75], v[16:19], v[132:135], v[60:75]
    ds_read_b64_tr_b16 v[36:37], v6 offset:12288
    ds_read_b64_tr_b16 v[38:39], v6 offset:13312
    s_waitcnt lgkmcnt(8)
    v_mfma_f32_32x32x16_bf16 v[76:91], v[20:23], v[132:135], v[76:91]
    ds_read_b64_tr_b16 v[40:41], v7 offset:12288
    ds_read_b64_tr_b16 v[42:43], v7 offset:13312
    s_waitcnt lgkmcnt(8)
    v_mfma_f32_32x32x16_bf16 v[92:107], v[24:27], v[132:135], v[92:107]
    s_mov_b32 s29, s28
    s_add_u32 s28, s28, 16384
    s_cmp_eq_u32 s28, 81920
    s_cselect_b32 s28, 0, s28
    s_sub_u32 s29, s28, s29
    v_add_u32 v4, s29, v4
    v_add_u32 v5, s29, v5
    v_add_u32 v6, s29, v6
    v_add_u32 v7, s29, v7
    ds_read_b64_tr_b16 v[12:13], v4 offset:0
    ds_read_b64_tr_b16 v[14:15], v4 offset:1024
    s_add_u32 s17, s26, 53248
    buffer_load_dwordx4 v[132:135], v2, s[32:35], s17 offen offset:2048
    s_waitcnt vmcnt(31) lgkmcnt(8)
    v_mfma_f32_32x32x16_bf16 v[44:59], v[28:31], v[136:139], v[44:59]
    ds_read_b64_tr_b16 v[16:17], v5 offset:0
    ds_read_b64_tr_b16 v[18:19], v5 offset:1024
    s_waitcnt lgkmcnt(8)
    v_mfma_f32_32x32x16_bf16 v[60:75], v[32:35], v[136:139], v[60:75]
    ds_read_b64_tr_b16 v[20:21], v6 offset:0
    ds_read_b64_tr_b16 v[22:23], v6 offset:1024
    s_waitcnt lgkmcnt(8)
    v_mfma_f32_32x32x16_bf16 v[76:91], v[36:39], v[136:139], v[76:91]
    ds_read_b64_tr_b16 v[24:25], v7 offset:0
    ds_read_b64_tr_b16 v[26:27], v7 offset:1024
    s_waitcnt lgkmcnt(8)
    v_mfma_f32_32x32x16_bf16 v[92:107], v[40:43], v[136:139], v[92:107]
    ds_read_b64_tr_b16 v[28:29], v4 offset:4096
    ds_read_b64_tr_b16 v[30:31], v4 offset:5120
    s_add_u32 s17, s26, 53248
    buffer_load_dwordx4 v[136:139], v2, s[32:35], s17 offen offset:3072
    s_waitcnt vmcnt(19)
    s_barrier
    s_waitcnt vmcnt(29) lgkmcnt(8)
    v_mfma_f32_32x32x16_bf16 v[44:59], v[12:15], v[140:143], v[44:59]
    ds_read_b64_tr_b16 v[32:33], v5 offset:4096
    ds_read_b64_tr_b16 v[34:35], v5 offset:5120
    s_waitcnt lgkmcnt(8)
    v_mfma_f32_32x32x16_bf16 v[60:75], v[16:19], v[140:143], v[60:75]
    ds_read_b64_tr_b16 v[36:37], v6 offset:4096
    ds_read_b64_tr_b16 v[38:39], v6 offset:5120
    s_add_u32 m0, s23, 0
    s_add_u32 s16, s25, 0
    buffer_load_dwordx4 v3, s[4:7], s16 offen lds
    s_waitcnt lgkmcnt(8)
    v_mfma_f32_32x32x16_bf16 v[76:91], v[20:23], v[140:143], v[76:91]
    ds_read_b64_tr_b16 v[40:41], v7 offset:4096
    ds_read_b64_tr_b16 v[42:43], v7 offset:5120
    s_waitcnt lgkmcnt(8)
    v_mfma_f32_32x32x16_bf16 v[92:107], v[24:27], v[140:143], v[92:107]
    ds_read_b64_tr_b16 v[12:13], v4 offset:8192
    ds_read_b64_tr_b16 v[14:15], v4 offset:9216
    s_add_u32 m0, s23, 4096
    s_add_u32 s16, s25, 16384
    buffer_load_dwordx4 v3, s[4:7], s16 offen lds
    s_add_u32 s17, s26, 57344
    buffer_load_dwordx4 v[140:143], v2, s[32:35], s17 offen offset:0
    s_waitcnt vmcnt(29) lgkmcnt(8)
    v_mfma_f32_32x32x16_bf16 v[44:59], v[28:31], v[144:147], v[44:59]
    ds_read_b64_tr_b16 v[16:17], v5 offset:8192
    ds_read_b64_tr_b16 v[18:19], v5 offset:9216
    s_waitcnt lgkmcnt(8)
    v_mfma_f32_32x32x16_bf16 v[60:75], v[32:35], v[144:147], v[60:75]
    ds_read_b64_tr_b16 v[20:21], v6 offset:8192
    ds_read_b64_tr_b16 v[22:23], v6 offset:9216
    s_add_u32 m0, s23, 8192
    s_add_u32 s16, s25, 32768
    buffer_load_dwordx4 v3, s[4:7], s16 offen lds
    s_waitcnt lgkmcnt(8)
    v_mfma_f32_32x32x16_bf16 v[76:91], v[36:39], v[144:147], v[76:91]
    ds_read_b64_tr_b16 v[24:25], v7 offset:8192
    ds_read_b64_tr_b16 v[26:27], v7 offset:9216
    s_waitcnt lgkmcnt(8)
    v_mfma_f32_32x32x16_bf16 v[92:107], v[40:43], v[144:147], v[92:107]
    ds_read_b64_tr_b16 v[28:29], v4 offset:12288
    ds_read_b64_tr_b16 v[30:31], v4 offset:13312
    s_add_u32 m0, s23, 12288
    s_add_u32 s16, s25, 49152
    buffer_load_dwordx4 v3, s[4:7], s16 offen lds
    s_add_u32 s25, s25, 65536
    s_add_u32 s22, s22, 16384
    s_cmp_eq_u32 s22, 81920
    s_cselect_b32 s22, 0, s22
    s_add_u32 s23, s22, s24
    s_add_u32 s17, s26, 57344
    buffer_load_dwordx4 v[144:147], v2, s[32:35], s17 offen offset:1024
    s_waitcnt vmcnt(31) lgkmcnt(8)
    v_mfma_f32_32x32x16_bf16 v[44:59], v[12:15], v[148:151], v[44:59]
    ds_read_b64_tr_b16 v[32:33], v5 offset:12288
    ds_read_b64_tr_b16 v[34:35], v5 offset:13312
    s_waitcnt lgkmcnt(8)
    v_mfma_f32_32x32x16_bf16 v[60:75], v[16:19], v[148:151], v[60:75]
    ds_read_b64_tr_b16 v[36:37], v6 offset:12288
    ds_read_b64_tr_b16 v[38:39], v6 offset:13312
    s_waitcnt lgkmcnt(8)
    v_mfma_f32_32x32x16_bf16 v[76:91], v[20:23], v[148:151], v[76:91]
    ds_read_b64_tr_b16 v[40:41], v7 offset:12288
    ds_read_b64_tr_b16 v[42:43], v7 offset:13312
    s_waitcnt lgkmcnt(8)
    v_mfma_f32_32x32x16_bf16 v[92:107], v[24:27], v[148:151], v[92:107]
    s_mov_b32 s29, s28
    s_add_u32 s28, s28, 16384
    s_cmp_eq_u32 s28, 81920
    s_cselect_b32 s28, 0, s28
    s_sub_u32 s29, s28, s29
    v_add_u32 v4, s29, v4
    v_add_u32 v5, s29, v5
    v_add_u32 v6, s29, v6
    v_add_u32 v7, s29, v7
    ds_read_b64_tr_b16 v[12:13], v4 offset:0
    ds_read_b64_tr_b16 v[14:15], v4 offset:1024
    s_add_u32 s17, s26, 57344
    buffer_load_dwordx4 v[148:151], v2, s[32:35], s17 offen offset:2048
    s_waitcnt vmcnt(31) lgkmcnt(8)
    v_mfma_f32_32x32x16_bf16 v[44:59], v[28:31], v[152:155], v[44:59]
    ds_read_b64_tr_b16 v[16:17], v5 offset:0
    ds_read_b64_tr_b16 v[18:19], v5 offset:1024
    s_waitcnt lgkmcnt(8)
    v_mfma_f32_32x32x16_bf16 v[60:75], v[32:35], v[152:155], v[60:75]
    ds_read_b64_tr_b16 v[20:21], v6 offset:0
    ds_read_b64_tr_b16 v[22:23], v6 offset:1024
    s_waitcnt lgkmcnt(8)
    v_mfma_f32_32x32x16_bf16 v[76:91], v[36:39], v[152:155], v[76:91]
    ds_read_b64_tr_b16 v[24:25], v7 offset:0
    ds_read_b64_tr_b16 v[26:27], v7 offset:1024
    s_waitcnt lgkmcnt(8)
    v_mfma_f32_32x32x16_bf16 v[92:107], v[40:43], v[152:155], v[92:107]
    ds_read_b64_tr_b16 v[28:29], v4 offset:4096
    ds_read_b64_tr_b16 v[30:31], v4 offset:5120
    s_add_u32 s17, s26, 57344
    buffer_load_dwordx4 v[152:155], v2, s[32:35], s17 offen offset:3072
    s_waitcnt vmcnt(19)
    s_barrier
    s_waitcnt vmcnt(29) lgkmcnt(8)
    v_mfma_f32_32x32x16_bf16 v[44:59], v[12:15], v[156:159], v[44:59]
    ds_read_b64_tr_b16 v[32:33], v5 offset:4096
    ds_read_b64_tr_b16 v[34:35], v5 offset:5120
    s_waitcnt lgkmcnt(8)
    v_mfma_f32_32x32x16_bf16 v[60:75], v[16:19], v[156:159], v[60:75]
    ds_read_b64_tr_b16 v[36:37], v6 offset:4096
    ds_read_b64_tr_b16 v[38:39], v6 offset:5120
    s_add_u32 m0, s23, 0
    s_add_u32 s16, s25, 0
    buffer_load_dwordx4 v3, s[4:7], s16 offen lds
    s_waitcnt lgkmcnt(8)
    v_mfma_f32_32x32x16_bf16 v[76:91], v[20:23], v[156:159], v[76:91]
    ds_read_b64_tr_b16 v[40:41], v7 offset:4096
    ds_read_b64_tr_b16 v[42:43], v7 offset:5120
    s_waitcnt lgkmcnt(8)
    v_mfma_f32_32x32x16_bf16 v[92:107], v[24:27], v[156:159], v[92:107]
    ds_read_b64_tr_b16 v[12:13], v4 offset:8192
    ds_read_b64_tr_b16 v[14:15], v4 offset:9216
    s_add_u32 m0, s23, 4096
    s_add_u32 s16, s25, 16384
    buffer_load_dwordx4 v3, s[4:7], s16 offen lds
    s_add_u32 s17, s26, 61440
    buffer_load_dwordx4 v[156:159], v2, s[32:35], s17 offen offset:0
    s_waitcnt vmcnt(29) lgkmcnt(8)
    v_mfma_f32_32x32x16_bf16 v[44:59], v[28:31], v[160:163], v[44:59]
    ds_read_b64_tr_b16 v[16:17], v5 offset:8192
    ds_read_b64_tr_b16 v[18:19], v5 offset:9216
    s_waitcnt lgkmcnt(8)
    v_mfma_f32_32x32x16_bf16 v[60:75], v[32:35], v[160:163], v[60:75]
    ds_read_b64_tr_b16 v[20:21], v6 offset:8192
    ds_read_b64_tr_b16 v[22:23], v6 offset:9216
    s_add_u32 m0, s23, 8192
    s_add_u32 s16, s25, 32768
    buffer_load_dwordx4 v3, s[4:7], s16 offen lds
    s_waitcnt lgkmcnt(8)
    v_mfma_f32_32x32x16_bf16 v[76:91], v[36:39], v[160:163], v[76:91]
    ds_read_b64_tr_b16 v[24:25], v7 offset:8192
    ds_read_b64_tr_b16 v[26:27], v7 offset:9216
    s_waitcnt lgkmcnt(8)
    v_mfma_f32_32x32x16_bf16 v[92:107], v[40:43], v[160:163], v[92:107]
    ds_read_b64_tr_b16 v[28:29], v4 offset:12288
    ds_read_b64_tr_b16 v[30:31], v4 offset:13312
    s_add_u32 m0, s23, 12288
    s_add_u32 s16, s25, 49152
    buffer_load_dwordx4 v3, s[4:7], s16 offen lds
    s_add_u32 s25, s25, 65536
    s_add_u32 s22, s22, 16384
    s_cmp_eq_u32 s22, 81920
    s_cselect_b32 s22, 0, s22
    s_add_u32 s23, s22, s24
    s_add_u32 s17, s26, 61440
    buffer_load_dwordx4 v[160:163], v2, s[32:35], s17 offen offset:1024
    s_waitcnt vmcnt(31) lgkmcnt(8)
    v_mfma_f32_32x32x16_bf16 v[44:59], v[12:15], v[164:167], v[44:59]
    ds_read_b64_tr_b16 v[32:33], v5 offset:12288
    ds_read_b64_tr_b16 v[34:35], v5 offset:13312
    s_waitcnt lgkmcnt(8)
    v_mfma_f32_32x32x16_bf16 v[60:75], v[16:19], v[164:167], v[60:75]
    ds_read_b64_tr_b16 v[36:37], v6 offset:12288
    ds_read_b64_tr_b16 v[38:39], v6 offset:13312
    s_waitcnt lgkmcnt(8)
    v_mfma_f32_32x32x16_bf16 v[76:91], v[20:23], v[164:167], v[76:91]
    ds_read_b64_tr_b16 v[40:41], v7 offset:12288
    ds_read_b64_tr_b16 v[42:43], v7 offset:13312
    s_waitcnt lgkmcnt(8)
    v_mfma_f32_32x32x16_bf16 v[92:107], v[24:27], v[164:167], v[92:107]
    s_mov_b32 s29, s28
    s_add_u32 s28, s28, 16384
    s_cmp_eq_u32 s28, 81920
    s_cselect_b32 s28, 0, s28
    s_sub_u32 s29, s28, s29
    v_add_u32 v4, s29, v4
    v_add_u32 v5, s29, v5
    v_add_u32 v6, s29, v6
    v_add_u32 v7, s29, v7
    ds_read_b64_tr_b16 v[12:13], v4 offset:0
    ds_read_b64_tr_b16 v[14:15], v4 offset:1024
    s_add_u32 s17, s26, 61440
    buffer_load_dwordx4 v[164:167], v2, s[32:35], s17 offen offset:2048
    s_waitcnt vmcnt(31) lgkmcnt(8)
    v_mfma_f32_32x32x16_bf16 v[44:59], v[28:31], v[168:171], v[44:59]
    ds_read_b64_tr_b16 v[16:17], v5 offset:0
    ds_read_b64_tr_b16 v[18:19], v5 offset:1024
    s_waitcnt lgkmcnt(8)
    v_mfma_f32_32x32x16_bf16 v[60:75], v[32:35], v[168:171], v[60:75]
    ds_read_b64_tr_b16 v[20:21], v6 offset:0
    ds_read_b64_tr_b16 v[22:23], v6 offset:1024
    s_waitcnt lgkmcnt(8)
    v_mfma_f32_32x32x16_bf16 v[76:91], v[36:39], v[168:171], v[76:91]
    ds_read_b64_tr_b16 v[24:25], v7 offset:0
    ds_read_b64_tr_b16 v[26:27], v7 offset:1024
    s_waitcnt lgkmcnt(8)
    v_mfma_f32_32x32x16_bf16 v[92:107], v[40:43], v[168:171], v[92:107]
    ds_read_b64_tr_b16 v[28:29], v4 offset:4096
    ds_read_b64_tr_b16 v[30:31], v4 offset:5120
    s_add_u32 s17, s26, 61440
    buffer_load_dwordx4 v[168:171], v2, s[32:35], s17 offen offset:3072
    s_waitcnt vmcnt(19)
    s_barrier
    s_waitcnt vmcnt(29) lgkmcnt(8)
    v_mfma_f32_32x32x16_bf16 v[44:59], v[12:15], v[108:111], v[44:59]
    ds_read_b64_tr_b16 v[32:33], v5 offset:4096
    ds_read_b64_tr_b16 v[34:35], v5 offset:5120
    s_waitcnt lgkmcnt(8)
    v_mfma_f32_32x32x16_bf16 v[60:75], v[16:19], v[108:111], v[60:75]
    ds_read_b64_tr_b16 v[36:37], v6 offset:4096
    ds_read_b64_tr_b16 v[38:39], v6 offset:5120
    s_waitcnt lgkmcnt(8)
    v_mfma_f32_32x32x16_bf16 v[76:91], v[20:23], v[108:111], v[76:91]
    ds_read_b64_tr_b16 v[40:41], v7 offset:4096
    ds_read_b64_tr_b16 v[42:43], v7 offset:5120
    s_waitcnt lgkmcnt(8)
    v_mfma_f32_32x32x16_bf16 v[92:107], v[24:27], v[108:111], v[92:107]
    ds_read_b64_tr_b16 v[12:13], v4 offset:8192
    ds_read_b64_tr_b16 v[14:15], v4 offset:9216
    s_waitcnt vmcnt(26) lgkmcnt(8)
    v_mfma_f32_32x32x16_bf16 v[44:59], v[28:31], v[112:115], v[44:59]
    ds_read_b64_tr_b16 v[16:17], v5 offset:8192
    ds_read_b64_tr_b16 v[18:19], v5 offset:9216
    s_waitcnt lgkmcnt(8)
    v_mfma_f32_32x32x16_bf16 v[60:75], v[32:35], v[112:115], v[60:75]
    ds_read_b64_tr_b16 v[20:21], v6 offset:8192
    ds_read_b64_tr_b16 v[22:23], v6 offset:9216
    s_waitcnt lgkmcnt(8)
    v_mfma_f32_32x32x16_bf16 v[76:91], v[36:39], v[112:115], v[76:91]
    ds_read_b64_tr_b16 v[24:25], v7 offset:8192
    ds_read_b64_tr_b16 v[26:27], v7 offset:9216
    s_waitcnt lgkmcnt(8)
    v_mfma_f32_32x32x16_bf16 v[92:107], v[40:43], v[112:115], v[92:107]
    ds_read_b64_tr_b16 v[28:29], v4 offset:12288
    ds_read_b64_tr_b16 v[30:31], v4 offset:13312
    s_waitcnt vmcnt(25) lgkmcnt(8)
    v_mfma_f32_32x32x16_bf16 v[44:59], v[12:15], v[116:119], v[44:59]
    ds_read_b64_tr_b16 v[32:33], v5 offset:12288
    ds_read_b64_tr_b16 v[34:35], v5 offset:13312
    s_waitcnt lgkmcnt(8)
    v_mfma_f32_32x32x16_bf16 v[60:75], v[16:19], v[116:119], v[60:75]
    ds_read_b64_tr_b16 v[36:37], v6 offset:12288
    ds_read_b64_tr_b16 v[38:39], v6 offset:13312
    s_waitcnt lgkmcnt(8)
    v_mfma_f32_32x32x16_bf16 v[76:91], v[20:23], v[116:119], v[76:91]
    ds_read_b64_tr_b16 v[40:41], v7 offset:12288
    ds_read_b64_tr_b16 v[42:43], v7 offset:13312
    s_waitcnt lgkmcnt(8)
    v_mfma_f32_32x32x16_bf16 v[92:107], v[24:27], v[116:119], v[92:107]
    s_mov_b32 s29, s28
    s_add_u32 s28, s28, 16384
    s_cmp_eq_u32 s28, 81920
    s_cselect_b32 s28, 0, s28
    s_sub_u32 s29, s28, s29
    v_add_u32 v4, s29, v4
    v_add_u32 v5, s29, v5
    v_add_u32 v6, s29, v6
    v_add_u32 v7, s29, v7
    ds_read_b64_tr_b16 v[12:13], v4 offset:0
    ds_read_b64_tr_b16 v[14:15], v4 offset:1024
    s_waitcnt vmcnt(24) lgkmcnt(8)
    v_mfma_f32_32x32x16_bf16 v[44:59], v[28:31], v[120:123], v[44:59]
    ds_read_b64_tr_b16 v[16:17], v5 offset:0
    ds_read_b64_tr_b16 v[18:19], v5 offset:1024
    s_waitcnt lgkmcnt(8)
    v_mfma_f32_32x32x16_bf16 v[60:75], v[32:35], v[120:123], v[60:75]
    ds_read_b64_tr_b16 v[20:21], v6 offset:0
    ds_read_b64_tr_b16 v[22:23], v6 offset:1024
    s_waitcnt lgkmcnt(8)
    v_mfma_f32_32x32x16_bf16 v[76:91], v[36:39], v[120:123], v[76:91]
    ds_read_b64_tr_b16 v[24:25], v7 offset:0
    ds_read_b64_tr_b16 v[26:27], v7 offset:1024
    s_waitcnt lgkmcnt(8)
    v_mfma_f32_32x32x16_bf16 v[92:107], v[40:43], v[120:123], v[92:107]
    ds_read_b64_tr_b16 v[28:29], v4 offset:4096
    ds_read_b64_tr_b16 v[30:31], v4 offset:5120
    s_waitcnt vmcnt(11)
    s_barrier
    s_waitcnt vmcnt(21) lgkmcnt(8)
    v_mfma_f32_32x32x16_bf16 v[44:59], v[12:15], v[124:127], v[44:59]
    ds_read_b64_tr_b16 v[32:33], v5 offset:4096
    ds_read_b64_tr_b16 v[34:35], v5 offset:5120
    s_waitcnt lgkmcnt(8)
    v_mfma_f32_32x32x16_bf16 v[60:75], v[16:19], v[124:127], v[60:75]
    ds_read_b64_tr_b16 v[36:37], v6 offset:4096
    ds_read_b64_tr_b16 v[38:39], v6 offset:5120
    s_waitcnt lgkmcnt(8)
    v_mfma_f32_32x32x16_bf16 v[76:91], v[20:23], v[124:127], v[76:91]
    ds_read_b64_tr_b16 v[40:41], v7 offset:4096
    ds_read_b64_tr_b16 v[42:43], v7 offset:5120
    s_waitcnt lgkmcnt(8)
    v_mfma_f32_32x32x16_bf16 v[92:107], v[24:27], v[124:127], v[92:107]
    ds_read_b64_tr_b16 v[12:13], v4 offset:8192
    ds_read_b64_tr_b16 v[14:15], v4 offset:9216
    s_waitcnt vmcnt(18) lgkmcnt(8)
    v_mfma_f32_32x32x16_bf16 v[44:59], v[28:31], v[128:131], v[44:59]
    ds_read_b64_tr_b16 v[16:17], v5 offset:8192
    ds_read_b64_tr_b16 v[18:19], v5 offset:9216
    s_waitcnt lgkmcnt(8)
    v_mfma_f32_32x32x16_bf16 v[60:75], v[32:35], v[128:131], v[60:75]
    ds_read_b64_tr_b16 v[20:21], v6 offset:8192
    ds_read_b64_tr_b16 v[22:23], v6 offset:9216
    s_waitcnt lgkmcnt(8)
    v_mfma_f32_32x32x16_bf16 v[76:91], v[36:39], v[128:131], v[76:91]
    ds_read_b64_tr_b16 v[24:25], v7 offset:8192
    ds_read_b64_tr_b16 v[26:27], v7 offset:9216
    s_waitcnt lgkmcnt(8)
    v_mfma_f32_32x32x16_bf16 v[92:107], v[40:43], v[128:131], v[92:107]
    ds_read_b64_tr_b16 v[28:29], v4 offset:12288
    ds_read_b64_tr_b16 v[30:31], v4 offset:13312
    s_waitcnt vmcnt(17) lgkmcnt(8)
    v_mfma_f32_32x32x16_bf16 v[44:59], v[12:15], v[132:135], v[44:59]
    ds_read_b64_tr_b16 v[32:33], v5 offset:12288
    ds_read_b64_tr_b16 v[34:35], v5 offset:13312
    s_waitcnt lgkmcnt(8)
    v_mfma_f32_32x32x16_bf16 v[60:75], v[16:19], v[132:135], v[60:75]
    ds_read_b64_tr_b16 v[36:37], v6 offset:12288
    ds_read_b64_tr_b16 v[38:39], v6 offset:13312
    s_waitcnt lgkmcnt(8)
    v_mfma_f32_32x32x16_bf16 v[76:91], v[20:23], v[132:135], v[76:91]
    ds_read_b64_tr_b16 v[40:41], v7 offset:12288
    ds_read_b64_tr_b16 v[42:43], v7 offset:13312
    s_waitcnt lgkmcnt(8)
    v_mfma_f32_32x32x16_bf16 v[92:107], v[24:27], v[132:135], v[92:107]
    s_mov_b32 s29, s28
    s_add_u32 s28, s28, 16384
    s_cmp_eq_u32 s28, 81920
    s_cselect_b32 s28, 0, s28
    s_sub_u32 s29, s28, s29
    v_add_u32 v4, s29, v4
    v_add_u32 v5, s29, v5
    v_add_u32 v6, s29, v6
    v_add_u32 v7, s29, v7
    ds_read_b64_tr_b16 v[12:13], v4 offset:0
    ds_read_b64_tr_b16 v[14:15], v4 offset:1024
    s_waitcnt vmcnt(16) lgkmcnt(8)
    v_mfma_f32_32x32x16_bf16 v[44:59], v[28:31], v[136:139], v[44:59]
    ds_read_b64_tr_b16 v[16:17], v5 offset:0
    ds_read_b64_tr_b16 v[18:19], v5 offset:1024
    s_waitcnt lgkmcnt(8)
    v_mfma_f32_32x32x16_bf16 v[60:75], v[32:35], v[136:139], v[60:75]
    ds_read_b64_tr_b16 v[20:21], v6 offset:0
    ds_read_b64_tr_b16 v[22:23], v6 offset:1024
    s_waitcnt lgkmcnt(8)
    v_mfma_f32_32x32x16_bf16 v[76:91], v[36:39], v[136:139], v[76:91]
    ds_read_b64_tr_b16 v[24:25], v7 offset:0
    ds_read_b64_tr_b16 v[26:27], v7 offset:1024
    s_waitcnt lgkmcnt(8)
    v_mfma_f32_32x32x16_bf16 v[92:107], v[40:43], v[136:139], v[92:107]
    ds_read_b64_tr_b16 v[28:29], v4 offset:4096
    ds_read_b64_tr_b16 v[30:31], v4 offset:5120
    s_waitcnt vmcnt(3)
    s_barrier
    s_waitcnt vmcnt(13) lgkmcnt(8)
    v_mfma_f32_32x32x16_bf16 v[44:59], v[12:15], v[140:143], v[44:59]
    ds_read_b64_tr_b16 v[32:33], v5 offset:4096
    ds_read_b64_tr_b16 v[34:35], v5 offset:5120
    s_waitcnt lgkmcnt(8)
    v_mfma_f32_32x32x16_bf16 v[60:75], v[16:19], v[140:143], v[60:75]
    ds_read_b64_tr_b16 v[36:37], v6 offset:4096
    ds_read_b64_tr_b16 v[38:39], v6 offset:5120
    s_waitcnt lgkmcnt(8)
    v_mfma_f32_32x32x16_bf16 v[76:91], v[20:23], v[140:143], v[76:91]
    ds_read_b64_tr_b16 v[40:41], v7 offset:4096
    ds_read_b64_tr_b16 v[42:43], v7 offset:5120
    s_waitcnt lgkmcnt(8)
    v_mfma_f32_32x32x16_bf16 v[92:107], v[24:27], v[140:143], v[92:107]
    ds_read_b64_tr_b16 v[12:13], v4 offset:8192
    ds_read_b64_tr_b16 v[14:15], v4 offset:9216
    s_waitcnt vmcnt(10) lgkmcnt(8)
    v_mfma_f32_32x32x16_bf16 v[44:59], v[28:31], v[144:147], v[44:59]
    ds_read_b64_tr_b16 v[16:17], v5 offset:8192
    ds_read_b64_tr_b16 v[18:19], v5 offset:9216
    s_waitcnt lgkmcnt(8)
    v_mfma_f32_32x32x16_bf16 v[60:75], v[32:35], v[144:147], v[60:75]
    ds_read_b64_tr_b16 v[20:21], v6 offset:8192
    ds_read_b64_tr_b16 v[22:23], v6 offset:9216
    s_waitcnt lgkmcnt(8)
    v_mfma_f32_32x32x16_bf16 v[76:91], v[36:39], v[144:147], v[76:91]
    ds_read_b64_tr_b16 v[24:25], v7 offset:8192
    ds_read_b64_tr_b16 v[26:27], v7 offset:9216
    s_waitcnt lgkmcnt(8)
    v_mfma_f32_32x32x16_bf16 v[92:107], v[40:43], v[144:147], v[92:107]
    ds_read_b64_tr_b16 v[28:29], v4 offset:12288
    ds_read_b64_tr_b16 v[30:31], v4 offset:13312
    s_waitcnt vmcnt(9) lgkmcnt(8)
    v_mfma_f32_32x32x16_bf16 v[44:59], v[12:15], v[148:151], v[44:59]
    ds_read_b64_tr_b16 v[32:33], v5 offset:12288
    ds_read_b64_tr_b16 v[34:35], v5 offset:13312
    s_waitcnt lgkmcnt(8)
    v_mfma_f32_32x32x16_bf16 v[60:75], v[16:19], v[148:151], v[60:75]
    ds_read_b64_tr_b16 v[36:37], v6 offset:12288
    ds_read_b64_tr_b16 v[38:39], v6 offset:13312
    s_waitcnt lgkmcnt(8)
    v_mfma_f32_32x32x16_bf16 v[76:91], v[20:23], v[148:151], v[76:91]
    ds_read_b64_tr_b16 v[40:41], v7 offset:12288
    ds_read_b64_tr_b16 v[42:43], v7 offset:13312
    s_waitcnt lgkmcnt(8)
    v_mfma_f32_32x32x16_bf16 v[92:107], v[24:27], v[148:151], v[92:107]
    s_mov_b32 s29, s28
    s_add_u32 s28, s28, 16384
    s_cmp_eq_u32 s28, 81920
    s_cselect_b32 s28, 0, s28
    s_sub_u32 s29, s28, s29
    v_add_u32 v4, s29, v4
    v_add_u32 v5, s29, v5
    v_add_u32 v6, s29, v6
    v_add_u32 v7, s29, v7
    ds_read_b64_tr_b16 v[12:13], v4 offset:0
    ds_read_b64_tr_b16 v[14:15], v4 offset:1024
    s_waitcnt vmcnt(8) lgkmcnt(8)
    v_mfma_f32_32x32x16_bf16 v[44:59], v[28:31], v[152:155], v[44:59]
    ds_read_b64_tr_b16 v[16:17], v5 offset:0
    ds_read_b64_tr_b16 v[18:19], v5 offset:1024
    s_waitcnt lgkmcnt(8)
    v_mfma_f32_32x32x16_bf16 v[60:75], v[32:35], v[152:155], v[60:75]
    ds_read_b64_tr_b16 v[20:21], v6 offset:0
    ds_read_b64_tr_b16 v[22:23], v6 offset:1024
    s_waitcnt lgkmcnt(8)
    v_mfma_f32_32x32x16_bf16 v[76:91], v[36:39], v[152:155], v[76:91]
    ds_read_b64_tr_b16 v[24:25], v7 offset:0
    ds_read_b64_tr_b16 v[26:27], v7 offset:1024
    s_waitcnt lgkmcnt(8)
    v_mfma_f32_32x32x16_bf16 v[92:107], v[40:43], v[152:155], v[92:107]
    ds_read_b64_tr_b16 v[28:29], v4 offset:4096
    ds_read_b64_tr_b16 v[30:31], v4 offset:5120
    s_barrier
    s_waitcnt vmcnt(5) lgkmcnt(8)
    v_mfma_f32_32x32x16_bf16 v[44:59], v[12:15], v[156:159], v[44:59]
    ds_read_b64_tr_b16 v[32:33], v5 offset:4096
    ds_read_b64_tr_b16 v[34:35], v5 offset:5120
    s_waitcnt lgkmcnt(8)
    v_mfma_f32_32x32x16_bf16 v[60:75], v[16:19], v[156:159], v[60:75]
    ds_read_b64_tr_b16 v[36:37], v6 offset:4096
    ds_read_b64_tr_b16 v[38:39], v6 offset:5120
    s_waitcnt lgkmcnt(8)
    v_mfma_f32_32x32x16_bf16 v[76:91], v[20:23], v[156:159], v[76:91]
    ds_read_b64_tr_b16 v[40:41], v7 offset:4096
    ds_read_b64_tr_b16 v[42:43], v7 offset:5120
    s_waitcnt lgkmcnt(8)
    v_mfma_f32_32x32x16_bf16 v[92:107], v[24:27], v[156:159], v[92:107]
    ds_read_b64_tr_b16 v[12:13], v4 offset:8192
    ds_read_b64_tr_b16 v[14:15], v4 offset:9216
    s_waitcnt vmcnt(2) lgkmcnt(8)
    v_mfma_f32_32x32x16_bf16 v[44:59], v[28:31], v[160:163], v[44:59]
    ds_read_b64_tr_b16 v[16:17], v5 offset:8192
    ds_read_b64_tr_b16 v[18:19], v5 offset:9216
    s_waitcnt lgkmcnt(8)
    v_mfma_f32_32x32x16_bf16 v[60:75], v[32:35], v[160:163], v[60:75]
    ds_read_b64_tr_b16 v[20:21], v6 offset:8192
    ds_read_b64_tr_b16 v[22:23], v6 offset:9216
    s_waitcnt lgkmcnt(8)
    v_mfma_f32_32x32x16_bf16 v[76:91], v[36:39], v[160:163], v[76:91]
    ds_read_b64_tr_b16 v[24:25], v7 offset:8192
    ds_read_b64_tr_b16 v[26:27], v7 offset:9216
    s_waitcnt lgkmcnt(8)
    v_mfma_f32_32x32x16_bf16 v[92:107], v[40:43], v[160:163], v[92:107]
    ds_read_b64_tr_b16 v[28:29], v4 offset:12288
    ds_read_b64_tr_b16 v[30:31], v4 offset:13312
    s_waitcnt vmcnt(1) lgkmcnt(8)
    v_mfma_f32_32x32x16_bf16 v[44:59], v[12:15], v[164:167], v[44:59]
    ds_read_b64_tr_b16 v[32:33], v5 offset:12288
    ds_read_b64_tr_b16 v[34:35], v5 offset:13312
    s_waitcnt lgkmcnt(8)
    v_mfma_f32_32x32x16_bf16 v[60:75], v[16:19], v[164:167], v[60:75]
    ds_read_b64_tr_b16 v[36:37], v6 offset:12288
    ds_read_b64_tr_b16 v[38:39], v6 offset:13312
    s_waitcnt lgkmcnt(8)
    v_mfma_f32_32x32x16_bf16 v[76:91], v[20:23], v[164:167], v[76:91]
    ds_read_b64_tr_b16 v[40:41], v7 offset:12288
    ds_read_b64_tr_b16 v[42:43], v7 offset:13312
    s_waitcnt lgkmcnt(8)
    v_mfma_f32_32x32x16_bf16 v[92:107], v[24:27], v[164:167], v[92:107]
    s_waitcnt vmcnt(0) lgkmcnt(6)
    v_mfma_f32_32x32x16_bf16 v[44:59], v[28:31], v[168:171], v[44:59]
    s_waitcnt lgkmcnt(4)
    v_mfma_f32_32x32x16_bf16 v[60:75], v[32:35], v[168:171], v[60:75]
    s_waitcnt lgkmcnt(2)
    v_mfma_f32_32x32x16_bf16 v[76:91], v[36:39], v[168:171], v[76:91]
    s_waitcnt lgkmcnt(0)
    v_mfma_f32_32x32x16_bf16 v[92:107], v[40:43], v[168:171], v[92:107]
    s_nop 15
    s_nop 3
    s_waitcnt vmcnt(0) lgkmcnt(0)
    s_barrier
    s_cmp_eq_u32 s31, 0
    s_cbranch_scc1 L2_h0
    ds_write_b128 v9, v[44:47] offset:8192
    ds_write_b128 v9, v[48:51] offset:9216
    ds_write_b128 v9, v[52:55] offset:10240
    ds_write_b128 v9, v[56:59] offset:11264
    ds_write_b128 v9, v[60:63] offset:12288
    ds_write_b128 v9, v[64:67] offset:13312
    ds_write_b128 v9, v[68:71] offset:14336
    ds_write_b128 v9, v[72:75] offset:15360
    s_waitcnt lgkmcnt(0)
    s_barrier
    ds_read_b128 v[108:111], v9 offset:0
    ds_read_b128 v[112:115], v9 offset:1024
    ds_read_b128 v[116:119], v9 offset:2048
    ds_read_b128 v[120:123], v9 offset:3072
    ds_read_b128 v[124:127], v9 offset:4096
    ds_read_b128 v[128:131], v9 offset:5120
    ds_read_b128 v[132:135], v9 offset:6144
    ds_read_b128 v[136:139], v9 offset:7168
    s_waitcnt lgkmcnt(0)
    v_add_f32 v44, v76, v108
    v_add_f32 v45, v77, v109
    v_add_f32 v46, v78, v110
    v_add_f32 v47, v79, v111
    v_add_f32 v48, v80, v112
    v_add_f32 v49, v81, v113
    v_add_f32 v50, v82, v114
    v_add_f32 v51, v83, v115
    v_add_f32 v52, v84, v116
    v_add_f32 v53, v85, v117
    v_add_f32 v54, v86, v118
    v_add_f32 v55, v87, v119
    v_add_f32 v56, v88, v120
    v_add_f32 v57, v89, v121
    v_add_f32 v58, v90, v122
    v_add_f32 v59, v91, v123
    v_add_f32 v60, v92, v124
    v_add_f32 v61, v93, v125
    v_add_f32 v62, v94, v126
    v_add_f32 v63, v95, v127
    v_add_f32 v64, v96, v128
    v_add_f32 v65, v97, v129
    v_add_f32 v66, v98, v130
    v_add_f32 v67, v99, v131
    v_add_f32 v68, v100, v132
    v_add_f32 v69, v101, v133
    v_add_f32 v70, v102, v134
    v_add_f32 v71, v103, v135
    v_add_f32 v72, v104, v136
    v_add_f32 v73, v105, v137
    v_add_f32 v74, v106, v138
    v_add_f32 v75, v107, v139
    s_branch L2_j
L2_h0:
    ds_write_b128 v9, v[76:79] offset:0
    ds_write_b128 v9, v[80:83] offset:1024
    ds_write_b128 v9, v[84:87] offset:2048
    ds_write_b128 v9, v[88:91] offset:3072
    ds_write_b128 v9, v[92:95] offset:4096
    ds_write_b128 v9, v[96:99] offset:5120
    ds_write_b128 v9, v[100:103] offset:6144
    ds_write_b128 v9, v[104:107] offset:7168
    s_waitcnt lgkmcnt(0)
    s_barrier
    ds_read_b128 v[108:111], v9 offset:8192
    ds_read_b128 v[112:115], v9 offset:9216
    ds_read_b128 v[116:119], v9 offset:10240
    ds_read_b128 v[120:123], v9 offset:11264
    ds_read_b128 v[124:127], v9 offset:12288
    ds_read_b128 v[128:131], v9 offset:13312
    ds_read_b128 v[132:135], v9 offset:14336
    ds_read_b128 v[136:139], v9 offset:15360
    s_waitcnt lgkmcnt(0)
    v_add_f32 v44, v44, v108
    v_add_f32 v45, v45, v109
    v_add_f32 v46, v46, v110
    v_add_f32 v47, v47, v111
    v_add_f32 v48, v48, v112
    v_add_f32 v49, v49, v113
    v_add_f32 v50, v50, v114
    v_add_f32 v51, v51, v115
    v_add_f32 v52, v52, v116
    v_add_f32 v53, v53, v117
    v_add_f32 v54, v54, v118
    v_add_f32 v55, v55, v119
    v_add_f32 v56, v56, v120
    v_add_f32 v57, v57, v121
    v_add_f32 v58, v58, v122
    v_add_f32 v59, v59, v123
    v_add_f32 v60, v60, v124
    v_add_f32 v61, v61, v125
    v_add_f32 v62, v62, v126
    v_add_f32 v63, v63, v127
    v_add_f32 v64, v64, v128
    v_add_f32 v65, v65, v129
    v_add_f32 v66, v66, v130
    v_add_f32 v67, v67, v131
    v_add_f32 v68, v68, v132
    v_add_f32 v69, v69, v133
    v_add_f32 v70, v70, v134
    v_add_f32 v71, v71, v135
    v_add_f32 v72, v72, v136
    v_add_f32 v73, v73, v137
    v_add_f32 v74, v74, v138
    v_add_f32 v75, v75, v139
L2_j:
    s_lshl_b32 s18, s31, 13
    s_add_u32 s42, s42, s18
    s_lshl_b32 s16, s41, 16
    s_add_u32 s16, s16, s42
    s_add_u32 s17, s16, 0
    buffer_store_dwordx4 v[44:47], v9, s[8:11], s17 offen offset:0 sc1
    buffer_store_dwordx4 v[48:51], v9, s[8:11], s17 offen offset:1024 sc1
    buffer_store_dwordx4 v[52:55], v9, s[8:11], s17 offen offset:2048 sc1
    buffer_store_dwordx4 v[56:59], v9, s[8:11], s17 offen offset:3072 sc1
    s_add_u32 s17, s16, 4096
    buffer_store_dwordx4 v[60:63], v9, s[8:11], s17 offen offset:0 sc1
    buffer_store_dwordx4 v[64:67], v9, s[8:11], s17 offen offset:1024 sc1
    buffer_store_dwordx4 v[68:71], v9, s[8:11], s17 offen offset:2048 sc1
    buffer_store_dwordx4 v[72:75], v9, s[8:11], s17 offen offset:3072 sc1
    s_waitcnt vmcnt(0)
    s_barrier
    s_cmp_eq_u32 s24, 0
    s_cbranch_scc0 L2_noat
    s_lshr_b32 s16, s40, 1
    s_lshl_b32 s16, s16, 2
    s_and_b32 s17, s40, 1
    s_lshl_b32 s17, s17, 4
    s_lshl_b32 s18, 1, s17
    v_mov_b32 v240, s18
    v_mov_b32 v241, s16
    s_mov_b64 s[44:45], exec
    s_mov_b64 exec, 1
    buffer_atomic_add v240, v241, s[36:39], 0 offen sc0 sc1
    s_waitcnt vmcnt(0)
    v_lshrrev_b32 v240, s17, v240
    v_and_b32 v240, 0xffff, v240
    v_mov_b32 v241, 65536
    ds_write_b32 v241, v240
    s_waitcnt lgkmcnt(0)
    s_mov_b64 exec, s[44:45]
L2_noat:
    s_barrier
    v_mov_b32 v241, 65536
    ds_read_b32 v240, v241
    s_waitcnt lgkmcnt(0)
    v_readfirstlane_b32 s16, v240
    s_and_b32 s16, s16, 1
    s_cmp_eq_u32 s16, 0
    s_cbranch_scc1 L2_end
    s_xor_b32 s16, s41, 1
    s_lshl_b32 s16, s16, 16
    s_add_u32 s16, s16, s42
    s_add_u32 s17, s16, 0
    buffer_load_dwordx4 v[108:111], v9, s[8:11], s17 offen offset:0 sc1
    buffer_load_dwordx4 v[112:115], v9, s[8:11], s17 offen offset:1024 sc1
    buffer_load_dwordx4 v[116:119], v9, s[8:11], s17 offen offset:2048 sc1
    buffer_load_dwordx4 v[120:123], v9, s[8:11], s17 offen offset:3072 sc1
    s_add_u32 s17, s16, 4096
    buffer_load_dwordx4 v[124:127], v9, s[8:11], s17 offen offset:0 sc1
    buffer_load_dwordx4 v[128:131], v9, s[8:11], s17 offen offset:1024 sc1
    buffer_load_dwordx4 v[132:135], v9, s[8:11], s17 offen offset:2048 sc1
    buffer_load_dwordx4 v[136:139], v9, s[8:11], s17 offen offset:3072 sc1
    s_lshl_b32 s18, s31, 7
    s_waitcnt vmcnt(4)
    v_add_f32 v44, v44, v108
    v_add_f32 v45, v45, v109
    v_add_f32 v46, v46, v110
    v_add_f32 v47, v47, v111
    v_add_f32 v48, v48, v112
    v_add_f32 v49, v49, v113
    v_add_f32 v50, v50, v114
    v_add_f32 v51, v51, v115
    v_add_f32 v52, v52, v116
    v_add_f32 v53, v53, v117
    v_add_f32 v54, v54, v118
    v_add_f32 v55, v55, v119
    v_add_f32 v56, v56, v120
    v_add_f32 v57, v57, v121
    v_add_f32 v58, v58, v122
    v_add_f32 v59, v59, v123
    v_cvt_pk_bf16_f32 v172, v44, v45
    v_cvt_pk_bf16_f32 v173, v46, v47
    v_cvt_pk_bf16_f32 v174, v48, v49
    v_cvt_pk_bf16_f32 v175, v50, v51
    v_cvt_pk_bf16_f32 v176, v52, v53
    v_cvt_pk_bf16_f32 v177, v54, v55
    v_cvt_pk_bf16_f32 v178, v56, v57
    v_cvt_pk_bf16_f32 v179, v58, v59
    buffer_store_dwordx4 v[172:175], v8, s[12:15], s18 offen offset:0
    buffer_store_dwordx4 v[176:179], v8, s[12:15], s18 offen offset:32
    s_waitcnt vmcnt(2)
    v_add_f32 v60, v60, v124
    v_add_f32 v61, v61, v125
    v_add_f32 v62, v62, v126
    v_add_f32 v63, v63, v127
    v_add_f32 v64, v64, v128
    v_add_f32 v65, v65, v129
    v_add_f32 v66, v66, v130
    v_add_f32 v67, v67, v131
    v_add_f32 v68, v68, v132
    v_add_f32 v69, v69, v133
    v_add_f32 v70, v70, v134
    v_add_f32 v71, v71, v135
    v_add_f32 v72, v72, v136
    v_add_f32 v73, v73, v137
    v_add_f32 v74, v74, v138
    v_add_f32 v75, v75, v139
    v_cvt_pk_bf16_f32 v180, v60, v61
    v_cvt_pk_bf16_f32 v181, v62, v63
    v_cvt_pk_bf16_f32 v182, v64, v65
    v_cvt_pk_bf16_f32 v183, v66, v67
    v_cvt_pk_bf16_f32 v184, v68, v69
    v_cvt_pk_bf16_f32 v185, v70, v71
    v_cvt_pk_bf16_f32 v186, v72, v73
    v_cvt_pk_bf16_f32 v187, v74, v75
    buffer_store_dwordx4 v[180:183], v8, s[12:15], s18 offen offset:64
    buffer_store_dwordx4 v[184:187], v8, s[12:15], s18 offen offset:96
L2_end:
    s_endpgm
.section .rodata,"a"
.p2align 6
.amdhsa_kernel attn1_kernel
  .amdhsa_next_free_vgpr 256
  .amdhsa_next_free_sgpr 96
  .amdhsa_accum_offset 160
  .amdhsa_group_segment_fixed_size 0
  .amdhsa_kernarg_size 104
  .amdhsa_user_sgpr_count 2
  .amdhsa_user_sgpr_kernarg_segment_ptr 1
  .amdhsa_system_sgpr_workgroup_id_x 1
.end_amdhsa_kernel
.p2align 6
.amdhsa_kernel oproj_kernel
  .amdhsa_next_free_vgpr 256
  .amdhsa_next_free_sgpr 96
  .amdhsa_accum_offset 256
  .amdhsa_group_segment_fixed_size 0
  .amdhsa_kernarg_size 104
  .amdhsa_user_sgpr_count 2
  .amdhsa_user_sgpr_kernarg_segment_ptr 1
  .amdhsa_system_sgpr_workgroup_id_x 1
.end_amdhsa_kernel
```
